```python
import torch

def _softmax(x, axis=-1):
    return torch.softmax(x, dim=axis)

def _gelu(x):
    return torch.nn.functional.gelu(x, approximate='tanh')

def _silu(x):
    return torch.nn.functional.silu(x)

def _sigmoid(x):
    return torch.sigmoid(x)

def _layernorm(x, axis=-1, eps=1e-05):
    m = x.mean(dim=axis, keepdim=True)
    v = x.var(dim=axis, keepdim=True, unbiased=False)
    return (x - m) / torch.sqrt(v + eps)

def _scatter_add(tgt, idx, src, axis=0):
    return tgt.clone().index_add_(axis, idx, src)

def _segment_sum(src, seg, n):
    out = torch.zeros((n,) + src.shape[1:], dtype=src.dtype)
    return out.index_add_(0, seg, src)

def _pad(x, pw):
    flat = tuple((v for pair in reversed(pw) for v in pair))
    return torch.nn.functional.pad(x, flat)
kernel_name = 'concat_heads__softmax_full_mha__memory_aug_recurrent_mem_tr__prompt'

def setup_inputs():

    _w = lambda a: (lambda t: t.to(torch.bfloat16) if t.is_floating_point() else t)(torch.as_tensor(a))

    def _A_setup():
        B, S, D = (1, 2048, 1024)
        return {'x': _w((lambda *s: torch.randn(*s, dtype=torch.bfloat16) * 0.2)(B, S, D)), 'wqkv': _w((lambda *s: torch.randn(*s, dtype=torch.bfloat16) * 0.2)(D, 3 * D)), 'wo': _w((lambda *s: torch.randn(*s, dtype=torch.bfloat16) * 0.05)(D, D))}
    _A_in = _A_setup()

    def _B_setup():
        B, S, Dm = (1, 2048, 1024)
        H, Dh = (32, 128)
        M, seg = (8, 32)
        seg = min(seg, S)
        S = S // seg * seg
        return {'x': _w((lambda *s: torch.randn(*s, dtype=torch.bfloat16) * 0.05)(B, S, Dm)), 'mem0': _w((lambda *s: torch.randn(*s, dtype=torch.bfloat16) * 1.6)(B, M, Dm)), 'Wq': _w((lambda *s: torch.randn(*s, dtype=torch.bfloat16) * 0.8)(Dm, H, Dh) * Dm ** (-0.5)), 'Wk': _w((lambda *s: torch.randn(*s, dtype=torch.bfloat16) * 0.8)(Dm, H, Dh) * Dm ** (-0.5)), 'Wv': _w((lambda *s: torch.randn(*s, dtype=torch.bfloat16) * 1.6)(Dm, H, Dh) * Dm ** (-0.5)), 'Wo': _w((lambda *s: torch.randn(*s, dtype=torch.bfloat16) * 1.6)(H, Dh, Dm) * (H * Dh) ** (-0.5)), 'seg_len': seg}
    _B_in = _B_setup()
    return {'A_x': _A_in['x'], 'A_wqkv': _A_in['wqkv'], 'A_wo': _A_in['wo'], 'B_x': _B_in['x'], 'B_mem0': _B_in['mem0'], 'B_Wq': _B_in['Wq'], 'B_Wk': _B_in['Wk'], 'B_Wv': _B_in['Wv'], 'B_Wo': _B_in['Wo'], 'B_seg_len': _B_in['seg_len']}

def reference(A_x, A_wqkv, A_wo, B_x, B_mem0, B_Wq, B_Wk, B_Wv, B_Wo, B_seg_len):

    def _A_ref(x, wqkv, wo):
        B, S, D = x.shape
        H = 32
        Dh = D // H
        qkv = (lambda x, *d: x.permute(*d))((x @ wqkv).reshape(B, S, 3, H, Dh), 2, 0, 3, 1, 4)
        q, k, v = (qkv[0], qkv[1], qkv[2])
        scale = Dh ** (-0.5)
        scores = torch.einsum('bhqd,bhkd->bhqk', q, k) * scale
        p = _softmax(scores, axis=-1)
        o = torch.einsum('bhqk,bhkd->bhqd', p, v)
        return (lambda x, *d: x.permute(*d))(o, 0, 2, 1, 3).reshape(B, S, D) @ wo

    def _B_ref(x, mem0, Wq, Wk, Wv, Wo, seg_len):
        B, S, Dm = x.shape
        H, Dh = (Wq.shape[1], Wq.shape[2])
        M = mem0.shape[1]
        scale = Dh ** (-0.5)
        n_seg = S // seg_len
        L = M + seg_len
        idx = torch.arange(L)
        mask = (idx[:, None] < M) | (idx[:, None] >= idx[None, :])
        mem = mem0
        outs = []
        for s in range(n_seg):
            xs = x[:, s * seg_len:(s + 1) * seg_len, :].clone()
            h = torch.concatenate([mem, xs], axis=1)
            q = torch.einsum('btd,dhe->bhte', h, Wq)
            k = torch.einsum('btd,dhe->bhte', h, Wk)
            v = torch.einsum('btd,dhe->bhte', h, Wv)
            scores = torch.einsum('bhqe,bhke->bhqk', q, k) * scale
            scores = torch.where(mask[None, None], scores, -1000000000.0)
            p = _softmax(scores, axis=-1)
            o = torch.einsum('bhqk,bhke->bhqe', p, v)
            o = torch.einsum('bhte,hed->btd', o, Wo)
            mem = o[:, :M, :].clone()
            outs.append(o[:, M:, :])
        return torch.concatenate(outs, axis=1)
    a = _A_ref(A_x, A_wqkv, A_wo)
    b = _B_ref(B_x, B_mem0, B_Wq, B_Wk, B_Wv, B_Wo, B_seg_len)
    return torch.concatenate([a, b], axis=-1)
```

```asm
; @launch grid=(256,1,1) block=(256,1,1) lds=147456
.amdgcn_target "amdgcn-amd-amdhsa--gfx950"
.text
.globl concat_heads__softmax_full_mha__memory_aug_recurrent_mem_tr__prompt_kernel
.p2align 8
.type concat_heads__softmax_full_mha__memory_aug_recurrent_mem_tr__prompt_kernel,@function
concat_heads__softmax_full_mha__memory_aug_recurrent_mem_tr__prompt_kernel:
    s_cmp_ge_u32 s2, 256
    s_cbranch_scc1 L_end
    s_load_dwordx16 s[4:19], s[0:1], 0
    s_load_dwordx8 s[20:27], s[0:1], 64
    s_load_dwordx2 s[28:29], s[0:1], 96
    s_getreg_b32 s3, hwreg(HW_REG_XCC_ID)
    s_and_b32 s3, s3, 15
    v_and_b32 v1, 63, v0
    v_lshrrev_b32 v2, 6, v0
    s_nop 0
    v_readfirstlane_b32 s30, v2
    v_bfe_i32 v240, v1, 0, 1
    v_bfe_i32 v241, v1, 1, 1
    v_bfe_i32 v242, v1, 2, 1
    v_bfe_i32 v243, v1, 3, 1
    v_bfe_i32 v244, v1, 4, 1
    v_bfe_i32 v245, v1, 5, 1
    s_mov_b32 s90, -1
    s_mov_b32 s91, 0
    s_mov_b32 s92, 0
    s_mov_b32 s93, -1
    s_waitcnt lgkmcnt(0)
    s_mov_b32 s32, s28
    s_and_b32 s33, s29, 0xffff
    s_mov_b32 s34, 0x10000000
    s_mov_b32 s35, 0x00020000
    s_mov_b32 s36, s26
    s_and_b32 s37, s27, 0xffff
    s_mov_b32 s38, 0x100
    s_mov_b32 s39, 0x00020000
    s_mov_b32 s40, s24
    s_and_b32 s41, s25, 0xffff
    s_mov_b32 s42, 0x800000
    s_mov_b32 s43, 0x00020000
    v_mov_b32 v2, 0
    s_add_u32 s94, s28, 37748735
    s_and_b32 s94, s94, 0xffc00000
    s_sub_u32 s94, s94, s28
    s_cmp_lg_u32 s30, 0
    s_cbranch_scc1 L_p_join
    s_and_b32 s53, s3, 7
    s_mul_i32 s53, s53, 7
    s_lshl_b64 s[54:55], 1, s53
    v_mov_b32 v9, 0x7fff0000
    v_cmp_eq_u32 vcc, 0, v1
    s_nop 1
    v_cndmask_b32 v9, v9, 0, vcc
    v_mov_b32 v4, s54
    v_mov_b32 v5, s55
    buffer_atomic_add_x2 v[4:5], v9, s[36:39], 0 offen sc0
    s_waitcnt vmcnt(0)
    v_readfirstlane_b32 s58, v4
    v_readfirstlane_b32 s59, v5
    s_lshr_b32 s57, s59, 24
    s_lshl_b32 s57, s57, 2
    s_lshr_b64 s[60:61], s[58:59], s53
    s_and_b32 s63, s60, 31
    s_add_u32 s58, s58, s54
    s_addc_u32 s59, s59, s55
    s_and_b32 s59, s59, 0xffffff
    s_mov_b32 s56, 0
    s_mov_b32 s62, 0
    s_lshr_b64 s[54:55], s[58:59], 0
    s_and_b32 s54, s54, 127
    s_add_u32 s56, s56, s54
    s_xor_b32 s54, s54, 32
    s_or_b32 s62, s62, s54
    s_lshr_b64 s[54:55], s[58:59], 7
    s_and_b32 s54, s54, 127
    s_add_u32 s56, s56, s54
    s_xor_b32 s54, s54, 32
    s_or_b32 s62, s62, s54
    s_lshr_b64 s[54:55], s[58:59], 14
    s_and_b32 s54, s54, 127
    s_add_u32 s56, s56, s54
    s_xor_b32 s54, s54, 32
    s_or_b32 s62, s62, s54
    s_lshr_b64 s[54:55], s[58:59], 21
    s_and_b32 s54, s54, 127
    s_add_u32 s56, s56, s54
    s_xor_b32 s54, s54, 32
    s_or_b32 s62, s62, s54
    s_lshr_b64 s[54:55], s[58:59], 28
    s_and_b32 s54, s54, 127
    s_add_u32 s56, s56, s54
    s_xor_b32 s54, s54, 32
    s_or_b32 s62, s62, s54
    s_lshr_b64 s[54:55], s[58:59], 35
    s_and_b32 s54, s54, 127
    s_add_u32 s56, s56, s54
    s_xor_b32 s54, s54, 32
    s_or_b32 s62, s62, s54
    s_lshr_b64 s[54:55], s[58:59], 42
    s_and_b32 s54, s54, 127
    s_add_u32 s56, s56, s54
    s_xor_b32 s54, s54, 32
    s_or_b32 s62, s62, s54
    s_lshr_b64 s[54:55], s[58:59], 49
    s_and_b32 s54, s54, 127
    s_add_u32 s56, s56, s54
    s_xor_b32 s54, s54, 32
    s_or_b32 s62, s62, s54
    s_cmp_lg_u32 s56, 256
    s_cbranch_scc1 L_p_wait
    s_cmp_eq_u32 s62, 0
    s_cselect_b32 s56, 1, 2
    s_lshr_b32 s60, s3, 3
    s_cmp_lg_u32 s60, 0
    s_cselect_b32 s56, 2, s56
    s_or_b32 s56, s56, s57
    v_mov_b32 v8, s56
    buffer_store_dword v8, v9, s[36:39], 0 offen offset:128 sc1
    s_sub_u32 s54, 0, s58
    s_subb_u32 s55, 0x1000000, s59
    v_mov_b32 v4, s54
    v_mov_b32 v5, s55
    buffer_atomic_add_x2 v[4:5], v9, s[36:39], 0 offen
L_p_wait:
    s_mov_b32 s54, s63
    s_lshl_b32 s55, s3, 5
    s_add_u32 s55, s55, s54
    s_and_b32 s55, s55, 0xff
L_p_pub:
    s_lshl_b32 s57, s57, 8
    s_or_b32 s55, s55, s57
    v_mov_b32 v5, s55
    ds_write_b32 v2, v5
    s_waitcnt lgkmcnt(0)
L_p_join:
    s_barrier
    ds_read_b32 v5, v2
    s_waitcnt lgkmcnt(0)
    v_readfirstlane_b32 s55, v5
    s_and_b32 s31, s55, 0xff
    s_mov_b32 s52, 2
    s_mov_b32 s83, s2
    s_lshr_b32 s2, s55, 8
    s_and_b32 s2, s2, 0x3fc
    s_barrier
L_dispatch:
    s_cmp_lt_u32 s31, 128
    s_cbranch_scc0 L_worker
L_chain:
    s_lshr_b32 s53, s31, 5
    s_and_b32 s54, s31, 31
    s_lshr_b32 s55, s31, 4
    s_and_b32 s56, s31, 15
    s_lshr_b32 s57, s31, 2
    s_and_b32 s58, s31, 3
    s_lshl_b32 s59, s55, 2
    s_add_u32 s59, s59, s30
    s_lshl_b32 s74, s30, 15
    s_lshl_b32 s72, s30, 21
    s_lshl_b32 s73, s31, 6
    v_mov_b32 v200, 0x0
    v_and_b32 v246, 0x10, v240
    v_xor_b32 v200, v200, v246
    v_and_b32 v246, 0x20, v241
    v_xor_b32 v200, v200, v246
    v_and_b32 v246, 0x2000, v242
    v_xor_b32 v200, v200, v246
    v_and_b32 v246, 0x8000, v243
    v_xor_b32 v200, v200, v246
    v_and_b32 v246, 0x4000, v244
    v_xor_b32 v200, v200, v246
    v_and_b32 v246, 0x10000, v245
    v_xor_b32 v200, v200, v246
    v_add_u32 v200, s72, v200
    v_add_u32 v200, s73, v200
    v_xor_b32 v201, 48, v200
    s_lshl_b32 s73, s57, 8
    s_add_u32 s72, s72, s73
    s_and_b32 s73, s58, 1
    s_lshl_b32 s73, s73, 7
    v_mov_b32 v212, 0x0
    v_and_b32 v246, 0x10, v240
    v_xor_b32 v212, v212, v246
    v_and_b32 v246, 0x20, v241
    v_xor_b32 v212, v212, v246
    v_and_b32 v246, 0x40, v242
    v_xor_b32 v212, v212, v246
    v_and_b32 v246, 0x2000, v243
    v_xor_b32 v212, v212, v246
    v_and_b32 v246, 0x4000, v244
    v_xor_b32 v212, v212, v246
    v_and_b32 v246, 0x8010, v245
    v_xor_b32 v212, v212, v246
    v_add_u32 v212, s72, v212
    v_add_u32 v212, s73, v212
    v_xor_b32 v213, 64, v212
    s_cmp_ge_u32 s58, 2
    s_cselect_b32 s76, s16, s14
    s_cselect_b32 s77, s17, s15
    s_lshl_b32 s72, s59, 18
    s_lshl_b32 s73, s56, 7
    s_add_u32 s72, s72, s73
    v_mov_b32 v202, 0x0
    v_and_b32 v246, 0x10, v240
    v_xor_b32 v202, v202, v246
    v_and_b32 v246, 0x20, v241
    v_xor_b32 v202, v202, v246
    v_and_b32 v246, 0x40, v242
    v_xor_b32 v202, v202, v246
    v_and_b32 v246, 0x800, v243
    v_xor_b32 v202, v202, v246
    v_and_b32 v246, 0x1000, v244
    v_xor_b32 v202, v202, v246
    v_and_b32 v246, 0x2020, v245
    v_xor_b32 v202, v202, v246
    v_add_u32 v202, s72, v202
    v_xor_b32 v203, 64, v202
    s_mov_b32 s44, s76
    s_and_b32 s45, s77, 0xffff
    s_mov_b32 s46, 0x800000
    s_mov_b32 s47, 0x00020000
    s_add_u32 m0, s74, 0
    s_mov_b32 s72, 0
    buffer_load_dwordx4 v212, s[44:47], s72 offen lds
    s_add_u32 m0, s74, 1024
    s_mov_b32 s72, 65536
    buffer_load_dwordx4 v212, s[44:47], s72 offen lds
    s_add_u32 m0, s74, 2048
    s_mov_b32 s72, 131072
    buffer_load_dwordx4 v213, s[44:47], s72 offen lds
    s_add_u32 m0, s74, 3072
    s_mov_b32 s72, 196608
    buffer_load_dwordx4 v213, s[44:47], s72 offen lds
    s_add_u32 m0, s74, 4096
    s_mov_b32 s72, 262144
    buffer_load_dwordx4 v212, s[44:47], s72 offen lds
    s_add_u32 m0, s74, 5120
    s_mov_b32 s72, 327680
    buffer_load_dwordx4 v212, s[44:47], s72 offen lds
    s_add_u32 m0, s74, 6144
    s_mov_b32 s72, 393216
    buffer_load_dwordx4 v213, s[44:47], s72 offen lds
    s_add_u32 m0, s74, 7168
    s_mov_b32 s72, 458752
    buffer_load_dwordx4 v213, s[44:47], s72 offen lds
    s_add_u32 m0, s74, 8192
    s_mov_b32 s72, 524288
    buffer_load_dwordx4 v212, s[44:47], s72 offen lds
    s_add_u32 m0, s74, 9216
    s_mov_b32 s72, 589824
    buffer_load_dwordx4 v212, s[44:47], s72 offen lds
    s_add_u32 m0, s74, 10240
    s_mov_b32 s72, 655360
    buffer_load_dwordx4 v213, s[44:47], s72 offen lds
    s_add_u32 m0, s74, 11264
    s_mov_b32 s72, 720896
    buffer_load_dwordx4 v213, s[44:47], s72 offen lds
    s_add_u32 m0, s74, 12288
    s_mov_b32 s72, 786432
    buffer_load_dwordx4 v212, s[44:47], s72 offen lds
    s_add_u32 m0, s74, 13312
    s_mov_b32 s72, 851968
    buffer_load_dwordx4 v212, s[44:47], s72 offen lds
    s_add_u32 m0, s74, 14336
    s_mov_b32 s72, 917504
    buffer_load_dwordx4 v213, s[44:47], s72 offen lds
    s_add_u32 m0, s74, 15360
    s_mov_b32 s72, 983040
    buffer_load_dwordx4 v213, s[44:47], s72 offen lds
    s_lshl_b32 s72, s53, 16
    s_add_u32 s72, s72, 65536
    s_lshl_b32 s73, s30, 12
    v_mov_b32 v2, 0x0
    v_and_b32 v246, 0x10, v240
    v_xor_b32 v2, v2, v246
    v_and_b32 v246, 0x20, v241
    v_xor_b32 v2, v2, v246
    v_and_b32 v246, 0x40, v242
    v_xor_b32 v2, v2, v246
    v_and_b32 v246, 0x80, v243
    v_xor_b32 v2, v2, v246
    v_and_b32 v246, 0x100, v244
    v_xor_b32 v2, v2, v246
    v_and_b32 v246, 0x200, v245
    v_xor_b32 v2, v2, v246
    v_add_u32 v2, s72, v2
    v_add_u32 v2, s73, v2
    s_lshl_b32 s73, s54, 9
    s_add_u32 s72, s72, s73
    s_lshl_b32 s73, s30, 8
    v_mov_b32 v3, 0x0
    v_and_b32 v246, 0x10, v240
    v_xor_b32 v3, v3, v246
    v_and_b32 v246, 0x20, v241
    v_xor_b32 v3, v3, v246
    v_and_b32 v246, 0x40, v242
    v_xor_b32 v3, v3, v246
    v_and_b32 v246, 0x80, v243
    v_xor_b32 v3, v3, v246
    v_and_b32 v246, 0x8, v244
    v_xor_b32 v3, v3, v246
    v_add_u32 v3, s72, v3
    v_add_u32 v3, s73, v3
    s_mov_b32 s86, 0xffffffff
    s_mov_b32 s87, 0x0
    v_mov_b32 v246, 0x7fff0000
    v_cndmask_b32 v3, v246, v3, s[86:87]
    v_mov_b32 v204, 0x0
    v_and_b32 v246, 0x10, v240
    v_xor_b32 v204, v204, v246
    v_and_b32 v246, 0x20, v241
    v_xor_b32 v204, v204, v246
    v_and_b32 v246, 0x40, v242
    v_xor_b32 v204, v204, v246
    v_and_b32 v246, 0x8, v243
    v_xor_b32 v204, v204, v246
    v_and_b32 v246, 0x80, v244
    v_xor_b32 v204, v204, v246
    v_and_b32 v246, 0x100, v245
    v_xor_b32 v204, v204, v246
    v_mov_b32 v206, 0x0
    v_and_b32 v246, 0x10, v240
    v_xor_b32 v206, v206, v246
    v_and_b32 v246, 0x20, v241
    v_xor_b32 v206, v206, v246
    v_and_b32 v246, 0x40, v242
    v_xor_b32 v206, v206, v246
    v_and_b32 v246, 0x80, v244
    v_xor_b32 v206, v206, v246
    v_and_b32 v246, 0x100, v245
    v_xor_b32 v206, v206, v246
    s_mov_b32 s86, 0xff00ff
    s_mov_b32 s87, 0xff00ff
    v_mov_b32 v246, 0x7fff0000
    v_cndmask_b32 v206, v246, v206, s[86:87]
    s_cmp_eq_u32 s30, 2
    s_cselect_b64 s[78:79], -1, 0
    v_cndmask_b32 v4, v204, v206, s[78:79]
    s_mul_i32 s72, s55, 98304
    s_add_u32 s72, s72, 331776
    s_mul_i32 s73, s30, 6144
    v_mov_b32 v6, 0x0
    v_and_b32 v246, 0x10, v240
    v_xor_b32 v6, v6, v246
    v_and_b32 v246, 0x20, v241
    v_xor_b32 v6, v6, v246
    v_and_b32 v246, 0x40, v242
    v_xor_b32 v6, v6, v246
    v_and_b32 v246, 0x80, v243
    v_xor_b32 v6, v6, v246
    v_and_b32 v246, 0x100, v244
    v_xor_b32 v6, v6, v246
    v_and_b32 v246, 0x200, v245
    v_xor_b32 v6, v6, v246
    v_add_u32 v6, s72, v6
    v_add_u32 v6, s73, v6
    s_lshr_b32 s73, s56, 2
    s_mul_i32 s73, s73, 6144
    s_add_u32 s72, s72, s73
    s_sub_u32 s72, s72, 4096
    v_mov_b32 v5, 0x0
    v_and_b32 v246, 0x10, v240
    v_xor_b32 v5, v5, v246
    v_and_b32 v246, 0x20, v241
    v_xor_b32 v5, v5, v246
    v_and_b32 v246, 0x40, v242
    v_xor_b32 v5, v5, v246
    v_and_b32 v246, 0x200, v243
    v_xor_b32 v5, v5, v246
    v_and_b32 v246, 0x80, v244
    v_xor_b32 v5, v5, v246
    v_and_b32 v246, 0x100, v245
    v_xor_b32 v5, v5, v246
    v_add_u32 v5, s72, v5
    v_mov_b32 v122, 0x800
    v_and_b32 v246, 0x10, v240
    v_xor_b32 v122, v122, v246
    v_and_b32 v246, 0x20, v241
    v_xor_b32 v122, v122, v246
    v_and_b32 v246, 0x40, v242
    v_xor_b32 v122, v122, v246
    v_and_b32 v246, 0x80, v244
    v_xor_b32 v122, v122, v246
    v_and_b32 v246, 0x100, v245
    v_xor_b32 v122, v122, v246
    v_add_u32 v122, s72, v122
    s_lshl_b32 s73, s58, 9
    s_add_u32 s72, s72, s73
    s_add_u32 s73, s72, 4096
    v_add_u32 v123, s73, v206
    s_lshl_b32 s73, s58, 9
    s_lshl_b32 s80, s30, 9
    s_add_u32 s80, s80, s73
    s_cmp_eq_u32 s30, 2
    s_cselect_b32 s80, 4096, s80
    s_add_u32 s72, s72, s80
    v_add_u32 v4, s72, v4
    s_lshl_b32 s72, s30, 10
    v_mov_b32 v11, 0x10000
    v_and_b32 v246, 0x10, v240
    v_xor_b32 v11, v11, v246
    v_and_b32 v246, 0x20, v241
    v_xor_b32 v11, v11, v246
    v_and_b32 v246, 0x40, v242
    v_xor_b32 v11, v11, v246
    v_and_b32 v246, 0x80, v243
    v_xor_b32 v11, v11, v246
    v_and_b32 v246, 0x100, v244
    v_xor_b32 v11, v11, v246
    v_and_b32 v246, 0x200, v245
    v_xor_b32 v11, v11, v246
    v_add_u32 v11, s72, v11
    s_lshl_b32 s72, s30, 12
    v_mov_b32 v12, 0x10000
    v_and_b32 v246, 0x10, v240
    v_xor_b32 v12, v12, v246
    v_and_b32 v246, 0x20, v241
    v_xor_b32 v12, v12, v246
    v_and_b32 v246, 0x40, v242
    v_xor_b32 v12, v12, v246
    v_and_b32 v246, 0x80, v243
    v_xor_b32 v12, v12, v246
    v_and_b32 v246, 0x100, v244
    v_xor_b32 v12, v12, v246
    v_and_b32 v246, 0x200, v245
    v_xor_b32 v12, v12, v246
    v_add_u32 v12, s72, v12
    v_mov_b32 v14, 0x0
    v_and_b32 v246, 0x10, v240
    v_xor_b32 v14, v14, v246
    v_and_b32 v246, 0x20, v241
    v_xor_b32 v14, v14, v246
    v_and_b32 v246, 0x40, v242
    v_xor_b32 v14, v14, v246
    v_and_b32 v246, 0x80, v243
    v_xor_b32 v14, v14, v246
    v_and_b32 v246, 0x100, v244
    v_xor_b32 v14, v14, v246
    v_and_b32 v246, 0x200, v245
    v_xor_b32 v14, v14, v246
    v_add_u32 v13, 73728, v14
    s_and_b32 s72, s30, 1
    s_lshl_b32 s72, s72, 10
    s_add_u32 s72, s72, 10240
    v_add_u32 v225, s72, v14
    v_mov_b32 v16, 0x4444
    s_mov_b32 s86, 0xff00ff00
    s_mov_b32 s87, 0xff00ff00
    v_mov_b32 v246, 0xeeee
    v_cndmask_b32 v16, v16, v246, s[86:87]
    v_mov_b32 v20, -1
    v_mov_b32 v21, -1
    v_mov_b32 v22, -1
    v_mov_b32 v23, -1
    s_mov_b32 s75, -1
    s_mov_b32 s71, 0x3e0293ee
    v_mov_b32 v24, 0x0
    s_mov_b32 s86, 0x100001
    s_mov_b32 s87, 0x100001
    v_mov_b32 v246, 0x3f80
    v_cndmask_b32 v24, v24, v246, s[86:87]
    s_mov_b32 s86, 0x200002
    s_mov_b32 s87, 0x200002
    v_mov_b32 v246, 0x3f800000
    v_cndmask_b32 v24, v24, v246, s[86:87]
    v_mov_b32 v28, 0x0
    s_mov_b32 s86, 0x1010101
    s_mov_b32 s87, 0x1010101
    v_mov_b32 v246, 0x3f80
    v_cndmask_b32 v28, v28, v246, s[86:87]
    s_mov_b32 s86, 0x2020202
    s_mov_b32 s87, 0x2020202
    v_mov_b32 v246, 0x3f800000
    v_cndmask_b32 v28, v28, v246, s[86:87]
    v_mov_b32 v25, 0x0
    s_mov_b32 s86, 0x800008
    s_mov_b32 s87, 0x800008
    v_mov_b32 v246, 0x3f800000
    v_cndmask_b32 v25, v25, v246, s[86:87]
    s_mov_b32 s86, 0x400004
    s_mov_b32 s87, 0x400004
    v_mov_b32 v246, 0x3f80
    v_cndmask_b32 v25, v25, v246, s[86:87]
    v_mov_b32 v29, 0x0
    s_mov_b32 s86, 0x8080808
    s_mov_b32 s87, 0x8080808
    v_mov_b32 v246, 0x3f800000
    v_cndmask_b32 v29, v29, v246, s[86:87]
    s_mov_b32 s86, 0x4040404
    s_mov_b32 s87, 0x4040404
    v_mov_b32 v246, 0x3f80
    v_cndmask_b32 v29, v29, v246, s[86:87]
    v_mov_b32 v26, 0x0
    s_mov_b32 s86, 0x20000200
    s_mov_b32 s87, 0x20000200
    v_mov_b32 v246, 0x3f800000
    v_cndmask_b32 v26, v26, v246, s[86:87]
    s_mov_b32 s86, 0x10000100
    s_mov_b32 s87, 0x10000100
    v_mov_b32 v246, 0x3f80
    v_cndmask_b32 v26, v26, v246, s[86:87]
    v_mov_b32 v30, 0x0
    s_mov_b32 s86, 0x20202020
    s_mov_b32 s87, 0x20202020
    v_mov_b32 v246, 0x3f800000
    v_cndmask_b32 v30, v30, v246, s[86:87]
    s_mov_b32 s86, 0x10101010
    s_mov_b32 s87, 0x10101010
    v_mov_b32 v246, 0x3f80
    v_cndmask_b32 v30, v30, v246, s[86:87]
    v_mov_b32 v27, 0x0
    s_mov_b32 s86, 0x80000800
    s_mov_b32 s87, 0x80000800
    v_mov_b32 v246, 0x3f800000
    v_cndmask_b32 v27, v27, v246, s[86:87]
    s_mov_b32 s86, 0x40000400
    s_mov_b32 s87, 0x40000400
    v_mov_b32 v246, 0x3f80
    v_cndmask_b32 v27, v27, v246, s[86:87]
    v_mov_b32 v31, 0x0
    s_mov_b32 s86, 0x80808080
    s_mov_b32 s87, 0x80808080
    v_mov_b32 v246, 0x3f800000
    v_cndmask_b32 v31, v31, v246, s[86:87]
    s_mov_b32 s86, 0x40404040
    s_mov_b32 s87, 0x40404040
    v_mov_b32 v246, 0x3f80
    v_cndmask_b32 v31, v31, v246, s[86:87]
    v_mov_b32 v218, 0x0
    v_and_b32 v246, 0x8, v240
    v_xor_b32 v218, v218, v246
    v_and_b32 v246, 0x10, v241
    v_xor_b32 v218, v218, v246
    v_and_b32 v246, 0x40, v242
    v_xor_b32 v218, v218, v246
    v_and_b32 v246, 0x80, v243
    v_xor_b32 v218, v218, v246
    v_and_b32 v246, 0x430, v244
    v_xor_b32 v218, v218, v246
    v_and_b32 v246, 0x200, v245
    v_xor_b32 v218, v218, v246
    v_add_u32 v218, s74, v218
    v_mov_b32 v219, 0x20
    v_and_b32 v246, 0x8, v240
    v_xor_b32 v219, v219, v246
    v_and_b32 v246, 0x10, v241
    v_xor_b32 v219, v219, v246
    v_and_b32 v246, 0x40, v242
    v_xor_b32 v219, v219, v246
    v_and_b32 v246, 0x80, v243
    v_xor_b32 v219, v219, v246
    v_and_b32 v246, 0x430, v244
    v_xor_b32 v219, v219, v246
    v_and_b32 v246, 0x200, v245
    v_xor_b32 v219, v219, v246
    v_add_u32 v219, s74, v219
    v_mov_b32 v214, 0x0
    v_and_b32 v246, 0x8, v240
    v_xor_b32 v214, v214, v246
    v_and_b32 v246, 0x20, v241
    v_xor_b32 v214, v214, v246
    v_and_b32 v246, 0x80, v242
    v_xor_b32 v214, v214, v246
    v_and_b32 v246, 0x210, v243
    v_xor_b32 v214, v214, v246
    v_and_b32 v246, 0x840, v244
    v_xor_b32 v214, v214, v246
    v_and_b32 v246, 0x400, v245
    v_xor_b32 v214, v214, v246
    v_add_u32 v214, s74, v214
    v_mov_b32 v215, 0x10
    v_and_b32 v246, 0x8, v240
    v_xor_b32 v215, v215, v246
    v_and_b32 v246, 0x20, v241
    v_xor_b32 v215, v215, v246
    v_and_b32 v246, 0x80, v242
    v_xor_b32 v215, v215, v246
    v_and_b32 v246, 0x210, v243
    v_xor_b32 v215, v215, v246
    v_and_b32 v246, 0x840, v244
    v_xor_b32 v215, v215, v246
    v_and_b32 v246, 0x400, v245
    v_xor_b32 v215, v215, v246
    v_add_u32 v215, s74, v215
    v_mov_b32 v216, 0x40
    v_and_b32 v246, 0x8, v240
    v_xor_b32 v216, v216, v246
    v_and_b32 v246, 0x20, v241
    v_xor_b32 v216, v216, v246
    v_and_b32 v246, 0x80, v242
    v_xor_b32 v216, v216, v246
    v_and_b32 v246, 0x210, v243
    v_xor_b32 v216, v216, v246
    v_and_b32 v246, 0x840, v244
    v_xor_b32 v216, v216, v246
    v_and_b32 v246, 0x400, v245
    v_xor_b32 v216, v216, v246
    v_add_u32 v216, s74, v216
    v_mov_b32 v217, 0x50
    v_and_b32 v246, 0x8, v240
    v_xor_b32 v217, v217, v246
    v_and_b32 v246, 0x20, v241
    v_xor_b32 v217, v217, v246
    v_and_b32 v246, 0x80, v242
    v_xor_b32 v217, v217, v246
    v_and_b32 v246, 0x210, v243
    v_xor_b32 v217, v217, v246
    v_and_b32 v246, 0x840, v244
    v_xor_b32 v217, v217, v246
    v_and_b32 v246, 0x400, v245
    v_xor_b32 v217, v217, v246
    v_add_u32 v217, s74, v217
    v_mov_b32 v208, 0x0
    v_and_b32 v246, 0x8, v240
    v_xor_b32 v208, v208, v246
    v_and_b32 v246, 0x10, v241
    v_xor_b32 v208, v208, v246
    v_and_b32 v246, 0x80, v242
    v_xor_b32 v208, v208, v246
    v_and_b32 v246, 0x220, v243
    v_xor_b32 v208, v208, v246
    v_and_b32 v246, 0x840, v244
    v_xor_b32 v208, v208, v246
    v_and_b32 v246, 0x400, v245
    v_xor_b32 v208, v208, v246
    v_add_u32 v208, s74, v208
    v_mov_b32 v209, 0x20
    v_and_b32 v246, 0x8, v240
    v_xor_b32 v209, v209, v246
    v_and_b32 v246, 0x10, v241
    v_xor_b32 v209, v209, v246
    v_and_b32 v246, 0x80, v242
    v_xor_b32 v209, v209, v246
    v_and_b32 v246, 0x220, v243
    v_xor_b32 v209, v209, v246
    v_and_b32 v246, 0x840, v244
    v_xor_b32 v209, v209, v246
    v_and_b32 v246, 0x400, v245
    v_xor_b32 v209, v209, v246
    v_add_u32 v209, s74, v209
    v_mov_b32 v210, 0x40
    v_and_b32 v246, 0x8, v240
    v_xor_b32 v210, v210, v246
    v_and_b32 v246, 0x10, v241
    v_xor_b32 v210, v210, v246
    v_and_b32 v246, 0x80, v242
    v_xor_b32 v210, v210, v246
    v_and_b32 v246, 0x220, v243
    v_xor_b32 v210, v210, v246
    v_and_b32 v246, 0x840, v244
    v_xor_b32 v210, v210, v246
    v_and_b32 v246, 0x400, v245
    v_xor_b32 v210, v210, v246
    v_add_u32 v210, s74, v210
    v_mov_b32 v211, 0x60
    v_and_b32 v246, 0x8, v240
    v_xor_b32 v211, v211, v246
    v_and_b32 v246, 0x10, v241
    v_xor_b32 v211, v211, v246
    v_and_b32 v246, 0x80, v242
    v_xor_b32 v211, v211, v246
    v_and_b32 v246, 0x220, v243
    v_xor_b32 v211, v211, v246
    v_and_b32 v246, 0x840, v244
    v_xor_b32 v211, v211, v246
    v_and_b32 v246, 0x400, v245
    v_xor_b32 v211, v211, v246
    v_add_u32 v211, s74, v211
    s_cmp_lg_u32 s52, 2
    s_cbranch_scc1 L_cfd_2
    s_mov_b32 s88, 0
    v_mov_b32 v246, 128
L_cf_1:
    s_add_u32 s88, s88, 1
    s_mov_b32 s89, 1
    s_cmp_ge_u32 s88, 262144
    s_cbranch_scc1 L_abort
    buffer_load_dword v247, v246, s[36:39], 0 offen sc1
    s_waitcnt vmcnt(0)
    v_readfirstlane_b32 s52, v247
    s_cmp_le_u32 s52, s2
    s_cbranch_scc1 L_cf_1
    s_and_b32 s52, s52, 3
    s_sub_u32 s52, s52, 1
    s_cmp_eq_u32 s52, 0
    s_cbranch_scc1 L_cfd_2
    s_mov_b32 s52, 1
    s_mov_b32 s31, s83
    s_waitcnt vmcnt(0) lgkmcnt(0)
    s_barrier
    s_branch L_dispatch
L_cfd_2:
    s_mov_b32 s88, 0
    v_mov_b32 v246, 132
L_side_3:
    s_add_u32 s88, s88, 1
    s_mov_b32 s89, 18
    s_cmp_ge_u32 s88, 262144
    s_cbranch_scc1 L_abort
    buffer_load_dword v247, v246, s[36:39], 0 offen sc1
    s_waitcnt vmcnt(0)
    v_readfirstlane_b32 s95, v247
    s_cmp_le_u32 s95, s2
    s_cbranch_scc1 L_side_3
    s_sub_u32 s95, s95, 1
    s_and_b32 s95, s95, 1
    s_lshl_b32 s95, s95, 13
    s_lshr_b32 s73, s57, 1
    s_and_b32 s73, s73, 1
    s_lshl_b32 s73, s73, 13
    s_xor_b32 s73, s73, s95
    s_xor_b32 s73, s73, 0x2000
    s_add_u32 s73, s73, s94
    s_add_u32 s73, s73, 104857600
    s_lshl_b32 s72, s57, 20
    s_add_u32 s72, s72, s73
    s_lshl_b32 s73, s58, 11
    s_add_u32 s72, s72, s73
    s_and_b32 s73, s30, 1
    s_lshl_b32 s73, s73, 8
    v_mov_b32 v9, 0x0
    v_and_b32 v246, 0x10, v240
    v_xor_b32 v9, v9, v246
    v_and_b32 v246, 0x20, v241
    v_xor_b32 v9, v9, v246
    v_and_b32 v246, 0x40, v242
    v_xor_b32 v9, v9, v246
    v_and_b32 v246, 0x80, v243
    v_xor_b32 v9, v9, v246
    v_and_b32 v246, 0x200, v244
    v_xor_b32 v9, v9, v246
    v_and_b32 v246, 0x400, v245
    v_xor_b32 v9, v9, v246
    v_add_u32 v9, s72, v9
    v_add_u32 v9, s73, v9
    s_lshr_b32 s72, s31, 6
    s_lshl_b32 s72, s72, 14
    s_and_b32 s73, s31, 63
    s_lshl_b32 s73, s73, 7
    s_add_u32 s72, s72, s73
    s_add_u32 s72, s72, s94
    s_add_u32 s72, s72, s95
    s_add_u32 s72, s72, 1245184
    v_mov_b32 v19, 0x0
    v_add_u32 v19, s72, v19
    s_mov_b32 s86, 0x1
    s_mov_b32 s87, 0x0
    v_mov_b32 v246, 0x7fff0000
    v_cndmask_b32 v19, v246, v19, s[86:87]
    s_lshl_b32 s72, s56, 14
    s_lshl_b32 s73, s30, 12
    s_add_u32 s72, s72, s73
    s_lshl_b32 s73, s55, 9
    s_add_u32 s72, s72, s73
    s_add_u32 s72, s72, s94
    s_add_u32 s72, s72, s95
    v_add_u32 v7, s72, v204
    s_lshr_b32 s72, s54, 1
    s_lshl_b32 s72, s72, 14
    s_and_b32 s73, s54, 1
    s_lshl_b32 s73, s73, 12
    s_add_u32 s72, s72, s73
    s_lshl_b32 s73, s30, 8
    s_add_u32 s72, s72, s73
    s_add_u32 s72, s72, s94
    s_add_u32 s72, s72, s95
    v_mov_b32 v8, 0x0
    v_and_b32 v246, 0x10, v240
    v_xor_b32 v8, v8, v246
    v_and_b32 v246, 0x20, v241
    v_xor_b32 v8, v8, v246
    v_and_b32 v246, 0x40, v242
    v_xor_b32 v8, v8, v246
    v_and_b32 v246, 0x80, v243
    v_xor_b32 v8, v8, v246
    v_and_b32 v246, 0x200, v244
    v_xor_b32 v8, v8, v246
    v_and_b32 v246, 0x400, v245
    v_xor_b32 v8, v8, v246
    v_add_u32 v8, s72, v8
    s_lshl_b32 s72, s57, 20
    s_lshr_b32 s73, s57, 1
    s_and_b32 s73, s73, 1
    s_lshl_b32 s73, s73, 13
    s_xor_b32 s73, s73, s95
    s_add_u32 s73, s73, s94
    v_mov_b32 v10, 0x0
    v_and_b32 v246, 0x10, v240
    v_xor_b32 v10, v10, v246
    v_and_b32 v246, 0x20, v241
    v_xor_b32 v10, v10, v246
    v_and_b32 v246, 0x40, v242
    v_xor_b32 v10, v10, v246
    v_and_b32 v246, 0x80, v243
    v_xor_b32 v10, v10, v246
    v_and_b32 v246, 0x100, v244
    v_xor_b32 v10, v10, v246
    v_and_b32 v246, 0x200, v245
    v_xor_b32 v10, v10, v246
    v_add_u32 v10, s72, v10
    v_add_u32 v10, s73, v10
    s_lshl_b32 s72, s58, 11
    v_add_u32 v15, s72, v10
    s_lshl_b32 s73, s57, 4
    s_lshr_b32 s72, s73, 6
    s_lshl_b32 s72, s72, 14
    s_and_b32 s80, s73, 63
    s_lshl_b32 s80, s80, 7
    s_add_u32 s72, s72, s80
    s_add_u32 s72, s72, s94
    s_add_u32 s72, s72, s95
    s_add_u32 s72, s72, 1114112
    v_mov_b32 v17, 0x0
    v_and_b32 v246, 0x80, v240
    v_xor_b32 v17, v17, v246
    v_and_b32 v246, 0x100, v241
    v_xor_b32 v17, v17, v246
    v_and_b32 v246, 0x200, v242
    v_xor_b32 v17, v17, v246
    v_and_b32 v246, 0x400, v243
    v_xor_b32 v17, v17, v246
    v_add_u32 v17, s72, v17
    s_mov_b32 s86, 0xfff0fff
    s_mov_b32 s87, 0xfff0fff
    v_add_u32 v207, -512, v17
    v_cndmask_b32 v17, v207, v17, s[86:87]
    s_cmp_eq_u32 s30, 3
    s_cbranch_scc1 L_ci_clr
    s_cmp_eq_u32 s30, 2
    s_cbranch_scc1 L_ci_clr2
    s_mov_b32 s72, 0
    buffer_store_dwordx2 v[20:21], v4, s[32:35], s72 offen sc1
    s_mov_b32 s72, 0
    buffer_store_dwordx2 v[20:21], v7, s[32:35], s72 offen sc1
    s_mov_b32 s72, 0
    buffer_store_dwordx2 v[20:21], v3, s[32:35], s72 offen sc1
    s_mov_b32 s72, 24576
    buffer_store_dwordx2 v[20:21], v4, s[32:35], s72 offen sc1
    s_mov_b32 s72, 262144
    buffer_store_dwordx2 v[20:21], v7, s[32:35], s72 offen sc1
    s_mov_b32 s72, 16384
    buffer_store_dwordx2 v[20:21], v3, s[32:35], s72 offen sc1
    s_mov_b32 s72, 49152
    buffer_store_dwordx2 v[20:21], v4, s[32:35], s72 offen sc1
    s_mov_b32 s72, 524288
    buffer_store_dwordx2 v[20:21], v7, s[32:35], s72 offen sc1
    s_mov_b32 s72, 32768
    buffer_store_dwordx2 v[20:21], v3, s[32:35], s72 offen sc1
    s_mov_b32 s72, 73728
    buffer_store_dwordx2 v[20:21], v4, s[32:35], s72 offen sc1
    s_mov_b32 s72, 786432
    buffer_store_dwordx2 v[20:21], v7, s[32:35], s72 offen sc1
    s_mov_b32 s72, 49152
    buffer_store_dwordx2 v[20:21], v3, s[32:35], s72 offen sc1
    s_branch L_ci_clr
L_ci_clr2:
    s_mov_b32 s72, 0
    buffer_store_dwordx4 v[20:23], v4, s[32:35], s72 offen sc1
    s_mov_b32 s72, 24576
    buffer_store_dwordx4 v[20:23], v4, s[32:35], s72 offen sc1
    s_mov_b32 s72, 49152
    buffer_store_dwordx4 v[20:23], v4, s[32:35], s72 offen sc1
    s_mov_b32 s72, 73728
    buffer_store_dwordx4 v[20:23], v4, s[32:35], s72 offen sc1
L_ci_clr:
    s_mov_b32 s48, s76
    s_and_b32 s49, s77, 0xffff
    s_mov_b32 s50, 0x800000
    s_mov_b32 s51, 0x00020000
    s_add_u32 m0, s74, 16384
    s_mov_b32 s72, 1048576
    buffer_load_dwordx4 v212, s[48:51], s72 offen lds
    s_add_u32 m0, s74, 17408
    s_mov_b32 s72, 1114112
    buffer_load_dwordx4 v212, s[48:51], s72 offen lds
    s_add_u32 m0, s74, 18432
    s_mov_b32 s72, 1179648
    buffer_load_dwordx4 v213, s[48:51], s72 offen lds
    s_add_u32 m0, s74, 19456
    s_mov_b32 s72, 1245184
    buffer_load_dwordx4 v213, s[48:51], s72 offen lds
    s_add_u32 m0, s74, 20480
    s_mov_b32 s72, 1310720
    buffer_load_dwordx4 v212, s[48:51], s72 offen lds
    s_add_u32 m0, s74, 21504
    s_mov_b32 s72, 1376256
    buffer_load_dwordx4 v212, s[48:51], s72 offen lds
    s_add_u32 m0, s74, 22528
    s_mov_b32 s72, 1441792
    buffer_load_dwordx4 v213, s[48:51], s72 offen lds
    s_add_u32 m0, s74, 23552
    s_mov_b32 s72, 1507328
    buffer_load_dwordx4 v213, s[48:51], s72 offen lds
    s_add_u32 m0, s74, 24576
    s_mov_b32 s72, 1572864
    buffer_load_dwordx4 v212, s[48:51], s72 offen lds
    s_add_u32 m0, s74, 25600
    s_mov_b32 s72, 1638400
    buffer_load_dwordx4 v212, s[48:51], s72 offen lds
    s_add_u32 m0, s74, 26624
    s_mov_b32 s72, 1703936
    buffer_load_dwordx4 v213, s[48:51], s72 offen lds
    s_add_u32 m0, s74, 27648
    s_mov_b32 s72, 1769472
    buffer_load_dwordx4 v213, s[48:51], s72 offen lds
    s_add_u32 m0, s74, 28672
    s_mov_b32 s72, 1835008
    buffer_load_dwordx4 v212, s[48:51], s72 offen lds
    s_add_u32 m0, s74, 29696
    s_mov_b32 s72, 1900544
    buffer_load_dwordx4 v212, s[48:51], s72 offen lds
    s_add_u32 m0, s74, 30720
    s_mov_b32 s72, 1966080
    buffer_load_dwordx4 v213, s[48:51], s72 offen lds
    s_add_u32 m0, s74, 31744
    s_mov_b32 s72, 2031616
    buffer_load_dwordx4 v213, s[48:51], s72 offen lds
    s_waitcnt vmcnt(16)
    s_barrier
    s_cmp_lg_u32 s30, 0
    s_cbranch_scc1 L_sr_4
    v_mov_b32 v246, 0x7fff0000
    v_mov_b32 v247, 72
    v_cmp_eq_u32 vcc, 0, v1
    s_nop 1
    v_cndmask_b32 v246, v246, v247, vcc
    v_mov_b32 v247, 1
    buffer_atomic_add v247, v246, s[36:39], 0 offen
L_sr_4:
    ds_read_b64_tr_b16 a[0:1], v214 offset:0
    ds_read_b64_tr_b16 a[2:3], v214 offset:256
    ds_read_b64_tr_b16 a[4:5], v214 offset:4096
    ds_read_b64_tr_b16 a[6:7], v214 offset:4352
    ds_read_b64_tr_b16 a[8:9], v215 offset:0
    ds_read_b64_tr_b16 a[10:11], v215 offset:256
    ds_read_b64_tr_b16 a[12:13], v215 offset:4096
    ds_read_b64_tr_b16 a[14:15], v215 offset:4352
    ds_read_b64_tr_b16 a[16:17], v216 offset:0
    ds_read_b64_tr_b16 a[18:19], v216 offset:256
    ds_read_b64_tr_b16 a[20:21], v216 offset:4096
    ds_read_b64_tr_b16 a[22:23], v216 offset:4352
    ds_read_b64_tr_b16 a[24:25], v217 offset:0
    ds_read_b64_tr_b16 a[26:27], v217 offset:256
    ds_read_b64_tr_b16 a[28:29], v217 offset:4096
    ds_read_b64_tr_b16 a[30:31], v217 offset:4352
    ds_read_b64_tr_b16 a[48:49], v214 offset:8192
    ds_read_b64_tr_b16 a[50:51], v214 offset:8448
    ds_read_b64_tr_b16 a[52:53], v214 offset:12288
    ds_read_b64_tr_b16 a[54:55], v214 offset:12544
    ds_read_b64_tr_b16 a[56:57], v215 offset:8192
    ds_read_b64_tr_b16 a[58:59], v215 offset:8448
    ds_read_b64_tr_b16 a[60:61], v215 offset:12288
    ds_read_b64_tr_b16 a[62:63], v215 offset:12544
    ds_read_b64_tr_b16 a[64:65], v216 offset:8192
    ds_read_b64_tr_b16 a[66:67], v216 offset:8448
    ds_read_b64_tr_b16 a[68:69], v216 offset:12288
    ds_read_b64_tr_b16 a[70:71], v216 offset:12544
    ds_read_b64_tr_b16 a[72:73], v217 offset:8192
    ds_read_b64_tr_b16 a[74:75], v217 offset:8448
    ds_read_b64_tr_b16 a[76:77], v217 offset:12288
    ds_read_b64_tr_b16 a[78:79], v217 offset:12544
    s_waitcnt lgkmcnt(0)
    s_mov_b32 s44, s18
    s_and_b32 s45, s19, 0xffff
    s_mov_b32 s46, 0x800000
    s_mov_b32 s47, 0x00020000
    s_add_u32 m0, s74, 0
    s_mov_b32 s72, 0
    buffer_load_dwordx4 v200, s[44:47], s72 offen lds
    s_add_u32 m0, s74, 1024
    s_mov_b32 s72, 131072
    buffer_load_dwordx4 v201, s[44:47], s72 offen lds
    s_add_u32 m0, s74, 2048
    s_mov_b32 s72, 262144
    buffer_load_dwordx4 v200, s[44:47], s72 offen lds
    s_add_u32 m0, s74, 3072
    s_mov_b32 s72, 393216
    buffer_load_dwordx4 v201, s[44:47], s72 offen lds
    s_add_u32 m0, s74, 4096
    s_mov_b32 s72, 524288
    buffer_load_dwordx4 v200, s[44:47], s72 offen lds
    s_add_u32 m0, s74, 5120
    s_mov_b32 s72, 655360
    buffer_load_dwordx4 v201, s[44:47], s72 offen lds
    s_add_u32 m0, s74, 6144
    s_mov_b32 s72, 786432
    buffer_load_dwordx4 v200, s[44:47], s72 offen lds
    s_add_u32 m0, s74, 7168
    s_mov_b32 s72, 917504
    buffer_load_dwordx4 v201, s[44:47], s72 offen lds
    s_add_u32 m0, s74, 8192
    s_mov_b32 s72, 1048576
    buffer_load_dwordx4 v200, s[44:47], s72 offen lds
    s_add_u32 m0, s74, 9216
    s_mov_b32 s72, 1179648
    buffer_load_dwordx4 v201, s[44:47], s72 offen lds
    s_add_u32 m0, s74, 10240
    s_mov_b32 s72, 1310720
    buffer_load_dwordx4 v200, s[44:47], s72 offen lds
    s_add_u32 m0, s74, 11264
    s_mov_b32 s72, 1441792
    buffer_load_dwordx4 v201, s[44:47], s72 offen lds
    s_add_u32 m0, s74, 12288
    s_mov_b32 s72, 1572864
    buffer_load_dwordx4 v200, s[44:47], s72 offen lds
    s_add_u32 m0, s74, 13312
    s_mov_b32 s72, 1703936
    buffer_load_dwordx4 v201, s[44:47], s72 offen lds
    s_add_u32 m0, s74, 14336
    s_mov_b32 s72, 1835008
    buffer_load_dwordx4 v200, s[44:47], s72 offen lds
    s_add_u32 m0, s74, 15360
    s_mov_b32 s72, 1966080
    buffer_load_dwordx4 v201, s[44:47], s72 offen lds
    s_waitcnt vmcnt(16)
    ds_read_b64_tr_b16 a[96:97], v214 offset:16384
    ds_read_b64_tr_b16 a[98:99], v214 offset:16640
    ds_read_b64_tr_b16 a[100:101], v214 offset:20480
    ds_read_b64_tr_b16 a[102:103], v214 offset:20736
    ds_read_b64_tr_b16 a[104:105], v215 offset:16384
    ds_read_b64_tr_b16 a[106:107], v215 offset:16640
    ds_read_b64_tr_b16 a[108:109], v215 offset:20480
    ds_read_b64_tr_b16 a[110:111], v215 offset:20736
    ds_read_b64_tr_b16 a[112:113], v216 offset:16384
    ds_read_b64_tr_b16 a[114:115], v216 offset:16640
    ds_read_b64_tr_b16 a[116:117], v216 offset:20480
    ds_read_b64_tr_b16 a[118:119], v216 offset:20736
    ds_read_b64_tr_b16 a[120:121], v217 offset:16384
    ds_read_b64_tr_b16 a[122:123], v217 offset:16640
    ds_read_b64_tr_b16 a[124:125], v217 offset:20480
    ds_read_b64_tr_b16 a[126:127], v217 offset:20736
    ds_read_b64_tr_b16 a[144:145], v214 offset:24576
    ds_read_b64_tr_b16 a[146:147], v214 offset:24832
    ds_read_b64_tr_b16 a[148:149], v214 offset:28672
    ds_read_b64_tr_b16 a[150:151], v214 offset:28928
    ds_read_b64_tr_b16 a[152:153], v215 offset:24576
    ds_read_b64_tr_b16 a[154:155], v215 offset:24832
    ds_read_b64_tr_b16 a[156:157], v215 offset:28672
    ds_read_b64_tr_b16 a[158:159], v215 offset:28928
    ds_read_b64_tr_b16 a[160:161], v216 offset:24576
    ds_read_b64_tr_b16 a[162:163], v216 offset:24832
    ds_read_b64_tr_b16 a[164:165], v216 offset:28672
    ds_read_b64_tr_b16 a[166:167], v216 offset:28928
    ds_read_b64_tr_b16 a[168:169], v217 offset:24576
    ds_read_b64_tr_b16 a[170:171], v217 offset:24832
    ds_read_b64_tr_b16 a[172:173], v217 offset:28672
    ds_read_b64_tr_b16 a[174:175], v217 offset:28928
    s_waitcnt lgkmcnt(0)
    s_mov_b32 s48, s20
    s_and_b32 s49, s21, 0xffff
    s_mov_b32 s50, 0x800000
    s_mov_b32 s51, 0x00020000
    s_add_u32 m0, s74, 16384
    s_mov_b32 s72, 0
    buffer_load_dwordx4 v202, s[48:51], s72 offen lds
    s_add_u32 m0, s74, 17408
    s_mov_b32 s72, 16384
    buffer_load_dwordx4 v202, s[48:51], s72 offen lds
    s_add_u32 m0, s74, 18432
    s_mov_b32 s72, 32768
    buffer_load_dwordx4 v203, s[48:51], s72 offen lds
    s_add_u32 m0, s74, 19456
    s_mov_b32 s72, 49152
    buffer_load_dwordx4 v203, s[48:51], s72 offen lds
    s_add_u32 m0, s74, 20480
    s_mov_b32 s72, 65536
    buffer_load_dwordx4 v202, s[48:51], s72 offen lds
    s_add_u32 m0, s74, 21504
    s_mov_b32 s72, 81920
    buffer_load_dwordx4 v202, s[48:51], s72 offen lds
    s_add_u32 m0, s74, 22528
    s_mov_b32 s72, 98304
    buffer_load_dwordx4 v203, s[48:51], s72 offen lds
    s_add_u32 m0, s74, 23552
    s_mov_b32 s72, 114688
    buffer_load_dwordx4 v203, s[48:51], s72 offen lds
    s_add_u32 m0, s74, 24576
    s_mov_b32 s72, 131072
    buffer_load_dwordx4 v202, s[48:51], s72 offen lds
    s_add_u32 m0, s74, 25600
    s_mov_b32 s72, 147456
    buffer_load_dwordx4 v202, s[48:51], s72 offen lds
    s_add_u32 m0, s74, 26624
    s_mov_b32 s72, 163840
    buffer_load_dwordx4 v203, s[48:51], s72 offen lds
    s_add_u32 m0, s74, 27648
    s_mov_b32 s72, 180224
    buffer_load_dwordx4 v203, s[48:51], s72 offen lds
    s_add_u32 m0, s74, 28672
    s_mov_b32 s72, 196608
    buffer_load_dwordx4 v202, s[48:51], s72 offen lds
    s_add_u32 m0, s74, 29696
    s_mov_b32 s72, 212992
    buffer_load_dwordx4 v202, s[48:51], s72 offen lds
    s_add_u32 m0, s74, 30720
    s_mov_b32 s72, 229376
    buffer_load_dwordx4 v203, s[48:51], s72 offen lds
    s_add_u32 m0, s74, 31744
    s_mov_b32 s72, 245760
    buffer_load_dwordx4 v203, s[48:51], s72 offen lds
    s_waitcnt vmcnt(16)
    ds_read_b64_tr_b16 a[32:33], v218 offset:0
    ds_read_b64_tr_b16 a[34:35], v218 offset:256
    ds_read_b64_tr_b16 a[36:37], v218 offset:2048
    ds_read_b64_tr_b16 a[38:39], v218 offset:2304
    ds_read_b64_tr_b16 a[40:41], v219 offset:0
    ds_read_b64_tr_b16 a[42:43], v219 offset:256
    ds_read_b64_tr_b16 a[44:45], v219 offset:2048
    ds_read_b64_tr_b16 a[46:47], v219 offset:2304
    ds_read_b64_tr_b16 a[80:81], v218 offset:4096
    ds_read_b64_tr_b16 a[82:83], v218 offset:4352
    ds_read_b64_tr_b16 a[84:85], v218 offset:6144
    ds_read_b64_tr_b16 a[86:87], v218 offset:6400
    ds_read_b64_tr_b16 a[88:89], v219 offset:4096
    ds_read_b64_tr_b16 a[90:91], v219 offset:4352
    ds_read_b64_tr_b16 a[92:93], v219 offset:6144
    ds_read_b64_tr_b16 a[94:95], v219 offset:6400
    ds_read_b64_tr_b16 a[128:129], v218 offset:8192
    ds_read_b64_tr_b16 a[130:131], v218 offset:8448
    ds_read_b64_tr_b16 a[132:133], v218 offset:10240
    ds_read_b64_tr_b16 a[134:135], v218 offset:10496
    ds_read_b64_tr_b16 a[136:137], v219 offset:8192
    ds_read_b64_tr_b16 a[138:139], v219 offset:8448
    ds_read_b64_tr_b16 a[140:141], v219 offset:10240
    ds_read_b64_tr_b16 a[142:143], v219 offset:10496
    ds_read_b64_tr_b16 a[176:177], v218 offset:12288
    ds_read_b64_tr_b16 a[178:179], v218 offset:12544
    ds_read_b64_tr_b16 a[180:181], v218 offset:14336
    ds_read_b64_tr_b16 a[182:183], v218 offset:14592
    ds_read_b64_tr_b16 a[184:185], v219 offset:12288
    ds_read_b64_tr_b16 a[186:187], v219 offset:12544
    ds_read_b64_tr_b16 a[188:189], v219 offset:14336
    ds_read_b64_tr_b16 a[190:191], v219 offset:14592
    s_waitcnt lgkmcnt(0)
    s_waitcnt vmcnt(0)
    ds_read_b64_tr_b16 a[192:193], v208 offset:16384
    ds_read_b64_tr_b16 a[194:195], v208 offset:16640
    ds_read_b64_tr_b16 a[196:197], v208 offset:20480
    ds_read_b64_tr_b16 a[198:199], v208 offset:20736
    ds_read_b64_tr_b16 a[200:201], v209 offset:16384
    ds_read_b64_tr_b16 a[202:203], v209 offset:16640
    ds_read_b64_tr_b16 a[204:205], v209 offset:20480
    ds_read_b64_tr_b16 a[206:207], v209 offset:20736
    ds_read_b64_tr_b16 a[208:209], v210 offset:16384
    ds_read_b64_tr_b16 a[210:211], v210 offset:16640
    ds_read_b64_tr_b16 a[212:213], v210 offset:20480
    ds_read_b64_tr_b16 a[214:215], v210 offset:20736
    ds_read_b64_tr_b16 a[216:217], v211 offset:16384
    ds_read_b64_tr_b16 a[218:219], v211 offset:16640
    ds_read_b64_tr_b16 a[220:221], v211 offset:20480
    ds_read_b64_tr_b16 a[222:223], v211 offset:20736
    ds_read_b64_tr_b16 a[224:225], v208 offset:24576
    ds_read_b64_tr_b16 a[226:227], v208 offset:24832
    ds_read_b64_tr_b16 a[228:229], v208 offset:28672
    ds_read_b64_tr_b16 a[230:231], v208 offset:28928
    ds_read_b64_tr_b16 a[232:233], v209 offset:24576
    ds_read_b64_tr_b16 a[234:235], v209 offset:24832
    ds_read_b64_tr_b16 a[236:237], v209 offset:28672
    ds_read_b64_tr_b16 a[238:239], v209 offset:28928
    ds_read_b64_tr_b16 a[240:241], v210 offset:24576
    ds_read_b64_tr_b16 a[242:243], v210 offset:24832
    ds_read_b64_tr_b16 a[244:245], v210 offset:28672
    ds_read_b64_tr_b16 a[246:247], v210 offset:28928
    ds_read_b64_tr_b16 a[248:249], v211 offset:24576
    ds_read_b64_tr_b16 a[250:251], v211 offset:24832
    ds_read_b64_tr_b16 a[252:253], v211 offset:28672
    ds_read_b64_tr_b16 a[254:255], v211 offset:28928
    s_waitcnt lgkmcnt(0)
    s_mov_b32 s88, 0
    v_mov_b32 v246, 72
L_rdy_5:
    s_add_u32 s88, s88, 1
    s_mov_b32 s89, 2
    s_cmp_ge_u32 s88, 262144
    s_cbranch_scc1 L_abort
    buffer_load_dword v247, v246, s[36:39], 0 offen sc1
    s_mul_i32 s89, s2, 34
    s_add_u32 s89, s89, 136
    s_waitcnt vmcnt(0)
    v_cmp_gt_u32 vcc, s89, v247
    s_cbranch_vccnz L_rdy_5
    s_cmp_ge_u32 s30, 2
    s_cbranch_scc1 L_ci_noM
    s_mov_b32 s44, s12
    s_and_b32 s45, s13, 0xffff
    s_mov_b32 s46, 0x4000
    s_mov_b32 s47, 0x00020000
    s_lshl_b32 s72, s54, 6
    s_lshl_b32 s73, s30, 4
    s_add_u32 s72, s72, s73
    v_mov_b32 v203, 0x0
    v_and_b32 v246, 0x800, v240
    v_xor_b32 v203, v203, v246
    v_and_b32 v246, 0x1000, v241
    v_xor_b32 v203, v203, v246
    v_and_b32 v246, 0x2000, v242
    v_xor_b32 v203, v203, v246
    v_and_b32 v246, 0x8, v243
    v_xor_b32 v203, v203, v246
    v_and_b32 v246, 0x20, v244
    v_xor_b32 v203, v203, v246
    v_add_u32 v203, s72, v203
    buffer_load_dwordx2 v[120:121], v203, s[44:47], 0 offen
    s_waitcnt vmcnt(0)
    v_min_u32 v120, 0xfffffffe, v120
    v_min_u32 v121, 0xfffffffe, v121
    buffer_store_dwordx2 v[120:121], v3, s[32:35], 0 offen sc1
L_ci_noM:
    s_barrier
    s_mov_b32 s69, 0
    s_mov_b32 s53, 0
    s_mov_b32 s55, 0
    s_cmp_lg_u32 s30, 3
    s_cbranch_scc1 L_ci_noX
    s_mov_b32 s88, 0
L_wf_6:
    s_add_u32 s88, s88, 1
    s_mov_b32 s89, 3
    s_cmp_ge_u32 s88, 262144
    s_cbranch_scc1 L_abort
    buffer_load_dword v247, v17, s[32:35], 0 offen sc1
    s_waitcnt vmcnt(0)
    v_cmp_gt_u32 vcc, 1, v247
    s_cbranch_vccnz L_wf_6
    s_add_u32 m0, s53, 0
    s_add_u32 s72, s69, 4194304
    buffer_load_dwordx4 v10, s[32:35], s72 offen offset:0 lds
    buffer_load_dwordx4 v10, s[32:35], s72 offen offset:1024 lds
    buffer_load_dwordx4 v10, s[32:35], s72 offen offset:2048 lds
    buffer_load_dwordx4 v10, s[32:35], s72 offen offset:3072 lds
    s_add_u32 m0, s53, 4096
    s_add_u32 s72, s69, 4198400
    buffer_load_dwordx4 v10, s[32:35], s72 offen offset:0 lds
    buffer_load_dwordx4 v10, s[32:35], s72 offen offset:1024 lds
    buffer_load_dwordx4 v10, s[32:35], s72 offen offset:2048 lds
    buffer_load_dwordx4 v10, s[32:35], s72 offen offset:3072 lds
    s_add_u32 m0, s53, 8192
    s_add_u32 s72, s69, 37748736
    buffer_load_dwordx4 v15, s[32:35], s72 offen offset:0 lds
    buffer_load_dwordx4 v15, s[32:35], s72 offen offset:1024 lds
    s_add_u32 m0, s53, 10240
    s_add_u32 s72, s69, 71303168
    buffer_load_dwordx4 v10, s[32:35], s72 offen offset:0 lds
    buffer_load_dwordx4 v10, s[32:35], s72 offen offset:1024 lds
    buffer_load_dwordx4 v10, s[32:35], s72 offen offset:2048 lds
    buffer_load_dwordx4 v10, s[32:35], s72 offen offset:3072 lds
    s_add_u32 m0, s53, 14336
    s_add_u32 s72, s69, 71307264
    buffer_load_dwordx4 v10, s[32:35], s72 offen offset:0 lds
    buffer_load_dwordx4 v10, s[32:35], s72 offen offset:1024 lds
    buffer_load_dwordx4 v10, s[32:35], s72 offen offset:2048 lds
    buffer_load_dwordx4 v10, s[32:35], s72 offen offset:3072 lds
L_ci_noX:
    v_mov_b32 v48, 0
    v_mov_b32 v49, 0
    v_mov_b32 v50, 0
    v_mov_b32 v51, 0
    v_mov_b32 v52, 0
    v_mov_b32 v53, 0
    v_mov_b32 v54, 0
    v_mov_b32 v55, 0
    v_mov_b32 v56, 0
    v_mov_b32 v57, 0
    v_mov_b32 v58, 0
    v_mov_b32 v59, 0
    v_mov_b32 v60, 0
    v_mov_b32 v61, 0
    v_mov_b32 v62, 0
    v_mov_b32 v63, 0
    v_mov_b32 v64, 0
    v_mov_b32 v65, 0
    v_mov_b32 v66, 0
    v_mov_b32 v67, 0
    v_mov_b32 v68, 0
    v_mov_b32 v69, 0
    v_mov_b32 v70, 0
    v_mov_b32 v71, 0
    v_mov_b32 v72, 0
    v_mov_b32 v73, 0
    v_mov_b32 v74, 0
    v_mov_b32 v75, 0
    v_mov_b32 v76, 0
    v_mov_b32 v77, 0
    v_mov_b32 v78, 0
    v_mov_b32 v79, 0
    v_mov_b32 v80, 0
    v_mov_b32 v81, 0
    v_mov_b32 v82, 0
    v_mov_b32 v83, 0
    v_mov_b32 v84, 0
    v_mov_b32 v85, 0
    v_mov_b32 v86, 0
    v_mov_b32 v87, 0
    s_mov_b32 s60, 0
    s_and_b32 s72, s60, 3
    s_lshl_b32 s61, s72, 14
    s_mul_i32 s62, s72, 24576
    s_lshl_b32 s63, s72, 18
    s_xor_b32 s73, s72, 2
    s_lshl_b32 s64, s73, 14
    s_mul_i32 s65, s73, 24576
    s_lshl_b32 s66, s73, 18
    s_xor_b32 s53, s53, 0x8000
    s_sub_u32 s54, s60, 1
    s_lshl_b32 s68, s54, 14
    s_cmp_eq_u32 s60, 0
    s_cselect_b32 s68, 0x40000000, s68
    s_max_i32 s54, s54, 0
    s_add_u32 s69, s69, 16384
    s_add_u32 s70, s60, 2
    s_waitcnt vmcnt(0)
    s_barrier
    s_and_b32 s72, s30, 1
    s_cmp_eq_u32 s72, 1
    s_cselect_b64 s[96:97], -1, 0
    v_mov_b32 v248, 0x7f800000
    s_mov_b32 s86, 0xf0000
    s_mov_b32 s87, 0xfff00ff
    v_mov_b32 v246, 0xd028965f
    v_cndmask_b32 v248, v248, v246, s[86:87]
    v_mov_b32 v252, 0xd028965f
    v_cndmask_b32 v252, v252, v248, s[96:97]
    v_mov_b32 v246, 0x7f800000
    v_cndmask_b32 v248, v248, v246, s[96:97]
    v_mov_b32 v249, 0x7f800000
    s_mov_b32 s86, 0x1f0001
    s_mov_b32 s87, 0x1fff01ff
    v_mov_b32 v246, 0xd028965f
    v_cndmask_b32 v249, v249, v246, s[86:87]
    v_mov_b32 v253, 0xd028965f
    v_cndmask_b32 v253, v253, v249, s[96:97]
    v_mov_b32 v246, 0x7f800000
    v_cndmask_b32 v249, v249, v246, s[96:97]
    v_mov_b32 v250, 0x7f800000
    s_mov_b32 s86, 0x3f0003
    s_mov_b32 s87, 0x3fff03ff
    v_mov_b32 v246, 0xd028965f
    v_cndmask_b32 v250, v250, v246, s[86:87]
    v_mov_b32 v254, 0xd028965f
    v_cndmask_b32 v254, v254, v250, s[96:97]
    v_mov_b32 v246, 0x7f800000
    v_cndmask_b32 v250, v250, v246, s[96:97]
    v_mov_b32 v251, 0xd028965f
    s_mov_b32 s86, 0xff80fff8
    s_mov_b32 s87, 0x8000f800
    v_mov_b32 v246, 0x7f800000
    v_cndmask_b32 v251, v251, v246, s[86:87]
    v_mov_b32 v255, 0xd028965f
    v_cndmask_b32 v255, v255, v251, s[96:97]
    v_mov_b32 v246, 0x7f800000
    v_cndmask_b32 v251, v251, v246, s[96:97]
    v_mov_b32 v208, 0x3f803f80
    v_mov_b32 v209, 0x3f803f80
    v_mov_b32 v210, 0x3f803f80
    v_mov_b32 v211, 0x3f803f80
    s_cmp_lg_u32 s52, 0
    s_cbranch_scc1 L_step_s
L_step_f:
    s_mov_b32 s88, 0
    buffer_load_dwordx4 v[32:35], v2, s[32:35], s61 offen offset:0 sc1
    buffer_load_dwordx4 v[36:39], v2, s[32:35], s61 offen offset:1024 sc1
    buffer_load_dwordx4 v[40:43], v2, s[32:35], s61 offen offset:2048 sc1
    buffer_load_dwordx4 v[44:47], v2, s[32:35], s61 offen offset:3072 sc1
    s_waitcnt vmcnt(3)
    v_max3_u32 v223, v32, v33, v34
    v_max_u32 v223, v223, v35
    v_cmp_eq_u32 vcc, s75, v223
    s_cbranch_vccnz L_Af_r0
L_Af_k0:
    s_waitcnt vmcnt(2)
    v_smfmac_f32_16x16x64_bf16 v[48:51], v[32:35], a[0:7], v16
    v_max3_u32 v223, v36, v37, v38
    v_smfmac_f32_16x16x64_bf16 v[52:55], v[32:35], a[8:15], v16
    v_max_u32 v223, v223, v39
    v_smfmac_f32_16x16x64_bf16 v[56:59], v[32:35], a[16:23], v16
    v_cmp_eq_u32 vcc, s75, v223
    v_smfmac_f32_16x16x64_bf16 v[60:63], v[32:35], a[24:31], v16
    s_cbranch_vccnz L_Af_r1
L_Af_k1:
    s_waitcnt vmcnt(1)
    v_smfmac_f32_16x16x64_bf16 v[48:51], v[36:39], a[48:55], v16
    v_max3_u32 v223, v40, v41, v42
    v_smfmac_f32_16x16x64_bf16 v[52:55], v[36:39], a[56:63], v16
    v_max_u32 v223, v223, v43
    v_smfmac_f32_16x16x64_bf16 v[56:59], v[36:39], a[64:71], v16
    v_cmp_eq_u32 vcc, s75, v223
    v_smfmac_f32_16x16x64_bf16 v[60:63], v[36:39], a[72:79], v16
    s_cbranch_vccnz L_Af_r2
L_Af_k2:
    s_waitcnt vmcnt(0)
    v_smfmac_f32_16x16x64_bf16 v[48:51], v[40:43], a[96:103], v16
    v_max3_u32 v223, v44, v45, v46
    v_smfmac_f32_16x16x64_bf16 v[52:55], v[40:43], a[104:111], v16
    v_max_u32 v223, v223, v47
    v_smfmac_f32_16x16x64_bf16 v[56:59], v[40:43], a[112:119], v16
    v_cmp_eq_u32 vcc, s75, v223
    v_smfmac_f32_16x16x64_bf16 v[60:63], v[40:43], a[120:127], v16
    s_cbranch_vccnz L_Af_r3
L_Af_k3:
    v_smfmac_f32_16x16x64_bf16 v[48:51], v[44:47], a[144:151], v16
    v_smfmac_f32_16x16x64_bf16 v[52:55], v[44:47], a[152:159], v16
    v_smfmac_f32_16x16x64_bf16 v[56:59], v[44:47], a[160:167], v16
    v_smfmac_f32_16x16x64_bf16 v[60:63], v[44:47], a[168:175], v16
    v_smfmac_f32_16x16x64_bf16 v[64:67], v[32:35], a[32:39], v16
    v_smfmac_f32_16x16x64_bf16 v[68:71], v[32:35], a[40:47], v16
    s_nop 2
    v_cvt_pk_bf16_f32 v88, v48, v49
    v_cvt_pk_bf16_f32 v89, v50, v51
    v_cvt_pk_bf16_f32 v90, v52, v53
    v_cvt_pk_bf16_f32 v91, v54, v55
    ds_write_b128 v11, v[88:91] offset:0
    v_cvt_pk_bf16_f32 v92, v56, v57
    v_cvt_pk_bf16_f32 v93, v58, v59
    v_cvt_pk_bf16_f32 v94, v60, v61
    v_cvt_pk_bf16_f32 v95, v62, v63
    ds_write_b128 v11, v[92:95] offset:4096
    s_waitcnt lgkmcnt(0)
    s_barrier
    s_cmp_ge_u32 s30, 2
    s_cbranch_scc1 L_w23_f
    ds_read_b128 v[100:103], v12 offset:0
    ds_read_b128 v[104:107], v12 offset:1024
    ds_read_b128 v[108:111], v12 offset:2048
    ds_read_b128 v[112:115], v12 offset:3072
    v_smfmac_f32_16x16x64_bf16 v[64:67], v[36:39], a[80:87], v16
    v_smfmac_f32_16x16x64_bf16 v[68:71], v[36:39], a[88:95], v16
    v_smfmac_f32_16x16x64_bf16 v[64:67], v[40:43], a[128:135], v16
    s_waitcnt lgkmcnt(3)
    v_mfma_f32_16x16x32_bf16 v[116:119], v[100:103], v[24:27], 0
    s_waitcnt lgkmcnt(2)
    v_mfma_f32_16x16x32_bf16 v[116:119], v[104:107], v[24:27], v[116:119]
    s_waitcnt lgkmcnt(1)
    v_mfma_f32_16x16x32_bf16 v[116:119], v[108:111], v[24:27], v[116:119]
    s_waitcnt lgkmcnt(0)
    v_mfma_f32_16x16x32_bf16 v[116:119], v[112:115], v[24:27], v[116:119]
    s_nop 7
    v_cvt_pk_bf16_f32 v120, v116, v117
    v_cvt_pk_bf16_f32 v121, v118, v119
    buffer_store_dwordx2 v[120:121], v4, s[32:35], s62 offen
    v_smfmac_f32_16x16x64_bf16 v[68:71], v[40:43], a[136:143], v16
    v_smfmac_f32_16x16x64_bf16 v[64:67], v[44:47], a[176:183], v16
    v_smfmac_f32_16x16x64_bf16 v[68:71], v[44:47], a[184:191], v16
    s_nop 6
    v_cvt_pk_bf16_f32 v96, v64, v65
    v_cvt_pk_bf16_f32 v97, v66, v67
    v_cvt_pk_bf16_f32 v98, v68, v69
    v_cvt_pk_bf16_f32 v99, v70, v71
    ds_write_b128 v11, v[96:99] offset:8192
    s_waitcnt lgkmcnt(0)
    s_barrier
    s_cmp_eq_u32 s60, 63
    s_cbranch_scc1 L_chain_w01
    s_barrier
    buffer_store_dwordx2 v[20:21], v7, s[32:35], s66 offen sc1
    buffer_store_dwordx2 v[20:21], v3, s[32:35], s64 offen
    buffer_store_dwordx2 v[20:21], v4, s[32:35], s65 offen
    s_cmp_eq_u32 s30, 1
    s_cbranch_scc1 L_w01j_f
    buffer_store_dwordx4 v[20:23], v123, s[32:35], s65 offen
L_w01j_f:
    v_mov_b32 v64, 0
    v_mov_b32 v65, 0
    v_mov_b32 v66, 0
    v_mov_b32 v67, 0
    v_mov_b32 v68, 0
    v_mov_b32 v69, 0
    v_mov_b32 v70, 0
    v_mov_b32 v71, 0
    s_waitcnt vmcnt(0)
    s_branch L_b3_f
L_w23_f:
    v_smfmac_f32_16x16x64_bf16 v[64:67], v[36:39], a[80:87], v16
    v_smfmac_f32_16x16x64_bf16 v[68:71], v[36:39], a[88:95], v16
    v_smfmac_f32_16x16x64_bf16 v[64:67], v[40:43], a[128:135], v16
    v_smfmac_f32_16x16x64_bf16 v[68:71], v[40:43], a[136:143], v16
    v_smfmac_f32_16x16x64_bf16 v[64:67], v[44:47], a[176:183], v16
    v_smfmac_f32_16x16x64_bf16 v[68:71], v[44:47], a[184:191], v16
    s_cmp_eq_u32 s30, 3
    s_cbranch_scc1 L_w3_f
    ds_read_b128 v[144:147], v14 offset:0
    ds_read_b128 v[148:151], v14 offset:1024
    ds_read_b128 v[152:155], v14 offset:2048
    ds_read_b128 v[156:159], v14 offset:3072
    ds_read_b128 v[160:163], v14 offset:4096
    ds_read_b128 v[164:167], v14 offset:5120
    ds_read_b128 v[168:171], v14 offset:6144
    ds_read_b128 v[172:175], v14 offset:7168
    ds_read_b128 v[176:179], v14 offset:8192
    ds_read_b128 v[180:183], v14 offset:9216
    v_mov_b32 v48, 0
    v_mov_b32 v49, 0
    v_mov_b32 v50, 0
    v_mov_b32 v51, 0
    v_mov_b32 v52, 0
    v_mov_b32 v53, 0
    v_mov_b32 v54, 0
    v_mov_b32 v55, 0
    v_mov_b32 v56, 0
    v_mov_b32 v57, 0
    v_mov_b32 v58, 0
    v_mov_b32 v59, 0
    v_mov_b32 v60, 0
    v_mov_b32 v61, 0
    v_mov_b32 v62, 0
    v_mov_b32 v63, 0
    v_cvt_pk_bf16_f32 v96, v64, v65
    v_cvt_pk_bf16_f32 v97, v66, v67
    v_cvt_pk_bf16_f32 v98, v68, v69
    v_cvt_pk_bf16_f32 v99, v70, v71
    ds_write_b128 v11, v[96:99] offset:8192
    s_waitcnt lgkmcnt(0)
    s_barrier
    s_cmp_eq_u32 s60, 63
    s_cbranch_scc1 L_chain_fin2
    s_mov_b32 s88, 0
    buffer_load_dwordx4 v[128:131], v5, s[32:35], s62 offen offset:0 sc1
    buffer_load_dwordx4 v[132:135], v5, s[32:35], s62 offen offset:1024 sc1
    buffer_load_dwordx4 v[136:139], v5, s[32:35], s62 offen offset:2048 sc1
    buffer_load_dwordx4 v[140:143], v5, s[32:35], s62 offen offset:3072 sc1
    ds_read_b128 v[100:103], v12 offset:0
    ds_read_b128 v[104:107], v12 offset:1024
    ds_read_b128 v[108:111], v12 offset:2048
    ds_read_b128 v[112:115], v12 offset:3072
    s_waitcnt lgkmcnt(3)
    v_mfma_f32_16x16x32_bf16 v[116:119], v[24:27], v[100:103], 0
    s_waitcnt lgkmcnt(2)
    v_mfma_f32_16x16x32_bf16 v[116:119], v[24:27], v[104:107], v[116:119]
    s_waitcnt lgkmcnt(1)
    v_mfma_f32_16x16x32_bf16 v[116:119], v[24:27], v[108:111], v[116:119]
    s_waitcnt lgkmcnt(0)
    v_mfma_f32_16x16x32_bf16 v[116:119], v[24:27], v[112:115], v[116:119]
    s_waitcnt vmcnt(3)
    v_max3_u32 v223, v128, v129, v130
    v_max_u32 v223, v223, v131
    v_cmp_eq_u32 vcc, s75, v223
    s_cbranch_vccnz L_Bf_r0
L_Bf_k0:
    s_waitcnt vmcnt(2)
    v_mfma_f32_16x16x32_bf16 v[184:187], v[144:147], v[128:131], 0
    v_max3_u32 v223, v132, v133, v134
    v_mfma_f32_16x16x32_bf16 v[188:191], v[152:155], v[128:131], 0
    v_max_u32 v223, v223, v135
    v_mfma_f32_16x16x32_bf16 v[192:195], v[148:151], v[128:131], 0
    v_cmp_eq_u32 vcc, s75, v223
    v_mfma_f32_16x16x32_bf16 v[196:199], v[156:159], v[128:131], 0
    s_cbranch_vccnz L_Bf_r1
L_Bf_k1:
    s_waitcnt vmcnt(1)
    v_mfma_f32_16x16x32_bf16 v[184:187], v[160:163], v[132:135], v[184:187]
    v_max3_u32 v223, v136, v137, v138
    v_mfma_f32_16x16x32_bf16 v[188:191], v[168:171], v[132:135], v[188:191]
    v_max_u32 v223, v223, v139
    v_mfma_f32_16x16x32_bf16 v[192:195], v[164:167], v[132:135], v[192:195]
    v_cmp_eq_u32 vcc, s75, v223
    v_mfma_f32_16x16x32_bf16 v[196:199], v[172:175], v[132:135], v[196:199]
    s_cbranch_vccnz L_Bf_r2
L_Bf_k2:
    s_waitcnt vmcnt(0)
    v_mfma_f32_16x16x32_bf16 v[200:203], v[136:139], v[128:131], 0
    v_max3_u32 v223, v140, v141, v142
    v_add_f32_dpp v184, v188, v184 row_ror:8 row_mask:0xf bank_mask:0xf
    v_max_u32 v223, v223, v143
    v_add_f32_dpp v185, v189, v185 row_ror:8 row_mask:0xf bank_mask:0xf
    v_cmp_eq_u32 vcc, s75, v223
    v_add_f32_dpp v186, v190, v186 row_ror:8 row_mask:0xf bank_mask:0xf
    v_add_f32_dpp v187, v191, v187 row_ror:8 row_mask:0xf bank_mask:0xf
    v_add_f32_dpp v192, v196, v192 row_ror:8 row_mask:0xf bank_mask:0xf
    v_add_f32_dpp v193, v197, v193 row_ror:8 row_mask:0xf bank_mask:0xf
    v_add_f32_dpp v194, v198, v194 row_ror:8 row_mask:0xf bank_mask:0xf
    v_add_f32_dpp v195, v199, v195 row_ror:8 row_mask:0xf bank_mask:0xf
    s_cbranch_vccnz L_Bf_r3
L_Bf_k3:
    v_mfma_f32_16x16x32_bf16 v[200:203], v[140:143], v[132:135], v[200:203]
    s_barrier
    v_max3_f32 v222, v184, v185, v186
    v_max3_f32 v222, v222, v187, v192
    v_max3_f32 v222, v222, v193, v194
    v_cvt_pk_bf16_f32 v120, v116, v117
    v_cvt_pk_bf16_f32 v121, v118, v119
    s_nop 1
    v_mov_b32 v204, v200
    v_mov_b32 v205, v201
    v_mov_b32 v206, v202
    v_mov_b32 v207, v203
    v_permlane32_swap_b32 v200, v204
    v_permlane32_swap_b32 v201, v205
    v_permlane32_swap_b32 v202, v206
    v_permlane32_swap_b32 v203, v207
    v_add_f32_dpp v200, v204, v200 row_ror:8 row_mask:0xf bank_mask:0xf
    v_add_f32_dpp v201, v205, v201 row_ror:8 row_mask:0xf bank_mask:0xf
    v_add_f32_dpp v202, v206, v202 row_ror:8 row_mask:0xf bank_mask:0xf
    v_add_f32_dpp v203, v207, v203 row_ror:8 row_mask:0xf bank_mask:0xf
    v_max3_f32 v222, v222, v195, v200
    v_max3_f32 v222, v222, v201, v202
    v_max_f32 v222, v222, v203
    v_mov_b32 v204, v222
    s_nop 1
    v_permlane16_swap_b32 v222, v204
    v_max_f32 v222, v222, v204
    v_mov_b32 v204, v222
    s_nop 1
    v_permlane32_swap_b32 v222, v204
    v_max_f32 v222, v222, v204
    v_mul_f32 v226, s71, v222
    v_fma_f32 v184, v184, s71, -v226
    v_fma_f32 v185, v185, s71, -v226
    v_fma_f32 v186, v186, s71, -v226
    v_fma_f32 v187, v187, s71, -v226
    v_fma_f32 v192, v192, s71, -v226
    v_fma_f32 v193, v193, s71, -v226
    v_fma_f32 v194, v194, s71, -v226
    v_fma_f32 v195, v195, s71, -v226
    v_exp_f32 v184, v184
    v_exp_f32 v185, v185
    v_exp_f32 v186, v186
    v_exp_f32 v187, v187
    v_exp_f32 v192, v192
    v_exp_f32 v193, v193
    v_exp_f32 v194, v194
    v_exp_f32 v195, v195
    v_fma_f32 v200, v200, s71, -v226
    v_fma_f32 v201, v201, s71, -v226
    v_cvt_pk_bf16_f32 v212, v184, v185
    v_cvt_pk_bf16_f32 v213, v186, v187
    v_cvt_pk_bf16_f32 v214, v192, v193
    v_cvt_pk_bf16_f32 v215, v194, v195
    v_fma_f32 v202, v202, s71, -v226
    v_fma_f32 v203, v203, s71, -v226
    v_mfma_f32_16x16x32_bf16 v[228:231], v[176:179], v[212:215], 0
    v_exp_f32 v200, v200
    v_mfma_f32_16x16x32_bf16 v[232:235], v[180:183], v[212:215], 0
    v_exp_f32 v201, v201
    v_mfma_f32_16x16x32_bf16 v[196:199], v[208:211], v[212:215], 0
    v_exp_f32 v202, v202
    v_exp_f32 v203, v203
    v_cvt_pk_bf16_f32 v206, v200, v201
    v_cvt_pk_bf16_f32 v207, v202, v203
    v_cndmask_b32 v216, 0, v206, s[90:91]
    v_cndmask_b32 v217, 0, v207, s[90:91]
    v_cndmask_b32 v218, 0, v206, s[92:93]
    v_cndmask_b32 v219, 0, v207, s[92:93]
    v_mfma_f32_16x16x16_bf16 v[196:199], v[208:209], v[216:217], v[196:199]
    v_mfma_f32_16x16x16_bf16 v[228:231], v[120:121], v[216:217], v[228:231]
    v_mfma_f32_16x16x16_bf16 v[232:235], v[120:121], v[218:219], v[232:235]
    v_mov_b32 v64, 0
    v_mov_b32 v65, 0
    v_mov_b32 v66, 0
    v_mov_b32 v67, 0
    v_mov_b32 v68, 0
    v_mov_b32 v69, 0
    v_rcp_f32 v220, v196
    s_nop 0
    v_pk_mul_f32 v[228:229], v[228:229], v[220:221] op_sel_hi:[1,0]
    v_pk_mul_f32 v[230:231], v[230:231], v[220:221] op_sel_hi:[1,0]
    v_pk_mul_f32 v[232:233], v[232:233], v[220:221] op_sel_hi:[1,0]
    v_pk_mul_f32 v[234:235], v[234:235], v[220:221] op_sel_hi:[1,0]
    v_cvt_pk_bf16_f32 v124, v228, v229
    v_cvt_pk_bf16_f32 v125, v230, v231
    v_cvt_pk_bf16_f32 v126, v232, v233
    v_cvt_pk_bf16_f32 v127, v234, v235
    buffer_store_dwordx4 v[124:127], v4, s[32:35], s62 offen
    v_mov_b32 v70, 0
    v_mov_b32 v71, 0
    s_branch L_b3_f
L_w3_f:
    v_mov_b32 v48, 0
    v_mov_b32 v49, 0
    v_mov_b32 v50, 0
    v_mov_b32 v51, 0
    v_mov_b32 v52, 0
    v_mov_b32 v53, 0
    v_mov_b32 v54, 0
    v_mov_b32 v55, 0
    v_mov_b32 v56, 0
    v_mov_b32 v57, 0
    v_mov_b32 v58, 0
    v_mov_b32 v59, 0
    v_mov_b32 v60, 0
    v_mov_b32 v61, 0
    v_mov_b32 v62, 0
    v_mov_b32 v63, 0
    v_cvt_pk_bf16_f32 v96, v64, v65
    v_cvt_pk_bf16_f32 v97, v66, v67
    v_cvt_pk_bf16_f32 v98, v68, v69
    v_cvt_pk_bf16_f32 v99, v70, v71
    ds_write_b128 v11, v[96:99] offset:8192
    s_waitcnt lgkmcnt(0)
    s_barrier
    s_cmp_eq_u32 s60, 63
    s_cbranch_scc1 L_chain_fin3
    s_barrier
    ds_read_b128 v[100:103], v13 offset:0
    ds_read_b128 v[104:107], v13 offset:1024
    ds_read_b128 v[108:111], v13 offset:2048
    ds_read_b128 v[112:115], v13 offset:3072
    ds_read_b128 v[144:147], v14 offset:0
    ds_read_b128 v[148:151], v14 offset:1024
    ds_read_b128 v[152:155], v14 offset:2048
    ds_read_b128 v[156:159], v14 offset:3072
    ds_read_b128 v[160:163], v14 offset:4096
    ds_read_b128 v[164:167], v14 offset:5120
    ds_read_b128 v[168:171], v14 offset:6144
    ds_read_b128 v[172:175], v14 offset:7168
    ds_read_b128 v[176:179], v14 offset:8192
    ds_read_b128 v[180:183], v14 offset:9216
    ds_read_b128 v[32:35], v225 offset:0
    ds_read_b128 v[36:39], v225 offset:2048
    ds_read_b128 v[40:43], v225 offset:4096
    ds_read_b128 v[44:47], v225 offset:6144
    v_mov_b32 v64, 0
    v_mov_b32 v65, 0
    v_mov_b32 v66, 0
    v_mov_b32 v67, 0
    v_mov_b32 v68, 0
    v_mov_b32 v69, 0
    v_mov_b32 v70, 0
    v_mov_b32 v71, 0
    s_waitcnt lgkmcnt(14)
    v_mfma_f32_16x16x32_bf16 v[116:119], v[24:27], v[100:103], 0
    v_mfma_f32_16x16x32_bf16 v[116:119], v[24:27], v[104:107], v[116:119]
    v_mfma_f32_16x16x32_bf16 v[116:119], v[24:27], v[108:111], v[116:119]
    v_mfma_f32_16x16x32_bf16 v[116:119], v[24:27], v[112:115], v[116:119]
    buffer_load_dwordx4 v[100:103], v122, s[32:35], s62 offen offset:0 sc1
    buffer_load_dwordx4 v[104:107], v122, s[32:35], s62 offen offset:512 sc1
    buffer_load_dwordx4 v[108:111], v122, s[32:35], s62 offen offset:1024 sc1
    buffer_load_dwordx4 v[112:115], v122, s[32:35], s62 offen offset:1536 sc1
    s_nop 3
    v_cvt_pk_bf16_f32 v120, v116, v117
    v_cvt_pk_bf16_f32 v121, v118, v119
    s_cmp_lt_u32 s55, s70
    s_cbranch_scc1 L_Fw_f
L_Fok_f:
L_b3_f:
    s_barrier
    s_mov_b32 s88, 0
    buffer_load_dwordx4 v[128:131], v6, s[32:35], s62 offen offset:0 sc1
    buffer_load_dwordx4 v[132:135], v6, s[32:35], s62 offen offset:1024 sc1
    s_waitcnt vmcnt(1)
    v_max3_u32 v223, v128, v129, v130
    v_max_u32 v223, v223, v131
    v_cmp_eq_u32 vcc, s75, v223
    s_cbranch_vccnz L_Of_r0
L_Of_k0:
    v_smfmac_f32_16x16x64_bf16 v[72:75], v[128:131], a[192:199], v16
    v_smfmac_f32_16x16x64_bf16 v[76:79], v[128:131], a[200:207], v16
    s_waitcnt vmcnt(0)
    v_smfmac_f32_16x16x64_bf16 v[80:83], v[128:131], a[208:215], v16
    v_max3_u32 v223, v132, v133, v134
    v_max_u32 v223, v223, v135
    v_smfmac_f32_16x16x64_bf16 v[84:87], v[128:131], a[216:223], v16
    v_cmp_eq_u32 vcc, s75, v223
    s_cbranch_vccnz L_Of_r1
L_Of_k1:
    v_smfmac_f32_16x16x64_bf16 v[72:75], v[132:135], a[224:231], v16
    v_smfmac_f32_16x16x64_bf16 v[76:79], v[132:135], a[232:239], v16
    v_smfmac_f32_16x16x64_bf16 v[80:83], v[132:135], a[240:247], v16
    v_smfmac_f32_16x16x64_bf16 v[84:87], v[132:135], a[248:255], v16
    s_cmp_lg_u32 s30, 2
    s_cbranch_scc1 L_nokd_f
    buffer_load_dwordx4 v[100:103], v122, s[32:35], s62 offen offset:0 sc1
    buffer_load_dwordx4 v[104:107], v122, s[32:35], s62 offen offset:512 sc1
    buffer_load_dwordx4 v[108:111], v122, s[32:35], s62 offen offset:1024 sc1
    buffer_load_dwordx4 v[112:115], v122, s[32:35], s62 offen offset:1536 sc1
L_nokd_f:
    s_nop 2
    v_cvt_pk_bf16_f32 v88, v72, v73
    v_cvt_pk_bf16_f32 v89, v74, v75
    v_cvt_pk_bf16_f32 v90, v76, v77
    v_cvt_pk_bf16_f32 v91, v78, v79
    ds_write_b128 v11, v[88:91] offset:12288
    v_cvt_pk_bf16_f32 v92, v80, v81
    v_cvt_pk_bf16_f32 v93, v82, v83
    v_cvt_pk_bf16_f32 v94, v84, v85
    v_cvt_pk_bf16_f32 v95, v86, v87
    ds_write_b128 v11, v[92:95] offset:16384
    s_waitcnt lgkmcnt(0)
    s_barrier
    s_cmp_ge_u32 s30, 2
    s_cbranch_scc1 L_tail23_f
    ds_read_b128 v[100:103], v12 offset:12288
    ds_read_b128 v[104:107], v12 offset:13312
    ds_read_b128 v[108:111], v12 offset:14336
    ds_read_b128 v[112:115], v12 offset:15360
    s_waitcnt lgkmcnt(3)
    v_mfma_f32_16x16x32_bf16 v[116:119], v[100:103], v[24:27], 0
    s_waitcnt lgkmcnt(2)
    v_mfma_f32_16x16x32_bf16 v[116:119], v[104:107], v[24:27], v[116:119]
    s_waitcnt lgkmcnt(1)
    v_mfma_f32_16x16x32_bf16 v[116:119], v[108:111], v[24:27], v[116:119]
    s_waitcnt lgkmcnt(0)
    v_mfma_f32_16x16x32_bf16 v[116:119], v[112:115], v[24:27], v[116:119]
    s_add_u32 s72, s60, 1
    s_and_b32 s72, s72, 3
    s_lshl_b32 s67, s72, 14
    s_nop 4
    v_cvt_pk_bf16_f32 v120, v116, v117
    v_cvt_pk_bf16_f32 v121, v118, v119
    buffer_store_dwordx2 v[120:121], v7, s[32:35], s63 offen sc1
    s_barrier
    v_mov_b32 v72, 0
    v_mov_b32 v73, 0
    v_mov_b32 v74, 0
    v_mov_b32 v75, 0
    v_mov_b32 v76, 0
    v_mov_b32 v77, 0
    v_mov_b32 v78, 0
    v_mov_b32 v79, 0
    v_mov_b32 v80, 0
    v_mov_b32 v81, 0
    v_mov_b32 v82, 0
    v_mov_b32 v83, 0
    v_mov_b32 v84, 0
    v_mov_b32 v85, 0
    v_mov_b32 v86, 0
    v_mov_b32 v87, 0
    v_mov_b32 v56, 0
    v_mov_b32 v57, 0
    v_mov_b32 v58, 0
    v_mov_b32 v59, 0
    v_mov_b32 v60, 0
    v_mov_b32 v61, 0
    v_mov_b32 v62, 0
    v_mov_b32 v63, 0
    s_waitcnt vmcnt(0)
    s_mov_b32 s88, 0
    buffer_load_dwordx4 v[136:139], v8, s[32:35], s63 offen offset:0 sc1
    buffer_load_dwordx4 v[140:143], v8, s[32:35], s63 offen offset:2048 sc1
    s_waitcnt vmcnt(1)
    v_max3_u32 v223, v136, v137, v138
    v_max_u32 v223, v223, v139
    v_cmp_eq_u32 vcc, s75, v223
    s_cbranch_vccnz L_Cf_r0
L_Cf_k0:
    v_mfma_f32_16x16x32_bf16 v[116:119], v[28:31], v[136:139], 0
    s_waitcnt vmcnt(0)
    v_max3_u32 v223, v140, v141, v142
    v_max_u32 v223, v223, v143
    v_cmp_eq_u32 vcc, s75, v223
    s_cbranch_vccnz L_Cf_r1
L_Cf_k1:
    v_mfma_f32_16x16x32_bf16 v[116:119], v[28:31], v[140:143], v[116:119]
    s_add_u32 s60, s60, 1
    s_and_b32 s72, s60, 3
    s_lshl_b32 s61, s72, 14
    s_mul_i32 s62, s72, 24576
    s_lshl_b32 s63, s72, 18
    s_xor_b32 s73, s72, 2
    s_lshl_b32 s64, s73, 14
    s_mul_i32 s65, s73, 24576
    v_cvt_pk_bf16_f32 v120, v116, v117
    v_cvt_pk_bf16_f32 v121, v118, v119
    buffer_store_dwordx2 v[120:121], v3, s[32:35], s67 offen
    s_lshl_b32 s66, s73, 18
    s_xor_b32 s53, s53, 0x8000
    s_sub_u32 s54, s60, 1
    s_lshl_b32 s68, s54, 14
    s_cmp_eq_u32 s60, 0
    s_cselect_b32 s68, 0x40000000, s68
    s_max_i32 s54, s54, 0
    s_add_u32 s69, s69, 16384
    s_add_u32 s70, s60, 2
    v_mov_b32 v48, 0
    v_mov_b32 v49, 0
    v_mov_b32 v50, 0
    v_mov_b32 v51, 0
    v_mov_b32 v52, 0
    v_mov_b32 v53, 0
    v_mov_b32 v54, 0
    v_mov_b32 v55, 0
    s_barrier
    s_branch L_step_f
L_tail23_f:
    s_cmp_eq_u32 s30, 3
    s_cbranch_scc1 L_tail3_f
    ds_read_b128 v[32:35], v225 offset:0
    ds_read_b128 v[36:39], v225 offset:2048
    ds_read_b128 v[40:43], v225 offset:4096
    ds_read_b128 v[44:47], v225 offset:6144
    v_mov_b32 v224, s54
    s_barrier
    buffer_store_dword v224, v19, s[32:35], 0 offen sc1
    buffer_store_dwordx4 v[236:239], v9, s[32:35], s68 offen sc1
    s_waitcnt vmcnt(2) lgkmcnt(0)
    s_branch L_tailj_f
L_tail3_f:
    s_barrier
    buffer_store_dwordx4 v[236:239], v9, s[32:35], s68 offen sc1
    s_add_u32 m0, s53, 0
    s_add_u32 s72, s69, 4194304
    buffer_load_dwordx4 v10, s[32:35], s72 offen offset:0 lds
    buffer_load_dwordx4 v10, s[32:35], s72 offen offset:1024 lds
    buffer_load_dwordx4 v10, s[32:35], s72 offen offset:2048 lds
    buffer_load_dwordx4 v10, s[32:35], s72 offen offset:3072 lds
    s_add_u32 m0, s53, 4096
    s_add_u32 s72, s69, 4198400
    buffer_load_dwordx4 v10, s[32:35], s72 offen offset:0 lds
    buffer_load_dwordx4 v10, s[32:35], s72 offen offset:1024 lds
    buffer_load_dwordx4 v10, s[32:35], s72 offen offset:2048 lds
    buffer_load_dwordx4 v10, s[32:35], s72 offen offset:3072 lds
    s_add_u32 m0, s53, 8192
    s_add_u32 s72, s69, 37748736
    buffer_load_dwordx4 v15, s[32:35], s72 offen offset:0 lds
    buffer_load_dwordx4 v15, s[32:35], s72 offen offset:1024 lds
    s_add_u32 m0, s53, 10240
    s_add_u32 s72, s69, 71303168
    buffer_load_dwordx4 v10, s[32:35], s72 offen offset:0 lds
    buffer_load_dwordx4 v10, s[32:35], s72 offen offset:1024 lds
    buffer_load_dwordx4 v10, s[32:35], s72 offen offset:2048 lds
    buffer_load_dwordx4 v10, s[32:35], s72 offen offset:3072 lds
    s_add_u32 m0, s53, 14336
    s_add_u32 s72, s69, 71307264
    buffer_load_dwordx4 v10, s[32:35], s72 offen offset:0 lds
    buffer_load_dwordx4 v10, s[32:35], s72 offen offset:1024 lds
    buffer_load_dwordx4 v10, s[32:35], s72 offen offset:2048 lds
    buffer_load_dwordx4 v10, s[32:35], s72 offen offset:3072 lds
L_tailj_f:
    v_mfma_f32_16x16x32_bf16 v[184:187], v[144:147], v[32:35], 0
    v_mfma_f32_16x16x32_bf16 v[192:195], v[148:151], v[32:35], 0
    v_mfma_f32_16x16x32_bf16 v[200:203], v[100:103], v[32:35], 0
    v_mfma_f32_16x16x32_bf16 v[184:187], v[152:155], v[36:39], v[184:187]
    v_mfma_f32_16x16x32_bf16 v[192:195], v[156:159], v[36:39], v[192:195]
    v_mfma_f32_16x16x32_bf16 v[200:203], v[104:107], v[36:39], v[200:203]
    v_mfma_f32_16x16x32_bf16 v[184:187], v[160:163], v[40:43], v[184:187]
    v_mfma_f32_16x16x32_bf16 v[192:195], v[164:167], v[40:43], v[192:195]
    v_mfma_f32_16x16x32_bf16 v[200:203], v[108:111], v[40:43], v[200:203]
    v_mfma_f32_16x16x32_bf16 v[184:187], v[168:171], v[44:47], v[184:187]
    v_mfma_f32_16x16x32_bf16 v[192:195], v[172:175], v[44:47], v[192:195]
    v_mfma_f32_16x16x32_bf16 v[200:203], v[112:115], v[44:47], v[200:203]
    s_nop 5
    v_min_f32 v184, v184, v248
    v_min_f32 v185, v185, v249
    v_min_f32 v186, v186, v250
    v_min_f32 v187, v187, v251
    v_min_f32 v192, v192, v252
    v_min_f32 v193, v193, v253
    v_min_f32 v194, v194, v254
    v_min_f32 v195, v195, v255
    v_max3_f32 v222, v184, v185, v186
    v_max3_f32 v222, v222, v187, v192
    v_max3_f32 v222, v222, v193, v194
    v_max3_f32 v222, v222, v195, v200
    v_max3_f32 v222, v222, v201, v202
    v_max_f32 v222, v222, v203
    v_mov_b32 v204, v222
    s_nop 1
    v_permlane16_swap_b32 v222, v204
    v_max_f32 v222, v222, v204
    v_mov_b32 v204, v222
    s_nop 1
    v_permlane32_swap_b32 v222, v204
    v_max_f32 v222, v222, v204
    v_mul_f32 v222, s71, v222
    v_fma_f32 v184, v184, s71, -v222
    v_fma_f32 v185, v185, s71, -v222
    v_fma_f32 v186, v186, s71, -v222
    v_fma_f32 v187, v187, s71, -v222
    v_fma_f32 v192, v192, s71, -v222
    v_fma_f32 v193, v193, s71, -v222
    v_fma_f32 v194, v194, s71, -v222
    v_fma_f32 v195, v195, s71, -v222
    v_fma_f32 v200, v200, s71, -v222
    v_fma_f32 v201, v201, s71, -v222
    v_fma_f32 v202, v202, s71, -v222
    v_fma_f32 v203, v203, s71, -v222
    v_exp_f32 v184, v184
    v_exp_f32 v185, v185
    v_exp_f32 v186, v186
    v_exp_f32 v187, v187
    v_exp_f32 v192, v192
    v_exp_f32 v193, v193
    v_exp_f32 v194, v194
    v_exp_f32 v195, v195
    v_exp_f32 v200, v200
    v_cvt_pk_bf16_f32 v212, v184, v185
    v_cvt_pk_bf16_f32 v213, v186, v187
    v_cvt_pk_bf16_f32 v214, v192, v193
    v_cvt_pk_bf16_f32 v215, v194, v195
    v_exp_f32 v201, v201
    s_nop 0
    v_mfma_f32_16x16x32_bf16 v[228:231], v[176:179], v[212:215], 0
    v_exp_f32 v202, v202
    v_mfma_f32_16x16x32_bf16 v[232:235], v[180:183], v[212:215], 0
    v_exp_f32 v203, v203
    v_cvt_pk_bf16_f32 v206, v200, v201
    v_add_f32 v184, v184, v185
    v_cvt_pk_bf16_f32 v207, v202, v203
    v_cndmask_b32 v216, 0, v206, s[90:91]
    v_cndmask_b32 v217, 0, v207, s[90:91]
    v_cndmask_b32 v218, 0, v206, s[92:93]
    v_cndmask_b32 v219, 0, v207, s[92:93]
    v_mfma_f32_16x16x16_bf16 v[228:231], v[120:121], v[216:217], v[228:231]
    v_add_f32 v200, v200, v201
    v_mfma_f32_16x16x16_bf16 v[232:235], v[120:121], v[218:219], v[232:235]
    v_add_f32 v202, v202, v203
    v_add_f32 v186, v186, v187
    v_add_f32 v192, v192, v193
    v_add_f32 v194, v194, v195
    v_add_f32 v200, v200, v202
    v_add_f32 v184, v184, v186
    v_add_f32 v192, v192, v194
    v_add_f32 v184, v184, v192
    v_fma_f32 v222, v200, 0.5, v184
    v_mov_b32 v204, v222
    s_nop 1
    v_permlane16_swap_b32 v222, v204
    v_add_f32 v222, v222, v204
    v_mov_b32 v204, v222
    s_nop 1
    v_permlane32_swap_b32 v222, v204
    v_add_f32 v222, v222, v204
    v_rcp_f32 v220, v222
    s_nop 0
    v_pk_mul_f32 v[228:229], v[228:229], v[220:221] op_sel_hi:[1,0]
    v_pk_mul_f32 v[230:231], v[230:231], v[220:221] op_sel_hi:[1,0]
    v_pk_mul_f32 v[232:233], v[232:233], v[220:221] op_sel_hi:[1,0]
    v_pk_mul_f32 v[234:235], v[234:235], v[220:221] op_sel_hi:[1,0]
    v_cvt_pk_bf16_f32 v236, v228, v229
    v_cvt_pk_bf16_f32 v237, v230, v231
    v_cvt_pk_bf16_f32 v238, v232, v233
    v_cvt_pk_bf16_f32 v239, v234, v235
    v_xor_b32 v14, 0x8000, v14
    v_xor_b32 v225, 0x8000, v225
    v_mov_b32 v72, 0
    v_mov_b32 v73, 0
    v_mov_b32 v74, 0
    v_mov_b32 v75, 0
    v_mov_b32 v76, 0
    v_mov_b32 v77, 0
    v_mov_b32 v78, 0
    v_mov_b32 v79, 0
    v_mov_b32 v80, 0
    v_mov_b32 v81, 0
    v_mov_b32 v82, 0
    v_mov_b32 v83, 0
    v_mov_b32 v84, 0
    v_mov_b32 v85, 0
    v_mov_b32 v86, 0
    v_mov_b32 v87, 0
    s_add_u32 s60, s60, 1
    s_and_b32 s72, s60, 3
    s_lshl_b32 s61, s72, 14
    s_mul_i32 s62, s72, 24576
    s_lshl_b32 s63, s72, 18
    s_xor_b32 s73, s72, 2
    s_lshl_b32 s64, s73, 14
    s_mul_i32 s65, s73, 24576
    s_lshl_b32 s66, s73, 18
    s_xor_b32 s53, s53, 0x8000
    s_sub_u32 s54, s60, 1
    s_lshl_b32 s68, s54, 14
    s_cmp_eq_u32 s60, 0
    s_cselect_b32 s68, 0x40000000, s68
    s_max_i32 s54, s54, 0
    s_add_u32 s69, s69, 16384
    s_add_u32 s70, s60, 2
    s_waitcnt vmcnt(0)
    s_barrier
    s_branch L_step_f
L_Af_r0:
    s_add_u32 s88, s88, 1
    s_mov_b32 s89, 4
    s_cmp_ge_u32 s88, 262144
    s_cbranch_scc1 L_abort
    buffer_load_dwordx4 v[32:35], v2, s[32:35], s61 offen offset:0 sc1
    buffer_load_dwordx4 v[36:39], v2, s[32:35], s61 offen offset:1024 sc1
    buffer_load_dwordx4 v[40:43], v2, s[32:35], s61 offen offset:2048 sc1
    buffer_load_dwordx4 v[44:47], v2, s[32:35], s61 offen offset:3072 sc1
    s_waitcnt vmcnt(3)
    v_max3_u32 v223, v32, v33, v34
    v_max_u32 v223, v223, v35
    v_cmp_eq_u32 vcc, s75, v223
    s_cbranch_vccnz L_Af_r0
    s_branch L_Af_k0
L_Af_r1:
    s_add_u32 s88, s88, 1
    s_mov_b32 s89, 4
    s_cmp_ge_u32 s88, 262144
    s_cbranch_scc1 L_abort
    buffer_load_dwordx4 v[36:39], v2, s[32:35], s61 offen offset:1024 sc1
    buffer_load_dwordx4 v[40:43], v2, s[32:35], s61 offen offset:2048 sc1
    buffer_load_dwordx4 v[44:47], v2, s[32:35], s61 offen offset:3072 sc1
    s_waitcnt vmcnt(2)
    v_max3_u32 v223, v36, v37, v38
    v_max_u32 v223, v223, v39
    v_cmp_eq_u32 vcc, s75, v223
    s_cbranch_vccnz L_Af_r1
    s_branch L_Af_k1
L_Af_r2:
    s_add_u32 s88, s88, 1
    s_mov_b32 s89, 4
    s_cmp_ge_u32 s88, 262144
    s_cbranch_scc1 L_abort
    buffer_load_dwordx4 v[40:43], v2, s[32:35], s61 offen offset:2048 sc1
    buffer_load_dwordx4 v[44:47], v2, s[32:35], s61 offen offset:3072 sc1
    s_waitcnt vmcnt(1)
    v_max3_u32 v223, v40, v41, v42
    v_max_u32 v223, v223, v43
    v_cmp_eq_u32 vcc, s75, v223
    s_cbranch_vccnz L_Af_r2
    s_branch L_Af_k2
L_Af_r3:
    s_add_u32 s88, s88, 1
    s_mov_b32 s89, 4
    s_cmp_ge_u32 s88, 262144
    s_cbranch_scc1 L_abort
    buffer_load_dwordx4 v[44:47], v2, s[32:35], s61 offen offset:3072 sc1
    s_waitcnt vmcnt(0)
    v_max3_u32 v223, v44, v45, v46
    v_max_u32 v223, v223, v47
    v_cmp_eq_u32 vcc, s75, v223
    s_cbranch_vccnz L_Af_r3
    s_branch L_Af_k3
L_Bf_r0:
    s_add_u32 s88, s88, 1
    s_mov_b32 s89, 5
    s_cmp_ge_u32 s88, 262144
    s_cbranch_scc1 L_abort
    buffer_load_dwordx4 v[128:131], v5, s[32:35], s62 offen offset:0 sc1
    buffer_load_dwordx4 v[132:135], v5, s[32:35], s62 offen offset:1024 sc1
    buffer_load_dwordx4 v[136:139], v5, s[32:35], s62 offen offset:2048 sc1
    buffer_load_dwordx4 v[140:143], v5, s[32:35], s62 offen offset:3072 sc1
    s_waitcnt vmcnt(3)
    v_max3_u32 v223, v128, v129, v130
    v_max_u32 v223, v223, v131
    v_cmp_eq_u32 vcc, s75, v223
    s_cbranch_vccnz L_Bf_r0
    s_branch L_Bf_k0
L_Bf_r1:
    s_add_u32 s88, s88, 1
    s_mov_b32 s89, 5
    s_cmp_ge_u32 s88, 262144
    s_cbranch_scc1 L_abort
    buffer_load_dwordx4 v[132:135], v5, s[32:35], s62 offen offset:1024 sc1
    buffer_load_dwordx4 v[136:139], v5, s[32:35], s62 offen offset:2048 sc1
    buffer_load_dwordx4 v[140:143], v5, s[32:35], s62 offen offset:3072 sc1
    s_waitcnt vmcnt(2)
    v_max3_u32 v223, v132, v133, v134
    v_max_u32 v223, v223, v135
    v_cmp_eq_u32 vcc, s75, v223
    s_cbranch_vccnz L_Bf_r1
    s_branch L_Bf_k1
L_Bf_r2:
    s_add_u32 s88, s88, 1
    s_mov_b32 s89, 5
    s_cmp_ge_u32 s88, 262144
    s_cbranch_scc1 L_abort
    buffer_load_dwordx4 v[136:139], v5, s[32:35], s62 offen offset:2048 sc1
    buffer_load_dwordx4 v[140:143], v5, s[32:35], s62 offen offset:3072 sc1
    s_waitcnt vmcnt(1)
    v_max3_u32 v223, v136, v137, v138
    v_max_u32 v223, v223, v139
    v_cmp_eq_u32 vcc, s75, v223
    s_cbranch_vccnz L_Bf_r2
    s_branch L_Bf_k2
L_Bf_r3:
    s_add_u32 s88, s88, 1
    s_mov_b32 s89, 5
    s_cmp_ge_u32 s88, 262144
    s_cbranch_scc1 L_abort
    buffer_load_dwordx4 v[140:143], v5, s[32:35], s62 offen offset:3072 sc1
    s_waitcnt vmcnt(0)
    v_max3_u32 v223, v140, v141, v142
    v_max_u32 v223, v223, v143
    v_cmp_eq_u32 vcc, s75, v223
    s_cbranch_vccnz L_Bf_r3
    s_branch L_Bf_k3
L_Of_r0:
    s_add_u32 s88, s88, 1
    s_mov_b32 s89, 11
    s_cmp_ge_u32 s88, 262144
    s_cbranch_scc1 L_abort
    buffer_load_dwordx4 v[128:131], v6, s[32:35], s62 offen offset:0 sc1
    buffer_load_dwordx4 v[132:135], v6, s[32:35], s62 offen offset:1024 sc1
    s_waitcnt vmcnt(1)
    v_max3_u32 v223, v128, v129, v130
    v_max_u32 v223, v223, v131
    v_cmp_eq_u32 vcc, s75, v223
    s_cbranch_vccnz L_Of_r0
    s_branch L_Of_k0
L_Of_r1:
    s_add_u32 s88, s88, 1
    s_mov_b32 s89, 11
    s_cmp_ge_u32 s88, 262144
    s_cbranch_scc1 L_abort
    buffer_load_dwordx4 v[132:135], v6, s[32:35], s62 offen offset:1024 sc1
    s_waitcnt vmcnt(0)
    v_max3_u32 v223, v132, v133, v134
    v_max_u32 v223, v223, v135
    v_cmp_eq_u32 vcc, s75, v223
    s_cbranch_vccnz L_Of_r1
    s_branch L_Of_k1
L_Cf_r0:
    s_add_u32 s88, s88, 1
    s_mov_b32 s89, 6
    s_cmp_ge_u32 s88, 262144
    s_cbranch_scc1 L_abort
    buffer_load_dwordx4 v[136:139], v8, s[32:35], s63 offen offset:0 sc1
    buffer_load_dwordx4 v[140:143], v8, s[32:35], s63 offen offset:2048 sc1
    s_waitcnt vmcnt(1)
    v_max3_u32 v223, v136, v137, v138
    v_max_u32 v223, v223, v139
    v_cmp_eq_u32 vcc, s75, v223
    s_cbranch_vccnz L_Cf_r0
    s_branch L_Cf_k0
L_Cf_r1:
    s_add_u32 s88, s88, 1
    s_mov_b32 s89, 6
    s_cmp_ge_u32 s88, 262144
    s_cbranch_scc1 L_abort
    buffer_load_dwordx4 v[140:143], v8, s[32:35], s63 offen offset:2048 sc1
    s_waitcnt vmcnt(0)
    v_max3_u32 v223, v140, v141, v142
    v_max_u32 v223, v223, v143
    v_cmp_eq_u32 vcc, s75, v223
    s_cbranch_vccnz L_Cf_r1
    s_branch L_Cf_k1
L_Fw_f:
    s_mov_b32 s88, 0
L_wf_7:
    s_add_u32 s88, s88, 1
    s_mov_b32 s89, 7
    s_cmp_ge_u32 s88, 262144
    s_cbranch_scc1 L_abort
    buffer_load_dword v18, v17, s[32:35], 0 offen sc1
    s_waitcnt vmcnt(0)
    v_cmp_gt_u32 vcc, s70, v18
    s_cbranch_vccnz L_wf_7
    v_min_u32_dpp v18, v18, v18 row_ror:8 row_mask:0xf bank_mask:0xf
    s_nop 1
    v_min_u32_dpp v18, v18, v18 row_ror:4 row_mask:0xf bank_mask:0xf
    s_nop 1
    v_min_u32_dpp v18, v18, v18 row_ror:2 row_mask:0xf bank_mask:0xf
    s_nop 1
    v_min_u32_dpp v18, v18, v18 row_ror:1 row_mask:0xf bank_mask:0xf
    s_nop 0
    v_readfirstlane_b32 s55, v18
    s_branch L_Fok_f
L_step_s:
    s_mov_b32 s88, 0
    buffer_load_dwordx4 v[32:35], v2, s[32:35], s61 offen offset:0 sc1
    buffer_load_dwordx4 v[36:39], v2, s[32:35], s61 offen offset:1024 sc1
    buffer_load_dwordx4 v[40:43], v2, s[32:35], s61 offen offset:2048 sc1
    buffer_load_dwordx4 v[44:47], v2, s[32:35], s61 offen offset:3072 sc1
    s_waitcnt vmcnt(3)
    v_max3_u32 v223, v32, v33, v34
    v_max_u32 v223, v223, v35
    v_cmp_eq_u32 vcc, s75, v223
    s_cbranch_vccnz L_As_r0
L_As_k0:
    s_waitcnt vmcnt(2)
    v_smfmac_f32_16x16x64_bf16 v[48:51], v[32:35], a[0:7], v16
    v_max3_u32 v223, v36, v37, v38
    v_smfmac_f32_16x16x64_bf16 v[52:55], v[32:35], a[8:15], v16
    v_max_u32 v223, v223, v39
    v_smfmac_f32_16x16x64_bf16 v[56:59], v[32:35], a[16:23], v16
    v_cmp_eq_u32 vcc, s75, v223
    v_smfmac_f32_16x16x64_bf16 v[60:63], v[32:35], a[24:31], v16
    s_cbranch_vccnz L_As_r1
L_As_k1:
    s_waitcnt vmcnt(1)
    v_smfmac_f32_16x16x64_bf16 v[48:51], v[36:39], a[48:55], v16
    v_max3_u32 v223, v40, v41, v42
    v_smfmac_f32_16x16x64_bf16 v[52:55], v[36:39], a[56:63], v16
    v_max_u32 v223, v223, v43
    v_smfmac_f32_16x16x64_bf16 v[56:59], v[36:39], a[64:71], v16
    v_cmp_eq_u32 vcc, s75, v223
    v_smfmac_f32_16x16x64_bf16 v[60:63], v[36:39], a[72:79], v16
    s_cbranch_vccnz L_As_r2
L_As_k2:
    s_waitcnt vmcnt(0)
    v_smfmac_f32_16x16x64_bf16 v[48:51], v[40:43], a[96:103], v16
    v_max3_u32 v223, v44, v45, v46
    v_smfmac_f32_16x16x64_bf16 v[52:55], v[40:43], a[104:111], v16
    v_max_u32 v223, v223, v47
    v_smfmac_f32_16x16x64_bf16 v[56:59], v[40:43], a[112:119], v16
    v_cmp_eq_u32 vcc, s75, v223
    v_smfmac_f32_16x16x64_bf16 v[60:63], v[40:43], a[120:127], v16
    s_cbranch_vccnz L_As_r3
L_As_k3:
    v_smfmac_f32_16x16x64_bf16 v[48:51], v[44:47], a[144:151], v16
    v_smfmac_f32_16x16x64_bf16 v[52:55], v[44:47], a[152:159], v16
    v_smfmac_f32_16x16x64_bf16 v[56:59], v[44:47], a[160:167], v16
    v_smfmac_f32_16x16x64_bf16 v[60:63], v[44:47], a[168:175], v16
    v_smfmac_f32_16x16x64_bf16 v[64:67], v[32:35], a[32:39], v16
    v_smfmac_f32_16x16x64_bf16 v[68:71], v[32:35], a[40:47], v16
    s_nop 2
    v_cvt_pk_bf16_f32 v88, v48, v49
    v_cvt_pk_bf16_f32 v89, v50, v51
    v_cvt_pk_bf16_f32 v90, v52, v53
    v_cvt_pk_bf16_f32 v91, v54, v55
    ds_write_b128 v11, v[88:91] offset:0
    v_cvt_pk_bf16_f32 v92, v56, v57
    v_cvt_pk_bf16_f32 v93, v58, v59
    v_cvt_pk_bf16_f32 v94, v60, v61
    v_cvt_pk_bf16_f32 v95, v62, v63
    ds_write_b128 v11, v[92:95] offset:4096
    s_waitcnt lgkmcnt(0)
    s_barrier
    s_cmp_ge_u32 s30, 2
    s_cbranch_scc1 L_w23_s
    ds_read_b128 v[100:103], v12 offset:0
    ds_read_b128 v[104:107], v12 offset:1024
    ds_read_b128 v[108:111], v12 offset:2048
    ds_read_b128 v[112:115], v12 offset:3072
    v_smfmac_f32_16x16x64_bf16 v[64:67], v[36:39], a[80:87], v16
    v_smfmac_f32_16x16x64_bf16 v[68:71], v[36:39], a[88:95], v16
    v_smfmac_f32_16x16x64_bf16 v[64:67], v[40:43], a[128:135], v16
    s_waitcnt lgkmcnt(3)
    v_mfma_f32_16x16x32_bf16 v[116:119], v[100:103], v[24:27], 0
    s_waitcnt lgkmcnt(2)
    v_mfma_f32_16x16x32_bf16 v[116:119], v[104:107], v[24:27], v[116:119]
    s_waitcnt lgkmcnt(1)
    v_mfma_f32_16x16x32_bf16 v[116:119], v[108:111], v[24:27], v[116:119]
    s_waitcnt lgkmcnt(0)
    v_mfma_f32_16x16x32_bf16 v[116:119], v[112:115], v[24:27], v[116:119]
    s_nop 7
    v_cvt_pk_bf16_f32 v120, v116, v117
    v_cvt_pk_bf16_f32 v121, v118, v119
    buffer_store_dwordx2 v[120:121], v4, s[32:35], s62 offen sc1
    v_smfmac_f32_16x16x64_bf16 v[68:71], v[40:43], a[136:143], v16
    v_smfmac_f32_16x16x64_bf16 v[64:67], v[44:47], a[176:183], v16
    v_smfmac_f32_16x16x64_bf16 v[68:71], v[44:47], a[184:191], v16
    s_nop 6
    v_cvt_pk_bf16_f32 v96, v64, v65
    v_cvt_pk_bf16_f32 v97, v66, v67
    v_cvt_pk_bf16_f32 v98, v68, v69
    v_cvt_pk_bf16_f32 v99, v70, v71
    ds_write_b128 v11, v[96:99] offset:8192
    s_waitcnt lgkmcnt(0)
    s_barrier
    s_cmp_eq_u32 s60, 63
    s_cbranch_scc1 L_chain_w01
    s_barrier
    buffer_store_dwordx2 v[20:21], v7, s[32:35], s66 offen sc1
    buffer_store_dwordx2 v[20:21], v3, s[32:35], s64 offen sc1
    buffer_store_dwordx2 v[20:21], v4, s[32:35], s65 offen sc1
    s_cmp_eq_u32 s30, 1
    s_cbranch_scc1 L_w01j_s
    buffer_store_dwordx4 v[20:23], v123, s[32:35], s65 offen sc1
L_w01j_s:
    v_mov_b32 v64, 0
    v_mov_b32 v65, 0
    v_mov_b32 v66, 0
    v_mov_b32 v67, 0
    v_mov_b32 v68, 0
    v_mov_b32 v69, 0
    v_mov_b32 v70, 0
    v_mov_b32 v71, 0
    s_waitcnt vmcnt(0)
    s_branch L_b3_s
L_w23_s:
    v_smfmac_f32_16x16x64_bf16 v[64:67], v[36:39], a[80:87], v16
    v_smfmac_f32_16x16x64_bf16 v[68:71], v[36:39], a[88:95], v16
    v_smfmac_f32_16x16x64_bf16 v[64:67], v[40:43], a[128:135], v16
    v_smfmac_f32_16x16x64_bf16 v[68:71], v[40:43], a[136:143], v16
    v_smfmac_f32_16x16x64_bf16 v[64:67], v[44:47], a[176:183], v16
    v_smfmac_f32_16x16x64_bf16 v[68:71], v[44:47], a[184:191], v16
    s_cmp_eq_u32 s30, 3
    s_cbranch_scc1 L_w3_s
    ds_read_b128 v[144:147], v14 offset:0
    ds_read_b128 v[148:151], v14 offset:1024
    ds_read_b128 v[152:155], v14 offset:2048
    ds_read_b128 v[156:159], v14 offset:3072
    ds_read_b128 v[160:163], v14 offset:4096
    ds_read_b128 v[164:167], v14 offset:5120
    ds_read_b128 v[168:171], v14 offset:6144
    ds_read_b128 v[172:175], v14 offset:7168
    ds_read_b128 v[176:179], v14 offset:8192
    ds_read_b128 v[180:183], v14 offset:9216
    v_mov_b32 v48, 0
    v_mov_b32 v49, 0
    v_mov_b32 v50, 0
    v_mov_b32 v51, 0
    v_mov_b32 v52, 0
    v_mov_b32 v53, 0
    v_mov_b32 v54, 0
    v_mov_b32 v55, 0
    v_mov_b32 v56, 0
    v_mov_b32 v57, 0
    v_mov_b32 v58, 0
    v_mov_b32 v59, 0
    v_mov_b32 v60, 0
    v_mov_b32 v61, 0
    v_mov_b32 v62, 0
    v_mov_b32 v63, 0
    v_cvt_pk_bf16_f32 v96, v64, v65
    v_cvt_pk_bf16_f32 v97, v66, v67
    v_cvt_pk_bf16_f32 v98, v68, v69
    v_cvt_pk_bf16_f32 v99, v70, v71
    ds_write_b128 v11, v[96:99] offset:8192
    s_waitcnt lgkmcnt(0)
    s_barrier
    s_cmp_eq_u32 s60, 63
    s_cbranch_scc1 L_chain_fin2
    s_mov_b32 s88, 0
    buffer_load_dwordx4 v[128:131], v5, s[32:35], s62 offen offset:0 sc1
    buffer_load_dwordx4 v[132:135], v5, s[32:35], s62 offen offset:1024 sc1
    buffer_load_dwordx4 v[136:139], v5, s[32:35], s62 offen offset:2048 sc1
    buffer_load_dwordx4 v[140:143], v5, s[32:35], s62 offen offset:3072 sc1
    ds_read_b128 v[100:103], v12 offset:0
    ds_read_b128 v[104:107], v12 offset:1024
    ds_read_b128 v[108:111], v12 offset:2048
    ds_read_b128 v[112:115], v12 offset:3072
    s_waitcnt lgkmcnt(3)
    v_mfma_f32_16x16x32_bf16 v[116:119], v[24:27], v[100:103], 0
    s_waitcnt lgkmcnt(2)
    v_mfma_f32_16x16x32_bf16 v[116:119], v[24:27], v[104:107], v[116:119]
    s_waitcnt lgkmcnt(1)
    v_mfma_f32_16x16x32_bf16 v[116:119], v[24:27], v[108:111], v[116:119]
    s_waitcnt lgkmcnt(0)
    v_mfma_f32_16x16x32_bf16 v[116:119], v[24:27], v[112:115], v[116:119]
    s_waitcnt vmcnt(3)
    v_max3_u32 v223, v128, v129, v130
    v_max_u32 v223, v223, v131
    v_cmp_eq_u32 vcc, s75, v223
    s_cbranch_vccnz L_Bs_r0
L_Bs_k0:
    s_waitcnt vmcnt(2)
    v_mfma_f32_16x16x32_bf16 v[184:187], v[144:147], v[128:131], 0
    v_max3_u32 v223, v132, v133, v134
    v_mfma_f32_16x16x32_bf16 v[188:191], v[152:155], v[128:131], 0
    v_max_u32 v223, v223, v135
    v_mfma_f32_16x16x32_bf16 v[192:195], v[148:151], v[128:131], 0
    v_cmp_eq_u32 vcc, s75, v223
    v_mfma_f32_16x16x32_bf16 v[196:199], v[156:159], v[128:131], 0
    s_cbranch_vccnz L_Bs_r1
L_Bs_k1:
    s_waitcnt vmcnt(1)
    v_mfma_f32_16x16x32_bf16 v[184:187], v[160:163], v[132:135], v[184:187]
    v_max3_u32 v223, v136, v137, v138
    v_mfma_f32_16x16x32_bf16 v[188:191], v[168:171], v[132:135], v[188:191]
    v_max_u32 v223, v223, v139
    v_mfma_f32_16x16x32_bf16 v[192:195], v[164:167], v[132:135], v[192:195]
    v_cmp_eq_u32 vcc, s75, v223
    v_mfma_f32_16x16x32_bf16 v[196:199], v[172:175], v[132:135], v[196:199]
    s_cbranch_vccnz L_Bs_r2
L_Bs_k2:
    s_waitcnt vmcnt(0)
    v_mfma_f32_16x16x32_bf16 v[200:203], v[136:139], v[128:131], 0
    v_max3_u32 v223, v140, v141, v142
    v_add_f32_dpp v184, v188, v184 row_ror:8 row_mask:0xf bank_mask:0xf
    v_max_u32 v223, v223, v143
    v_add_f32_dpp v185, v189, v185 row_ror:8 row_mask:0xf bank_mask:0xf
    v_cmp_eq_u32 vcc, s75, v223
    v_add_f32_dpp v186, v190, v186 row_ror:8 row_mask:0xf bank_mask:0xf
    v_add_f32_dpp v187, v191, v187 row_ror:8 row_mask:0xf bank_mask:0xf
    v_add_f32_dpp v192, v196, v192 row_ror:8 row_mask:0xf bank_mask:0xf
    v_add_f32_dpp v193, v197, v193 row_ror:8 row_mask:0xf bank_mask:0xf
    v_add_f32_dpp v194, v198, v194 row_ror:8 row_mask:0xf bank_mask:0xf
    v_add_f32_dpp v195, v199, v195 row_ror:8 row_mask:0xf bank_mask:0xf
    s_cbranch_vccnz L_Bs_r3
L_Bs_k3:
    v_mfma_f32_16x16x32_bf16 v[200:203], v[140:143], v[132:135], v[200:203]
    s_barrier
    v_max3_f32 v222, v184, v185, v186
    v_max3_f32 v222, v222, v187, v192
    v_max3_f32 v222, v222, v193, v194
    v_cvt_pk_bf16_f32 v120, v116, v117
    v_cvt_pk_bf16_f32 v121, v118, v119
    s_nop 1
    v_mov_b32 v204, v200
    v_mov_b32 v205, v201
    v_mov_b32 v206, v202
    v_mov_b32 v207, v203
    v_permlane32_swap_b32 v200, v204
    v_permlane32_swap_b32 v201, v205
    v_permlane32_swap_b32 v202, v206
    v_permlane32_swap_b32 v203, v207
    v_add_f32_dpp v200, v204, v200 row_ror:8 row_mask:0xf bank_mask:0xf
    v_add_f32_dpp v201, v205, v201 row_ror:8 row_mask:0xf bank_mask:0xf
    v_add_f32_dpp v202, v206, v202 row_ror:8 row_mask:0xf bank_mask:0xf
    v_add_f32_dpp v203, v207, v203 row_ror:8 row_mask:0xf bank_mask:0xf
    v_max3_f32 v222, v222, v195, v200
    v_max3_f32 v222, v222, v201, v202
    v_max_f32 v222, v222, v203
    v_mov_b32 v204, v222
    s_nop 1
    v_permlane16_swap_b32 v222, v204
    v_max_f32 v222, v222, v204
    v_mov_b32 v204, v222
    s_nop 1
    v_permlane32_swap_b32 v222, v204
    v_max_f32 v222, v222, v204
    v_mul_f32 v226, s71, v222
    v_fma_f32 v184, v184, s71, -v226
    v_fma_f32 v185, v185, s71, -v226
    v_fma_f32 v186, v186, s71, -v226
    v_fma_f32 v187, v187, s71, -v226
    v_fma_f32 v192, v192, s71, -v226
    v_fma_f32 v193, v193, s71, -v226
    v_fma_f32 v194, v194, s71, -v226
    v_fma_f32 v195, v195, s71, -v226
    v_exp_f32 v184, v184
    v_exp_f32 v185, v185
    v_exp_f32 v186, v186
    v_exp_f32 v187, v187
    v_exp_f32 v192, v192
    v_exp_f32 v193, v193
    v_exp_f32 v194, v194
    v_exp_f32 v195, v195
    v_fma_f32 v200, v200, s71, -v226
    v_fma_f32 v201, v201, s71, -v226
    v_cvt_pk_bf16_f32 v212, v184, v185
    v_cvt_pk_bf16_f32 v213, v186, v187
    v_cvt_pk_bf16_f32 v214, v192, v193
    v_cvt_pk_bf16_f32 v215, v194, v195
    v_fma_f32 v202, v202, s71, -v226
    v_fma_f32 v203, v203, s71, -v226
    v_mfma_f32_16x16x32_bf16 v[228:231], v[176:179], v[212:215], 0
    v_exp_f32 v200, v200
    v_mfma_f32_16x16x32_bf16 v[232:235], v[180:183], v[212:215], 0
    v_exp_f32 v201, v201
    v_mfma_f32_16x16x32_bf16 v[196:199], v[208:211], v[212:215], 0
    v_exp_f32 v202, v202
    v_exp_f32 v203, v203
    v_cvt_pk_bf16_f32 v206, v200, v201
    v_cvt_pk_bf16_f32 v207, v202, v203
    v_cndmask_b32 v216, 0, v206, s[90:91]
    v_cndmask_b32 v217, 0, v207, s[90:91]
    v_cndmask_b32 v218, 0, v206, s[92:93]
    v_cndmask_b32 v219, 0, v207, s[92:93]
    v_mfma_f32_16x16x16_bf16 v[196:199], v[208:209], v[216:217], v[196:199]
    v_mfma_f32_16x16x16_bf16 v[228:231], v[120:121], v[216:217], v[228:231]
    v_mfma_f32_16x16x16_bf16 v[232:235], v[120:121], v[218:219], v[232:235]
    v_mov_b32 v64, 0
    v_mov_b32 v65, 0
    v_mov_b32 v66, 0
    v_mov_b32 v67, 0
    v_mov_b32 v68, 0
    v_mov_b32 v69, 0
    v_rcp_f32 v220, v196
    s_nop 0
    v_pk_mul_f32 v[228:229], v[228:229], v[220:221] op_sel_hi:[1,0]
    v_pk_mul_f32 v[230:231], v[230:231], v[220:221] op_sel_hi:[1,0]
    v_pk_mul_f32 v[232:233], v[232:233], v[220:221] op_sel_hi:[1,0]
    v_pk_mul_f32 v[234:235], v[234:235], v[220:221] op_sel_hi:[1,0]
    v_cvt_pk_bf16_f32 v124, v228, v229
    v_cvt_pk_bf16_f32 v125, v230, v231
    v_cvt_pk_bf16_f32 v126, v232, v233
    v_cvt_pk_bf16_f32 v127, v234, v235
    buffer_store_dwordx4 v[124:127], v4, s[32:35], s62 offen sc1
    v_mov_b32 v70, 0
    v_mov_b32 v71, 0
    s_branch L_b3_s
L_w3_s:
    v_mov_b32 v48, 0
    v_mov_b32 v49, 0
    v_mov_b32 v50, 0
    v_mov_b32 v51, 0
    v_mov_b32 v52, 0
    v_mov_b32 v53, 0
    v_mov_b32 v54, 0
    v_mov_b32 v55, 0
    v_mov_b32 v56, 0
    v_mov_b32 v57, 0
    v_mov_b32 v58, 0
    v_mov_b32 v59, 0
    v_mov_b32 v60, 0
    v_mov_b32 v61, 0
    v_mov_b32 v62, 0
    v_mov_b32 v63, 0
    v_cvt_pk_bf16_f32 v96, v64, v65
    v_cvt_pk_bf16_f32 v97, v66, v67
    v_cvt_pk_bf16_f32 v98, v68, v69
    v_cvt_pk_bf16_f32 v99, v70, v71
    ds_write_b128 v11, v[96:99] offset:8192
    s_waitcnt lgkmcnt(0)
    s_barrier
    s_cmp_eq_u32 s60, 63
    s_cbranch_scc1 L_chain_fin3
    s_barrier
    ds_read_b128 v[100:103], v13 offset:0
    ds_read_b128 v[104:107], v13 offset:1024
    ds_read_b128 v[108:111], v13 offset:2048
    ds_read_b128 v[112:115], v13 offset:3072
    ds_read_b128 v[144:147], v14 offset:0
    ds_read_b128 v[148:151], v14 offset:1024
    ds_read_b128 v[152:155], v14 offset:2048
    ds_read_b128 v[156:159], v14 offset:3072
    ds_read_b128 v[160:163], v14 offset:4096
    ds_read_b128 v[164:167], v14 offset:5120
    ds_read_b128 v[168:171], v14 offset:6144
    ds_read_b128 v[172:175], v14 offset:7168
    ds_read_b128 v[176:179], v14 offset:8192
    ds_read_b128 v[180:183], v14 offset:9216
    ds_read_b128 v[32:35], v225 offset:0
    ds_read_b128 v[36:39], v225 offset:2048
    ds_read_b128 v[40:43], v225 offset:4096
    ds_read_b128 v[44:47], v225 offset:6144
    v_mov_b32 v64, 0
    v_mov_b32 v65, 0
    v_mov_b32 v66, 0
    v_mov_b32 v67, 0
    v_mov_b32 v68, 0
    v_mov_b32 v69, 0
    v_mov_b32 v70, 0
    v_mov_b32 v71, 0
    s_waitcnt lgkmcnt(14)
    v_mfma_f32_16x16x32_bf16 v[116:119], v[24:27], v[100:103], 0
    v_mfma_f32_16x16x32_bf16 v[116:119], v[24:27], v[104:107], v[116:119]
    v_mfma_f32_16x16x32_bf16 v[116:119], v[24:27], v[108:111], v[116:119]
    v_mfma_f32_16x16x32_bf16 v[116:119], v[24:27], v[112:115], v[116:119]
    buffer_load_dwordx4 v[100:103], v122, s[32:35], s62 offen offset:0 sc1
    buffer_load_dwordx4 v[104:107], v122, s[32:35], s62 offen offset:512 sc1
    buffer_load_dwordx4 v[108:111], v122, s[32:35], s62 offen offset:1024 sc1
    buffer_load_dwordx4 v[112:115], v122, s[32:35], s62 offen offset:1536 sc1
    s_nop 3
    v_cvt_pk_bf16_f32 v120, v116, v117
    v_cvt_pk_bf16_f32 v121, v118, v119
    s_cmp_lt_u32 s55, s70
    s_cbranch_scc1 L_Fw_s
L_Fok_s:
L_b3_s:
    s_barrier
    s_mov_b32 s88, 0
    buffer_load_dwordx4 v[128:131], v6, s[32:35], s62 offen offset:0 sc1
    buffer_load_dwordx4 v[132:135], v6, s[32:35], s62 offen offset:1024 sc1
    s_waitcnt vmcnt(1)
    v_max3_u32 v223, v128, v129, v130
    v_max_u32 v223, v223, v131
    v_cmp_eq_u32 vcc, s75, v223
    s_cbranch_vccnz L_Os_r0
L_Os_k0:
    v_smfmac_f32_16x16x64_bf16 v[72:75], v[128:131], a[192:199], v16
    v_smfmac_f32_16x16x64_bf16 v[76:79], v[128:131], a[200:207], v16
    s_waitcnt vmcnt(0)
    v_smfmac_f32_16x16x64_bf16 v[80:83], v[128:131], a[208:215], v16
    v_max3_u32 v223, v132, v133, v134
    v_max_u32 v223, v223, v135
    v_smfmac_f32_16x16x64_bf16 v[84:87], v[128:131], a[216:223], v16
    v_cmp_eq_u32 vcc, s75, v223
    s_cbranch_vccnz L_Os_r1
L_Os_k1:
    v_smfmac_f32_16x16x64_bf16 v[72:75], v[132:135], a[224:231], v16
    v_smfmac_f32_16x16x64_bf16 v[76:79], v[132:135], a[232:239], v16
    v_smfmac_f32_16x16x64_bf16 v[80:83], v[132:135], a[240:247], v16
    v_smfmac_f32_16x16x64_bf16 v[84:87], v[132:135], a[248:255], v16
    s_cmp_lg_u32 s30, 2
    s_cbranch_scc1 L_nokd_s
    buffer_load_dwordx4 v[100:103], v122, s[32:35], s62 offen offset:0 sc1
    buffer_load_dwordx4 v[104:107], v122, s[32:35], s62 offen offset:512 sc1
    buffer_load_dwordx4 v[108:111], v122, s[32:35], s62 offen offset:1024 sc1
    buffer_load_dwordx4 v[112:115], v122, s[32:35], s62 offen offset:1536 sc1
L_nokd_s:
    s_nop 2
    v_cvt_pk_bf16_f32 v88, v72, v73
    v_cvt_pk_bf16_f32 v89, v74, v75
    v_cvt_pk_bf16_f32 v90, v76, v77
    v_cvt_pk_bf16_f32 v91, v78, v79
    ds_write_b128 v11, v[88:91] offset:12288
    v_cvt_pk_bf16_f32 v92, v80, v81
    v_cvt_pk_bf16_f32 v93, v82, v83
    v_cvt_pk_bf16_f32 v94, v84, v85
    v_cvt_pk_bf16_f32 v95, v86, v87
    ds_write_b128 v11, v[92:95] offset:16384
    s_waitcnt lgkmcnt(0)
    s_barrier
    s_cmp_ge_u32 s30, 2
    s_cbranch_scc1 L_tail23_s
    ds_read_b128 v[100:103], v12 offset:12288
    ds_read_b128 v[104:107], v12 offset:13312
    ds_read_b128 v[108:111], v12 offset:14336
    ds_read_b128 v[112:115], v12 offset:15360
    s_waitcnt lgkmcnt(3)
    v_mfma_f32_16x16x32_bf16 v[116:119], v[100:103], v[24:27], 0
    s_waitcnt lgkmcnt(2)
    v_mfma_f32_16x16x32_bf16 v[116:119], v[104:107], v[24:27], v[116:119]
    s_waitcnt lgkmcnt(1)
    v_mfma_f32_16x16x32_bf16 v[116:119], v[108:111], v[24:27], v[116:119]
    s_waitcnt lgkmcnt(0)
    v_mfma_f32_16x16x32_bf16 v[116:119], v[112:115], v[24:27], v[116:119]
    s_add_u32 s72, s60, 1
    s_and_b32 s72, s72, 3
    s_lshl_b32 s67, s72, 14
    s_nop 4
    v_cvt_pk_bf16_f32 v120, v116, v117
    v_cvt_pk_bf16_f32 v121, v118, v119
    buffer_store_dwordx2 v[120:121], v7, s[32:35], s63 offen sc1
    s_barrier
    v_mov_b32 v72, 0
    v_mov_b32 v73, 0
    v_mov_b32 v74, 0
    v_mov_b32 v75, 0
    v_mov_b32 v76, 0
    v_mov_b32 v77, 0
    v_mov_b32 v78, 0
    v_mov_b32 v79, 0
    v_mov_b32 v80, 0
    v_mov_b32 v81, 0
    v_mov_b32 v82, 0
    v_mov_b32 v83, 0
    v_mov_b32 v84, 0
    v_mov_b32 v85, 0
    v_mov_b32 v86, 0
    v_mov_b32 v87, 0
    v_mov_b32 v56, 0
    v_mov_b32 v57, 0
    v_mov_b32 v58, 0
    v_mov_b32 v59, 0
    v_mov_b32 v60, 0
    v_mov_b32 v61, 0
    v_mov_b32 v62, 0
    v_mov_b32 v63, 0
    s_waitcnt vmcnt(0)
    s_mov_b32 s88, 0
    buffer_load_dwordx4 v[136:139], v8, s[32:35], s63 offen offset:0 sc1
    buffer_load_dwordx4 v[140:143], v8, s[32:35], s63 offen offset:2048 sc1
    s_waitcnt vmcnt(1)
    v_max3_u32 v223, v136, v137, v138
    v_max_u32 v223, v223, v139
    v_cmp_eq_u32 vcc, s75, v223
    s_cbranch_vccnz L_Cs_r0
L_Cs_k0:
    v_mfma_f32_16x16x32_bf16 v[116:119], v[28:31], v[136:139], 0
    s_waitcnt vmcnt(0)
    v_max3_u32 v223, v140, v141, v142
    v_max_u32 v223, v223, v143
    v_cmp_eq_u32 vcc, s75, v223
    s_cbranch_vccnz L_Cs_r1
L_Cs_k1:
    v_mfma_f32_16x16x32_bf16 v[116:119], v[28:31], v[140:143], v[116:119]
    s_add_u32 s60, s60, 1
    s_and_b32 s72, s60, 3
    s_lshl_b32 s61, s72, 14
    s_mul_i32 s62, s72, 24576
    s_lshl_b32 s63, s72, 18
    s_xor_b32 s73, s72, 2
    s_lshl_b32 s64, s73, 14
    s_mul_i32 s65, s73, 24576
    v_cvt_pk_bf16_f32 v120, v116, v117
    v_cvt_pk_bf16_f32 v121, v118, v119
    buffer_store_dwordx2 v[120:121], v3, s[32:35], s67 offen sc1
    s_lshl_b32 s66, s73, 18
    s_xor_b32 s53, s53, 0x8000
    s_sub_u32 s54, s60, 1
    s_lshl_b32 s68, s54, 14
    s_cmp_eq_u32 s60, 0
    s_cselect_b32 s68, 0x40000000, s68
    s_max_i32 s54, s54, 0
    s_add_u32 s69, s69, 16384
    s_add_u32 s70, s60, 2
    v_mov_b32 v48, 0
    v_mov_b32 v49, 0
    v_mov_b32 v50, 0
    v_mov_b32 v51, 0
    v_mov_b32 v52, 0
    v_mov_b32 v53, 0
    v_mov_b32 v54, 0
    v_mov_b32 v55, 0
    s_barrier
    s_branch L_step_s
L_tail23_s:
    s_cmp_eq_u32 s30, 3
    s_cbranch_scc1 L_tail3_s
    ds_read_b128 v[32:35], v225 offset:0
    ds_read_b128 v[36:39], v225 offset:2048
    ds_read_b128 v[40:43], v225 offset:4096
    ds_read_b128 v[44:47], v225 offset:6144
    v_mov_b32 v224, s54
    s_barrier
    buffer_store_dword v224, v19, s[32:35], 0 offen sc1
    buffer_store_dwordx4 v[236:239], v9, s[32:35], s68 offen sc1
    s_waitcnt vmcnt(2) lgkmcnt(0)
    s_branch L_tailj_s
L_tail3_s:
    s_barrier
    buffer_store_dwordx4 v[236:239], v9, s[32:35], s68 offen sc1
    s_add_u32 m0, s53, 0
    s_add_u32 s72, s69, 4194304
    buffer_load_dwordx4 v10, s[32:35], s72 offen offset:0 lds
    buffer_load_dwordx4 v10, s[32:35], s72 offen offset:1024 lds
    buffer_load_dwordx4 v10, s[32:35], s72 offen offset:2048 lds
    buffer_load_dwordx4 v10, s[32:35], s72 offen offset:3072 lds
    s_add_u32 m0, s53, 4096
    s_add_u32 s72, s69, 4198400
    buffer_load_dwordx4 v10, s[32:35], s72 offen offset:0 lds
    buffer_load_dwordx4 v10, s[32:35], s72 offen offset:1024 lds
    buffer_load_dwordx4 v10, s[32:35], s72 offen offset:2048 lds
    buffer_load_dwordx4 v10, s[32:35], s72 offen offset:3072 lds
    s_add_u32 m0, s53, 8192
    s_add_u32 s72, s69, 37748736
    buffer_load_dwordx4 v15, s[32:35], s72 offen offset:0 lds
    buffer_load_dwordx4 v15, s[32:35], s72 offen offset:1024 lds
    s_add_u32 m0, s53, 10240
    s_add_u32 s72, s69, 71303168
    buffer_load_dwordx4 v10, s[32:35], s72 offen offset:0 lds
    buffer_load_dwordx4 v10, s[32:35], s72 offen offset:1024 lds
    buffer_load_dwordx4 v10, s[32:35], s72 offen offset:2048 lds
    buffer_load_dwordx4 v10, s[32:35], s72 offen offset:3072 lds
    s_add_u32 m0, s53, 14336
    s_add_u32 s72, s69, 71307264
    buffer_load_dwordx4 v10, s[32:35], s72 offen offset:0 lds
    buffer_load_dwordx4 v10, s[32:35], s72 offen offset:1024 lds
    buffer_load_dwordx4 v10, s[32:35], s72 offen offset:2048 lds
    buffer_load_dwordx4 v10, s[32:35], s72 offen offset:3072 lds
L_tailj_s:
    v_mfma_f32_16x16x32_bf16 v[184:187], v[144:147], v[32:35], 0
    v_mfma_f32_16x16x32_bf16 v[192:195], v[148:151], v[32:35], 0
    v_mfma_f32_16x16x32_bf16 v[200:203], v[100:103], v[32:35], 0
    v_mfma_f32_16x16x32_bf16 v[184:187], v[152:155], v[36:39], v[184:187]
    v_mfma_f32_16x16x32_bf16 v[192:195], v[156:159], v[36:39], v[192:195]
    v_mfma_f32_16x16x32_bf16 v[200:203], v[104:107], v[36:39], v[200:203]
    v_mfma_f32_16x16x32_bf16 v[184:187], v[160:163], v[40:43], v[184:187]
    v_mfma_f32_16x16x32_bf16 v[192:195], v[164:167], v[40:43], v[192:195]
    v_mfma_f32_16x16x32_bf16 v[200:203], v[108:111], v[40:43], v[200:203]
    v_mfma_f32_16x16x32_bf16 v[184:187], v[168:171], v[44:47], v[184:187]
    v_mfma_f32_16x16x32_bf16 v[192:195], v[172:175], v[44:47], v[192:195]
    v_mfma_f32_16x16x32_bf16 v[200:203], v[112:115], v[44:47], v[200:203]
    s_nop 5
    v_min_f32 v184, v184, v248
    v_min_f32 v185, v185, v249
    v_min_f32 v186, v186, v250
    v_min_f32 v187, v187, v251
    v_min_f32 v192, v192, v252
    v_min_f32 v193, v193, v253
    v_min_f32 v194, v194, v254
    v_min_f32 v195, v195, v255
    v_max3_f32 v222, v184, v185, v186
    v_max3_f32 v222, v222, v187, v192
    v_max3_f32 v222, v222, v193, v194
    v_max3_f32 v222, v222, v195, v200
    v_max3_f32 v222, v222, v201, v202
    v_max_f32 v222, v222, v203
    v_mov_b32 v204, v222
    s_nop 1
    v_permlane16_swap_b32 v222, v204
    v_max_f32 v222, v222, v204
    v_mov_b32 v204, v222
    s_nop 1
    v_permlane32_swap_b32 v222, v204
    v_max_f32 v222, v222, v204
    v_mul_f32 v222, s71, v222
    v_fma_f32 v184, v184, s71, -v222
    v_fma_f32 v185, v185, s71, -v222
    v_fma_f32 v186, v186, s71, -v222
    v_fma_f32 v187, v187, s71, -v222
    v_fma_f32 v192, v192, s71, -v222
    v_fma_f32 v193, v193, s71, -v222
    v_fma_f32 v194, v194, s71, -v222
    v_fma_f32 v195, v195, s71, -v222
    v_fma_f32 v200, v200, s71, -v222
    v_fma_f32 v201, v201, s71, -v222
    v_fma_f32 v202, v202, s71, -v222
    v_fma_f32 v203, v203, s71, -v222
    v_exp_f32 v184, v184
    v_exp_f32 v185, v185
    v_exp_f32 v186, v186
    v_exp_f32 v187, v187
    v_exp_f32 v192, v192
    v_exp_f32 v193, v193
    v_exp_f32 v194, v194
    v_exp_f32 v195, v195
    v_exp_f32 v200, v200
    v_cvt_pk_bf16_f32 v212, v184, v185
    v_cvt_pk_bf16_f32 v213, v186, v187
    v_cvt_pk_bf16_f32 v214, v192, v193
    v_cvt_pk_bf16_f32 v215, v194, v195
    v_exp_f32 v201, v201
    s_nop 0
    v_mfma_f32_16x16x32_bf16 v[228:231], v[176:179], v[212:215], 0
    v_exp_f32 v202, v202
    v_mfma_f32_16x16x32_bf16 v[232:235], v[180:183], v[212:215], 0
    v_exp_f32 v203, v203
    v_cvt_pk_bf16_f32 v206, v200, v201
    v_add_f32 v184, v184, v185
    v_cvt_pk_bf16_f32 v207, v202, v203
    v_cndmask_b32 v216, 0, v206, s[90:91]
    v_cndmask_b32 v217, 0, v207, s[90:91]
    v_cndmask_b32 v218, 0, v206, s[92:93]
    v_cndmask_b32 v219, 0, v207, s[92:93]
    v_mfma_f32_16x16x16_bf16 v[228:231], v[120:121], v[216:217], v[228:231]
    v_add_f32 v200, v200, v201
    v_mfma_f32_16x16x16_bf16 v[232:235], v[120:121], v[218:219], v[232:235]
    v_add_f32 v202, v202, v203
    v_add_f32 v186, v186, v187
    v_add_f32 v192, v192, v193
    v_add_f32 v194, v194, v195
    v_add_f32 v200, v200, v202
    v_add_f32 v184, v184, v186
    v_add_f32 v192, v192, v194
    v_add_f32 v184, v184, v192
    v_fma_f32 v222, v200, 0.5, v184
    v_mov_b32 v204, v222
    s_nop 1
    v_permlane16_swap_b32 v222, v204
    v_add_f32 v222, v222, v204
    v_mov_b32 v204, v222
    s_nop 1
    v_permlane32_swap_b32 v222, v204
    v_add_f32 v222, v222, v204
    v_rcp_f32 v220, v222
    s_nop 0
    v_pk_mul_f32 v[228:229], v[228:229], v[220:221] op_sel_hi:[1,0]
    v_pk_mul_f32 v[230:231], v[230:231], v[220:221] op_sel_hi:[1,0]
    v_pk_mul_f32 v[232:233], v[232:233], v[220:221] op_sel_hi:[1,0]
    v_pk_mul_f32 v[234:235], v[234:235], v[220:221] op_sel_hi:[1,0]
    v_cvt_pk_bf16_f32 v236, v228, v229
    v_cvt_pk_bf16_f32 v237, v230, v231
    v_cvt_pk_bf16_f32 v238, v232, v233
    v_cvt_pk_bf16_f32 v239, v234, v235
    v_xor_b32 v14, 0x8000, v14
    v_xor_b32 v225, 0x8000, v225
    v_mov_b32 v72, 0
    v_mov_b32 v73, 0
    v_mov_b32 v74, 0
    v_mov_b32 v75, 0
    v_mov_b32 v76, 0
    v_mov_b32 v77, 0
    v_mov_b32 v78, 0
    v_mov_b32 v79, 0
    v_mov_b32 v80, 0
    v_mov_b32 v81, 0
    v_mov_b32 v82, 0
    v_mov_b32 v83, 0
    v_mov_b32 v84, 0
    v_mov_b32 v85, 0
    v_mov_b32 v86, 0
    v_mov_b32 v87, 0
    s_add_u32 s60, s60, 1
    s_and_b32 s72, s60, 3
    s_lshl_b32 s61, s72, 14
    s_mul_i32 s62, s72, 24576
    s_lshl_b32 s63, s72, 18
    s_xor_b32 s73, s72, 2
    s_lshl_b32 s64, s73, 14
    s_mul_i32 s65, s73, 24576
    s_lshl_b32 s66, s73, 18
    s_xor_b32 s53, s53, 0x8000
    s_sub_u32 s54, s60, 1
    s_lshl_b32 s68, s54, 14
    s_cmp_eq_u32 s60, 0
    s_cselect_b32 s68, 0x40000000, s68
    s_max_i32 s54, s54, 0
    s_add_u32 s69, s69, 16384
    s_add_u32 s70, s60, 2
    s_waitcnt vmcnt(0)
    s_barrier
    s_branch L_step_s
L_As_r0:
    s_add_u32 s88, s88, 1
    s_mov_b32 s89, 4
    s_cmp_ge_u32 s88, 262144
    s_cbranch_scc1 L_abort
    buffer_load_dwordx4 v[32:35], v2, s[32:35], s61 offen offset:0 sc1
    buffer_load_dwordx4 v[36:39], v2, s[32:35], s61 offen offset:1024 sc1
    buffer_load_dwordx4 v[40:43], v2, s[32:35], s61 offen offset:2048 sc1
    buffer_load_dwordx4 v[44:47], v2, s[32:35], s61 offen offset:3072 sc1
    s_waitcnt vmcnt(3)
    v_max3_u32 v223, v32, v33, v34
    v_max_u32 v223, v223, v35
    v_cmp_eq_u32 vcc, s75, v223
    s_cbranch_vccnz L_As_r0
    s_branch L_As_k0
L_As_r1:
    s_add_u32 s88, s88, 1
    s_mov_b32 s89, 4
    s_cmp_ge_u32 s88, 262144
    s_cbranch_scc1 L_abort
    buffer_load_dwordx4 v[36:39], v2, s[32:35], s61 offen offset:1024 sc1
    buffer_load_dwordx4 v[40:43], v2, s[32:35], s61 offen offset:2048 sc1
    buffer_load_dwordx4 v[44:47], v2, s[32:35], s61 offen offset:3072 sc1
    s_waitcnt vmcnt(2)
    v_max3_u32 v223, v36, v37, v38
    v_max_u32 v223, v223, v39
    v_cmp_eq_u32 vcc, s75, v223
    s_cbranch_vccnz L_As_r1
    s_branch L_As_k1
L_As_r2:
    s_add_u32 s88, s88, 1
    s_mov_b32 s89, 4
    s_cmp_ge_u32 s88, 262144
    s_cbranch_scc1 L_abort
    buffer_load_dwordx4 v[40:43], v2, s[32:35], s61 offen offset:2048 sc1
    buffer_load_dwordx4 v[44:47], v2, s[32:35], s61 offen offset:3072 sc1
    s_waitcnt vmcnt(1)
    v_max3_u32 v223, v40, v41, v42
    v_max_u32 v223, v223, v43
    v_cmp_eq_u32 vcc, s75, v223
    s_cbranch_vccnz L_As_r2
    s_branch L_As_k2
L_As_r3:
    s_add_u32 s88, s88, 1
    s_mov_b32 s89, 4
    s_cmp_ge_u32 s88, 262144
    s_cbranch_scc1 L_abort
    buffer_load_dwordx4 v[44:47], v2, s[32:35], s61 offen offset:3072 sc1
    s_waitcnt vmcnt(0)
    v_max3_u32 v223, v44, v45, v46
    v_max_u32 v223, v223, v47
    v_cmp_eq_u32 vcc, s75, v223
    s_cbranch_vccnz L_As_r3
    s_branch L_As_k3
L_Bs_r0:
    s_add_u32 s88, s88, 1
    s_mov_b32 s89, 5
    s_cmp_ge_u32 s88, 262144
    s_cbranch_scc1 L_abort
    buffer_load_dwordx4 v[128:131], v5, s[32:35], s62 offen offset:0 sc1
    buffer_load_dwordx4 v[132:135], v5, s[32:35], s62 offen offset:1024 sc1
    buffer_load_dwordx4 v[136:139], v5, s[32:35], s62 offen offset:2048 sc1
    buffer_load_dwordx4 v[140:143], v5, s[32:35], s62 offen offset:3072 sc1
    s_waitcnt vmcnt(3)
    v_max3_u32 v223, v128, v129, v130
    v_max_u32 v223, v223, v131
    v_cmp_eq_u32 vcc, s75, v223
    s_cbranch_vccnz L_Bs_r0
    s_branch L_Bs_k0
L_Bs_r1:
    s_add_u32 s88, s88, 1
    s_mov_b32 s89, 5
    s_cmp_ge_u32 s88, 262144
    s_cbranch_scc1 L_abort
    buffer_load_dwordx4 v[132:135], v5, s[32:35], s62 offen offset:1024 sc1
    buffer_load_dwordx4 v[136:139], v5, s[32:35], s62 offen offset:2048 sc1
    buffer_load_dwordx4 v[140:143], v5, s[32:35], s62 offen offset:3072 sc1
    s_waitcnt vmcnt(2)
    v_max3_u32 v223, v132, v133, v134
    v_max_u32 v223, v223, v135
    v_cmp_eq_u32 vcc, s75, v223
    s_cbranch_vccnz L_Bs_r1
    s_branch L_Bs_k1
L_Bs_r2:
    s_add_u32 s88, s88, 1
    s_mov_b32 s89, 5
    s_cmp_ge_u32 s88, 262144
    s_cbranch_scc1 L_abort
    buffer_load_dwordx4 v[136:139], v5, s[32:35], s62 offen offset:2048 sc1
    buffer_load_dwordx4 v[140:143], v5, s[32:35], s62 offen offset:3072 sc1
    s_waitcnt vmcnt(1)
    v_max3_u32 v223, v136, v137, v138
    v_max_u32 v223, v223, v139
    v_cmp_eq_u32 vcc, s75, v223
    s_cbranch_vccnz L_Bs_r2
    s_branch L_Bs_k2
L_Bs_r3:
    s_add_u32 s88, s88, 1
    s_mov_b32 s89, 5
    s_cmp_ge_u32 s88, 262144
    s_cbranch_scc1 L_abort
    buffer_load_dwordx4 v[140:143], v5, s[32:35], s62 offen offset:3072 sc1
    s_waitcnt vmcnt(0)
    v_max3_u32 v223, v140, v141, v142
    v_max_u32 v223, v223, v143
    v_cmp_eq_u32 vcc, s75, v223
    s_cbranch_vccnz L_Bs_r3
    s_branch L_Bs_k3
L_Os_r0:
    s_add_u32 s88, s88, 1
    s_mov_b32 s89, 11
    s_cmp_ge_u32 s88, 262144
    s_cbranch_scc1 L_abort
    buffer_load_dwordx4 v[128:131], v6, s[32:35], s62 offen offset:0 sc1
    buffer_load_dwordx4 v[132:135], v6, s[32:35], s62 offen offset:1024 sc1
    s_waitcnt vmcnt(1)
    v_max3_u32 v223, v128, v129, v130
    v_max_u32 v223, v223, v131
    v_cmp_eq_u32 vcc, s75, v223
    s_cbranch_vccnz L_Os_r0
    s_branch L_Os_k0
L_Os_r1:
    s_add_u32 s88, s88, 1
    s_mov_b32 s89, 11
    s_cmp_ge_u32 s88, 262144
    s_cbranch_scc1 L_abort
    buffer_load_dwordx4 v[132:135], v6, s[32:35], s62 offen offset:1024 sc1
    s_waitcnt vmcnt(0)
    v_max3_u32 v223, v132, v133, v134
    v_max_u32 v223, v223, v135
    v_cmp_eq_u32 vcc, s75, v223
    s_cbranch_vccnz L_Os_r1
    s_branch L_Os_k1
L_Cs_r0:
    s_add_u32 s88, s88, 1
    s_mov_b32 s89, 6
    s_cmp_ge_u32 s88, 262144
    s_cbranch_scc1 L_abort
    buffer_load_dwordx4 v[136:139], v8, s[32:35], s63 offen offset:0 sc1
    buffer_load_dwordx4 v[140:143], v8, s[32:35], s63 offen offset:2048 sc1
    s_waitcnt vmcnt(1)
    v_max3_u32 v223, v136, v137, v138
    v_max_u32 v223, v223, v139
    v_cmp_eq_u32 vcc, s75, v223
    s_cbranch_vccnz L_Cs_r0
    s_branch L_Cs_k0
L_Cs_r1:
    s_add_u32 s88, s88, 1
    s_mov_b32 s89, 6
    s_cmp_ge_u32 s88, 262144
    s_cbranch_scc1 L_abort
    buffer_load_dwordx4 v[140:143], v8, s[32:35], s63 offen offset:2048 sc1
    s_waitcnt vmcnt(0)
    v_max3_u32 v223, v140, v141, v142
    v_max_u32 v223, v223, v143
    v_cmp_eq_u32 vcc, s75, v223
    s_cbranch_vccnz L_Cs_r1
    s_branch L_Cs_k1
L_Fw_s:
    s_mov_b32 s88, 0
L_wf_8:
    s_add_u32 s88, s88, 1
    s_mov_b32 s89, 7
    s_cmp_ge_u32 s88, 262144
    s_cbranch_scc1 L_abort
    buffer_load_dword v18, v17, s[32:35], 0 offen sc1
    s_waitcnt vmcnt(0)
    v_cmp_gt_u32 vcc, s70, v18
    s_cbranch_vccnz L_wf_8
    v_min_u32_dpp v18, v18, v18 row_ror:8 row_mask:0xf bank_mask:0xf
    s_nop 1
    v_min_u32_dpp v18, v18, v18 row_ror:4 row_mask:0xf bank_mask:0xf
    s_nop 1
    v_min_u32_dpp v18, v18, v18 row_ror:2 row_mask:0xf bank_mask:0xf
    s_nop 1
    v_min_u32_dpp v18, v18, v18 row_ror:1 row_mask:0xf bank_mask:0xf
    s_nop 0
    v_readfirstlane_b32 s55, v18
    s_branch L_Fok_s
L_chain_fin3:
    ds_read_b128 v[144:147], v14 offset:0
    ds_read_b128 v[148:151], v14 offset:1024
    ds_read_b128 v[152:155], v14 offset:2048
    ds_read_b128 v[156:159], v14 offset:3072
    ds_read_b128 v[160:163], v14 offset:4096
    ds_read_b128 v[164:167], v14 offset:5120
    ds_read_b128 v[168:171], v14 offset:6144
    ds_read_b128 v[172:175], v14 offset:7168
    ds_read_b128 v[176:179], v14 offset:8192
    ds_read_b128 v[180:183], v14 offset:9216
    ds_read_b128 v[32:35], v225 offset:0
    ds_read_b128 v[36:39], v225 offset:2048
    ds_read_b128 v[40:43], v225 offset:4096
    ds_read_b128 v[44:47], v225 offset:6144
    s_branch L_chain_fin
L_chain_fin2:
    ds_read_b128 v[32:35], v225 offset:0
    ds_read_b128 v[36:39], v225 offset:2048
    ds_read_b128 v[40:43], v225 offset:4096
    ds_read_b128 v[44:47], v225 offset:6144
L_chain_fin:
    s_waitcnt lgkmcnt(0)
    ds_read_b128 v[100:103], v13 offset:0
    ds_read_b128 v[104:107], v13 offset:1024
    ds_read_b128 v[108:111], v13 offset:2048
    ds_read_b128 v[112:115], v13 offset:3072
    s_waitcnt lgkmcnt(3)
    v_mfma_f32_16x16x32_bf16 v[116:119], v[24:27], v[100:103], 0
    s_waitcnt lgkmcnt(2)
    v_mfma_f32_16x16x32_bf16 v[116:119], v[24:27], v[104:107], v[116:119]
    s_waitcnt lgkmcnt(1)
    v_mfma_f32_16x16x32_bf16 v[116:119], v[24:27], v[108:111], v[116:119]
    s_waitcnt lgkmcnt(0)
    v_mfma_f32_16x16x32_bf16 v[116:119], v[24:27], v[112:115], v[116:119]
    s_nop 7
    v_cvt_pk_bf16_f32 v120, v116, v117
    v_cvt_pk_bf16_f32 v121, v118, v119
    buffer_store_dwordx4 v[236:239], v9, s[32:35], s68 offen sc1
    s_mov_b32 s88, 0
    buffer_load_dwordx4 v[100:103], v122, s[32:35], s62 offen offset:0 sc1
    buffer_load_dwordx4 v[104:107], v122, s[32:35], s62 offen offset:512 sc1
    buffer_load_dwordx4 v[108:111], v122, s[32:35], s62 offen offset:1024 sc1
    buffer_load_dwordx4 v[112:115], v122, s[32:35], s62 offen offset:1536 sc1
    s_waitcnt vmcnt(3)
    v_max3_u32 v223, v100, v101, v102
    v_max_u32 v223, v223, v103
    v_cmp_eq_u32 vcc, s75, v223
    s_cbranch_vccnz L_Kf_r0
L_Kf_k0:
    s_waitcnt vmcnt(2)
    v_max3_u32 v223, v104, v105, v106
    v_max_u32 v223, v223, v107
    v_cmp_eq_u32 vcc, s75, v223
    s_cbranch_vccnz L_Kf_r1
L_Kf_k1:
    s_waitcnt vmcnt(1)
    v_max3_u32 v223, v108, v109, v110
    v_max_u32 v223, v223, v111
    v_cmp_eq_u32 vcc, s75, v223
    s_cbranch_vccnz L_Kf_r2
L_Kf_k2:
    s_waitcnt vmcnt(0)
    v_max3_u32 v223, v112, v113, v114
    v_max_u32 v223, v223, v115
    v_cmp_eq_u32 vcc, s75, v223
    s_cbranch_vccnz L_Kf_r3
L_Kf_k3:
    v_mfma_f32_16x16x32_bf16 v[184:187], v[144:147], v[32:35], 0
    v_mfma_f32_16x16x32_bf16 v[192:195], v[148:151], v[32:35], 0
    v_mfma_f32_16x16x32_bf16 v[200:203], v[100:103], v[32:35], 0
    v_mfma_f32_16x16x32_bf16 v[184:187], v[152:155], v[36:39], v[184:187]
    v_mfma_f32_16x16x32_bf16 v[192:195], v[156:159], v[36:39], v[192:195]
    v_mfma_f32_16x16x32_bf16 v[200:203], v[104:107], v[36:39], v[200:203]
    v_mfma_f32_16x16x32_bf16 v[184:187], v[160:163], v[40:43], v[184:187]
    v_mfma_f32_16x16x32_bf16 v[192:195], v[164:167], v[40:43], v[192:195]
    v_mfma_f32_16x16x32_bf16 v[200:203], v[108:111], v[40:43], v[200:203]
    v_mfma_f32_16x16x32_bf16 v[184:187], v[168:171], v[44:47], v[184:187]
    v_mfma_f32_16x16x32_bf16 v[192:195], v[172:175], v[44:47], v[192:195]
    v_mfma_f32_16x16x32_bf16 v[200:203], v[112:115], v[44:47], v[200:203]
    s_nop 5
    v_min_f32 v184, v184, v248
    v_min_f32 v185, v185, v249
    v_min_f32 v186, v186, v250
    v_min_f32 v187, v187, v251
    v_min_f32 v192, v192, v252
    v_min_f32 v193, v193, v253
    v_min_f32 v194, v194, v254
    v_min_f32 v195, v195, v255
    v_max3_f32 v222, v184, v185, v186
    v_max3_f32 v222, v222, v187, v192
    v_max3_f32 v222, v222, v193, v194
    v_max3_f32 v222, v222, v195, v200
    v_max3_f32 v222, v222, v201, v202
    v_max_f32 v222, v222, v203
    v_mov_b32 v204, v222
    s_nop 1
    v_permlane16_swap_b32 v222, v204
    v_max_f32 v222, v222, v204
    v_mov_b32 v204, v222
    s_nop 1
    v_permlane32_swap_b32 v222, v204
    v_max_f32 v222, v222, v204
    v_mul_f32 v222, s71, v222
    v_fma_f32 v184, v184, s71, -v222
    v_fma_f32 v185, v185, s71, -v222
    v_fma_f32 v186, v186, s71, -v222
    v_fma_f32 v187, v187, s71, -v222
    v_fma_f32 v192, v192, s71, -v222
    v_fma_f32 v193, v193, s71, -v222
    v_fma_f32 v194, v194, s71, -v222
    v_fma_f32 v195, v195, s71, -v222
    v_fma_f32 v200, v200, s71, -v222
    v_fma_f32 v201, v201, s71, -v222
    v_fma_f32 v202, v202, s71, -v222
    v_fma_f32 v203, v203, s71, -v222
    v_exp_f32 v184, v184
    v_exp_f32 v185, v185
    v_exp_f32 v186, v186
    v_exp_f32 v187, v187
    v_exp_f32 v192, v192
    v_exp_f32 v193, v193
    v_exp_f32 v194, v194
    v_exp_f32 v195, v195
    v_exp_f32 v200, v200
    v_cvt_pk_bf16_f32 v212, v184, v185
    v_cvt_pk_bf16_f32 v213, v186, v187
    v_cvt_pk_bf16_f32 v214, v192, v193
    v_cvt_pk_bf16_f32 v215, v194, v195
    v_exp_f32 v201, v201
    s_nop 0
    v_mfma_f32_16x16x32_bf16 v[228:231], v[176:179], v[212:215], 0
    v_exp_f32 v202, v202
    v_mfma_f32_16x16x32_bf16 v[232:235], v[180:183], v[212:215], 0
    v_exp_f32 v203, v203
    v_cvt_pk_bf16_f32 v206, v200, v201
    v_add_f32 v184, v184, v185
    v_cvt_pk_bf16_f32 v207, v202, v203
    v_cndmask_b32 v216, 0, v206, s[90:91]
    v_cndmask_b32 v217, 0, v207, s[90:91]
    v_cndmask_b32 v218, 0, v206, s[92:93]
    v_cndmask_b32 v219, 0, v207, s[92:93]
    v_mfma_f32_16x16x16_bf16 v[228:231], v[120:121], v[216:217], v[228:231]
    v_add_f32 v200, v200, v201
    v_mfma_f32_16x16x16_bf16 v[232:235], v[120:121], v[218:219], v[232:235]
    v_add_f32 v202, v202, v203
    v_add_f32 v186, v186, v187
    v_add_f32 v192, v192, v193
    v_add_f32 v194, v194, v195
    v_add_f32 v200, v200, v202
    v_add_f32 v184, v184, v186
    v_add_f32 v192, v192, v194
    v_add_f32 v184, v184, v192
    v_fma_f32 v222, v200, 0.5, v184
    v_mov_b32 v204, v222
    s_nop 1
    v_permlane16_swap_b32 v222, v204
    v_add_f32 v222, v222, v204
    v_mov_b32 v204, v222
    s_nop 1
    v_permlane32_swap_b32 v222, v204
    v_add_f32 v222, v222, v204
    v_rcp_f32 v220, v222
    s_nop 0
    v_pk_mul_f32 v[228:229], v[228:229], v[220:221] op_sel_hi:[1,0]
    v_pk_mul_f32 v[230:231], v[230:231], v[220:221] op_sel_hi:[1,0]
    v_pk_mul_f32 v[232:233], v[232:233], v[220:221] op_sel_hi:[1,0]
    v_pk_mul_f32 v[234:235], v[234:235], v[220:221] op_sel_hi:[1,0]
    v_cvt_pk_bf16_f32 v236, v228, v229
    v_cvt_pk_bf16_f32 v237, v230, v231
    v_cvt_pk_bf16_f32 v238, v232, v233
    v_cvt_pk_bf16_f32 v239, v234, v235
    s_add_u32 s68, s68, 16384
    buffer_store_dwordx4 v[236:239], v9, s[32:35], s68 offen sc1
    s_waitcnt vmcnt(0)
L_chain_w01:
    s_barrier
    s_cmp_lg_u32 s30, 2
    s_cbranch_scc1 L_chain_out
    v_mov_b32 v224, 64
    buffer_store_dword v224, v19, s[32:35], 0 offen sc1
L_chain_out:
    s_branch L_chain_exit
L_Kf_r0:
    s_add_u32 s88, s88, 1
    s_mov_b32 s89, 8
    s_cmp_ge_u32 s88, 262144
    s_cbranch_scc1 L_abort
    buffer_load_dwordx4 v[100:103], v122, s[32:35], s62 offen offset:0 sc1
    buffer_load_dwordx4 v[104:107], v122, s[32:35], s62 offen offset:512 sc1
    buffer_load_dwordx4 v[108:111], v122, s[32:35], s62 offen offset:1024 sc1
    buffer_load_dwordx4 v[112:115], v122, s[32:35], s62 offen offset:1536 sc1
    s_waitcnt vmcnt(3)
    v_max3_u32 v223, v100, v101, v102
    v_max_u32 v223, v223, v103
    v_cmp_eq_u32 vcc, s75, v223
    s_cbranch_vccnz L_Kf_r0
    s_branch L_Kf_k0
L_Kf_r1:
    s_add_u32 s88, s88, 1
    s_mov_b32 s89, 8
    s_cmp_ge_u32 s88, 262144
    s_cbranch_scc1 L_abort
    buffer_load_dwordx4 v[104:107], v122, s[32:35], s62 offen offset:512 sc1
    buffer_load_dwordx4 v[108:111], v122, s[32:35], s62 offen offset:1024 sc1
    buffer_load_dwordx4 v[112:115], v122, s[32:35], s62 offen offset:1536 sc1
    s_waitcnt vmcnt(2)
    v_max3_u32 v223, v104, v105, v106
    v_max_u32 v223, v223, v107
    v_cmp_eq_u32 vcc, s75, v223
    s_cbranch_vccnz L_Kf_r1
    s_branch L_Kf_k1
L_Kf_r2:
    s_add_u32 s88, s88, 1
    s_mov_b32 s89, 8
    s_cmp_ge_u32 s88, 262144
    s_cbranch_scc1 L_abort
    buffer_load_dwordx4 v[108:111], v122, s[32:35], s62 offen offset:1024 sc1
    buffer_load_dwordx4 v[112:115], v122, s[32:35], s62 offen offset:1536 sc1
    s_waitcnt vmcnt(1)
    v_max3_u32 v223, v108, v109, v110
    v_max_u32 v223, v223, v111
    v_cmp_eq_u32 vcc, s75, v223
    s_cbranch_vccnz L_Kf_r2
    s_branch L_Kf_k2
L_Kf_r3:
    s_add_u32 s88, s88, 1
    s_mov_b32 s89, 8
    s_cmp_ge_u32 s88, 262144
    s_cbranch_scc1 L_abort
    buffer_load_dwordx4 v[112:115], v122, s[32:35], s62 offen offset:1536 sc1
    s_waitcnt vmcnt(0)
    v_max3_u32 v223, v112, v113, v114
    v_max_u32 v223, v223, v115
    v_cmp_eq_u32 vcc, s75, v223
    s_cbranch_vccnz L_Kf_r3
    s_branch L_Kf_k3
L_chain_exit:
    s_mov_b32 s88, 0
    v_mov_b32 v246, 144
L_t5m_9:
    s_add_u32 s88, s88, 1
    s_mov_b32 s89, 19
    s_cmp_ge_u32 s88, 262144
    s_cbranch_scc1 L_abort
    buffer_load_dword v247, v246, s[36:39], 0 offen sc1
    s_waitcnt vmcnt(0)
    v_readfirstlane_b32 s75, v247
    s_cmp_le_u32 s75, s2
    s_cbranch_scc1 L_t5m_9
    s_and_b32 s75, s75, 3
    s_mov_b32 s99, 0
    s_cmp_lg_u32 s75, 3
    s_cbranch_scc1 L_t5
    s_waitcnt vmcnt(0)
    s_branch L_fin
L_worker:
    s_sub_u32 s77, s31, 128
    s_lshr_b32 s68, s77, 5
    s_and_b32 s69, s77, 31
    s_add_u32 s69, s69, 30
    s_and_b32 s69, s69, 31
    s_lshr_b32 s70, s69, 3
    s_lshl_b32 s70, s70, 5
    s_lshl_b32 s71, s68, 3
    s_add_u32 s70, s70, s71
    s_and_b32 s71, s69, 7
    s_add_u32 s70, s70, s71
    s_mul_i32 s71, s68, 6
    s_add_u32 s71, s71, s69
    s_add_u32 s71, s71, 72
    s_cmp_ge_u32 s69, 24
    s_cselect_b32 s70, s71, s70
    s_lshl_b32 s71, s68, 1
    s_add_u32 s71, s71, s69
    s_add_u32 s71, s71, 90
    s_cmp_ge_u32 s69, 30
    s_cselect_b32 s77, s71, s70
    s_cmp_ge_u32 s77, 120
    s_cbranch_scc1 L_spare
    s_cmp_ge_u32 s77, 96
    s_cbranch_scc1 L_t3
    s_lshr_b32 s68, s77, 5
    s_and_b32 s69, s77, 31
    s_cmp_eq_u32 s68, 0
    s_cselect_b32 s70, s16, s14
    s_cselect_b32 s71, s17, s15
    s_mov_b32 s72, 71303168
    s_cselect_b32 s72, 4194304, s72
    s_cselect_b32 s73, 16, 0
    s_cmp_eq_u32 s68, 1
    s_cselect_b32 s70, s18, s70
    s_cselect_b32 s71, s19, s71
    s_cselect_b32 s72, 37748736, s72
    s_cselect_b32 s73, 32, s73
    s_mov_b32 s44, s70
    s_and_b32 s45, s71, 0xffff
    s_mov_b32 s46, 0x800000
    s_mov_b32 s47, 0x00020000
    s_mov_b32 s48, s10
    s_and_b32 s49, s11, 0xffff
    s_mov_b32 s50, 0x400000
    s_mov_b32 s51, 0x00020000
    s_mov_b32 s53, 8192
    s_lshl_b32 s54, s69, 8
    v_mov_b32 v95, 0x0
    v_and_b32 v246, 0x10, v240
    v_xor_b32 v95, v95, v246
    v_and_b32 v246, 0x20, v241
    v_xor_b32 v95, v95, v246
    v_and_b32 v246, 0x40, v242
    v_xor_b32 v95, v95, v246
    v_and_b32 v246, 0x800, v243
    v_xor_b32 v95, v95, v246
    v_and_b32 v246, 0x1010, v244
    v_xor_b32 v95, v95, v246
    v_and_b32 v246, 0x2020, v245
    v_xor_b32 v95, v95, v246
    s_and_b32 s63, s30, 1
    s_lshl_b32 s63, s63, 6
    v_xor_b32 v95, s63, v95
    s_lshl_b32 s63, s30, 14
    v_add_u32 v95, s63, v95
    s_mov_b32 s55, 128
    s_mov_b32 s56, 1024
    v_mov_b32 v8, 0x0
    v_and_b32 v246, 0x80, v240
    v_xor_b32 v8, v8, v246
    v_and_b32 v246, 0x110, v241
    v_xor_b32 v8, v8, v246
    v_and_b32 v246, 0x220, v242
    v_xor_b32 v8, v8, v246
    v_and_b32 v246, 0x440, v243
    v_xor_b32 v8, v8, v246
    v_and_b32 v246, 0x10, v244
    v_xor_b32 v8, v8, v246
    v_and_b32 v246, 0x20, v245
    v_xor_b32 v8, v8, v246
    v_mov_b32 v9, 0x800
    v_and_b32 v246, 0x80, v240
    v_xor_b32 v9, v9, v246
    v_and_b32 v246, 0x110, v241
    v_xor_b32 v9, v9, v246
    v_and_b32 v246, 0x220, v242
    v_xor_b32 v9, v9, v246
    v_and_b32 v246, 0x440, v243
    v_xor_b32 v9, v9, v246
    v_and_b32 v246, 0x10, v244
    v_xor_b32 v9, v9, v246
    v_and_b32 v246, 0x20, v245
    v_xor_b32 v9, v9, v246
    v_mov_b32 v10, 0x40
    v_and_b32 v246, 0x80, v240
    v_xor_b32 v10, v10, v246
    v_and_b32 v246, 0x110, v241
    v_xor_b32 v10, v10, v246
    v_and_b32 v246, 0x220, v242
    v_xor_b32 v10, v10, v246
    v_and_b32 v246, 0x440, v243
    v_xor_b32 v10, v10, v246
    v_and_b32 v246, 0x10, v244
    v_xor_b32 v10, v10, v246
    v_and_b32 v246, 0x20, v245
    v_xor_b32 v10, v10, v246
    v_mov_b32 v11, 0x840
    v_and_b32 v246, 0x80, v240
    v_xor_b32 v11, v11, v246
    v_and_b32 v246, 0x110, v241
    v_xor_b32 v11, v11, v246
    v_and_b32 v246, 0x220, v242
    v_xor_b32 v11, v11, v246
    v_and_b32 v246, 0x440, v243
    v_xor_b32 v11, v11, v246
    v_and_b32 v246, 0x10, v244
    v_xor_b32 v11, v11, v246
    v_and_b32 v246, 0x20, v245
    v_xor_b32 v11, v11, v246
    v_add_u32 v12, 0x10000, v8
    v_add_u32 v13, 0x10000, v9
    v_add_u32 v14, 0x10000, v10
    v_add_u32 v15, 0x10000, v11
    s_mov_b32 s57, 0
    s_cmp_eq_u32 s68, 1
    s_cbranch_scc1 L_lw_v
    v_mov_b32 v2, 0x0
    v_and_b32 v246, 0x10, v240
    v_xor_b32 v2, v2, v246
    v_and_b32 v246, 0x20, v241
    v_xor_b32 v2, v2, v246
    v_and_b32 v246, 0x40, v242
    v_xor_b32 v2, v2, v246
    v_and_b32 v246, 0x80, v243
    v_xor_b32 v2, v2, v246
    v_and_b32 v246, 0x40, v244
    v_xor_b32 v2, v2, v246
    v_and_b32 v246, 0x80, v245
    v_xor_b32 v2, v2, v246
    v_lshrrev_b32 v3, 4, v1
    v_mul_lo_u32 v3, v3, s53
    v_add_u32 v2, v2, v3
    s_lshl_b32 s63, s30, 5
    s_mul_i32 s63, s63, s53
    s_add_u32 s63, s63, s54
    v_add_u32 v2, s63, v2
    s_lshl_b32 s65, s53, 2
    s_lshl_b32 s64, s30, 13
    s_mul_i32 s63, s53, 0
    s_add_u32 m0, s64, 0
    s_nop 0
    buffer_load_dwordx4 v2, s[44:47], s63 offen lds
    s_add_u32 s63, s63, s65
    s_add_u32 m0, s64, 1024
    s_nop 0
    buffer_load_dwordx4 v2, s[44:47], s63 offen lds
    s_add_u32 s63, s63, s65
    s_add_u32 m0, s64, 2048
    s_nop 0
    buffer_load_dwordx4 v2, s[44:47], s63 offen lds
    s_add_u32 s63, s63, s65
    s_add_u32 m0, s64, 3072
    s_nop 0
    buffer_load_dwordx4 v2, s[44:47], s63 offen lds
    s_add_u32 s63, s63, s65
    s_add_u32 m0, s64, 4096
    s_nop 0
    buffer_load_dwordx4 v2, s[44:47], s63 offen lds
    s_add_u32 s63, s63, s65
    s_add_u32 m0, s64, 5120
    s_nop 0
    buffer_load_dwordx4 v2, s[44:47], s63 offen lds
    s_add_u32 s63, s63, s65
    s_add_u32 m0, s64, 6144
    s_nop 0
    buffer_load_dwordx4 v2, s[44:47], s63 offen lds
    s_add_u32 s63, s63, s65
    s_add_u32 m0, s64, 7168
    s_nop 0
    buffer_load_dwordx4 v2, s[44:47], s63 offen lds
    s_mul_i32 s63, s53, 128
    s_add_u32 m0, s64, 32768
    s_nop 0
    buffer_load_dwordx4 v2, s[44:47], s63 offen lds
    s_add_u32 s63, s63, s65
    s_add_u32 m0, s64, 33792
    s_nop 0
    buffer_load_dwordx4 v2, s[44:47], s63 offen lds
    s_add_u32 s63, s63, s65
    s_add_u32 m0, s64, 34816
    s_nop 0
    buffer_load_dwordx4 v2, s[44:47], s63 offen lds
    s_add_u32 s63, s63, s65
    s_add_u32 m0, s64, 35840
    s_nop 0
    buffer_load_dwordx4 v2, s[44:47], s63 offen lds
    s_add_u32 s63, s63, s65
    s_add_u32 m0, s64, 36864
    s_nop 0
    buffer_load_dwordx4 v2, s[44:47], s63 offen lds
    s_add_u32 s63, s63, s65
    s_add_u32 m0, s64, 37888
    s_nop 0
    buffer_load_dwordx4 v2, s[44:47], s63 offen lds
    s_add_u32 s63, s63, s65
    s_add_u32 m0, s64, 38912
    s_nop 0
    buffer_load_dwordx4 v2, s[44:47], s63 offen lds
    s_add_u32 s63, s63, s65
    s_add_u32 m0, s64, 39936
    s_nop 0
    buffer_load_dwordx4 v2, s[44:47], s63 offen lds
    s_mul_i32 s63, s53, 256
    s_add_u32 m0, s64, 65536
    s_nop 0
    buffer_load_dwordx4 v2, s[44:47], s63 offen lds
    s_add_u32 s63, s63, s65
    s_add_u32 m0, s64, 66560
    s_nop 0
    buffer_load_dwordx4 v2, s[44:47], s63 offen lds
    s_add_u32 s63, s63, s65
    s_add_u32 m0, s64, 67584
    s_nop 0
    buffer_load_dwordx4 v2, s[44:47], s63 offen lds
    s_add_u32 s63, s63, s65
    s_add_u32 m0, s64, 68608
    s_nop 0
    buffer_load_dwordx4 v2, s[44:47], s63 offen lds
    s_add_u32 s63, s63, s65
    s_add_u32 m0, s64, 69632
    s_nop 0
    buffer_load_dwordx4 v2, s[44:47], s63 offen lds
    s_add_u32 s63, s63, s65
    s_add_u32 m0, s64, 70656
    s_nop 0
    buffer_load_dwordx4 v2, s[44:47], s63 offen lds
    s_add_u32 s63, s63, s65
    s_add_u32 m0, s64, 71680
    s_nop 0
    buffer_load_dwordx4 v2, s[44:47], s63 offen lds
    s_add_u32 s63, s63, s65
    s_add_u32 m0, s64, 72704
    s_nop 0
    buffer_load_dwordx4 v2, s[44:47], s63 offen lds
    s_mul_i32 s63, s53, 384
    s_add_u32 m0, s64, 98304
    s_nop 0
    buffer_load_dwordx4 v2, s[44:47], s63 offen lds
    s_add_u32 s63, s63, s65
    s_add_u32 m0, s64, 99328
    s_nop 0
    buffer_load_dwordx4 v2, s[44:47], s63 offen lds
    s_add_u32 s63, s63, s65
    s_add_u32 m0, s64, 100352
    s_nop 0
    buffer_load_dwordx4 v2, s[44:47], s63 offen lds
    s_add_u32 s63, s63, s65
    s_add_u32 m0, s64, 101376
    s_nop 0
    buffer_load_dwordx4 v2, s[44:47], s63 offen lds
    s_add_u32 s63, s63, s65
    s_add_u32 m0, s64, 102400
    s_nop 0
    buffer_load_dwordx4 v2, s[44:47], s63 offen lds
    s_add_u32 s63, s63, s65
    s_add_u32 m0, s64, 103424
    s_nop 0
    buffer_load_dwordx4 v2, s[44:47], s63 offen lds
    s_add_u32 s63, s63, s65
    s_add_u32 m0, s64, 104448
    s_nop 0
    buffer_load_dwordx4 v2, s[44:47], s63 offen lds
    s_add_u32 s63, s63, s65
    s_add_u32 m0, s64, 105472
    s_nop 0
    buffer_load_dwordx4 v2, s[44:47], s63 offen lds
    s_lshl_b32 s63, s30, 6
    v_mov_b32 v228, 0x0
    v_and_b32 v246, 0x8, v240
    v_xor_b32 v228, v228, v246
    v_and_b32 v246, 0x20, v241
    v_xor_b32 v228, v228, v246
    v_and_b32 v246, 0x140, v242
    v_xor_b32 v228, v228, v246
    v_and_b32 v246, 0x280, v243
    v_xor_b32 v228, v228, v246
    v_and_b32 v246, 0x800, v244
    v_xor_b32 v228, v228, v246
    v_and_b32 v246, 0x1000, v245
    v_xor_b32 v228, v228, v246
    v_xor_b32 v228, s63, v228
    v_add_u32 v229, 1024, v228
    v_mov_b32 v230, 0x10
    v_and_b32 v246, 0x8, v240
    v_xor_b32 v230, v230, v246
    v_and_b32 v246, 0x20, v241
    v_xor_b32 v230, v230, v246
    v_and_b32 v246, 0x140, v242
    v_xor_b32 v230, v230, v246
    v_and_b32 v246, 0x280, v243
    v_xor_b32 v230, v230, v246
    v_and_b32 v246, 0x800, v244
    v_xor_b32 v230, v230, v246
    v_and_b32 v246, 0x1000, v245
    v_xor_b32 v230, v230, v246
    v_xor_b32 v230, s63, v230
    v_add_u32 v231, 1024, v230
    v_add_u32 v232, 0x10000, v228
    v_add_u32 v233, 0x10000, v229
    v_add_u32 v234, 0x10000, v230
    v_add_u32 v235, 0x10000, v231
    s_waitcnt vmcnt(24)
    s_barrier
    ds_read_b64_tr_b16 a[0:1], v228 offset:0
    ds_read_b64_tr_b16 a[2:3], v229 offset:0
    ds_read_b64_tr_b16 a[4:5], v230 offset:0
    ds_read_b64_tr_b16 a[6:7], v231 offset:0
    ds_read_b64_tr_b16 a[8:9], v228 offset:8192
    ds_read_b64_tr_b16 a[10:11], v229 offset:8192
    ds_read_b64_tr_b16 a[12:13], v230 offset:8192
    ds_read_b64_tr_b16 a[14:15], v231 offset:8192
    ds_read_b64_tr_b16 a[16:17], v228 offset:16384
    ds_read_b64_tr_b16 a[18:19], v229 offset:16384
    ds_read_b64_tr_b16 a[20:21], v230 offset:16384
    ds_read_b64_tr_b16 a[22:23], v231 offset:16384
    ds_read_b64_tr_b16 a[24:25], v228 offset:24576
    ds_read_b64_tr_b16 a[26:27], v229 offset:24576
    ds_read_b64_tr_b16 a[28:29], v230 offset:24576
    ds_read_b64_tr_b16 a[30:31], v231 offset:24576
    s_waitcnt lgkmcnt(0)
    s_barrier
    s_mul_i32 s63, s53, 512
    s_add_u32 m0, s64, 0
    s_nop 0
    buffer_load_dwordx4 v2, s[44:47], s63 offen lds
    s_add_u32 s63, s63, s65
    s_add_u32 m0, s64, 1024
    s_nop 0
    buffer_load_dwordx4 v2, s[44:47], s63 offen lds
    s_add_u32 s63, s63, s65
    s_add_u32 m0, s64, 2048
    s_nop 0
    buffer_load_dwordx4 v2, s[44:47], s63 offen lds
    s_add_u32 s63, s63, s65
    s_add_u32 m0, s64, 3072
    s_nop 0
    buffer_load_dwordx4 v2, s[44:47], s63 offen lds
    s_add_u32 s63, s63, s65
    s_add_u32 m0, s64, 4096
    s_nop 0
    buffer_load_dwordx4 v2, s[44:47], s63 offen lds
    s_add_u32 s63, s63, s65
    s_add_u32 m0, s64, 5120
    s_nop 0
    buffer_load_dwordx4 v2, s[44:47], s63 offen lds
    s_add_u32 s63, s63, s65
    s_add_u32 m0, s64, 6144
    s_nop 0
    buffer_load_dwordx4 v2, s[44:47], s63 offen lds
    s_add_u32 s63, s63, s65
    s_add_u32 m0, s64, 7168
    s_nop 0
    buffer_load_dwordx4 v2, s[44:47], s63 offen lds
    s_waitcnt vmcnt(24)
    s_barrier
    ds_read_b64_tr_b16 a[32:33], v228 offset:32768
    ds_read_b64_tr_b16 a[34:35], v229 offset:32768
    ds_read_b64_tr_b16 a[36:37], v230 offset:32768
    ds_read_b64_tr_b16 a[38:39], v231 offset:32768
    ds_read_b64_tr_b16 a[40:41], v228 offset:40960
    ds_read_b64_tr_b16 a[42:43], v229 offset:40960
    ds_read_b64_tr_b16 a[44:45], v230 offset:40960
    ds_read_b64_tr_b16 a[46:47], v231 offset:40960
    ds_read_b64_tr_b16 a[48:49], v228 offset:49152
    ds_read_b64_tr_b16 a[50:51], v229 offset:49152
    ds_read_b64_tr_b16 a[52:53], v230 offset:49152
    ds_read_b64_tr_b16 a[54:55], v231 offset:49152
    ds_read_b64_tr_b16 a[56:57], v228 offset:57344
    ds_read_b64_tr_b16 a[58:59], v229 offset:57344
    ds_read_b64_tr_b16 a[60:61], v230 offset:57344
    ds_read_b64_tr_b16 a[62:63], v231 offset:57344
    s_waitcnt lgkmcnt(0)
    s_barrier
    s_mul_i32 s63, s53, 640
    s_add_u32 m0, s64, 32768
    s_nop 0
    buffer_load_dwordx4 v2, s[44:47], s63 offen lds
    s_add_u32 s63, s63, s65
    s_add_u32 m0, s64, 33792
    s_nop 0
    buffer_load_dwordx4 v2, s[44:47], s63 offen lds
    s_add_u32 s63, s63, s65
    s_add_u32 m0, s64, 34816
    s_nop 0
    buffer_load_dwordx4 v2, s[44:47], s63 offen lds
    s_add_u32 s63, s63, s65
    s_add_u32 m0, s64, 35840
    s_nop 0
    buffer_load_dwordx4 v2, s[44:47], s63 offen lds
    s_add_u32 s63, s63, s65
    s_add_u32 m0, s64, 36864
    s_nop 0
    buffer_load_dwordx4 v2, s[44:47], s63 offen lds
    s_add_u32 s63, s63, s65
    s_add_u32 m0, s64, 37888
    s_nop 0
    buffer_load_dwordx4 v2, s[44:47], s63 offen lds
    s_add_u32 s63, s63, s65
    s_add_u32 m0, s64, 38912
    s_nop 0
    buffer_load_dwordx4 v2, s[44:47], s63 offen lds
    s_add_u32 s63, s63, s65
    s_add_u32 m0, s64, 39936
    s_nop 0
    buffer_load_dwordx4 v2, s[44:47], s63 offen lds
    s_waitcnt vmcnt(24)
    s_barrier
    ds_read_b64_tr_b16 a[64:65], v232 offset:0
    ds_read_b64_tr_b16 a[66:67], v233 offset:0
    ds_read_b64_tr_b16 a[68:69], v234 offset:0
    ds_read_b64_tr_b16 a[70:71], v235 offset:0
    ds_read_b64_tr_b16 a[72:73], v232 offset:8192
    ds_read_b64_tr_b16 a[74:75], v233 offset:8192
    ds_read_b64_tr_b16 a[76:77], v234 offset:8192
    ds_read_b64_tr_b16 a[78:79], v235 offset:8192
    ds_read_b64_tr_b16 a[80:81], v232 offset:16384
    ds_read_b64_tr_b16 a[82:83], v233 offset:16384
    ds_read_b64_tr_b16 a[84:85], v234 offset:16384
    ds_read_b64_tr_b16 a[86:87], v235 offset:16384
    ds_read_b64_tr_b16 a[88:89], v232 offset:24576
    ds_read_b64_tr_b16 a[90:91], v233 offset:24576
    ds_read_b64_tr_b16 a[92:93], v234 offset:24576
    ds_read_b64_tr_b16 a[94:95], v235 offset:24576
    s_waitcnt lgkmcnt(0)
    s_barrier
    s_mul_i32 s63, s53, 768
    s_add_u32 m0, s64, 65536
    s_nop 0
    buffer_load_dwordx4 v2, s[44:47], s63 offen lds
    s_add_u32 s63, s63, s65
    s_add_u32 m0, s64, 66560
    s_nop 0
    buffer_load_dwordx4 v2, s[44:47], s63 offen lds
    s_add_u32 s63, s63, s65
    s_add_u32 m0, s64, 67584
    s_nop 0
    buffer_load_dwordx4 v2, s[44:47], s63 offen lds
    s_add_u32 s63, s63, s65
    s_add_u32 m0, s64, 68608
    s_nop 0
    buffer_load_dwordx4 v2, s[44:47], s63 offen lds
    s_add_u32 s63, s63, s65
    s_add_u32 m0, s64, 69632
    s_nop 0
    buffer_load_dwordx4 v2, s[44:47], s63 offen lds
    s_add_u32 s63, s63, s65
    s_add_u32 m0, s64, 70656
    s_nop 0
    buffer_load_dwordx4 v2, s[44:47], s63 offen lds
    s_add_u32 s63, s63, s65
    s_add_u32 m0, s64, 71680
    s_nop 0
    buffer_load_dwordx4 v2, s[44:47], s63 offen lds
    s_add_u32 s63, s63, s65
    s_add_u32 m0, s64, 72704
    s_nop 0
    buffer_load_dwordx4 v2, s[44:47], s63 offen lds
    s_waitcnt vmcnt(24)
    s_barrier
    ds_read_b64_tr_b16 a[96:97], v232 offset:32768
    ds_read_b64_tr_b16 a[98:99], v233 offset:32768
    ds_read_b64_tr_b16 a[100:101], v234 offset:32768
    ds_read_b64_tr_b16 a[102:103], v235 offset:32768
    ds_read_b64_tr_b16 a[104:105], v232 offset:40960
    ds_read_b64_tr_b16 a[106:107], v233 offset:40960
    ds_read_b64_tr_b16 a[108:109], v234 offset:40960
    ds_read_b64_tr_b16 a[110:111], v235 offset:40960
    ds_read_b64_tr_b16 a[112:113], v232 offset:49152
    ds_read_b64_tr_b16 a[114:115], v233 offset:49152
    ds_read_b64_tr_b16 a[116:117], v234 offset:49152
    ds_read_b64_tr_b16 a[118:119], v235 offset:49152
    ds_read_b64_tr_b16 a[120:121], v232 offset:57344
    ds_read_b64_tr_b16 a[122:123], v233 offset:57344
    ds_read_b64_tr_b16 a[124:125], v234 offset:57344
    ds_read_b64_tr_b16 a[126:127], v235 offset:57344
    s_waitcnt lgkmcnt(0)
    s_barrier
    s_mul_i32 s63, s53, 896
    s_add_u32 m0, s64, 98304
    s_nop 0
    buffer_load_dwordx4 v2, s[44:47], s63 offen lds
    s_add_u32 s63, s63, s65
    s_add_u32 m0, s64, 99328
    s_nop 0
    buffer_load_dwordx4 v2, s[44:47], s63 offen lds
    s_add_u32 s63, s63, s65
    s_add_u32 m0, s64, 100352
    s_nop 0
    buffer_load_dwordx4 v2, s[44:47], s63 offen lds
    s_add_u32 s63, s63, s65
    s_add_u32 m0, s64, 101376
    s_nop 0
    buffer_load_dwordx4 v2, s[44:47], s63 offen lds
    s_add_u32 s63, s63, s65
    s_add_u32 m0, s64, 102400
    s_nop 0
    buffer_load_dwordx4 v2, s[44:47], s63 offen lds
    s_add_u32 s63, s63, s65
    s_add_u32 m0, s64, 103424
    s_nop 0
    buffer_load_dwordx4 v2, s[44:47], s63 offen lds
    s_add_u32 s63, s63, s65
    s_add_u32 m0, s64, 104448
    s_nop 0
    buffer_load_dwordx4 v2, s[44:47], s63 offen lds
    s_add_u32 s63, s63, s65
    s_add_u32 m0, s64, 105472
    s_nop 0
    buffer_load_dwordx4 v2, s[44:47], s63 offen lds
    s_waitcnt vmcnt(24)
    s_barrier
    ds_read_b64_tr_b16 a[128:129], v228 offset:0
    ds_read_b64_tr_b16 a[130:131], v229 offset:0
    ds_read_b64_tr_b16 a[132:133], v230 offset:0
    ds_read_b64_tr_b16 a[134:135], v231 offset:0
    ds_read_b64_tr_b16 a[136:137], v228 offset:8192
    ds_read_b64_tr_b16 a[138:139], v229 offset:8192
    ds_read_b64_tr_b16 a[140:141], v230 offset:8192
    ds_read_b64_tr_b16 a[142:143], v231 offset:8192
    ds_read_b64_tr_b16 a[144:145], v228 offset:16384
    ds_read_b64_tr_b16 a[146:147], v229 offset:16384
    ds_read_b64_tr_b16 a[148:149], v230 offset:16384
    ds_read_b64_tr_b16 a[150:151], v231 offset:16384
    ds_read_b64_tr_b16 a[152:153], v228 offset:24576
    ds_read_b64_tr_b16 a[154:155], v229 offset:24576
    ds_read_b64_tr_b16 a[156:157], v230 offset:24576
    ds_read_b64_tr_b16 a[158:159], v231 offset:24576
    s_waitcnt lgkmcnt(0)
    s_barrier
    s_lshl_b32 s67, s30, 10
    s_mul_i32 s85, s55, 7
    s_sub_u32 s84, s56, s85
    s_add_u32 s85, s85, s56
    s_sub_u32 s85, 0x10000, s85
    s_sub_u32 s57, s57, s85
    s_add_u32 m0, s67, 0
    s_add_u32 s57, s57, s85
    buffer_load_dwordx4 v95, s[48:51], s57 offen lds
    s_add_u32 m0, s67, 4096
    s_add_u32 s57, s57, s55
    buffer_load_dwordx4 v95, s[48:51], s57 offen lds
    s_add_u32 m0, s67, 8192
    s_add_u32 s57, s57, s55
    buffer_load_dwordx4 v95, s[48:51], s57 offen lds
    s_add_u32 m0, s67, 12288
    s_add_u32 s57, s57, s55
    buffer_load_dwordx4 v95, s[48:51], s57 offen lds
    s_add_u32 m0, s67, 16384
    s_add_u32 s57, s57, s55
    buffer_load_dwordx4 v95, s[48:51], s57 offen lds
    s_add_u32 m0, s67, 20480
    s_add_u32 s57, s57, s55
    buffer_load_dwordx4 v95, s[48:51], s57 offen lds
    s_add_u32 m0, s67, 24576
    s_add_u32 s57, s57, s55
    buffer_load_dwordx4 v95, s[48:51], s57 offen lds
    s_add_u32 m0, s67, 28672
    s_add_u32 s57, s57, s55
    buffer_load_dwordx4 v95, s[48:51], s57 offen lds
    s_waitcnt vmcnt(24)
    s_barrier
    ds_read_b64_tr_b16 a[160:161], v228 offset:32768
    ds_read_b64_tr_b16 a[162:163], v229 offset:32768
    ds_read_b64_tr_b16 a[164:165], v230 offset:32768
    ds_read_b64_tr_b16 a[166:167], v231 offset:32768
    ds_read_b64_tr_b16 a[168:169], v228 offset:40960
    ds_read_b64_tr_b16 a[170:171], v229 offset:40960
    ds_read_b64_tr_b16 a[172:173], v230 offset:40960
    ds_read_b64_tr_b16 a[174:175], v231 offset:40960
    ds_read_b64_tr_b16 a[176:177], v228 offset:49152
    ds_read_b64_tr_b16 a[178:179], v229 offset:49152
    ds_read_b64_tr_b16 a[180:181], v230 offset:49152
    ds_read_b64_tr_b16 a[182:183], v231 offset:49152
    ds_read_b64_tr_b16 a[184:185], v228 offset:57344
    ds_read_b64_tr_b16 a[186:187], v229 offset:57344
    ds_read_b64_tr_b16 a[188:189], v230 offset:57344
    ds_read_b64_tr_b16 a[190:191], v231 offset:57344
    s_waitcnt lgkmcnt(0)
    s_barrier
    s_add_u32 m0, s67, 32768
    s_add_u32 s57, s57, s84
    buffer_load_dwordx4 v95, s[48:51], s57 offen lds
    s_add_u32 m0, s67, 36864
    s_add_u32 s57, s57, s55
    buffer_load_dwordx4 v95, s[48:51], s57 offen lds
    s_add_u32 m0, s67, 40960
    s_add_u32 s57, s57, s55
    buffer_load_dwordx4 v95, s[48:51], s57 offen lds
    s_add_u32 m0, s67, 45056
    s_add_u32 s57, s57, s55
    buffer_load_dwordx4 v95, s[48:51], s57 offen lds
    s_add_u32 m0, s67, 49152
    s_add_u32 s57, s57, s55
    buffer_load_dwordx4 v95, s[48:51], s57 offen lds
    s_add_u32 m0, s67, 53248
    s_add_u32 s57, s57, s55
    buffer_load_dwordx4 v95, s[48:51], s57 offen lds
    s_add_u32 m0, s67, 57344
    s_add_u32 s57, s57, s55
    buffer_load_dwordx4 v95, s[48:51], s57 offen lds
    s_add_u32 m0, s67, 61440
    s_add_u32 s57, s57, s55
    buffer_load_dwordx4 v95, s[48:51], s57 offen lds
    s_waitcnt vmcnt(24)
    s_barrier
    ds_read_b64_tr_b16 a[192:193], v232 offset:0
    ds_read_b64_tr_b16 a[194:195], v233 offset:0
    ds_read_b64_tr_b16 a[196:197], v234 offset:0
    ds_read_b64_tr_b16 a[198:199], v235 offset:0
    ds_read_b64_tr_b16 a[200:201], v232 offset:8192
    ds_read_b64_tr_b16 a[202:203], v233 offset:8192
    ds_read_b64_tr_b16 a[204:205], v234 offset:8192
    ds_read_b64_tr_b16 a[206:207], v235 offset:8192
    ds_read_b64_tr_b16 a[208:209], v232 offset:16384
    ds_read_b64_tr_b16 a[210:211], v233 offset:16384
    ds_read_b64_tr_b16 a[212:213], v234 offset:16384
    ds_read_b64_tr_b16 a[214:215], v235 offset:16384
    ds_read_b64_tr_b16 a[216:217], v232 offset:24576
    ds_read_b64_tr_b16 a[218:219], v233 offset:24576
    ds_read_b64_tr_b16 a[220:221], v234 offset:24576
    ds_read_b64_tr_b16 a[222:223], v235 offset:24576
    s_waitcnt lgkmcnt(0)
    s_barrier
    s_add_u32 m0, s67, 65536
    s_add_u32 s57, s57, s85
    buffer_load_dwordx4 v95, s[48:51], s57 offen lds
    s_add_u32 m0, s67, 69632
    s_add_u32 s57, s57, s55
    buffer_load_dwordx4 v95, s[48:51], s57 offen lds
    s_add_u32 m0, s67, 73728
    s_add_u32 s57, s57, s55
    buffer_load_dwordx4 v95, s[48:51], s57 offen lds
    s_add_u32 m0, s67, 77824
    s_add_u32 s57, s57, s55
    buffer_load_dwordx4 v95, s[48:51], s57 offen lds
    s_add_u32 m0, s67, 81920
    s_add_u32 s57, s57, s55
    buffer_load_dwordx4 v95, s[48:51], s57 offen lds
    s_waitcnt vmcnt(21)
    s_barrier
    ds_read_b64_tr_b16 a[224:225], v232 offset:32768
    ds_read_b64_tr_b16 a[226:227], v233 offset:32768
    ds_read_b64_tr_b16 a[228:229], v234 offset:32768
    ds_read_b64_tr_b16 a[230:231], v235 offset:32768
    ds_read_b64_tr_b16 a[232:233], v232 offset:40960
    ds_read_b64_tr_b16 a[234:235], v233 offset:40960
    ds_read_b64_tr_b16 a[236:237], v234 offset:40960
    ds_read_b64_tr_b16 a[238:239], v235 offset:40960
    ds_read_b64_tr_b16 a[240:241], v232 offset:49152
    ds_read_b64_tr_b16 a[242:243], v233 offset:49152
    ds_read_b64_tr_b16 a[244:245], v234 offset:49152
    ds_read_b64_tr_b16 a[246:247], v235 offset:49152
    ds_read_b64_tr_b16 a[248:249], v232 offset:57344
    ds_read_b64_tr_b16 a[250:251], v233 offset:57344
    ds_read_b64_tr_b16 a[252:253], v234 offset:57344
    ds_read_b64_tr_b16 a[254:255], v235 offset:57344
    s_waitcnt lgkmcnt(0)
    s_barrier
    s_branch L_lw_b
L_lw_v:
    v_mov_b32 v2, 0x0
    v_and_b32 v246, 0x10, v240
    v_xor_b32 v2, v2, v246
    v_and_b32 v246, 0x20, v241
    v_xor_b32 v2, v2, v246
    v_and_b32 v246, 0x40, v242
    v_xor_b32 v2, v2, v246
    v_and_b32 v246, 0x80, v243
    v_xor_b32 v2, v2, v246
    v_and_b32 v246, 0x40, v244
    v_xor_b32 v2, v2, v246
    v_and_b32 v246, 0x80, v245
    v_xor_b32 v2, v2, v246
    v_lshrrev_b32 v3, 4, v1
    v_mul_lo_u32 v3, v3, s53
    v_add_u32 v2, v2, v3
    s_lshl_b32 s63, s30, 5
    s_mul_i32 s63, s63, s53
    s_add_u32 s63, s63, s54
    v_add_u32 v2, s63, v2
    s_lshl_b32 s65, s53, 2
    s_lshl_b32 s64, s30, 13
    s_mul_i32 s63, s53, 0
    s_add_u32 m0, s64, 0
    s_nop 0
    buffer_load_dwordx4 v2, s[44:47], s63 offen lds
    s_add_u32 s63, s63, s65
    s_add_u32 m0, s64, 1024
    s_nop 0
    buffer_load_dwordx4 v2, s[44:47], s63 offen lds
    s_add_u32 s63, s63, s65
    s_add_u32 m0, s64, 2048
    s_nop 0
    buffer_load_dwordx4 v2, s[44:47], s63 offen lds
    s_add_u32 s63, s63, s65
    s_add_u32 m0, s64, 3072
    s_nop 0
    buffer_load_dwordx4 v2, s[44:47], s63 offen lds
    s_add_u32 s63, s63, s65
    s_add_u32 m0, s64, 4096
    s_nop 0
    buffer_load_dwordx4 v2, s[44:47], s63 offen lds
    s_add_u32 s63, s63, s65
    s_add_u32 m0, s64, 5120
    s_nop 0
    buffer_load_dwordx4 v2, s[44:47], s63 offen lds
    s_add_u32 s63, s63, s65
    s_add_u32 m0, s64, 6144
    s_nop 0
    buffer_load_dwordx4 v2, s[44:47], s63 offen lds
    s_add_u32 s63, s63, s65
    s_add_u32 m0, s64, 7168
    s_nop 0
    buffer_load_dwordx4 v2, s[44:47], s63 offen lds
    s_mul_i32 s63, s53, 128
    s_add_u32 m0, s64, 32768
    s_nop 0
    buffer_load_dwordx4 v2, s[44:47], s63 offen lds
    s_add_u32 s63, s63, s65
    s_add_u32 m0, s64, 33792
    s_nop 0
    buffer_load_dwordx4 v2, s[44:47], s63 offen lds
    s_add_u32 s63, s63, s65
    s_add_u32 m0, s64, 34816
    s_nop 0
    buffer_load_dwordx4 v2, s[44:47], s63 offen lds
    s_add_u32 s63, s63, s65
    s_add_u32 m0, s64, 35840
    s_nop 0
    buffer_load_dwordx4 v2, s[44:47], s63 offen lds
    s_add_u32 s63, s63, s65
    s_add_u32 m0, s64, 36864
    s_nop 0
    buffer_load_dwordx4 v2, s[44:47], s63 offen lds
    s_add_u32 s63, s63, s65
    s_add_u32 m0, s64, 37888
    s_nop 0
    buffer_load_dwordx4 v2, s[44:47], s63 offen lds
    s_add_u32 s63, s63, s65
    s_add_u32 m0, s64, 38912
    s_nop 0
    buffer_load_dwordx4 v2, s[44:47], s63 offen lds
    s_add_u32 s63, s63, s65
    s_add_u32 m0, s64, 39936
    s_nop 0
    buffer_load_dwordx4 v2, s[44:47], s63 offen lds
    s_mul_i32 s63, s53, 256
    s_add_u32 m0, s64, 65536
    s_nop 0
    buffer_load_dwordx4 v2, s[44:47], s63 offen lds
    s_add_u32 s63, s63, s65
    s_add_u32 m0, s64, 66560
    s_nop 0
    buffer_load_dwordx4 v2, s[44:47], s63 offen lds
    s_add_u32 s63, s63, s65
    s_add_u32 m0, s64, 67584
    s_nop 0
    buffer_load_dwordx4 v2, s[44:47], s63 offen lds
    s_add_u32 s63, s63, s65
    s_add_u32 m0, s64, 68608
    s_nop 0
    buffer_load_dwordx4 v2, s[44:47], s63 offen lds
    s_add_u32 s63, s63, s65
    s_add_u32 m0, s64, 69632
    s_nop 0
    buffer_load_dwordx4 v2, s[44:47], s63 offen lds
    s_add_u32 s63, s63, s65
    s_add_u32 m0, s64, 70656
    s_nop 0
    buffer_load_dwordx4 v2, s[44:47], s63 offen lds
    s_add_u32 s63, s63, s65
    s_add_u32 m0, s64, 71680
    s_nop 0
    buffer_load_dwordx4 v2, s[44:47], s63 offen lds
    s_add_u32 s63, s63, s65
    s_add_u32 m0, s64, 72704
    s_nop 0
    buffer_load_dwordx4 v2, s[44:47], s63 offen lds
    s_mul_i32 s63, s53, 384
    s_add_u32 m0, s64, 98304
    s_nop 0
    buffer_load_dwordx4 v2, s[44:47], s63 offen lds
    s_add_u32 s63, s63, s65
    s_add_u32 m0, s64, 99328
    s_nop 0
    buffer_load_dwordx4 v2, s[44:47], s63 offen lds
    s_add_u32 s63, s63, s65
    s_add_u32 m0, s64, 100352
    s_nop 0
    buffer_load_dwordx4 v2, s[44:47], s63 offen lds
    s_add_u32 s63, s63, s65
    s_add_u32 m0, s64, 101376
    s_nop 0
    buffer_load_dwordx4 v2, s[44:47], s63 offen lds
    s_add_u32 s63, s63, s65
    s_add_u32 m0, s64, 102400
    s_nop 0
    buffer_load_dwordx4 v2, s[44:47], s63 offen lds
    s_add_u32 s63, s63, s65
    s_add_u32 m0, s64, 103424
    s_nop 0
    buffer_load_dwordx4 v2, s[44:47], s63 offen lds
    s_add_u32 s63, s63, s65
    s_add_u32 m0, s64, 104448
    s_nop 0
    buffer_load_dwordx4 v2, s[44:47], s63 offen lds
    s_add_u32 s63, s63, s65
    s_add_u32 m0, s64, 105472
    s_nop 0
    buffer_load_dwordx4 v2, s[44:47], s63 offen lds
    s_lshl_b32 s63, s30, 6
    v_mov_b32 v228, 0x0
    v_and_b32 v246, 0x8, v240
    v_xor_b32 v228, v228, v246
    v_and_b32 v246, 0x10, v241
    v_xor_b32 v228, v228, v246
    v_and_b32 v246, 0x140, v242
    v_xor_b32 v228, v228, v246
    v_and_b32 v246, 0x280, v243
    v_xor_b32 v228, v228, v246
    v_and_b32 v246, 0x800, v244
    v_xor_b32 v228, v228, v246
    v_and_b32 v246, 0x1000, v245
    v_xor_b32 v228, v228, v246
    v_xor_b32 v228, s63, v228
    v_add_u32 v229, 1024, v228
    v_mov_b32 v230, 0x20
    v_and_b32 v246, 0x8, v240
    v_xor_b32 v230, v230, v246
    v_and_b32 v246, 0x10, v241
    v_xor_b32 v230, v230, v246
    v_and_b32 v246, 0x140, v242
    v_xor_b32 v230, v230, v246
    v_and_b32 v246, 0x280, v243
    v_xor_b32 v230, v230, v246
    v_and_b32 v246, 0x800, v244
    v_xor_b32 v230, v230, v246
    v_and_b32 v246, 0x1000, v245
    v_xor_b32 v230, v230, v246
    v_xor_b32 v230, s63, v230
    v_add_u32 v231, 1024, v230
    v_add_u32 v232, 0x10000, v228
    v_add_u32 v233, 0x10000, v229
    v_add_u32 v234, 0x10000, v230
    v_add_u32 v235, 0x10000, v231
    s_waitcnt vmcnt(24)
    s_barrier
    ds_read_b64_tr_b16 a[0:1], v228 offset:0
    ds_read_b64_tr_b16 a[2:3], v229 offset:0
    ds_read_b64_tr_b16 a[4:5], v230 offset:0
    ds_read_b64_tr_b16 a[6:7], v231 offset:0
    ds_read_b64_tr_b16 a[8:9], v228 offset:8192
    ds_read_b64_tr_b16 a[10:11], v229 offset:8192
    ds_read_b64_tr_b16 a[12:13], v230 offset:8192
    ds_read_b64_tr_b16 a[14:15], v231 offset:8192
    ds_read_b64_tr_b16 a[16:17], v228 offset:16384
    ds_read_b64_tr_b16 a[18:19], v229 offset:16384
    ds_read_b64_tr_b16 a[20:21], v230 offset:16384
    ds_read_b64_tr_b16 a[22:23], v231 offset:16384
    ds_read_b64_tr_b16 a[24:25], v228 offset:24576
    ds_read_b64_tr_b16 a[26:27], v229 offset:24576
    ds_read_b64_tr_b16 a[28:29], v230 offset:24576
    ds_read_b64_tr_b16 a[30:31], v231 offset:24576
    s_waitcnt lgkmcnt(0)
    s_barrier
    s_mul_i32 s63, s53, 512
    s_add_u32 m0, s64, 0
    s_nop 0
    buffer_load_dwordx4 v2, s[44:47], s63 offen lds
    s_add_u32 s63, s63, s65
    s_add_u32 m0, s64, 1024
    s_nop 0
    buffer_load_dwordx4 v2, s[44:47], s63 offen lds
    s_add_u32 s63, s63, s65
    s_add_u32 m0, s64, 2048
    s_nop 0
    buffer_load_dwordx4 v2, s[44:47], s63 offen lds
    s_add_u32 s63, s63, s65
    s_add_u32 m0, s64, 3072
    s_nop 0
    buffer_load_dwordx4 v2, s[44:47], s63 offen lds
    s_add_u32 s63, s63, s65
    s_add_u32 m0, s64, 4096
    s_nop 0
    buffer_load_dwordx4 v2, s[44:47], s63 offen lds
    s_add_u32 s63, s63, s65
    s_add_u32 m0, s64, 5120
    s_nop 0
    buffer_load_dwordx4 v2, s[44:47], s63 offen lds
    s_add_u32 s63, s63, s65
    s_add_u32 m0, s64, 6144
    s_nop 0
    buffer_load_dwordx4 v2, s[44:47], s63 offen lds
    s_add_u32 s63, s63, s65
    s_add_u32 m0, s64, 7168
    s_nop 0
    buffer_load_dwordx4 v2, s[44:47], s63 offen lds
    s_waitcnt vmcnt(24)
    s_barrier
    ds_read_b64_tr_b16 a[32:33], v228 offset:32768
    ds_read_b64_tr_b16 a[34:35], v229 offset:32768
    ds_read_b64_tr_b16 a[36:37], v230 offset:32768
    ds_read_b64_tr_b16 a[38:39], v231 offset:32768
    ds_read_b64_tr_b16 a[40:41], v228 offset:40960
    ds_read_b64_tr_b16 a[42:43], v229 offset:40960
    ds_read_b64_tr_b16 a[44:45], v230 offset:40960
    ds_read_b64_tr_b16 a[46:47], v231 offset:40960
    ds_read_b64_tr_b16 a[48:49], v228 offset:49152
    ds_read_b64_tr_b16 a[50:51], v229 offset:49152
    ds_read_b64_tr_b16 a[52:53], v230 offset:49152
    ds_read_b64_tr_b16 a[54:55], v231 offset:49152
    ds_read_b64_tr_b16 a[56:57], v228 offset:57344
    ds_read_b64_tr_b16 a[58:59], v229 offset:57344
    ds_read_b64_tr_b16 a[60:61], v230 offset:57344
    ds_read_b64_tr_b16 a[62:63], v231 offset:57344
    s_waitcnt lgkmcnt(0)
    s_barrier
    s_mul_i32 s63, s53, 640
    s_add_u32 m0, s64, 32768
    s_nop 0
    buffer_load_dwordx4 v2, s[44:47], s63 offen lds
    s_add_u32 s63, s63, s65
    s_add_u32 m0, s64, 33792
    s_nop 0
    buffer_load_dwordx4 v2, s[44:47], s63 offen lds
    s_add_u32 s63, s63, s65
    s_add_u32 m0, s64, 34816
    s_nop 0
    buffer_load_dwordx4 v2, s[44:47], s63 offen lds
    s_add_u32 s63, s63, s65
    s_add_u32 m0, s64, 35840
    s_nop 0
    buffer_load_dwordx4 v2, s[44:47], s63 offen lds
    s_add_u32 s63, s63, s65
    s_add_u32 m0, s64, 36864
    s_nop 0
    buffer_load_dwordx4 v2, s[44:47], s63 offen lds
    s_add_u32 s63, s63, s65
    s_add_u32 m0, s64, 37888
    s_nop 0
    buffer_load_dwordx4 v2, s[44:47], s63 offen lds
    s_add_u32 s63, s63, s65
    s_add_u32 m0, s64, 38912
    s_nop 0
    buffer_load_dwordx4 v2, s[44:47], s63 offen lds
    s_add_u32 s63, s63, s65
    s_add_u32 m0, s64, 39936
    s_nop 0
    buffer_load_dwordx4 v2, s[44:47], s63 offen lds
    s_waitcnt vmcnt(24)
    s_barrier
    ds_read_b64_tr_b16 a[64:65], v232 offset:0
    ds_read_b64_tr_b16 a[66:67], v233 offset:0
    ds_read_b64_tr_b16 a[68:69], v234 offset:0
    ds_read_b64_tr_b16 a[70:71], v235 offset:0
    ds_read_b64_tr_b16 a[72:73], v232 offset:8192
    ds_read_b64_tr_b16 a[74:75], v233 offset:8192
    ds_read_b64_tr_b16 a[76:77], v234 offset:8192
    ds_read_b64_tr_b16 a[78:79], v235 offset:8192
    ds_read_b64_tr_b16 a[80:81], v232 offset:16384
    ds_read_b64_tr_b16 a[82:83], v233 offset:16384
    ds_read_b64_tr_b16 a[84:85], v234 offset:16384
    ds_read_b64_tr_b16 a[86:87], v235 offset:16384
    ds_read_b64_tr_b16 a[88:89], v232 offset:24576
    ds_read_b64_tr_b16 a[90:91], v233 offset:24576
    ds_read_b64_tr_b16 a[92:93], v234 offset:24576
    ds_read_b64_tr_b16 a[94:95], v235 offset:24576
    s_waitcnt lgkmcnt(0)
    s_barrier
    s_mul_i32 s63, s53, 768
    s_add_u32 m0, s64, 65536
    s_nop 0
    buffer_load_dwordx4 v2, s[44:47], s63 offen lds
    s_add_u32 s63, s63, s65
    s_add_u32 m0, s64, 66560
    s_nop 0
    buffer_load_dwordx4 v2, s[44:47], s63 offen lds
    s_add_u32 s63, s63, s65
    s_add_u32 m0, s64, 67584
    s_nop 0
    buffer_load_dwordx4 v2, s[44:47], s63 offen lds
    s_add_u32 s63, s63, s65
    s_add_u32 m0, s64, 68608
    s_nop 0
    buffer_load_dwordx4 v2, s[44:47], s63 offen lds
    s_add_u32 s63, s63, s65
    s_add_u32 m0, s64, 69632
    s_nop 0
    buffer_load_dwordx4 v2, s[44:47], s63 offen lds
    s_add_u32 s63, s63, s65
    s_add_u32 m0, s64, 70656
    s_nop 0
    buffer_load_dwordx4 v2, s[44:47], s63 offen lds
    s_add_u32 s63, s63, s65
    s_add_u32 m0, s64, 71680
    s_nop 0
    buffer_load_dwordx4 v2, s[44:47], s63 offen lds
    s_add_u32 s63, s63, s65
    s_add_u32 m0, s64, 72704
    s_nop 0
    buffer_load_dwordx4 v2, s[44:47], s63 offen lds
    s_waitcnt vmcnt(24)
    s_barrier
    ds_read_b64_tr_b16 a[96:97], v232 offset:32768
    ds_read_b64_tr_b16 a[98:99], v233 offset:32768
    ds_read_b64_tr_b16 a[100:101], v234 offset:32768
    ds_read_b64_tr_b16 a[102:103], v235 offset:32768
    ds_read_b64_tr_b16 a[104:105], v232 offset:40960
    ds_read_b64_tr_b16 a[106:107], v233 offset:40960
    ds_read_b64_tr_b16 a[108:109], v234 offset:40960
    ds_read_b64_tr_b16 a[110:111], v235 offset:40960
    ds_read_b64_tr_b16 a[112:113], v232 offset:49152
    ds_read_b64_tr_b16 a[114:115], v233 offset:49152
    ds_read_b64_tr_b16 a[116:117], v234 offset:49152
    ds_read_b64_tr_b16 a[118:119], v235 offset:49152
    ds_read_b64_tr_b16 a[120:121], v232 offset:57344
    ds_read_b64_tr_b16 a[122:123], v233 offset:57344
    ds_read_b64_tr_b16 a[124:125], v234 offset:57344
    ds_read_b64_tr_b16 a[126:127], v235 offset:57344
    s_waitcnt lgkmcnt(0)
    s_barrier
    s_mul_i32 s63, s53, 896
    s_add_u32 m0, s64, 98304
    s_nop 0
    buffer_load_dwordx4 v2, s[44:47], s63 offen lds
    s_add_u32 s63, s63, s65
    s_add_u32 m0, s64, 99328
    s_nop 0
    buffer_load_dwordx4 v2, s[44:47], s63 offen lds
    s_add_u32 s63, s63, s65
    s_add_u32 m0, s64, 100352
    s_nop 0
    buffer_load_dwordx4 v2, s[44:47], s63 offen lds
    s_add_u32 s63, s63, s65
    s_add_u32 m0, s64, 101376
    s_nop 0
    buffer_load_dwordx4 v2, s[44:47], s63 offen lds
    s_add_u32 s63, s63, s65
    s_add_u32 m0, s64, 102400
    s_nop 0
    buffer_load_dwordx4 v2, s[44:47], s63 offen lds
    s_add_u32 s63, s63, s65
    s_add_u32 m0, s64, 103424
    s_nop 0
    buffer_load_dwordx4 v2, s[44:47], s63 offen lds
    s_add_u32 s63, s63, s65
    s_add_u32 m0, s64, 104448
    s_nop 0
    buffer_load_dwordx4 v2, s[44:47], s63 offen lds
    s_add_u32 s63, s63, s65
    s_add_u32 m0, s64, 105472
    s_nop 0
    buffer_load_dwordx4 v2, s[44:47], s63 offen lds
    s_waitcnt vmcnt(24)
    s_barrier
    ds_read_b64_tr_b16 a[128:129], v228 offset:0
    ds_read_b64_tr_b16 a[130:131], v229 offset:0
    ds_read_b64_tr_b16 a[132:133], v230 offset:0
    ds_read_b64_tr_b16 a[134:135], v231 offset:0
    ds_read_b64_tr_b16 a[136:137], v228 offset:8192
    ds_read_b64_tr_b16 a[138:139], v229 offset:8192
    ds_read_b64_tr_b16 a[140:141], v230 offset:8192
    ds_read_b64_tr_b16 a[142:143], v231 offset:8192
    ds_read_b64_tr_b16 a[144:145], v228 offset:16384
    ds_read_b64_tr_b16 a[146:147], v229 offset:16384
    ds_read_b64_tr_b16 a[148:149], v230 offset:16384
    ds_read_b64_tr_b16 a[150:151], v231 offset:16384
    ds_read_b64_tr_b16 a[152:153], v228 offset:24576
    ds_read_b64_tr_b16 a[154:155], v229 offset:24576
    ds_read_b64_tr_b16 a[156:157], v230 offset:24576
    ds_read_b64_tr_b16 a[158:159], v231 offset:24576
    s_waitcnt lgkmcnt(0)
    s_barrier
    s_lshl_b32 s67, s30, 10
    s_mul_i32 s85, s55, 7
    s_sub_u32 s84, s56, s85
    s_add_u32 s85, s85, s56
    s_sub_u32 s85, 0x10000, s85
    s_sub_u32 s57, s57, s85
    s_add_u32 m0, s67, 0
    s_add_u32 s57, s57, s85
    buffer_load_dwordx4 v95, s[48:51], s57 offen lds
    s_add_u32 m0, s67, 4096
    s_add_u32 s57, s57, s55
    buffer_load_dwordx4 v95, s[48:51], s57 offen lds
    s_add_u32 m0, s67, 8192
    s_add_u32 s57, s57, s55
    buffer_load_dwordx4 v95, s[48:51], s57 offen lds
    s_add_u32 m0, s67, 12288
    s_add_u32 s57, s57, s55
    buffer_load_dwordx4 v95, s[48:51], s57 offen lds
    s_add_u32 m0, s67, 16384
    s_add_u32 s57, s57, s55
    buffer_load_dwordx4 v95, s[48:51], s57 offen lds
    s_add_u32 m0, s67, 20480
    s_add_u32 s57, s57, s55
    buffer_load_dwordx4 v95, s[48:51], s57 offen lds
    s_add_u32 m0, s67, 24576
    s_add_u32 s57, s57, s55
    buffer_load_dwordx4 v95, s[48:51], s57 offen lds
    s_add_u32 m0, s67, 28672
    s_add_u32 s57, s57, s55
    buffer_load_dwordx4 v95, s[48:51], s57 offen lds
    s_waitcnt vmcnt(24)
    s_barrier
    ds_read_b64_tr_b16 a[160:161], v228 offset:32768
    ds_read_b64_tr_b16 a[162:163], v229 offset:32768
    ds_read_b64_tr_b16 a[164:165], v230 offset:32768
    ds_read_b64_tr_b16 a[166:167], v231 offset:32768
    ds_read_b64_tr_b16 a[168:169], v228 offset:40960
    ds_read_b64_tr_b16 a[170:171], v229 offset:40960
    ds_read_b64_tr_b16 a[172:173], v230 offset:40960
    ds_read_b64_tr_b16 a[174:175], v231 offset:40960
    ds_read_b64_tr_b16 a[176:177], v228 offset:49152
    ds_read_b64_tr_b16 a[178:179], v229 offset:49152
    ds_read_b64_tr_b16 a[180:181], v230 offset:49152
    ds_read_b64_tr_b16 a[182:183], v231 offset:49152
    ds_read_b64_tr_b16 a[184:185], v228 offset:57344
    ds_read_b64_tr_b16 a[186:187], v229 offset:57344
    ds_read_b64_tr_b16 a[188:189], v230 offset:57344
    ds_read_b64_tr_b16 a[190:191], v231 offset:57344
    s_waitcnt lgkmcnt(0)
    s_barrier
    s_add_u32 m0, s67, 32768
    s_add_u32 s57, s57, s84
    buffer_load_dwordx4 v95, s[48:51], s57 offen lds
    s_add_u32 m0, s67, 36864
    s_add_u32 s57, s57, s55
    buffer_load_dwordx4 v95, s[48:51], s57 offen lds
    s_add_u32 m0, s67, 40960
    s_add_u32 s57, s57, s55
    buffer_load_dwordx4 v95, s[48:51], s57 offen lds
    s_add_u32 m0, s67, 45056
    s_add_u32 s57, s57, s55
    buffer_load_dwordx4 v95, s[48:51], s57 offen lds
    s_add_u32 m0, s67, 49152
    s_add_u32 s57, s57, s55
    buffer_load_dwordx4 v95, s[48:51], s57 offen lds
    s_add_u32 m0, s67, 53248
    s_add_u32 s57, s57, s55
    buffer_load_dwordx4 v95, s[48:51], s57 offen lds
    s_add_u32 m0, s67, 57344
    s_add_u32 s57, s57, s55
    buffer_load_dwordx4 v95, s[48:51], s57 offen lds
    s_add_u32 m0, s67, 61440
    s_add_u32 s57, s57, s55
    buffer_load_dwordx4 v95, s[48:51], s57 offen lds
    s_waitcnt vmcnt(24)
    s_barrier
    ds_read_b64_tr_b16 a[192:193], v232 offset:0
    ds_read_b64_tr_b16 a[194:195], v233 offset:0
    ds_read_b64_tr_b16 a[196:197], v234 offset:0
    ds_read_b64_tr_b16 a[198:199], v235 offset:0
    ds_read_b64_tr_b16 a[200:201], v232 offset:8192
    ds_read_b64_tr_b16 a[202:203], v233 offset:8192
    ds_read_b64_tr_b16 a[204:205], v234 offset:8192
    ds_read_b64_tr_b16 a[206:207], v235 offset:8192
    ds_read_b64_tr_b16 a[208:209], v232 offset:16384
    ds_read_b64_tr_b16 a[210:211], v233 offset:16384
    ds_read_b64_tr_b16 a[212:213], v234 offset:16384
    ds_read_b64_tr_b16 a[214:215], v235 offset:16384
    ds_read_b64_tr_b16 a[216:217], v232 offset:24576
    ds_read_b64_tr_b16 a[218:219], v233 offset:24576
    ds_read_b64_tr_b16 a[220:221], v234 offset:24576
    ds_read_b64_tr_b16 a[222:223], v235 offset:24576
    s_waitcnt lgkmcnt(0)
    s_barrier
    s_add_u32 m0, s67, 65536
    s_add_u32 s57, s57, s85
    buffer_load_dwordx4 v95, s[48:51], s57 offen lds
    s_add_u32 m0, s67, 69632
    s_add_u32 s57, s57, s55
    buffer_load_dwordx4 v95, s[48:51], s57 offen lds
    s_add_u32 m0, s67, 73728
    s_add_u32 s57, s57, s55
    buffer_load_dwordx4 v95, s[48:51], s57 offen lds
    s_add_u32 m0, s67, 77824
    s_add_u32 s57, s57, s55
    buffer_load_dwordx4 v95, s[48:51], s57 offen lds
    s_add_u32 m0, s67, 81920
    s_add_u32 s57, s57, s55
    buffer_load_dwordx4 v95, s[48:51], s57 offen lds
    s_waitcnt vmcnt(21)
    s_barrier
    ds_read_b64_tr_b16 a[224:225], v232 offset:32768
    ds_read_b64_tr_b16 a[226:227], v233 offset:32768
    ds_read_b64_tr_b16 a[228:229], v234 offset:32768
    ds_read_b64_tr_b16 a[230:231], v235 offset:32768
    ds_read_b64_tr_b16 a[232:233], v232 offset:40960
    ds_read_b64_tr_b16 a[234:235], v233 offset:40960
    ds_read_b64_tr_b16 a[236:237], v234 offset:40960
    ds_read_b64_tr_b16 a[238:239], v235 offset:40960
    ds_read_b64_tr_b16 a[240:241], v232 offset:49152
    ds_read_b64_tr_b16 a[242:243], v233 offset:49152
    ds_read_b64_tr_b16 a[244:245], v234 offset:49152
    ds_read_b64_tr_b16 a[246:247], v235 offset:49152
    ds_read_b64_tr_b16 a[248:249], v232 offset:57344
    ds_read_b64_tr_b16 a[250:251], v233 offset:57344
    ds_read_b64_tr_b16 a[252:253], v234 offset:57344
    ds_read_b64_tr_b16 a[254:255], v235 offset:57344
    s_waitcnt lgkmcnt(0)
    s_barrier
L_lw_b:
    s_cmp_lg_u32 s52, 2
    s_cbranch_scc1 L_cfd_11
    s_mov_b32 s88, 0
    v_mov_b32 v246, 128
L_cf_10:
    s_add_u32 s88, s88, 1
    s_mov_b32 s89, 1
    s_cmp_ge_u32 s88, 262144
    s_cbranch_scc1 L_abort
    buffer_load_dword v247, v246, s[36:39], 0 offen sc1
    s_waitcnt vmcnt(0)
    v_readfirstlane_b32 s52, v247
    s_cmp_le_u32 s52, s2
    s_cbranch_scc1 L_cf_10
    s_and_b32 s52, s52, 3
    s_sub_u32 s52, s52, 1
    s_cmp_eq_u32 s52, 0
    s_cbranch_scc1 L_cfd_11
    s_mov_b32 s52, 1
    s_mov_b32 s31, s83
    s_waitcnt vmcnt(0) lgkmcnt(0)
    s_barrier
    s_branch L_dispatch
L_cfd_11:
    s_mov_b32 s88, 0
    v_mov_b32 v246, 132
L_side_12:
    s_add_u32 s88, s88, 1
    s_mov_b32 s89, 18
    s_cmp_ge_u32 s88, 262144
    s_cbranch_scc1 L_abort
    buffer_load_dword v247, v246, s[36:39], 0 offen sc1
    s_waitcnt vmcnt(0)
    v_readfirstlane_b32 s95, v247
    s_cmp_le_u32 s95, s2
    s_cbranch_scc1 L_side_12
    s_sub_u32 s95, s95, 1
    s_and_b32 s95, s95, 1
    s_lshl_b32 s95, s95, 13
    s_lshl_b32 s74, s69, 20
    s_lshr_b32 s75, s69, 1
    s_and_b32 s75, s75, 1
    s_lshl_b32 s75, s75, 13
    s_xor_b32 s75, s75, s95
    s_add_u32 s75, s75, s94
    s_add_u32 s74, s74, s75
    s_mov_b32 s59, 16384
    s_add_u32 s72, s72, s74
    s_lshl_b32 s74, s30, 11
    s_add_u32 s66, s72, s74
    s_mov_b32 s61, 64
    s_mov_b32 s62, 1.0
    v_mov_b32 v16, 0x0
    v_and_b32 v246, 0x10, v240
    v_xor_b32 v16, v16, v246
    v_and_b32 v246, 0x20, v241
    v_xor_b32 v16, v16, v246
    v_and_b32 v246, 0x40, v242
    v_xor_b32 v16, v16, v246
    v_and_b32 v246, 0x80, v243
    v_xor_b32 v16, v16, v246
    v_and_b32 v246, 0x100, v244
    v_xor_b32 v16, v16, v246
    v_and_b32 v246, 0x200, v245
    v_xor_b32 v16, v16, v246
    v_add_u32 v19, 1024, v16
    s_lshr_b32 s73, s73, 2
    s_lshl_b32 s74, s69, 4
    s_add_u32 s73, s73, s74
    s_add_u32 s73, s73, s30
    s_lshr_b32 s74, s73, 6
    s_lshl_b32 s74, s74, 14
    s_and_b32 s75, s73, 63
    s_lshl_b32 s75, s75, 7
    s_add_u32 s74, s74, s75
    s_add_u32 s74, s74, s94
    s_add_u32 s74, s74, s95
    s_add_u32 s74, s74, 1114112
    v_mov_b32 v17, 0x0
    v_add_u32 v17, s74, v17
    s_mov_b32 s86, 0x1
    s_mov_b32 s87, 0x0
    v_mov_b32 v246, 0x7fff0000
    v_cndmask_b32 v17, v246, v17, s[86:87]
    v_mov_b32 v94, v17
    s_mov_b32 s88, 0
    v_mov_b32 v246, 72
L_rdy_13:
    s_add_u32 s88, s88, 1
    s_mov_b32 s89, 8
    s_cmp_ge_u32 s88, 262144
    s_cbranch_scc1 L_abort
    buffer_load_dword v247, v246, s[36:39], 0 offen sc1
    s_mul_i32 s89, s2, 34
    s_add_u32 s89, s89, 136
    s_waitcnt vmcnt(0)
    v_cmp_gt_u32 vcc, s89, v247
    s_cbranch_vccnz L_rdy_13
    s_cmp_eq_u32 s68, 1
    s_cbranch_scc1 L_gE2
    s_branch L_gE1
L_t3:
    s_sub_u32 s69, s77, 96
    s_lshr_b32 s68, s69, 3
    s_and_b32 s69, s69, 7
    s_mov_b32 s44, s6
    s_and_b32 s45, s7, 0xffff
    s_mov_b32 s46, 0x600000
    s_mov_b32 s47, 0x00020000
    s_mov_b32 s48, s4
    s_and_b32 s49, s5, 0xffff
    s_mov_b32 s50, 0x400000
    s_mov_b32 s51, 0x00020000
    s_mov_b32 s53, 6144
    s_lshl_b32 s54, s68, 11
    s_lshl_b32 s74, s69, 8
    s_add_u32 s54, s54, s74
    v_mov_b32 v95, 0x0
    v_and_b32 v246, 0x10, v240
    v_xor_b32 v95, v95, v246
    v_and_b32 v246, 0x20, v241
    v_xor_b32 v95, v95, v246
    v_and_b32 v246, 0x40, v242
    v_xor_b32 v95, v95, v246
    v_and_b32 v246, 0x800, v243
    v_xor_b32 v95, v95, v246
    v_and_b32 v246, 0x1010, v244
    v_xor_b32 v95, v95, v246
    v_and_b32 v246, 0x2020, v245
    v_xor_b32 v95, v95, v246
    s_and_b32 s63, s30, 1
    s_lshl_b32 s63, s63, 6
    v_xor_b32 v95, s63, v95
    s_lshl_b32 s63, s30, 14
    v_add_u32 v95, s63, v95
    s_mov_b32 s55, 128
    s_mov_b32 s56, 1024
    v_mov_b32 v8, 0x0
    v_and_b32 v246, 0x80, v240
    v_xor_b32 v8, v8, v246
    v_and_b32 v246, 0x110, v241
    v_xor_b32 v8, v8, v246
    v_and_b32 v246, 0x220, v242
    v_xor_b32 v8, v8, v246
    v_and_b32 v246, 0x440, v243
    v_xor_b32 v8, v8, v246
    v_and_b32 v246, 0x10, v244
    v_xor_b32 v8, v8, v246
    v_and_b32 v246, 0x20, v245
    v_xor_b32 v8, v8, v246
    v_mov_b32 v9, 0x800
    v_and_b32 v246, 0x80, v240
    v_xor_b32 v9, v9, v246
    v_and_b32 v246, 0x110, v241
    v_xor_b32 v9, v9, v246
    v_and_b32 v246, 0x220, v242
    v_xor_b32 v9, v9, v246
    v_and_b32 v246, 0x440, v243
    v_xor_b32 v9, v9, v246
    v_and_b32 v246, 0x10, v244
    v_xor_b32 v9, v9, v246
    v_and_b32 v246, 0x20, v245
    v_xor_b32 v9, v9, v246
    v_mov_b32 v10, 0x40
    v_and_b32 v246, 0x80, v240
    v_xor_b32 v10, v10, v246
    v_and_b32 v246, 0x110, v241
    v_xor_b32 v10, v10, v246
    v_and_b32 v246, 0x220, v242
    v_xor_b32 v10, v10, v246
    v_and_b32 v246, 0x440, v243
    v_xor_b32 v10, v10, v246
    v_and_b32 v246, 0x10, v244
    v_xor_b32 v10, v10, v246
    v_and_b32 v246, 0x20, v245
    v_xor_b32 v10, v10, v246
    v_mov_b32 v11, 0x840
    v_and_b32 v246, 0x80, v240
    v_xor_b32 v11, v11, v246
    v_and_b32 v246, 0x110, v241
    v_xor_b32 v11, v11, v246
    v_and_b32 v246, 0x220, v242
    v_xor_b32 v11, v11, v246
    v_and_b32 v246, 0x440, v243
    v_xor_b32 v11, v11, v246
    v_and_b32 v246, 0x10, v244
    v_xor_b32 v11, v11, v246
    v_and_b32 v246, 0x20, v245
    v_xor_b32 v11, v11, v246
    v_add_u32 v12, 0x10000, v8
    v_add_u32 v13, 0x10000, v9
    v_add_u32 v14, 0x10000, v10
    v_add_u32 v15, 0x10000, v11
    s_mov_b32 s57, 0
    s_cmp_eq_u32 s68, 2
    s_cbranch_scc1 L_lw_va
    v_mov_b32 v2, 0x0
    v_and_b32 v246, 0x10, v240
    v_xor_b32 v2, v2, v246
    v_and_b32 v246, 0x20, v241
    v_xor_b32 v2, v2, v246
    v_and_b32 v246, 0x40, v242
    v_xor_b32 v2, v2, v246
    v_and_b32 v246, 0x80, v243
    v_xor_b32 v2, v2, v246
    v_and_b32 v246, 0x40, v244
    v_xor_b32 v2, v2, v246
    v_and_b32 v246, 0x80, v245
    v_xor_b32 v2, v2, v246
    v_lshrrev_b32 v3, 4, v1
    v_mul_lo_u32 v3, v3, s53
    v_add_u32 v2, v2, v3
    s_lshl_b32 s63, s30, 5
    s_mul_i32 s63, s63, s53
    s_add_u32 s63, s63, s54
    v_add_u32 v2, s63, v2
    s_lshl_b32 s65, s53, 2
    s_lshl_b32 s64, s30, 13
    s_mul_i32 s63, s53, 0
    s_add_u32 m0, s64, 0
    s_nop 0
    buffer_load_dwordx4 v2, s[44:47], s63 offen lds
    s_add_u32 s63, s63, s65
    s_add_u32 m0, s64, 1024
    s_nop 0
    buffer_load_dwordx4 v2, s[44:47], s63 offen lds
    s_add_u32 s63, s63, s65
    s_add_u32 m0, s64, 2048
    s_nop 0
    buffer_load_dwordx4 v2, s[44:47], s63 offen lds
    s_add_u32 s63, s63, s65
    s_add_u32 m0, s64, 3072
    s_nop 0
    buffer_load_dwordx4 v2, s[44:47], s63 offen lds
    s_add_u32 s63, s63, s65
    s_add_u32 m0, s64, 4096
    s_nop 0
    buffer_load_dwordx4 v2, s[44:47], s63 offen lds
    s_add_u32 s63, s63, s65
    s_add_u32 m0, s64, 5120
    s_nop 0
    buffer_load_dwordx4 v2, s[44:47], s63 offen lds
    s_add_u32 s63, s63, s65
    s_add_u32 m0, s64, 6144
    s_nop 0
    buffer_load_dwordx4 v2, s[44:47], s63 offen lds
    s_add_u32 s63, s63, s65
    s_add_u32 m0, s64, 7168
    s_nop 0
    buffer_load_dwordx4 v2, s[44:47], s63 offen lds
    s_mul_i32 s63, s53, 128
    s_add_u32 m0, s64, 32768
    s_nop 0
    buffer_load_dwordx4 v2, s[44:47], s63 offen lds
    s_add_u32 s63, s63, s65
    s_add_u32 m0, s64, 33792
    s_nop 0
    buffer_load_dwordx4 v2, s[44:47], s63 offen lds
    s_add_u32 s63, s63, s65
    s_add_u32 m0, s64, 34816
    s_nop 0
    buffer_load_dwordx4 v2, s[44:47], s63 offen lds
    s_add_u32 s63, s63, s65
    s_add_u32 m0, s64, 35840
    s_nop 0
    buffer_load_dwordx4 v2, s[44:47], s63 offen lds
    s_add_u32 s63, s63, s65
    s_add_u32 m0, s64, 36864
    s_nop 0
    buffer_load_dwordx4 v2, s[44:47], s63 offen lds
    s_add_u32 s63, s63, s65
    s_add_u32 m0, s64, 37888
    s_nop 0
    buffer_load_dwordx4 v2, s[44:47], s63 offen lds
    s_add_u32 s63, s63, s65
    s_add_u32 m0, s64, 38912
    s_nop 0
    buffer_load_dwordx4 v2, s[44:47], s63 offen lds
    s_add_u32 s63, s63, s65
    s_add_u32 m0, s64, 39936
    s_nop 0
    buffer_load_dwordx4 v2, s[44:47], s63 offen lds
    s_mul_i32 s63, s53, 256
    s_add_u32 m0, s64, 65536
    s_nop 0
    buffer_load_dwordx4 v2, s[44:47], s63 offen lds
    s_add_u32 s63, s63, s65
    s_add_u32 m0, s64, 66560
    s_nop 0
    buffer_load_dwordx4 v2, s[44:47], s63 offen lds
    s_add_u32 s63, s63, s65
    s_add_u32 m0, s64, 67584
    s_nop 0
    buffer_load_dwordx4 v2, s[44:47], s63 offen lds
    s_add_u32 s63, s63, s65
    s_add_u32 m0, s64, 68608
    s_nop 0
    buffer_load_dwordx4 v2, s[44:47], s63 offen lds
    s_add_u32 s63, s63, s65
    s_add_u32 m0, s64, 69632
    s_nop 0
    buffer_load_dwordx4 v2, s[44:47], s63 offen lds
    s_add_u32 s63, s63, s65
    s_add_u32 m0, s64, 70656
    s_nop 0
    buffer_load_dwordx4 v2, s[44:47], s63 offen lds
    s_add_u32 s63, s63, s65
    s_add_u32 m0, s64, 71680
    s_nop 0
    buffer_load_dwordx4 v2, s[44:47], s63 offen lds
    s_add_u32 s63, s63, s65
    s_add_u32 m0, s64, 72704
    s_nop 0
    buffer_load_dwordx4 v2, s[44:47], s63 offen lds
    s_mul_i32 s63, s53, 384
    s_add_u32 m0, s64, 98304
    s_nop 0
    buffer_load_dwordx4 v2, s[44:47], s63 offen lds
    s_add_u32 s63, s63, s65
    s_add_u32 m0, s64, 99328
    s_nop 0
    buffer_load_dwordx4 v2, s[44:47], s63 offen lds
    s_add_u32 s63, s63, s65
    s_add_u32 m0, s64, 100352
    s_nop 0
    buffer_load_dwordx4 v2, s[44:47], s63 offen lds
    s_add_u32 s63, s63, s65
    s_add_u32 m0, s64, 101376
    s_nop 0
    buffer_load_dwordx4 v2, s[44:47], s63 offen lds
    s_add_u32 s63, s63, s65
    s_add_u32 m0, s64, 102400
    s_nop 0
    buffer_load_dwordx4 v2, s[44:47], s63 offen lds
    s_add_u32 s63, s63, s65
    s_add_u32 m0, s64, 103424
    s_nop 0
    buffer_load_dwordx4 v2, s[44:47], s63 offen lds
    s_add_u32 s63, s63, s65
    s_add_u32 m0, s64, 104448
    s_nop 0
    buffer_load_dwordx4 v2, s[44:47], s63 offen lds
    s_add_u32 s63, s63, s65
    s_add_u32 m0, s64, 105472
    s_nop 0
    buffer_load_dwordx4 v2, s[44:47], s63 offen lds
    s_lshl_b32 s63, s30, 6
    v_mov_b32 v228, 0x0
    v_and_b32 v246, 0x8, v240
    v_xor_b32 v228, v228, v246
    v_and_b32 v246, 0x20, v241
    v_xor_b32 v228, v228, v246
    v_and_b32 v246, 0x140, v242
    v_xor_b32 v228, v228, v246
    v_and_b32 v246, 0x280, v243
    v_xor_b32 v228, v228, v246
    v_and_b32 v246, 0x800, v244
    v_xor_b32 v228, v228, v246
    v_and_b32 v246, 0x1000, v245
    v_xor_b32 v228, v228, v246
    v_xor_b32 v228, s63, v228
    v_add_u32 v229, 1024, v228
    v_mov_b32 v230, 0x10
    v_and_b32 v246, 0x8, v240
    v_xor_b32 v230, v230, v246
    v_and_b32 v246, 0x20, v241
    v_xor_b32 v230, v230, v246
    v_and_b32 v246, 0x140, v242
    v_xor_b32 v230, v230, v246
    v_and_b32 v246, 0x280, v243
    v_xor_b32 v230, v230, v246
    v_and_b32 v246, 0x800, v244
    v_xor_b32 v230, v230, v246
    v_and_b32 v246, 0x1000, v245
    v_xor_b32 v230, v230, v246
    v_xor_b32 v230, s63, v230
    v_add_u32 v231, 1024, v230
    v_add_u32 v232, 0x10000, v228
    v_add_u32 v233, 0x10000, v229
    v_add_u32 v234, 0x10000, v230
    v_add_u32 v235, 0x10000, v231
    s_waitcnt vmcnt(24)
    s_barrier
    ds_read_b64_tr_b16 a[0:1], v228 offset:0
    ds_read_b64_tr_b16 a[2:3], v229 offset:0
    ds_read_b64_tr_b16 a[4:5], v230 offset:0
    ds_read_b64_tr_b16 a[6:7], v231 offset:0
    ds_read_b64_tr_b16 a[8:9], v228 offset:8192
    ds_read_b64_tr_b16 a[10:11], v229 offset:8192
    ds_read_b64_tr_b16 a[12:13], v230 offset:8192
    ds_read_b64_tr_b16 a[14:15], v231 offset:8192
    ds_read_b64_tr_b16 a[16:17], v228 offset:16384
    ds_read_b64_tr_b16 a[18:19], v229 offset:16384
    ds_read_b64_tr_b16 a[20:21], v230 offset:16384
    ds_read_b64_tr_b16 a[22:23], v231 offset:16384
    ds_read_b64_tr_b16 a[24:25], v228 offset:24576
    ds_read_b64_tr_b16 a[26:27], v229 offset:24576
    ds_read_b64_tr_b16 a[28:29], v230 offset:24576
    ds_read_b64_tr_b16 a[30:31], v231 offset:24576
    s_waitcnt lgkmcnt(0)
    s_barrier
    s_mul_i32 s63, s53, 512
    s_add_u32 m0, s64, 0
    s_nop 0
    buffer_load_dwordx4 v2, s[44:47], s63 offen lds
    s_add_u32 s63, s63, s65
    s_add_u32 m0, s64, 1024
    s_nop 0
    buffer_load_dwordx4 v2, s[44:47], s63 offen lds
    s_add_u32 s63, s63, s65
    s_add_u32 m0, s64, 2048
    s_nop 0
    buffer_load_dwordx4 v2, s[44:47], s63 offen lds
    s_add_u32 s63, s63, s65
    s_add_u32 m0, s64, 3072
    s_nop 0
    buffer_load_dwordx4 v2, s[44:47], s63 offen lds
    s_add_u32 s63, s63, s65
    s_add_u32 m0, s64, 4096
    s_nop 0
    buffer_load_dwordx4 v2, s[44:47], s63 offen lds
    s_add_u32 s63, s63, s65
    s_add_u32 m0, s64, 5120
    s_nop 0
    buffer_load_dwordx4 v2, s[44:47], s63 offen lds
    s_add_u32 s63, s63, s65
    s_add_u32 m0, s64, 6144
    s_nop 0
    buffer_load_dwordx4 v2, s[44:47], s63 offen lds
    s_add_u32 s63, s63, s65
    s_add_u32 m0, s64, 7168
    s_nop 0
    buffer_load_dwordx4 v2, s[44:47], s63 offen lds
    s_waitcnt vmcnt(24)
    s_barrier
    ds_read_b64_tr_b16 a[32:33], v228 offset:32768
    ds_read_b64_tr_b16 a[34:35], v229 offset:32768
    ds_read_b64_tr_b16 a[36:37], v230 offset:32768
    ds_read_b64_tr_b16 a[38:39], v231 offset:32768
    ds_read_b64_tr_b16 a[40:41], v228 offset:40960
    ds_read_b64_tr_b16 a[42:43], v229 offset:40960
    ds_read_b64_tr_b16 a[44:45], v230 offset:40960
    ds_read_b64_tr_b16 a[46:47], v231 offset:40960
    ds_read_b64_tr_b16 a[48:49], v228 offset:49152
    ds_read_b64_tr_b16 a[50:51], v229 offset:49152
    ds_read_b64_tr_b16 a[52:53], v230 offset:49152
    ds_read_b64_tr_b16 a[54:55], v231 offset:49152
    ds_read_b64_tr_b16 a[56:57], v228 offset:57344
    ds_read_b64_tr_b16 a[58:59], v229 offset:57344
    ds_read_b64_tr_b16 a[60:61], v230 offset:57344
    ds_read_b64_tr_b16 a[62:63], v231 offset:57344
    s_waitcnt lgkmcnt(0)
    s_barrier
    s_mul_i32 s63, s53, 640
    s_add_u32 m0, s64, 32768
    s_nop 0
    buffer_load_dwordx4 v2, s[44:47], s63 offen lds
    s_add_u32 s63, s63, s65
    s_add_u32 m0, s64, 33792
    s_nop 0
    buffer_load_dwordx4 v2, s[44:47], s63 offen lds
    s_add_u32 s63, s63, s65
    s_add_u32 m0, s64, 34816
    s_nop 0
    buffer_load_dwordx4 v2, s[44:47], s63 offen lds
    s_add_u32 s63, s63, s65
    s_add_u32 m0, s64, 35840
    s_nop 0
    buffer_load_dwordx4 v2, s[44:47], s63 offen lds
    s_add_u32 s63, s63, s65
    s_add_u32 m0, s64, 36864
    s_nop 0
    buffer_load_dwordx4 v2, s[44:47], s63 offen lds
    s_add_u32 s63, s63, s65
    s_add_u32 m0, s64, 37888
    s_nop 0
    buffer_load_dwordx4 v2, s[44:47], s63 offen lds
    s_add_u32 s63, s63, s65
    s_add_u32 m0, s64, 38912
    s_nop 0
    buffer_load_dwordx4 v2, s[44:47], s63 offen lds
    s_add_u32 s63, s63, s65
    s_add_u32 m0, s64, 39936
    s_nop 0
    buffer_load_dwordx4 v2, s[44:47], s63 offen lds
    s_waitcnt vmcnt(24)
    s_barrier
    ds_read_b64_tr_b16 a[64:65], v232 offset:0
    ds_read_b64_tr_b16 a[66:67], v233 offset:0
    ds_read_b64_tr_b16 a[68:69], v234 offset:0
    ds_read_b64_tr_b16 a[70:71], v235 offset:0
    ds_read_b64_tr_b16 a[72:73], v232 offset:8192
    ds_read_b64_tr_b16 a[74:75], v233 offset:8192
    ds_read_b64_tr_b16 a[76:77], v234 offset:8192
    ds_read_b64_tr_b16 a[78:79], v235 offset:8192
    ds_read_b64_tr_b16 a[80:81], v232 offset:16384
    ds_read_b64_tr_b16 a[82:83], v233 offset:16384
    ds_read_b64_tr_b16 a[84:85], v234 offset:16384
    ds_read_b64_tr_b16 a[86:87], v235 offset:16384
    ds_read_b64_tr_b16 a[88:89], v232 offset:24576
    ds_read_b64_tr_b16 a[90:91], v233 offset:24576
    ds_read_b64_tr_b16 a[92:93], v234 offset:24576
    ds_read_b64_tr_b16 a[94:95], v235 offset:24576
    s_waitcnt lgkmcnt(0)
    s_barrier
    s_mul_i32 s63, s53, 768
    s_add_u32 m0, s64, 65536
    s_nop 0
    buffer_load_dwordx4 v2, s[44:47], s63 offen lds
    s_add_u32 s63, s63, s65
    s_add_u32 m0, s64, 66560
    s_nop 0
    buffer_load_dwordx4 v2, s[44:47], s63 offen lds
    s_add_u32 s63, s63, s65
    s_add_u32 m0, s64, 67584
    s_nop 0
    buffer_load_dwordx4 v2, s[44:47], s63 offen lds
    s_add_u32 s63, s63, s65
    s_add_u32 m0, s64, 68608
    s_nop 0
    buffer_load_dwordx4 v2, s[44:47], s63 offen lds
    s_add_u32 s63, s63, s65
    s_add_u32 m0, s64, 69632
    s_nop 0
    buffer_load_dwordx4 v2, s[44:47], s63 offen lds
    s_add_u32 s63, s63, s65
    s_add_u32 m0, s64, 70656
    s_nop 0
    buffer_load_dwordx4 v2, s[44:47], s63 offen lds
    s_add_u32 s63, s63, s65
    s_add_u32 m0, s64, 71680
    s_nop 0
    buffer_load_dwordx4 v2, s[44:47], s63 offen lds
    s_add_u32 s63, s63, s65
    s_add_u32 m0, s64, 72704
    s_nop 0
    buffer_load_dwordx4 v2, s[44:47], s63 offen lds
    s_waitcnt vmcnt(24)
    s_barrier
    ds_read_b64_tr_b16 a[96:97], v232 offset:32768
    ds_read_b64_tr_b16 a[98:99], v233 offset:32768
    ds_read_b64_tr_b16 a[100:101], v234 offset:32768
    ds_read_b64_tr_b16 a[102:103], v235 offset:32768
    ds_read_b64_tr_b16 a[104:105], v232 offset:40960
    ds_read_b64_tr_b16 a[106:107], v233 offset:40960
    ds_read_b64_tr_b16 a[108:109], v234 offset:40960
    ds_read_b64_tr_b16 a[110:111], v235 offset:40960
    ds_read_b64_tr_b16 a[112:113], v232 offset:49152
    ds_read_b64_tr_b16 a[114:115], v233 offset:49152
    ds_read_b64_tr_b16 a[116:117], v234 offset:49152
    ds_read_b64_tr_b16 a[118:119], v235 offset:49152
    ds_read_b64_tr_b16 a[120:121], v232 offset:57344
    ds_read_b64_tr_b16 a[122:123], v233 offset:57344
    ds_read_b64_tr_b16 a[124:125], v234 offset:57344
    ds_read_b64_tr_b16 a[126:127], v235 offset:57344
    s_waitcnt lgkmcnt(0)
    s_barrier
    s_mul_i32 s63, s53, 896
    s_add_u32 m0, s64, 98304
    s_nop 0
    buffer_load_dwordx4 v2, s[44:47], s63 offen lds
    s_add_u32 s63, s63, s65
    s_add_u32 m0, s64, 99328
    s_nop 0
    buffer_load_dwordx4 v2, s[44:47], s63 offen lds
    s_add_u32 s63, s63, s65
    s_add_u32 m0, s64, 100352
    s_nop 0
    buffer_load_dwordx4 v2, s[44:47], s63 offen lds
    s_add_u32 s63, s63, s65
    s_add_u32 m0, s64, 101376
    s_nop 0
    buffer_load_dwordx4 v2, s[44:47], s63 offen lds
    s_add_u32 s63, s63, s65
    s_add_u32 m0, s64, 102400
    s_nop 0
    buffer_load_dwordx4 v2, s[44:47], s63 offen lds
    s_add_u32 s63, s63, s65
    s_add_u32 m0, s64, 103424
    s_nop 0
    buffer_load_dwordx4 v2, s[44:47], s63 offen lds
    s_add_u32 s63, s63, s65
    s_add_u32 m0, s64, 104448
    s_nop 0
    buffer_load_dwordx4 v2, s[44:47], s63 offen lds
    s_add_u32 s63, s63, s65
    s_add_u32 m0, s64, 105472
    s_nop 0
    buffer_load_dwordx4 v2, s[44:47], s63 offen lds
    s_waitcnt vmcnt(24)
    s_barrier
    ds_read_b64_tr_b16 a[128:129], v228 offset:0
    ds_read_b64_tr_b16 a[130:131], v229 offset:0
    ds_read_b64_tr_b16 a[132:133], v230 offset:0
    ds_read_b64_tr_b16 a[134:135], v231 offset:0
    ds_read_b64_tr_b16 a[136:137], v228 offset:8192
    ds_read_b64_tr_b16 a[138:139], v229 offset:8192
    ds_read_b64_tr_b16 a[140:141], v230 offset:8192
    ds_read_b64_tr_b16 a[142:143], v231 offset:8192
    ds_read_b64_tr_b16 a[144:145], v228 offset:16384
    ds_read_b64_tr_b16 a[146:147], v229 offset:16384
    ds_read_b64_tr_b16 a[148:149], v230 offset:16384
    ds_read_b64_tr_b16 a[150:151], v231 offset:16384
    ds_read_b64_tr_b16 a[152:153], v228 offset:24576
    ds_read_b64_tr_b16 a[154:155], v229 offset:24576
    ds_read_b64_tr_b16 a[156:157], v230 offset:24576
    ds_read_b64_tr_b16 a[158:159], v231 offset:24576
    s_waitcnt lgkmcnt(0)
    s_barrier
    s_lshl_b32 s67, s30, 10
    s_mul_i32 s85, s55, 7
    s_sub_u32 s84, s56, s85
    s_add_u32 s85, s85, s56
    s_sub_u32 s85, 0x10000, s85
    s_sub_u32 s57, s57, s85
    s_add_u32 m0, s67, 0
    s_add_u32 s57, s57, s85
    buffer_load_dwordx4 v95, s[48:51], s57 offen lds
    s_add_u32 m0, s67, 4096
    s_add_u32 s57, s57, s55
    buffer_load_dwordx4 v95, s[48:51], s57 offen lds
    s_add_u32 m0, s67, 8192
    s_add_u32 s57, s57, s55
    buffer_load_dwordx4 v95, s[48:51], s57 offen lds
    s_add_u32 m0, s67, 12288
    s_add_u32 s57, s57, s55
    buffer_load_dwordx4 v95, s[48:51], s57 offen lds
    s_add_u32 m0, s67, 16384
    s_add_u32 s57, s57, s55
    buffer_load_dwordx4 v95, s[48:51], s57 offen lds
    s_add_u32 m0, s67, 20480
    s_add_u32 s57, s57, s55
    buffer_load_dwordx4 v95, s[48:51], s57 offen lds
    s_add_u32 m0, s67, 24576
    s_add_u32 s57, s57, s55
    buffer_load_dwordx4 v95, s[48:51], s57 offen lds
    s_add_u32 m0, s67, 28672
    s_add_u32 s57, s57, s55
    buffer_load_dwordx4 v95, s[48:51], s57 offen lds
    s_waitcnt vmcnt(24)
    s_barrier
    ds_read_b64_tr_b16 a[160:161], v228 offset:32768
    ds_read_b64_tr_b16 a[162:163], v229 offset:32768
    ds_read_b64_tr_b16 a[164:165], v230 offset:32768
    ds_read_b64_tr_b16 a[166:167], v231 offset:32768
    ds_read_b64_tr_b16 a[168:169], v228 offset:40960
    ds_read_b64_tr_b16 a[170:171], v229 offset:40960
    ds_read_b64_tr_b16 a[172:173], v230 offset:40960
    ds_read_b64_tr_b16 a[174:175], v231 offset:40960
    ds_read_b64_tr_b16 a[176:177], v228 offset:49152
    ds_read_b64_tr_b16 a[178:179], v229 offset:49152
    ds_read_b64_tr_b16 a[180:181], v230 offset:49152
    ds_read_b64_tr_b16 a[182:183], v231 offset:49152
    ds_read_b64_tr_b16 a[184:185], v228 offset:57344
    ds_read_b64_tr_b16 a[186:187], v229 offset:57344
    ds_read_b64_tr_b16 a[188:189], v230 offset:57344
    ds_read_b64_tr_b16 a[190:191], v231 offset:57344
    s_waitcnt lgkmcnt(0)
    s_barrier
    s_add_u32 m0, s67, 32768
    s_add_u32 s57, s57, s84
    buffer_load_dwordx4 v95, s[48:51], s57 offen lds
    s_add_u32 m0, s67, 36864
    s_add_u32 s57, s57, s55
    buffer_load_dwordx4 v95, s[48:51], s57 offen lds
    s_add_u32 m0, s67, 40960
    s_add_u32 s57, s57, s55
    buffer_load_dwordx4 v95, s[48:51], s57 offen lds
    s_add_u32 m0, s67, 45056
    s_add_u32 s57, s57, s55
    buffer_load_dwordx4 v95, s[48:51], s57 offen lds
    s_add_u32 m0, s67, 49152
    s_add_u32 s57, s57, s55
    buffer_load_dwordx4 v95, s[48:51], s57 offen lds
    s_add_u32 m0, s67, 53248
    s_add_u32 s57, s57, s55
    buffer_load_dwordx4 v95, s[48:51], s57 offen lds
    s_add_u32 m0, s67, 57344
    s_add_u32 s57, s57, s55
    buffer_load_dwordx4 v95, s[48:51], s57 offen lds
    s_add_u32 m0, s67, 61440
    s_add_u32 s57, s57, s55
    buffer_load_dwordx4 v95, s[48:51], s57 offen lds
    s_waitcnt vmcnt(24)
    s_barrier
    ds_read_b64_tr_b16 a[192:193], v232 offset:0
    ds_read_b64_tr_b16 a[194:195], v233 offset:0
    ds_read_b64_tr_b16 a[196:197], v234 offset:0
    ds_read_b64_tr_b16 a[198:199], v235 offset:0
    ds_read_b64_tr_b16 a[200:201], v232 offset:8192
    ds_read_b64_tr_b16 a[202:203], v233 offset:8192
    ds_read_b64_tr_b16 a[204:205], v234 offset:8192
    ds_read_b64_tr_b16 a[206:207], v235 offset:8192
    ds_read_b64_tr_b16 a[208:209], v232 offset:16384
    ds_read_b64_tr_b16 a[210:211], v233 offset:16384
    ds_read_b64_tr_b16 a[212:213], v234 offset:16384
    ds_read_b64_tr_b16 a[214:215], v235 offset:16384
    ds_read_b64_tr_b16 a[216:217], v232 offset:24576
    ds_read_b64_tr_b16 a[218:219], v233 offset:24576
    ds_read_b64_tr_b16 a[220:221], v234 offset:24576
    ds_read_b64_tr_b16 a[222:223], v235 offset:24576
    s_waitcnt lgkmcnt(0)
    s_barrier
    s_add_u32 m0, s67, 65536
    s_add_u32 s57, s57, s85
    buffer_load_dwordx4 v95, s[48:51], s57 offen lds
    s_add_u32 m0, s67, 69632
    s_add_u32 s57, s57, s55
    buffer_load_dwordx4 v95, s[48:51], s57 offen lds
    s_add_u32 m0, s67, 73728
    s_add_u32 s57, s57, s55
    buffer_load_dwordx4 v95, s[48:51], s57 offen lds
    s_add_u32 m0, s67, 77824
    s_add_u32 s57, s57, s55
    buffer_load_dwordx4 v95, s[48:51], s57 offen lds
    s_add_u32 m0, s67, 81920
    s_add_u32 s57, s57, s55
    buffer_load_dwordx4 v95, s[48:51], s57 offen lds
    s_waitcnt vmcnt(21)
    s_barrier
    ds_read_b64_tr_b16 a[224:225], v232 offset:32768
    ds_read_b64_tr_b16 a[226:227], v233 offset:32768
    ds_read_b64_tr_b16 a[228:229], v234 offset:32768
    ds_read_b64_tr_b16 a[230:231], v235 offset:32768
    ds_read_b64_tr_b16 a[232:233], v232 offset:40960
    ds_read_b64_tr_b16 a[234:235], v233 offset:40960
    ds_read_b64_tr_b16 a[236:237], v234 offset:40960
    ds_read_b64_tr_b16 a[238:239], v235 offset:40960
    ds_read_b64_tr_b16 a[240:241], v232 offset:49152
    ds_read_b64_tr_b16 a[242:243], v233 offset:49152
    ds_read_b64_tr_b16 a[244:245], v234 offset:49152
    ds_read_b64_tr_b16 a[246:247], v235 offset:49152
    ds_read_b64_tr_b16 a[248:249], v232 offset:57344
    ds_read_b64_tr_b16 a[250:251], v233 offset:57344
    ds_read_b64_tr_b16 a[252:253], v234 offset:57344
    ds_read_b64_tr_b16 a[254:255], v235 offset:57344
    s_waitcnt lgkmcnt(0)
    s_barrier
    s_branch L_lw_a
L_lw_va:
    v_mov_b32 v2, 0x0
    v_and_b32 v246, 0x10, v240
    v_xor_b32 v2, v2, v246
    v_and_b32 v246, 0x20, v241
    v_xor_b32 v2, v2, v246
    v_and_b32 v246, 0x40, v242
    v_xor_b32 v2, v2, v246
    v_and_b32 v246, 0x80, v243
    v_xor_b32 v2, v2, v246
    v_and_b32 v246, 0x40, v244
    v_xor_b32 v2, v2, v246
    v_and_b32 v246, 0x80, v245
    v_xor_b32 v2, v2, v246
    v_lshrrev_b32 v3, 4, v1
    v_mul_lo_u32 v3, v3, s53
    v_add_u32 v2, v2, v3
    s_lshl_b32 s63, s30, 5
    s_mul_i32 s63, s63, s53
    s_add_u32 s63, s63, s54
    v_add_u32 v2, s63, v2
    s_lshl_b32 s65, s53, 2
    s_lshl_b32 s64, s30, 13
    s_mul_i32 s63, s53, 0
    s_add_u32 m0, s64, 0
    s_nop 0
    buffer_load_dwordx4 v2, s[44:47], s63 offen lds
    s_add_u32 s63, s63, s65
    s_add_u32 m0, s64, 1024
    s_nop 0
    buffer_load_dwordx4 v2, s[44:47], s63 offen lds
    s_add_u32 s63, s63, s65
    s_add_u32 m0, s64, 2048
    s_nop 0
    buffer_load_dwordx4 v2, s[44:47], s63 offen lds
    s_add_u32 s63, s63, s65
    s_add_u32 m0, s64, 3072
    s_nop 0
    buffer_load_dwordx4 v2, s[44:47], s63 offen lds
    s_add_u32 s63, s63, s65
    s_add_u32 m0, s64, 4096
    s_nop 0
    buffer_load_dwordx4 v2, s[44:47], s63 offen lds
    s_add_u32 s63, s63, s65
    s_add_u32 m0, s64, 5120
    s_nop 0
    buffer_load_dwordx4 v2, s[44:47], s63 offen lds
    s_add_u32 s63, s63, s65
    s_add_u32 m0, s64, 6144
    s_nop 0
    buffer_load_dwordx4 v2, s[44:47], s63 offen lds
    s_add_u32 s63, s63, s65
    s_add_u32 m0, s64, 7168
    s_nop 0
    buffer_load_dwordx4 v2, s[44:47], s63 offen lds
    s_mul_i32 s63, s53, 128
    s_add_u32 m0, s64, 32768
    s_nop 0
    buffer_load_dwordx4 v2, s[44:47], s63 offen lds
    s_add_u32 s63, s63, s65
    s_add_u32 m0, s64, 33792
    s_nop 0
    buffer_load_dwordx4 v2, s[44:47], s63 offen lds
    s_add_u32 s63, s63, s65
    s_add_u32 m0, s64, 34816
    s_nop 0
    buffer_load_dwordx4 v2, s[44:47], s63 offen lds
    s_add_u32 s63, s63, s65
    s_add_u32 m0, s64, 35840
    s_nop 0
    buffer_load_dwordx4 v2, s[44:47], s63 offen lds
    s_add_u32 s63, s63, s65
    s_add_u32 m0, s64, 36864
    s_nop 0
    buffer_load_dwordx4 v2, s[44:47], s63 offen lds
    s_add_u32 s63, s63, s65
    s_add_u32 m0, s64, 37888
    s_nop 0
    buffer_load_dwordx4 v2, s[44:47], s63 offen lds
    s_add_u32 s63, s63, s65
    s_add_u32 m0, s64, 38912
    s_nop 0
    buffer_load_dwordx4 v2, s[44:47], s63 offen lds
    s_add_u32 s63, s63, s65
    s_add_u32 m0, s64, 39936
    s_nop 0
    buffer_load_dwordx4 v2, s[44:47], s63 offen lds
    s_mul_i32 s63, s53, 256
    s_add_u32 m0, s64, 65536
    s_nop 0
    buffer_load_dwordx4 v2, s[44:47], s63 offen lds
    s_add_u32 s63, s63, s65
    s_add_u32 m0, s64, 66560
    s_nop 0
    buffer_load_dwordx4 v2, s[44:47], s63 offen lds
    s_add_u32 s63, s63, s65
    s_add_u32 m0, s64, 67584
    s_nop 0
    buffer_load_dwordx4 v2, s[44:47], s63 offen lds
    s_add_u32 s63, s63, s65
    s_add_u32 m0, s64, 68608
    s_nop 0
    buffer_load_dwordx4 v2, s[44:47], s63 offen lds
    s_add_u32 s63, s63, s65
    s_add_u32 m0, s64, 69632
    s_nop 0
    buffer_load_dwordx4 v2, s[44:47], s63 offen lds
    s_add_u32 s63, s63, s65
    s_add_u32 m0, s64, 70656
    s_nop 0
    buffer_load_dwordx4 v2, s[44:47], s63 offen lds
    s_add_u32 s63, s63, s65
    s_add_u32 m0, s64, 71680
    s_nop 0
    buffer_load_dwordx4 v2, s[44:47], s63 offen lds
    s_add_u32 s63, s63, s65
    s_add_u32 m0, s64, 72704
    s_nop 0
    buffer_load_dwordx4 v2, s[44:47], s63 offen lds
    s_mul_i32 s63, s53, 384
    s_add_u32 m0, s64, 98304
    s_nop 0
    buffer_load_dwordx4 v2, s[44:47], s63 offen lds
    s_add_u32 s63, s63, s65
    s_add_u32 m0, s64, 99328
    s_nop 0
    buffer_load_dwordx4 v2, s[44:47], s63 offen lds
    s_add_u32 s63, s63, s65
    s_add_u32 m0, s64, 100352
    s_nop 0
    buffer_load_dwordx4 v2, s[44:47], s63 offen lds
    s_add_u32 s63, s63, s65
    s_add_u32 m0, s64, 101376
    s_nop 0
    buffer_load_dwordx4 v2, s[44:47], s63 offen lds
    s_add_u32 s63, s63, s65
    s_add_u32 m0, s64, 102400
    s_nop 0
    buffer_load_dwordx4 v2, s[44:47], s63 offen lds
    s_add_u32 s63, s63, s65
    s_add_u32 m0, s64, 103424
    s_nop 0
    buffer_load_dwordx4 v2, s[44:47], s63 offen lds
    s_add_u32 s63, s63, s65
    s_add_u32 m0, s64, 104448
    s_nop 0
    buffer_load_dwordx4 v2, s[44:47], s63 offen lds
    s_add_u32 s63, s63, s65
    s_add_u32 m0, s64, 105472
    s_nop 0
    buffer_load_dwordx4 v2, s[44:47], s63 offen lds
    s_lshl_b32 s63, s30, 6
    v_mov_b32 v228, 0x0
    v_and_b32 v246, 0x8, v240
    v_xor_b32 v228, v228, v246
    v_and_b32 v246, 0x10, v241
    v_xor_b32 v228, v228, v246
    v_and_b32 v246, 0x140, v242
    v_xor_b32 v228, v228, v246
    v_and_b32 v246, 0x280, v243
    v_xor_b32 v228, v228, v246
    v_and_b32 v246, 0x800, v244
    v_xor_b32 v228, v228, v246
    v_and_b32 v246, 0x1000, v245
    v_xor_b32 v228, v228, v246
    v_xor_b32 v228, s63, v228
    v_add_u32 v229, 1024, v228
    v_mov_b32 v230, 0x20
    v_and_b32 v246, 0x8, v240
    v_xor_b32 v230, v230, v246
    v_and_b32 v246, 0x10, v241
    v_xor_b32 v230, v230, v246
    v_and_b32 v246, 0x140, v242
    v_xor_b32 v230, v230, v246
    v_and_b32 v246, 0x280, v243
    v_xor_b32 v230, v230, v246
    v_and_b32 v246, 0x800, v244
    v_xor_b32 v230, v230, v246
    v_and_b32 v246, 0x1000, v245
    v_xor_b32 v230, v230, v246
    v_xor_b32 v230, s63, v230
    v_add_u32 v231, 1024, v230
    v_add_u32 v232, 0x10000, v228
    v_add_u32 v233, 0x10000, v229
    v_add_u32 v234, 0x10000, v230
    v_add_u32 v235, 0x10000, v231
    s_waitcnt vmcnt(24)
    s_barrier
    ds_read_b64_tr_b16 a[0:1], v228 offset:0
    ds_read_b64_tr_b16 a[2:3], v229 offset:0
    ds_read_b64_tr_b16 a[4:5], v230 offset:0
    ds_read_b64_tr_b16 a[6:7], v231 offset:0
    ds_read_b64_tr_b16 a[8:9], v228 offset:8192
    ds_read_b64_tr_b16 a[10:11], v229 offset:8192
    ds_read_b64_tr_b16 a[12:13], v230 offset:8192
    ds_read_b64_tr_b16 a[14:15], v231 offset:8192
    ds_read_b64_tr_b16 a[16:17], v228 offset:16384
    ds_read_b64_tr_b16 a[18:19], v229 offset:16384
    ds_read_b64_tr_b16 a[20:21], v230 offset:16384
    ds_read_b64_tr_b16 a[22:23], v231 offset:16384
    ds_read_b64_tr_b16 a[24:25], v228 offset:24576
    ds_read_b64_tr_b16 a[26:27], v229 offset:24576
    ds_read_b64_tr_b16 a[28:29], v230 offset:24576
    ds_read_b64_tr_b16 a[30:31], v231 offset:24576
    s_waitcnt lgkmcnt(0)
    s_barrier
    s_mul_i32 s63, s53, 512
    s_add_u32 m0, s64, 0
    s_nop 0
    buffer_load_dwordx4 v2, s[44:47], s63 offen lds
    s_add_u32 s63, s63, s65
    s_add_u32 m0, s64, 1024
    s_nop 0
    buffer_load_dwordx4 v2, s[44:47], s63 offen lds
    s_add_u32 s63, s63, s65
    s_add_u32 m0, s64, 2048
    s_nop 0
    buffer_load_dwordx4 v2, s[44:47], s63 offen lds
    s_add_u32 s63, s63, s65
    s_add_u32 m0, s64, 3072
    s_nop 0
    buffer_load_dwordx4 v2, s[44:47], s63 offen lds
    s_add_u32 s63, s63, s65
    s_add_u32 m0, s64, 4096
    s_nop 0
    buffer_load_dwordx4 v2, s[44:47], s63 offen lds
    s_add_u32 s63, s63, s65
    s_add_u32 m0, s64, 5120
    s_nop 0
    buffer_load_dwordx4 v2, s[44:47], s63 offen lds
    s_add_u32 s63, s63, s65
    s_add_u32 m0, s64, 6144
    s_nop 0
    buffer_load_dwordx4 v2, s[44:47], s63 offen lds
    s_add_u32 s63, s63, s65
    s_add_u32 m0, s64, 7168
    s_nop 0
    buffer_load_dwordx4 v2, s[44:47], s63 offen lds
    s_waitcnt vmcnt(24)
    s_barrier
    ds_read_b64_tr_b16 a[32:33], v228 offset:32768
    ds_read_b64_tr_b16 a[34:35], v229 offset:32768
    ds_read_b64_tr_b16 a[36:37], v230 offset:32768
    ds_read_b64_tr_b16 a[38:39], v231 offset:32768
    ds_read_b64_tr_b16 a[40:41], v228 offset:40960
    ds_read_b64_tr_b16 a[42:43], v229 offset:40960
    ds_read_b64_tr_b16 a[44:45], v230 offset:40960
    ds_read_b64_tr_b16 a[46:47], v231 offset:40960
    ds_read_b64_tr_b16 a[48:49], v228 offset:49152
    ds_read_b64_tr_b16 a[50:51], v229 offset:49152
    ds_read_b64_tr_b16 a[52:53], v230 offset:49152
    ds_read_b64_tr_b16 a[54:55], v231 offset:49152
    ds_read_b64_tr_b16 a[56:57], v228 offset:57344
    ds_read_b64_tr_b16 a[58:59], v229 offset:57344
    ds_read_b64_tr_b16 a[60:61], v230 offset:57344
    ds_read_b64_tr_b16 a[62:63], v231 offset:57344
    s_waitcnt lgkmcnt(0)
    s_barrier
    s_mul_i32 s63, s53, 640
    s_add_u32 m0, s64, 32768
    s_nop 0
    buffer_load_dwordx4 v2, s[44:47], s63 offen lds
    s_add_u32 s63, s63, s65
    s_add_u32 m0, s64, 33792
    s_nop 0
    buffer_load_dwordx4 v2, s[44:47], s63 offen lds
    s_add_u32 s63, s63, s65
    s_add_u32 m0, s64, 34816
    s_nop 0
    buffer_load_dwordx4 v2, s[44:47], s63 offen lds
    s_add_u32 s63, s63, s65
    s_add_u32 m0, s64, 35840
    s_nop 0
    buffer_load_dwordx4 v2, s[44:47], s63 offen lds
    s_add_u32 s63, s63, s65
    s_add_u32 m0, s64, 36864
    s_nop 0
    buffer_load_dwordx4 v2, s[44:47], s63 offen lds
    s_add_u32 s63, s63, s65
    s_add_u32 m0, s64, 37888
    s_nop 0
    buffer_load_dwordx4 v2, s[44:47], s63 offen lds
    s_add_u32 s63, s63, s65
    s_add_u32 m0, s64, 38912
    s_nop 0
    buffer_load_dwordx4 v2, s[44:47], s63 offen lds
    s_add_u32 s63, s63, s65
    s_add_u32 m0, s64, 39936
    s_nop 0
    buffer_load_dwordx4 v2, s[44:47], s63 offen lds
    s_waitcnt vmcnt(24)
    s_barrier
    ds_read_b64_tr_b16 a[64:65], v232 offset:0
    ds_read_b64_tr_b16 a[66:67], v233 offset:0
    ds_read_b64_tr_b16 a[68:69], v234 offset:0
    ds_read_b64_tr_b16 a[70:71], v235 offset:0
    ds_read_b64_tr_b16 a[72:73], v232 offset:8192
    ds_read_b64_tr_b16 a[74:75], v233 offset:8192
    ds_read_b64_tr_b16 a[76:77], v234 offset:8192
    ds_read_b64_tr_b16 a[78:79], v235 offset:8192
    ds_read_b64_tr_b16 a[80:81], v232 offset:16384
    ds_read_b64_tr_b16 a[82:83], v233 offset:16384
    ds_read_b64_tr_b16 a[84:85], v234 offset:16384
    ds_read_b64_tr_b16 a[86:87], v235 offset:16384
    ds_read_b64_tr_b16 a[88:89], v232 offset:24576
    ds_read_b64_tr_b16 a[90:91], v233 offset:24576
    ds_read_b64_tr_b16 a[92:93], v234 offset:24576
    ds_read_b64_tr_b16 a[94:95], v235 offset:24576
    s_waitcnt lgkmcnt(0)
    s_barrier
    s_mul_i32 s63, s53, 768
    s_add_u32 m0, s64, 65536
    s_nop 0
    buffer_load_dwordx4 v2, s[44:47], s63 offen lds
    s_add_u32 s63, s63, s65
    s_add_u32 m0, s64, 66560
    s_nop 0
    buffer_load_dwordx4 v2, s[44:47], s63 offen lds
    s_add_u32 s63, s63, s65
    s_add_u32 m0, s64, 67584
    s_nop 0
    buffer_load_dwordx4 v2, s[44:47], s63 offen lds
    s_add_u32 s63, s63, s65
    s_add_u32 m0, s64, 68608
    s_nop 0
    buffer_load_dwordx4 v2, s[44:47], s63 offen lds
    s_add_u32 s63, s63, s65
    s_add_u32 m0, s64, 69632
    s_nop 0
    buffer_load_dwordx4 v2, s[44:47], s63 offen lds
    s_add_u32 s63, s63, s65
    s_add_u32 m0, s64, 70656
    s_nop 0
    buffer_load_dwordx4 v2, s[44:47], s63 offen lds
    s_add_u32 s63, s63, s65
    s_add_u32 m0, s64, 71680
    s_nop 0
    buffer_load_dwordx4 v2, s[44:47], s63 offen lds
    s_add_u32 s63, s63, s65
    s_add_u32 m0, s64, 72704
    s_nop 0
    buffer_load_dwordx4 v2, s[44:47], s63 offen lds
    s_waitcnt vmcnt(24)
    s_barrier
    ds_read_b64_tr_b16 a[96:97], v232 offset:32768
    ds_read_b64_tr_b16 a[98:99], v233 offset:32768
    ds_read_b64_tr_b16 a[100:101], v234 offset:32768
    ds_read_b64_tr_b16 a[102:103], v235 offset:32768
    ds_read_b64_tr_b16 a[104:105], v232 offset:40960
    ds_read_b64_tr_b16 a[106:107], v233 offset:40960
    ds_read_b64_tr_b16 a[108:109], v234 offset:40960
    ds_read_b64_tr_b16 a[110:111], v235 offset:40960
    ds_read_b64_tr_b16 a[112:113], v232 offset:49152
    ds_read_b64_tr_b16 a[114:115], v233 offset:49152
    ds_read_b64_tr_b16 a[116:117], v234 offset:49152
    ds_read_b64_tr_b16 a[118:119], v235 offset:49152
    ds_read_b64_tr_b16 a[120:121], v232 offset:57344
    ds_read_b64_tr_b16 a[122:123], v233 offset:57344
    ds_read_b64_tr_b16 a[124:125], v234 offset:57344
    ds_read_b64_tr_b16 a[126:127], v235 offset:57344
    s_waitcnt lgkmcnt(0)
    s_barrier
    s_mul_i32 s63, s53, 896
    s_add_u32 m0, s64, 98304
    s_nop 0
    buffer_load_dwordx4 v2, s[44:47], s63 offen lds
    s_add_u32 s63, s63, s65
    s_add_u32 m0, s64, 99328
    s_nop 0
    buffer_load_dwordx4 v2, s[44:47], s63 offen lds
    s_add_u32 s63, s63, s65
    s_add_u32 m0, s64, 100352
    s_nop 0
    buffer_load_dwordx4 v2, s[44:47], s63 offen lds
    s_add_u32 s63, s63, s65
    s_add_u32 m0, s64, 101376
    s_nop 0
    buffer_load_dwordx4 v2, s[44:47], s63 offen lds
    s_add_u32 s63, s63, s65
    s_add_u32 m0, s64, 102400
    s_nop 0
    buffer_load_dwordx4 v2, s[44:47], s63 offen lds
    s_add_u32 s63, s63, s65
    s_add_u32 m0, s64, 103424
    s_nop 0
    buffer_load_dwordx4 v2, s[44:47], s63 offen lds
    s_add_u32 s63, s63, s65
    s_add_u32 m0, s64, 104448
    s_nop 0
    buffer_load_dwordx4 v2, s[44:47], s63 offen lds
    s_add_u32 s63, s63, s65
    s_add_u32 m0, s64, 105472
    s_nop 0
    buffer_load_dwordx4 v2, s[44:47], s63 offen lds
    s_waitcnt vmcnt(24)
    s_barrier
    ds_read_b64_tr_b16 a[128:129], v228 offset:0
    ds_read_b64_tr_b16 a[130:131], v229 offset:0
    ds_read_b64_tr_b16 a[132:133], v230 offset:0
    ds_read_b64_tr_b16 a[134:135], v231 offset:0
    ds_read_b64_tr_b16 a[136:137], v228 offset:8192
    ds_read_b64_tr_b16 a[138:139], v229 offset:8192
    ds_read_b64_tr_b16 a[140:141], v230 offset:8192
    ds_read_b64_tr_b16 a[142:143], v231 offset:8192
    ds_read_b64_tr_b16 a[144:145], v228 offset:16384
    ds_read_b64_tr_b16 a[146:147], v229 offset:16384
    ds_read_b64_tr_b16 a[148:149], v230 offset:16384
    ds_read_b64_tr_b16 a[150:151], v231 offset:16384
    ds_read_b64_tr_b16 a[152:153], v228 offset:24576
    ds_read_b64_tr_b16 a[154:155], v229 offset:24576
    ds_read_b64_tr_b16 a[156:157], v230 offset:24576
    ds_read_b64_tr_b16 a[158:159], v231 offset:24576
    s_waitcnt lgkmcnt(0)
    s_barrier
    s_lshl_b32 s67, s30, 10
    s_mul_i32 s85, s55, 7
    s_sub_u32 s84, s56, s85
    s_add_u32 s85, s85, s56
    s_sub_u32 s85, 0x10000, s85
    s_sub_u32 s57, s57, s85
    s_add_u32 m0, s67, 0
    s_add_u32 s57, s57, s85
    buffer_load_dwordx4 v95, s[48:51], s57 offen lds
    s_add_u32 m0, s67, 4096
    s_add_u32 s57, s57, s55
    buffer_load_dwordx4 v95, s[48:51], s57 offen lds
    s_add_u32 m0, s67, 8192
    s_add_u32 s57, s57, s55
    buffer_load_dwordx4 v95, s[48:51], s57 offen lds
    s_add_u32 m0, s67, 12288
    s_add_u32 s57, s57, s55
    buffer_load_dwordx4 v95, s[48:51], s57 offen lds
    s_add_u32 m0, s67, 16384
    s_add_u32 s57, s57, s55
    buffer_load_dwordx4 v95, s[48:51], s57 offen lds
    s_add_u32 m0, s67, 20480
    s_add_u32 s57, s57, s55
    buffer_load_dwordx4 v95, s[48:51], s57 offen lds
    s_add_u32 m0, s67, 24576
    s_add_u32 s57, s57, s55
    buffer_load_dwordx4 v95, s[48:51], s57 offen lds
    s_add_u32 m0, s67, 28672
    s_add_u32 s57, s57, s55
    buffer_load_dwordx4 v95, s[48:51], s57 offen lds
    s_waitcnt vmcnt(24)
    s_barrier
    ds_read_b64_tr_b16 a[160:161], v228 offset:32768
    ds_read_b64_tr_b16 a[162:163], v229 offset:32768
    ds_read_b64_tr_b16 a[164:165], v230 offset:32768
    ds_read_b64_tr_b16 a[166:167], v231 offset:32768
    ds_read_b64_tr_b16 a[168:169], v228 offset:40960
    ds_read_b64_tr_b16 a[170:171], v229 offset:40960
    ds_read_b64_tr_b16 a[172:173], v230 offset:40960
    ds_read_b64_tr_b16 a[174:175], v231 offset:40960
    ds_read_b64_tr_b16 a[176:177], v228 offset:49152
    ds_read_b64_tr_b16 a[178:179], v229 offset:49152
    ds_read_b64_tr_b16 a[180:181], v230 offset:49152
    ds_read_b64_tr_b16 a[182:183], v231 offset:49152
    ds_read_b64_tr_b16 a[184:185], v228 offset:57344
    ds_read_b64_tr_b16 a[186:187], v229 offset:57344
    ds_read_b64_tr_b16 a[188:189], v230 offset:57344
    ds_read_b64_tr_b16 a[190:191], v231 offset:57344
    s_waitcnt lgkmcnt(0)
    s_barrier
    s_add_u32 m0, s67, 32768
    s_add_u32 s57, s57, s84
    buffer_load_dwordx4 v95, s[48:51], s57 offen lds
    s_add_u32 m0, s67, 36864
    s_add_u32 s57, s57, s55
    buffer_load_dwordx4 v95, s[48:51], s57 offen lds
    s_add_u32 m0, s67, 40960
    s_add_u32 s57, s57, s55
    buffer_load_dwordx4 v95, s[48:51], s57 offen lds
    s_add_u32 m0, s67, 45056
    s_add_u32 s57, s57, s55
    buffer_load_dwordx4 v95, s[48:51], s57 offen lds
    s_add_u32 m0, s67, 49152
    s_add_u32 s57, s57, s55
    buffer_load_dwordx4 v95, s[48:51], s57 offen lds
    s_add_u32 m0, s67, 53248
    s_add_u32 s57, s57, s55
    buffer_load_dwordx4 v95, s[48:51], s57 offen lds
    s_add_u32 m0, s67, 57344
    s_add_u32 s57, s57, s55
    buffer_load_dwordx4 v95, s[48:51], s57 offen lds
    s_add_u32 m0, s67, 61440
    s_add_u32 s57, s57, s55
    buffer_load_dwordx4 v95, s[48:51], s57 offen lds
    s_waitcnt vmcnt(24)
    s_barrier
    ds_read_b64_tr_b16 a[192:193], v232 offset:0
    ds_read_b64_tr_b16 a[194:195], v233 offset:0
    ds_read_b64_tr_b16 a[196:197], v234 offset:0
    ds_read_b64_tr_b16 a[198:199], v235 offset:0
    ds_read_b64_tr_b16 a[200:201], v232 offset:8192
    ds_read_b64_tr_b16 a[202:203], v233 offset:8192
    ds_read_b64_tr_b16 a[204:205], v234 offset:8192
    ds_read_b64_tr_b16 a[206:207], v235 offset:8192
    ds_read_b64_tr_b16 a[208:209], v232 offset:16384
    ds_read_b64_tr_b16 a[210:211], v233 offset:16384
    ds_read_b64_tr_b16 a[212:213], v234 offset:16384
    ds_read_b64_tr_b16 a[214:215], v235 offset:16384
    ds_read_b64_tr_b16 a[216:217], v232 offset:24576
    ds_read_b64_tr_b16 a[218:219], v233 offset:24576
    ds_read_b64_tr_b16 a[220:221], v234 offset:24576
    ds_read_b64_tr_b16 a[222:223], v235 offset:24576
    s_waitcnt lgkmcnt(0)
    s_barrier
    s_add_u32 m0, s67, 65536
    s_add_u32 s57, s57, s85
    buffer_load_dwordx4 v95, s[48:51], s57 offen lds
    s_add_u32 m0, s67, 69632
    s_add_u32 s57, s57, s55
    buffer_load_dwordx4 v95, s[48:51], s57 offen lds
    s_add_u32 m0, s67, 73728
    s_add_u32 s57, s57, s55
    buffer_load_dwordx4 v95, s[48:51], s57 offen lds
    s_add_u32 m0, s67, 77824
    s_add_u32 s57, s57, s55
    buffer_load_dwordx4 v95, s[48:51], s57 offen lds
    s_add_u32 m0, s67, 81920
    s_add_u32 s57, s57, s55
    buffer_load_dwordx4 v95, s[48:51], s57 offen lds
    s_waitcnt vmcnt(21)
    s_barrier
    ds_read_b64_tr_b16 a[224:225], v232 offset:32768
    ds_read_b64_tr_b16 a[226:227], v233 offset:32768
    ds_read_b64_tr_b16 a[228:229], v234 offset:32768
    ds_read_b64_tr_b16 a[230:231], v235 offset:32768
    ds_read_b64_tr_b16 a[232:233], v232 offset:40960
    ds_read_b64_tr_b16 a[234:235], v233 offset:40960
    ds_read_b64_tr_b16 a[236:237], v234 offset:40960
    ds_read_b64_tr_b16 a[238:239], v235 offset:40960
    ds_read_b64_tr_b16 a[240:241], v232 offset:49152
    ds_read_b64_tr_b16 a[242:243], v233 offset:49152
    ds_read_b64_tr_b16 a[244:245], v234 offset:49152
    ds_read_b64_tr_b16 a[246:247], v235 offset:49152
    ds_read_b64_tr_b16 a[248:249], v232 offset:57344
    ds_read_b64_tr_b16 a[250:251], v233 offset:57344
    ds_read_b64_tr_b16 a[252:253], v234 offset:57344
    ds_read_b64_tr_b16 a[254:255], v235 offset:57344
    s_waitcnt lgkmcnt(0)
    s_barrier
L_lw_a:
    s_cmp_lg_u32 s52, 2
    s_cbranch_scc1 L_cfd_15
    s_mov_b32 s88, 0
    v_mov_b32 v246, 128
L_cf_14:
    s_add_u32 s88, s88, 1
    s_mov_b32 s89, 1
    s_cmp_ge_u32 s88, 262144
    s_cbranch_scc1 L_abort
    buffer_load_dword v247, v246, s[36:39], 0 offen sc1
    s_waitcnt vmcnt(0)
    v_readfirstlane_b32 s52, v247
    s_cmp_le_u32 s52, s2
    s_cbranch_scc1 L_cf_14
    s_and_b32 s52, s52, 3
    s_sub_u32 s52, s52, 1
    s_cmp_eq_u32 s52, 0
    s_cbranch_scc1 L_cfd_15
    s_mov_b32 s52, 1
    s_mov_b32 s31, s83
    s_waitcnt vmcnt(0) lgkmcnt(0)
    s_barrier
    s_branch L_dispatch
L_cfd_15:
    s_mov_b32 s88, 0
    v_mov_b32 v246, 132
L_side_16:
    s_add_u32 s88, s88, 1
    s_mov_b32 s89, 18
    s_cmp_ge_u32 s88, 262144
    s_cbranch_scc1 L_abort
    buffer_load_dword v247, v246, s[36:39], 0 offen sc1
    s_waitcnt vmcnt(0)
    v_readfirstlane_b32 s95, v247
    s_cmp_le_u32 s95, s2
    s_cbranch_scc1 L_side_16
    s_sub_u32 s95, s95, 1
    s_and_b32 s95, s95, 1
    s_lshl_b32 s95, s95, 13
    s_lshl_b32 s69, s69, 2
    s_add_u32 s69, s69, s30
    s_lshl_b32 s72, s68, 22
    s_add_u32 s72, s72, 4194304
    s_lshl_b32 s74, s69, 17
    s_add_u32 s66, s72, s74
    s_mov_b32 s59, 2048
    s_mov_b32 s61, 64
    s_cmp_eq_u32 s68, 0
    s_cselect_b32 s62, 0x3e8293ee, 1.0
    v_mov_b32 v16, 0x0
    v_and_b32 v246, 0x10, v240
    v_xor_b32 v16, v16, v246
    v_and_b32 v246, 0x20, v241
    v_xor_b32 v16, v16, v246
    v_and_b32 v246, 0x40, v242
    v_xor_b32 v16, v16, v246
    v_and_b32 v246, 0x80, v243
    v_xor_b32 v16, v16, v246
    v_and_b32 v246, 0x200, v244
    v_xor_b32 v16, v16, v246
    v_and_b32 v246, 0x400, v245
    v_xor_b32 v16, v16, v246
    v_add_u32 v19, 256, v16
    s_lshl_b32 s73, s69, 4
    s_lshl_b32 s74, s68, 2
    s_add_u32 s73, s73, s74
    v_mov_b32 v94, 0x1000
    v_add_u32 v94, s73, v94
    s_mov_b32 s86, 0x1
    s_mov_b32 s87, 0x0
    v_mov_b32 v246, 0x7fff0000
    v_cndmask_b32 v94, v246, v94, s[86:87]
    v_mov_b32 v17, 0x7fff0000
    s_mov_b32 s88, 0
    v_mov_b32 v246, 72
L_rdy_17:
    s_add_u32 s88, s88, 1
    s_mov_b32 s89, 9
    s_cmp_ge_u32 s88, 262144
    s_cbranch_scc1 L_abort
    buffer_load_dword v247, v246, s[36:39], 0 offen sc1
    s_mul_i32 s89, s2, 34
    s_add_u32 s89, s89, 136
    s_waitcnt vmcnt(0)
    v_cmp_gt_u32 vcc, s89, v247
    s_cbranch_vccnz L_rdy_17
    s_cmp_eq_u32 s68, 2
    s_cbranch_scc1 L_gE3
    s_cmp_eq_u32 s68, 1
    s_cbranch_scc1 L_gE1
    s_mov_b32 s58, 0x7fff0000
    s_mov_b32 s60, 0
    s_waitcnt vmcnt(13)
    s_barrier
    ds_read_b128 v[20:23], v8 offset:0
    ds_read_b128 v[24:27], v9 offset:0
    ds_read_b128 v[28:31], v10 offset:0
    ds_read_b128 v[32:35], v11 offset:0
    ds_read_b128 v[36:39], v8 offset:4096
    ds_read_b128 v[40:43], v9 offset:4096
L_ws_E1s:
    s_waitcnt lgkmcnt(4)
    v_mfma_f32_16x16x32_bf16 v[52:55], a[0:3], v[20:23], 0
    s_add_u32 m0, s67, 86016
    s_add_u32 s57, s57, s55
    v_mfma_f32_16x16x32_bf16 v[56:59], a[0:3], v[24:27], 0
    buffer_load_dwordx4 v95, s[48:51], s57 offen lds
    v_mfma_f32_16x16x32_bf16 v[60:63], a[4:7], v[20:23], 0
    ds_read_b128 v[44:47], v10 offset:4096
    v_mfma_f32_16x16x32_bf16 v[64:67], a[4:7], v[24:27], 0
    ds_read_b128 v[48:51], v11 offset:4096
    s_waitcnt lgkmcnt(4)
    v_mfma_f32_16x16x32_bf16 v[52:55], a[8:11], v[28:31], v[52:55]
    s_add_u32 m0, s67, 90112
    s_add_u32 s57, s57, s55
    v_mfma_f32_16x16x32_bf16 v[56:59], a[8:11], v[32:35], v[56:59]
    buffer_load_dwordx4 v95, s[48:51], s57 offen lds
    v_mfma_f32_16x16x32_bf16 v[60:63], a[12:15], v[28:31], v[60:63]
    ds_read_b128 v[20:23], v8 offset:8192
    v_mfma_f32_16x16x32_bf16 v[64:67], a[12:15], v[32:35], v[64:67]
    ds_read_b128 v[24:27], v9 offset:8192
    s_waitcnt lgkmcnt(4)
    v_mfma_f32_16x16x32_bf16 v[52:55], a[16:19], v[36:39], v[52:55]
    s_add_u32 m0, s67, 94208
    s_add_u32 s57, s57, s55
    v_mfma_f32_16x16x32_bf16 v[56:59], a[16:19], v[40:43], v[56:59]
    buffer_load_dwordx4 v95, s[48:51], s57 offen lds
    v_mfma_f32_16x16x32_bf16 v[60:63], a[20:23], v[36:39], v[60:63]
    ds_read_b128 v[28:31], v10 offset:8192
    v_mfma_f32_16x16x32_bf16 v[64:67], a[20:23], v[40:43], v[64:67]
    ds_read_b128 v[32:35], v11 offset:8192
    s_waitcnt lgkmcnt(4)
    v_mfma_f32_16x16x32_bf16 v[52:55], a[24:27], v[44:47], v[52:55]
    v_mul_f32 v68, s62, v68
    v_mul_f32 v69, s62, v69
    v_mfma_f32_16x16x32_bf16 v[56:59], a[24:27], v[48:51], v[56:59]
    v_mul_f32 v70, s62, v70
    v_mul_f32 v71, s62, v71
    v_mfma_f32_16x16x32_bf16 v[60:63], a[28:31], v[44:47], v[60:63]
    ds_read_b128 v[36:39], v8 offset:12288
    v_mfma_f32_16x16x32_bf16 v[64:67], a[28:31], v[48:51], v[64:67]
    ds_read_b128 v[40:43], v9 offset:12288
    s_waitcnt lgkmcnt(4)
    v_mfma_f32_16x16x32_bf16 v[52:55], a[32:35], v[20:23], v[52:55]
    v_mul_f32 v76, s62, v76
    v_mul_f32 v77, s62, v77
    v_mfma_f32_16x16x32_bf16 v[56:59], a[32:35], v[24:27], v[56:59]
    v_mul_f32 v78, s62, v78
    v_mul_f32 v79, s62, v79
    v_mfma_f32_16x16x32_bf16 v[60:63], a[36:39], v[20:23], v[60:63]
    ds_read_b128 v[44:47], v10 offset:12288
    v_mfma_f32_16x16x32_bf16 v[64:67], a[36:39], v[24:27], v[64:67]
    ds_read_b128 v[48:51], v11 offset:12288
    s_waitcnt lgkmcnt(4)
    v_mfma_f32_16x16x32_bf16 v[52:55], a[40:43], v[28:31], v[52:55]
    v_cvt_pk_bf16_f32 v84, v68, v69
    v_cvt_pk_bf16_f32 v85, v70, v71
    v_mfma_f32_16x16x32_bf16 v[56:59], a[40:43], v[32:35], v[56:59]
    v_cvt_pk_bf16_f32 v86, v76, v77
    v_cvt_pk_bf16_f32 v87, v78, v79
    v_mfma_f32_16x16x32_bf16 v[60:63], a[44:47], v[28:31], v[60:63]
    ds_read_b128 v[20:23], v8 offset:16384
    v_mfma_f32_16x16x32_bf16 v[64:67], a[44:47], v[32:35], v[64:67]
    ds_read_b128 v[24:27], v9 offset:16384
    s_waitcnt lgkmcnt(4)
    v_mfma_f32_16x16x32_bf16 v[52:55], a[48:51], v[36:39], v[52:55]
    v_mul_f32 v72, s62, v72
    v_mul_f32 v73, s62, v73
    v_mfma_f32_16x16x32_bf16 v[56:59], a[48:51], v[40:43], v[56:59]
    v_mul_f32 v74, s62, v74
    v_mul_f32 v75, s62, v75
    v_mfma_f32_16x16x32_bf16 v[60:63], a[52:55], v[36:39], v[60:63]
    ds_read_b128 v[28:31], v10 offset:16384
    v_mfma_f32_16x16x32_bf16 v[64:67], a[52:55], v[40:43], v[64:67]
    ds_read_b128 v[32:35], v11 offset:16384
    s_waitcnt lgkmcnt(4)
    v_mfma_f32_16x16x32_bf16 v[52:55], a[56:59], v[44:47], v[52:55]
    v_mul_f32 v80, s62, v80
    v_mul_f32 v81, s62, v81
    v_mfma_f32_16x16x32_bf16 v[56:59], a[56:59], v[48:51], v[56:59]
    v_mul_f32 v82, s62, v82
    v_mul_f32 v83, s62, v83
    v_mfma_f32_16x16x32_bf16 v[60:63], a[60:63], v[44:47], v[60:63]
    ds_read_b128 v[36:39], v8 offset:20480
    v_mfma_f32_16x16x32_bf16 v[64:67], a[60:63], v[48:51], v[64:67]
    ds_read_b128 v[40:43], v9 offset:20480
    s_waitcnt lgkmcnt(4)
    v_mfma_f32_16x16x32_bf16 v[52:55], a[64:67], v[20:23], v[52:55]
    v_cvt_pk_bf16_f32 v88, v72, v73
    v_cvt_pk_bf16_f32 v89, v74, v75
    v_mfma_f32_16x16x32_bf16 v[56:59], a[64:67], v[24:27], v[56:59]
    v_cvt_pk_bf16_f32 v90, v80, v81
    v_cvt_pk_bf16_f32 v91, v82, v83
    v_mfma_f32_16x16x32_bf16 v[60:63], a[68:71], v[20:23], v[60:63]
    ds_read_b128 v[44:47], v10 offset:20480
    v_mfma_f32_16x16x32_bf16 v[64:67], a[68:71], v[24:27], v[64:67]
    ds_read_b128 v[48:51], v11 offset:20480
    s_waitcnt lgkmcnt(4)
    v_mfma_f32_16x16x32_bf16 v[52:55], a[72:75], v[28:31], v[52:55]
    buffer_store_dwordx4 v[84:87], v16, s[32:35], s58 offen sc1
    v_mfma_f32_16x16x32_bf16 v[56:59], a[72:75], v[32:35], v[56:59]
    s_sub_u32 s89, s60, 1
    s_max_i32 s89, s89, 0
    v_mfma_f32_16x16x32_bf16 v[60:63], a[76:79], v[28:31], v[60:63]
    ds_read_b128 v[20:23], v8 offset:24576
    v_mfma_f32_16x16x32_bf16 v[64:67], a[76:79], v[32:35], v[64:67]
    ds_read_b128 v[24:27], v9 offset:24576
    s_waitcnt lgkmcnt(4)
    v_mfma_f32_16x16x32_bf16 v[52:55], a[80:83], v[36:39], v[52:55]
    buffer_store_dwordx4 v[88:91], v19, s[32:35], s58 offen sc1
    v_mfma_f32_16x16x32_bf16 v[56:59], a[80:83], v[40:43], v[56:59]
    s_mov_b32 s58, s66
    s_add_u32 s66, s66, s59
    v_mfma_f32_16x16x32_bf16 v[60:63], a[84:87], v[36:39], v[60:63]
    ds_read_b128 v[28:31], v10 offset:24576
    v_mov_b32 v18, s89
    v_mfma_f32_16x16x32_bf16 v[64:67], a[84:87], v[40:43], v[64:67]
    ds_read_b128 v[32:35], v11 offset:24576
    s_waitcnt lgkmcnt(4)
    v_mfma_f32_16x16x32_bf16 v[52:55], a[88:91], v[44:47], v[52:55]
    s_waitcnt vmcnt(10)
    s_barrier
    v_mfma_f32_16x16x32_bf16 v[56:59], a[88:91], v[48:51], v[56:59]
    s_add_u32 m0, s67, 98304
    s_add_u32 s57, s57, s84
    buffer_load_dwordx4 v95, s[48:51], s57 offen lds
    v_mfma_f32_16x16x32_bf16 v[60:63], a[92:95], v[44:47], v[60:63]
    ds_read_b128 v[36:39], v8 offset:28672
    v_mfma_f32_16x16x32_bf16 v[64:67], a[92:95], v[48:51], v[64:67]
    ds_read_b128 v[40:43], v9 offset:28672
    s_waitcnt lgkmcnt(4)
    v_mfma_f32_16x16x32_bf16 v[52:55], a[96:99], v[20:23], v[52:55]
    buffer_store_dword v18, v17, s[32:35], 0 offen sc1
    v_mfma_f32_16x16x32_bf16 v[56:59], a[96:99], v[24:27], v[56:59]
    s_add_u32 m0, s67, 102400
    s_add_u32 s57, s57, s55
    buffer_load_dwordx4 v95, s[48:51], s57 offen lds
    v_mfma_f32_16x16x32_bf16 v[60:63], a[100:103], v[20:23], v[60:63]
    ds_read_b128 v[44:47], v10 offset:28672
    v_mfma_f32_16x16x32_bf16 v[64:67], a[100:103], v[24:27], v[64:67]
    ds_read_b128 v[48:51], v11 offset:28672
    s_waitcnt lgkmcnt(4)
    v_mfma_f32_16x16x32_bf16 v[52:55], a[104:107], v[28:31], v[52:55]
    s_add_u32 m0, s67, 106496
    s_add_u32 s57, s57, s55
    v_mfma_f32_16x16x32_bf16 v[56:59], a[104:107], v[32:35], v[56:59]
    buffer_load_dwordx4 v95, s[48:51], s57 offen lds
    v_mfma_f32_16x16x32_bf16 v[60:63], a[108:111], v[28:31], v[60:63]
    ds_read_b128 v[20:23], v8 offset:32768
    v_mfma_f32_16x16x32_bf16 v[64:67], a[108:111], v[32:35], v[64:67]
    ds_read_b128 v[24:27], v9 offset:32768
    s_waitcnt lgkmcnt(4)
    v_mfma_f32_16x16x32_bf16 v[52:55], a[112:115], v[36:39], v[52:55]
    s_add_u32 m0, s67, 110592
    s_add_u32 s57, s57, s55
    v_mfma_f32_16x16x32_bf16 v[56:59], a[112:115], v[40:43], v[56:59]
    buffer_load_dwordx4 v95, s[48:51], s57 offen lds
    v_mfma_f32_16x16x32_bf16 v[60:63], a[116:119], v[36:39], v[60:63]
    ds_read_b128 v[28:31], v10 offset:32768
    v_mfma_f32_16x16x32_bf16 v[64:67], a[116:119], v[40:43], v[64:67]
    ds_read_b128 v[32:35], v11 offset:32768
    s_waitcnt lgkmcnt(4)
    v_mfma_f32_16x16x32_bf16 v[52:55], a[120:123], v[44:47], v[52:55]
    s_add_u32 m0, s67, 114688
    s_add_u32 s57, s57, s55
    v_mfma_f32_16x16x32_bf16 v[56:59], a[120:123], v[48:51], v[56:59]
    buffer_load_dwordx4 v95, s[48:51], s57 offen lds
    v_mfma_f32_16x16x32_bf16 v[60:63], a[124:127], v[44:47], v[60:63]
    ds_read_b128 v[36:39], v8 offset:36864
    v_mfma_f32_16x16x32_bf16 v[64:67], a[124:127], v[48:51], v[64:67]
    ds_read_b128 v[40:43], v9 offset:36864
    s_waitcnt lgkmcnt(4)
    v_mfma_f32_16x16x32_bf16 v[52:55], a[128:131], v[20:23], v[52:55]
    s_add_u32 m0, s67, 118784
    s_add_u32 s57, s57, s55
    v_mfma_f32_16x16x32_bf16 v[56:59], a[128:131], v[24:27], v[56:59]
    buffer_load_dwordx4 v95, s[48:51], s57 offen lds
    v_mfma_f32_16x16x32_bf16 v[60:63], a[132:135], v[20:23], v[60:63]
    ds_read_b128 v[44:47], v10 offset:36864
    v_mfma_f32_16x16x32_bf16 v[64:67], a[132:135], v[24:27], v[64:67]
    ds_read_b128 v[48:51], v11 offset:36864
    s_waitcnt lgkmcnt(4)
    v_mfma_f32_16x16x32_bf16 v[52:55], a[136:139], v[28:31], v[52:55]
    s_add_u32 m0, s67, 122880
    s_add_u32 s57, s57, s55
    v_mfma_f32_16x16x32_bf16 v[56:59], a[136:139], v[32:35], v[56:59]
    buffer_load_dwordx4 v95, s[48:51], s57 offen lds
    v_mfma_f32_16x16x32_bf16 v[60:63], a[140:143], v[28:31], v[60:63]
    ds_read_b128 v[20:23], v8 offset:40960
    v_mfma_f32_16x16x32_bf16 v[64:67], a[140:143], v[32:35], v[64:67]
    ds_read_b128 v[24:27], v9 offset:40960
    s_waitcnt lgkmcnt(4)
    v_mfma_f32_16x16x32_bf16 v[52:55], a[144:147], v[36:39], v[52:55]
    s_add_u32 m0, s67, 126976
    s_add_u32 s57, s57, s55
    v_mfma_f32_16x16x32_bf16 v[56:59], a[144:147], v[40:43], v[56:59]
    buffer_load_dwordx4 v95, s[48:51], s57 offen lds
    v_mfma_f32_16x16x32_bf16 v[60:63], a[148:151], v[36:39], v[60:63]
    ds_read_b128 v[28:31], v10 offset:40960
    v_mfma_f32_16x16x32_bf16 v[64:67], a[148:151], v[40:43], v[64:67]
    ds_read_b128 v[32:35], v11 offset:40960
    s_waitcnt lgkmcnt(4)
    v_mfma_f32_16x16x32_bf16 v[52:55], a[152:155], v[44:47], v[52:55]
    v_mfma_f32_16x16x32_bf16 v[56:59], a[152:155], v[48:51], v[56:59]
    v_mfma_f32_16x16x32_bf16 v[60:63], a[156:159], v[44:47], v[60:63]
    ds_read_b128 v[36:39], v8 offset:45056
    v_mfma_f32_16x16x32_bf16 v[64:67], a[156:159], v[48:51], v[64:67]
    ds_read_b128 v[40:43], v9 offset:45056
    s_waitcnt lgkmcnt(4)
    v_mfma_f32_16x16x32_bf16 v[52:55], a[160:163], v[20:23], v[52:55]
    v_mfma_f32_16x16x32_bf16 v[56:59], a[160:163], v[24:27], v[56:59]
    v_mfma_f32_16x16x32_bf16 v[60:63], a[164:167], v[20:23], v[60:63]
    ds_read_b128 v[44:47], v10 offset:45056
    v_mfma_f32_16x16x32_bf16 v[64:67], a[164:167], v[24:27], v[64:67]
    ds_read_b128 v[48:51], v11 offset:45056
    s_waitcnt lgkmcnt(4)
    v_mfma_f32_16x16x32_bf16 v[52:55], a[168:171], v[28:31], v[52:55]
    v_mfma_f32_16x16x32_bf16 v[56:59], a[168:171], v[32:35], v[56:59]
    v_mfma_f32_16x16x32_bf16 v[60:63], a[172:175], v[28:31], v[60:63]
    ds_read_b128 v[20:23], v8 offset:49152
    v_mfma_f32_16x16x32_bf16 v[64:67], a[172:175], v[32:35], v[64:67]
    ds_read_b128 v[24:27], v9 offset:49152
    s_waitcnt lgkmcnt(4)
    v_mfma_f32_16x16x32_bf16 v[52:55], a[176:179], v[36:39], v[52:55]
    v_mfma_f32_16x16x32_bf16 v[56:59], a[176:179], v[40:43], v[56:59]
    v_mfma_f32_16x16x32_bf16 v[60:63], a[180:183], v[36:39], v[60:63]
    ds_read_b128 v[28:31], v10 offset:49152
    v_mfma_f32_16x16x32_bf16 v[64:67], a[180:183], v[40:43], v[64:67]
    ds_read_b128 v[32:35], v11 offset:49152
    s_waitcnt lgkmcnt(4)
    v_mfma_f32_16x16x32_bf16 v[52:55], a[184:187], v[44:47], v[52:55]
    v_mfma_f32_16x16x32_bf16 v[56:59], a[184:187], v[48:51], v[56:59]
    v_mfma_f32_16x16x32_bf16 v[60:63], a[188:191], v[44:47], v[60:63]
    ds_read_b128 v[36:39], v8 offset:53248
    v_mfma_f32_16x16x32_bf16 v[64:67], a[188:191], v[48:51], v[64:67]
    ds_read_b128 v[40:43], v9 offset:53248
    s_waitcnt lgkmcnt(4)
    v_mfma_f32_16x16x32_bf16 v[52:55], a[192:195], v[20:23], v[52:55]
    v_mfma_f32_16x16x32_bf16 v[56:59], a[192:195], v[24:27], v[56:59]
    v_mfma_f32_16x16x32_bf16 v[60:63], a[196:199], v[20:23], v[60:63]
    ds_read_b128 v[44:47], v10 offset:53248
    v_mfma_f32_16x16x32_bf16 v[64:67], a[196:199], v[24:27], v[64:67]
    ds_read_b128 v[48:51], v11 offset:53248
    s_waitcnt lgkmcnt(4)
    v_mfma_f32_16x16x32_bf16 v[52:55], a[200:203], v[28:31], v[52:55]
    v_mfma_f32_16x16x32_bf16 v[56:59], a[200:203], v[32:35], v[56:59]
    v_mfma_f32_16x16x32_bf16 v[60:63], a[204:207], v[28:31], v[60:63]
    ds_read_b128 v[20:23], v8 offset:57344
    v_mfma_f32_16x16x32_bf16 v[64:67], a[204:207], v[32:35], v[64:67]
    ds_read_b128 v[24:27], v9 offset:57344
    s_waitcnt lgkmcnt(4)
    v_mfma_f32_16x16x32_bf16 v[52:55], a[208:211], v[36:39], v[52:55]
    v_mfma_f32_16x16x32_bf16 v[56:59], a[208:211], v[40:43], v[56:59]
    v_mfma_f32_16x16x32_bf16 v[60:63], a[212:215], v[36:39], v[60:63]
    ds_read_b128 v[28:31], v10 offset:57344
    v_mfma_f32_16x16x32_bf16 v[64:67], a[212:215], v[40:43], v[64:67]
    ds_read_b128 v[32:35], v11 offset:57344
    s_waitcnt lgkmcnt(4)
    v_mfma_f32_16x16x32_bf16 v[52:55], a[216:219], v[44:47], v[52:55]
    s_waitcnt vmcnt(11)
    s_barrier
    v_mfma_f32_16x16x32_bf16 v[56:59], a[216:219], v[48:51], v[56:59]
    s_add_u32 m0, s67, 0
    s_add_u32 s57, s57, s85
    buffer_load_dwordx4 v95, s[48:51], s57 offen lds
    v_mfma_f32_16x16x32_bf16 v[60:63], a[220:223], v[44:47], v[60:63]
    ds_read_b128 v[36:39], v8 offset:61440
    v_mfma_f32_16x16x32_bf16 v[64:67], a[220:223], v[48:51], v[64:67]
    ds_read_b128 v[40:43], v9 offset:61440
    s_waitcnt lgkmcnt(4)
    v_mfma_f32_16x16x32_bf16 v[52:55], a[224:227], v[20:23], v[52:55]
    s_add_u32 m0, s67, 4096
    s_add_u32 s57, s57, s55
    v_mfma_f32_16x16x32_bf16 v[56:59], a[224:227], v[24:27], v[56:59]
    buffer_load_dwordx4 v95, s[48:51], s57 offen lds
    v_mfma_f32_16x16x32_bf16 v[60:63], a[228:231], v[20:23], v[60:63]
    ds_read_b128 v[44:47], v10 offset:61440
    v_mfma_f32_16x16x32_bf16 v[64:67], a[228:231], v[24:27], v[64:67]
    ds_read_b128 v[48:51], v11 offset:61440
    s_waitcnt lgkmcnt(4)
    v_mfma_f32_16x16x32_bf16 v[52:55], a[232:235], v[28:31], v[52:55]
    s_add_u32 m0, s67, 8192
    s_add_u32 s57, s57, s55
    v_mfma_f32_16x16x32_bf16 v[56:59], a[232:235], v[32:35], v[56:59]
    buffer_load_dwordx4 v95, s[48:51], s57 offen lds
    v_mfma_f32_16x16x32_bf16 v[60:63], a[236:239], v[28:31], v[60:63]
    ds_read_b128 v[20:23], v12 offset:0
    v_mfma_f32_16x16x32_bf16 v[64:67], a[236:239], v[32:35], v[64:67]
    ds_read_b128 v[24:27], v13 offset:0
    s_waitcnt lgkmcnt(4)
    v_mfma_f32_16x16x32_bf16 v[52:55], a[240:243], v[36:39], v[52:55]
    s_add_u32 s60, s60, 1
    s_add_u32 m0, s67, 12288
    v_mfma_f32_16x16x32_bf16 v[56:59], a[240:243], v[40:43], v[56:59]
    s_add_u32 s57, s57, s55
    buffer_load_dwordx4 v95, s[48:51], s57 offen lds
    v_mfma_f32_16x16x32_bf16 v[60:63], a[244:247], v[36:39], v[60:63]
    ds_read_b128 v[28:31], v14 offset:0
    v_mfma_f32_16x16x32_bf16 v[64:67], a[244:247], v[40:43], v[64:67]
    ds_read_b128 v[32:35], v15 offset:0
    s_waitcnt lgkmcnt(4)
    v_mfma_f32_16x16x32_bf16 v[52:55], a[248:251], v[44:47], v[52:55]
    s_add_u32 m0, s67, 16384
    s_add_u32 s57, s57, s55
    v_mfma_f32_16x16x32_bf16 v[56:59], a[248:251], v[48:51], v[56:59]
    buffer_load_dwordx4 v95, s[48:51], s57 offen lds
    v_mfma_f32_16x16x32_bf16 v[60:63], a[252:255], v[44:47], v[60:63]
    ds_read_b128 v[36:39], v12 offset:4096
    v_mfma_f32_16x16x32_bf16 v[64:67], a[252:255], v[48:51], v[64:67]
    ds_read_b128 v[40:43], v13 offset:4096
    s_waitcnt lgkmcnt(4)
    v_mfma_f32_16x16x32_bf16 v[68:71], a[0:3], v[20:23], 0
    s_add_u32 m0, s67, 20480
    s_add_u32 s57, s57, s55
    v_mfma_f32_16x16x32_bf16 v[72:75], a[0:3], v[24:27], 0
    buffer_load_dwordx4 v95, s[48:51], s57 offen lds
    v_mfma_f32_16x16x32_bf16 v[76:79], a[4:7], v[20:23], 0
    ds_read_b128 v[44:47], v14 offset:4096
    v_mfma_f32_16x16x32_bf16 v[80:83], a[4:7], v[24:27], 0
    ds_read_b128 v[48:51], v15 offset:4096
    s_waitcnt lgkmcnt(4)
    v_mfma_f32_16x16x32_bf16 v[68:71], a[8:11], v[28:31], v[68:71]
    s_add_u32 m0, s67, 24576
    s_add_u32 s57, s57, s55
    v_mfma_f32_16x16x32_bf16 v[72:75], a[8:11], v[32:35], v[72:75]
    buffer_load_dwordx4 v95, s[48:51], s57 offen lds
    v_mfma_f32_16x16x32_bf16 v[76:79], a[12:15], v[28:31], v[76:79]
    ds_read_b128 v[20:23], v12 offset:8192
    v_mfma_f32_16x16x32_bf16 v[80:83], a[12:15], v[32:35], v[80:83]
    ds_read_b128 v[24:27], v13 offset:8192
    s_waitcnt lgkmcnt(4)
    v_mfma_f32_16x16x32_bf16 v[68:71], a[16:19], v[36:39], v[68:71]
    s_add_u32 m0, s67, 28672
    s_add_u32 s57, s57, s55
    v_mfma_f32_16x16x32_bf16 v[72:75], a[16:19], v[40:43], v[72:75]
    buffer_load_dwordx4 v95, s[48:51], s57 offen lds
    v_mfma_f32_16x16x32_bf16 v[76:79], a[20:23], v[36:39], v[76:79]
    ds_read_b128 v[28:31], v14 offset:8192
    v_mfma_f32_16x16x32_bf16 v[80:83], a[20:23], v[40:43], v[80:83]
    ds_read_b128 v[32:35], v15 offset:8192
    s_waitcnt lgkmcnt(4)
    v_mfma_f32_16x16x32_bf16 v[68:71], a[24:27], v[44:47], v[68:71]
    v_mul_f32 v52, s62, v52
    v_mul_f32 v53, s62, v53
    v_mfma_f32_16x16x32_bf16 v[72:75], a[24:27], v[48:51], v[72:75]
    v_mul_f32 v54, s62, v54
    v_mul_f32 v55, s62, v55
    v_mfma_f32_16x16x32_bf16 v[76:79], a[28:31], v[44:47], v[76:79]
    ds_read_b128 v[36:39], v12 offset:12288
    v_mfma_f32_16x16x32_bf16 v[80:83], a[28:31], v[48:51], v[80:83]
    ds_read_b128 v[40:43], v13 offset:12288
    s_waitcnt lgkmcnt(4)
    v_mfma_f32_16x16x32_bf16 v[68:71], a[32:35], v[20:23], v[68:71]
    v_mul_f32 v60, s62, v60
    v_mul_f32 v61, s62, v61
    v_mfma_f32_16x16x32_bf16 v[72:75], a[32:35], v[24:27], v[72:75]
    v_mul_f32 v62, s62, v62
    v_mul_f32 v63, s62, v63
    v_mfma_f32_16x16x32_bf16 v[76:79], a[36:39], v[20:23], v[76:79]
    ds_read_b128 v[44:47], v14 offset:12288
    v_mfma_f32_16x16x32_bf16 v[80:83], a[36:39], v[24:27], v[80:83]
    ds_read_b128 v[48:51], v15 offset:12288
    s_waitcnt lgkmcnt(4)
    v_mfma_f32_16x16x32_bf16 v[68:71], a[40:43], v[28:31], v[68:71]
    v_cvt_pk_bf16_f32 v84, v52, v53
    v_cvt_pk_bf16_f32 v85, v54, v55
    v_mfma_f32_16x16x32_bf16 v[72:75], a[40:43], v[32:35], v[72:75]
    v_cvt_pk_bf16_f32 v86, v60, v61
    v_cvt_pk_bf16_f32 v87, v62, v63
    v_mfma_f32_16x16x32_bf16 v[76:79], a[44:47], v[28:31], v[76:79]
    ds_read_b128 v[20:23], v12 offset:16384
    v_mfma_f32_16x16x32_bf16 v[80:83], a[44:47], v[32:35], v[80:83]
    ds_read_b128 v[24:27], v13 offset:16384
    s_waitcnt lgkmcnt(4)
    v_mfma_f32_16x16x32_bf16 v[68:71], a[48:51], v[36:39], v[68:71]
    v_mul_f32 v56, s62, v56
    v_mul_f32 v57, s62, v57
    v_mfma_f32_16x16x32_bf16 v[72:75], a[48:51], v[40:43], v[72:75]
    v_mul_f32 v58, s62, v58
    v_mul_f32 v59, s62, v59
    v_mfma_f32_16x16x32_bf16 v[76:79], a[52:55], v[36:39], v[76:79]
    ds_read_b128 v[28:31], v14 offset:16384
    v_mfma_f32_16x16x32_bf16 v[80:83], a[52:55], v[40:43], v[80:83]
    ds_read_b128 v[32:35], v15 offset:16384
    s_waitcnt lgkmcnt(4)
    v_mfma_f32_16x16x32_bf16 v[68:71], a[56:59], v[44:47], v[68:71]
    v_mul_f32 v64, s62, v64
    v_mul_f32 v65, s62, v65
    v_mfma_f32_16x16x32_bf16 v[72:75], a[56:59], v[48:51], v[72:75]
    v_mul_f32 v66, s62, v66
    v_mul_f32 v67, s62, v67
    v_mfma_f32_16x16x32_bf16 v[76:79], a[60:63], v[44:47], v[76:79]
    ds_read_b128 v[36:39], v12 offset:20480
    v_mfma_f32_16x16x32_bf16 v[80:83], a[60:63], v[48:51], v[80:83]
    ds_read_b128 v[40:43], v13 offset:20480
    s_waitcnt lgkmcnt(4)
    v_mfma_f32_16x16x32_bf16 v[68:71], a[64:67], v[20:23], v[68:71]
    v_cvt_pk_bf16_f32 v88, v56, v57
    v_cvt_pk_bf16_f32 v89, v58, v59
    v_mfma_f32_16x16x32_bf16 v[72:75], a[64:67], v[24:27], v[72:75]
    v_cvt_pk_bf16_f32 v90, v64, v65
    v_cvt_pk_bf16_f32 v91, v66, v67
    v_mfma_f32_16x16x32_bf16 v[76:79], a[68:71], v[20:23], v[76:79]
    ds_read_b128 v[44:47], v14 offset:20480
    v_mfma_f32_16x16x32_bf16 v[80:83], a[68:71], v[24:27], v[80:83]
    ds_read_b128 v[48:51], v15 offset:20480
    s_waitcnt lgkmcnt(4)
    v_mfma_f32_16x16x32_bf16 v[68:71], a[72:75], v[28:31], v[68:71]
    buffer_store_dwordx4 v[84:87], v16, s[32:35], s58 offen sc1
    v_mfma_f32_16x16x32_bf16 v[72:75], a[72:75], v[32:35], v[72:75]
    s_sub_u32 s89, s60, 1
    s_max_i32 s89, s89, 0
    v_mfma_f32_16x16x32_bf16 v[76:79], a[76:79], v[28:31], v[76:79]
    ds_read_b128 v[20:23], v12 offset:24576
    v_mfma_f32_16x16x32_bf16 v[80:83], a[76:79], v[32:35], v[80:83]
    ds_read_b128 v[24:27], v13 offset:24576
    s_waitcnt lgkmcnt(4)
    v_mfma_f32_16x16x32_bf16 v[68:71], a[80:83], v[36:39], v[68:71]
    buffer_store_dwordx4 v[88:91], v19, s[32:35], s58 offen sc1
    v_mfma_f32_16x16x32_bf16 v[72:75], a[80:83], v[40:43], v[72:75]
    s_mov_b32 s58, s66
    s_add_u32 s66, s66, s59
    v_mfma_f32_16x16x32_bf16 v[76:79], a[84:87], v[36:39], v[76:79]
    ds_read_b128 v[28:31], v14 offset:24576
    v_mov_b32 v18, s89
    v_mfma_f32_16x16x32_bf16 v[80:83], a[84:87], v[40:43], v[80:83]
    ds_read_b128 v[32:35], v15 offset:24576
    s_waitcnt lgkmcnt(4)
    v_mfma_f32_16x16x32_bf16 v[68:71], a[88:91], v[44:47], v[68:71]
    s_waitcnt vmcnt(10)
    s_barrier
    v_mfma_f32_16x16x32_bf16 v[72:75], a[88:91], v[48:51], v[72:75]
    s_add_u32 m0, s67, 32768
    s_add_u32 s57, s57, s84
    buffer_load_dwordx4 v95, s[48:51], s57 offen lds
    v_mfma_f32_16x16x32_bf16 v[76:79], a[92:95], v[44:47], v[76:79]
    ds_read_b128 v[36:39], v12 offset:28672
    v_mfma_f32_16x16x32_bf16 v[80:83], a[92:95], v[48:51], v[80:83]
    ds_read_b128 v[40:43], v13 offset:28672
    s_waitcnt lgkmcnt(4)
    v_mfma_f32_16x16x32_bf16 v[68:71], a[96:99], v[20:23], v[68:71]
    buffer_store_dword v18, v17, s[32:35], 0 offen sc1
    v_mfma_f32_16x16x32_bf16 v[72:75], a[96:99], v[24:27], v[72:75]
    s_add_u32 m0, s67, 36864
    s_add_u32 s57, s57, s55
    buffer_load_dwordx4 v95, s[48:51], s57 offen lds
    v_mfma_f32_16x16x32_bf16 v[76:79], a[100:103], v[20:23], v[76:79]
    ds_read_b128 v[44:47], v14 offset:28672
    v_mfma_f32_16x16x32_bf16 v[80:83], a[100:103], v[24:27], v[80:83]
    ds_read_b128 v[48:51], v15 offset:28672
    s_waitcnt lgkmcnt(4)
    v_mfma_f32_16x16x32_bf16 v[68:71], a[104:107], v[28:31], v[68:71]
    s_add_u32 m0, s67, 40960
    s_add_u32 s57, s57, s55
    v_mfma_f32_16x16x32_bf16 v[72:75], a[104:107], v[32:35], v[72:75]
    buffer_load_dwordx4 v95, s[48:51], s57 offen lds
    v_mfma_f32_16x16x32_bf16 v[76:79], a[108:111], v[28:31], v[76:79]
    ds_read_b128 v[20:23], v12 offset:32768
    v_mfma_f32_16x16x32_bf16 v[80:83], a[108:111], v[32:35], v[80:83]
    ds_read_b128 v[24:27], v13 offset:32768
    s_waitcnt lgkmcnt(4)
    v_mfma_f32_16x16x32_bf16 v[68:71], a[112:115], v[36:39], v[68:71]
    s_add_u32 m0, s67, 45056
    s_add_u32 s57, s57, s55
    v_mfma_f32_16x16x32_bf16 v[72:75], a[112:115], v[40:43], v[72:75]
    buffer_load_dwordx4 v95, s[48:51], s57 offen lds
    v_mfma_f32_16x16x32_bf16 v[76:79], a[116:119], v[36:39], v[76:79]
    ds_read_b128 v[28:31], v14 offset:32768
    v_mfma_f32_16x16x32_bf16 v[80:83], a[116:119], v[40:43], v[80:83]
    ds_read_b128 v[32:35], v15 offset:32768
    s_waitcnt lgkmcnt(4)
    v_mfma_f32_16x16x32_bf16 v[68:71], a[120:123], v[44:47], v[68:71]
    s_add_u32 m0, s67, 49152
    s_add_u32 s57, s57, s55
    v_mfma_f32_16x16x32_bf16 v[72:75], a[120:123], v[48:51], v[72:75]
    buffer_load_dwordx4 v95, s[48:51], s57 offen lds
    v_mfma_f32_16x16x32_bf16 v[76:79], a[124:127], v[44:47], v[76:79]
    ds_read_b128 v[36:39], v12 offset:36864
    v_mfma_f32_16x16x32_bf16 v[80:83], a[124:127], v[48:51], v[80:83]
    ds_read_b128 v[40:43], v13 offset:36864
    s_waitcnt lgkmcnt(4)
    v_mfma_f32_16x16x32_bf16 v[68:71], a[128:131], v[20:23], v[68:71]
    s_add_u32 m0, s67, 53248
    s_add_u32 s57, s57, s55
    v_mfma_f32_16x16x32_bf16 v[72:75], a[128:131], v[24:27], v[72:75]
    buffer_load_dwordx4 v95, s[48:51], s57 offen lds
    v_mfma_f32_16x16x32_bf16 v[76:79], a[132:135], v[20:23], v[76:79]
    ds_read_b128 v[44:47], v14 offset:36864
    v_mfma_f32_16x16x32_bf16 v[80:83], a[132:135], v[24:27], v[80:83]
    ds_read_b128 v[48:51], v15 offset:36864
    s_waitcnt lgkmcnt(4)
    v_mfma_f32_16x16x32_bf16 v[68:71], a[136:139], v[28:31], v[68:71]
    s_add_u32 m0, s67, 57344
    s_add_u32 s57, s57, s55
    v_mfma_f32_16x16x32_bf16 v[72:75], a[136:139], v[32:35], v[72:75]
    buffer_load_dwordx4 v95, s[48:51], s57 offen lds
    v_mfma_f32_16x16x32_bf16 v[76:79], a[140:143], v[28:31], v[76:79]
    ds_read_b128 v[20:23], v12 offset:40960
    v_mfma_f32_16x16x32_bf16 v[80:83], a[140:143], v[32:35], v[80:83]
    ds_read_b128 v[24:27], v13 offset:40960
    s_waitcnt lgkmcnt(4)
    v_mfma_f32_16x16x32_bf16 v[68:71], a[144:147], v[36:39], v[68:71]
    s_add_u32 m0, s67, 61440
    s_add_u32 s57, s57, s55
    v_mfma_f32_16x16x32_bf16 v[72:75], a[144:147], v[40:43], v[72:75]
    buffer_load_dwordx4 v95, s[48:51], s57 offen lds
    v_mfma_f32_16x16x32_bf16 v[76:79], a[148:151], v[36:39], v[76:79]
    ds_read_b128 v[28:31], v14 offset:40960
    v_mfma_f32_16x16x32_bf16 v[80:83], a[148:151], v[40:43], v[80:83]
    ds_read_b128 v[32:35], v15 offset:40960
    s_waitcnt lgkmcnt(4)
    v_mfma_f32_16x16x32_bf16 v[68:71], a[152:155], v[44:47], v[68:71]
    v_mfma_f32_16x16x32_bf16 v[72:75], a[152:155], v[48:51], v[72:75]
    v_mfma_f32_16x16x32_bf16 v[76:79], a[156:159], v[44:47], v[76:79]
    ds_read_b128 v[36:39], v12 offset:45056
    v_mfma_f32_16x16x32_bf16 v[80:83], a[156:159], v[48:51], v[80:83]
    ds_read_b128 v[40:43], v13 offset:45056
    s_waitcnt lgkmcnt(4)
    v_mfma_f32_16x16x32_bf16 v[68:71], a[160:163], v[20:23], v[68:71]
    v_mfma_f32_16x16x32_bf16 v[72:75], a[160:163], v[24:27], v[72:75]
    v_mfma_f32_16x16x32_bf16 v[76:79], a[164:167], v[20:23], v[76:79]
    ds_read_b128 v[44:47], v14 offset:45056
    v_mfma_f32_16x16x32_bf16 v[80:83], a[164:167], v[24:27], v[80:83]
    ds_read_b128 v[48:51], v15 offset:45056
    s_waitcnt lgkmcnt(4)
    v_mfma_f32_16x16x32_bf16 v[68:71], a[168:171], v[28:31], v[68:71]
    v_mfma_f32_16x16x32_bf16 v[72:75], a[168:171], v[32:35], v[72:75]
    v_mfma_f32_16x16x32_bf16 v[76:79], a[172:175], v[28:31], v[76:79]
    ds_read_b128 v[20:23], v12 offset:49152
    v_mfma_f32_16x16x32_bf16 v[80:83], a[172:175], v[32:35], v[80:83]
    ds_read_b128 v[24:27], v13 offset:49152
    s_waitcnt lgkmcnt(4)
    v_mfma_f32_16x16x32_bf16 v[68:71], a[176:179], v[36:39], v[68:71]
    v_mfma_f32_16x16x32_bf16 v[72:75], a[176:179], v[40:43], v[72:75]
    v_mfma_f32_16x16x32_bf16 v[76:79], a[180:183], v[36:39], v[76:79]
    ds_read_b128 v[28:31], v14 offset:49152
    v_mfma_f32_16x16x32_bf16 v[80:83], a[180:183], v[40:43], v[80:83]
    ds_read_b128 v[32:35], v15 offset:49152
    s_waitcnt lgkmcnt(4)
    v_mfma_f32_16x16x32_bf16 v[68:71], a[184:187], v[44:47], v[68:71]
    v_mfma_f32_16x16x32_bf16 v[72:75], a[184:187], v[48:51], v[72:75]
    v_mfma_f32_16x16x32_bf16 v[76:79], a[188:191], v[44:47], v[76:79]
    ds_read_b128 v[36:39], v12 offset:53248
    v_mfma_f32_16x16x32_bf16 v[80:83], a[188:191], v[48:51], v[80:83]
    ds_read_b128 v[40:43], v13 offset:53248
    s_waitcnt lgkmcnt(4)
    v_mfma_f32_16x16x32_bf16 v[68:71], a[192:195], v[20:23], v[68:71]
    v_mfma_f32_16x16x32_bf16 v[72:75], a[192:195], v[24:27], v[72:75]
    v_mfma_f32_16x16x32_bf16 v[76:79], a[196:199], v[20:23], v[76:79]
    ds_read_b128 v[44:47], v14 offset:53248
    v_mfma_f32_16x16x32_bf16 v[80:83], a[196:199], v[24:27], v[80:83]
    ds_read_b128 v[48:51], v15 offset:53248
    s_waitcnt lgkmcnt(4)
    v_mfma_f32_16x16x32_bf16 v[68:71], a[200:203], v[28:31], v[68:71]
    v_mfma_f32_16x16x32_bf16 v[72:75], a[200:203], v[32:35], v[72:75]
    v_mfma_f32_16x16x32_bf16 v[76:79], a[204:207], v[28:31], v[76:79]
    ds_read_b128 v[20:23], v12 offset:57344
    v_mfma_f32_16x16x32_bf16 v[80:83], a[204:207], v[32:35], v[80:83]
    ds_read_b128 v[24:27], v13 offset:57344
    s_waitcnt lgkmcnt(4)
    v_mfma_f32_16x16x32_bf16 v[68:71], a[208:211], v[36:39], v[68:71]
    v_mfma_f32_16x16x32_bf16 v[72:75], a[208:211], v[40:43], v[72:75]
    v_mfma_f32_16x16x32_bf16 v[76:79], a[212:215], v[36:39], v[76:79]
    ds_read_b128 v[28:31], v14 offset:57344
    v_mfma_f32_16x16x32_bf16 v[80:83], a[212:215], v[40:43], v[80:83]
    ds_read_b128 v[32:35], v15 offset:57344
    s_waitcnt lgkmcnt(4)
    v_mfma_f32_16x16x32_bf16 v[68:71], a[216:219], v[44:47], v[68:71]
    s_waitcnt vmcnt(11)
    s_barrier
    s_cmp_lg_u32 s60, 1
    s_cbranch_scc1 L_ws_nf_E1s
    v_mov_b32 v18, 1
    s_waitcnt vmcnt(9)
    buffer_store_dword v18, v17, s[32:35], 0 offen sc1
L_ws_nf_E1s:
    v_mfma_f32_16x16x32_bf16 v[72:75], a[216:219], v[48:51], v[72:75]
    s_add_u32 m0, s67, 65536
    s_add_u32 s57, s57, s85
    buffer_load_dwordx4 v95, s[48:51], s57 offen lds
    v_mfma_f32_16x16x32_bf16 v[76:79], a[220:223], v[44:47], v[76:79]
    ds_read_b128 v[36:39], v12 offset:61440
    v_mfma_f32_16x16x32_bf16 v[80:83], a[220:223], v[48:51], v[80:83]
    ds_read_b128 v[40:43], v13 offset:61440
    s_waitcnt lgkmcnt(4)
    v_mfma_f32_16x16x32_bf16 v[68:71], a[224:227], v[20:23], v[68:71]
    s_add_u32 m0, s67, 69632
    s_add_u32 s57, s57, s55
    v_mfma_f32_16x16x32_bf16 v[72:75], a[224:227], v[24:27], v[72:75]
    buffer_load_dwordx4 v95, s[48:51], s57 offen lds
    v_mfma_f32_16x16x32_bf16 v[76:79], a[228:231], v[20:23], v[76:79]
    ds_read_b128 v[44:47], v14 offset:61440
    v_mfma_f32_16x16x32_bf16 v[80:83], a[228:231], v[24:27], v[80:83]
    ds_read_b128 v[48:51], v15 offset:61440
    s_waitcnt lgkmcnt(4)
    v_mfma_f32_16x16x32_bf16 v[68:71], a[232:235], v[28:31], v[68:71]
    s_add_u32 m0, s67, 73728
    s_add_u32 s57, s57, s55
    v_mfma_f32_16x16x32_bf16 v[72:75], a[232:235], v[32:35], v[72:75]
    buffer_load_dwordx4 v95, s[48:51], s57 offen lds
    v_mfma_f32_16x16x32_bf16 v[76:79], a[236:239], v[28:31], v[76:79]
    ds_read_b128 v[20:23], v8 offset:0
    v_mfma_f32_16x16x32_bf16 v[80:83], a[236:239], v[32:35], v[80:83]
    ds_read_b128 v[24:27], v9 offset:0
    s_waitcnt lgkmcnt(4)
    v_mfma_f32_16x16x32_bf16 v[68:71], a[240:243], v[36:39], v[68:71]
    s_add_u32 s60, s60, 1
    s_add_u32 m0, s67, 77824
    v_mfma_f32_16x16x32_bf16 v[72:75], a[240:243], v[40:43], v[72:75]
    s_add_u32 s57, s57, s55
    buffer_load_dwordx4 v95, s[48:51], s57 offen lds
    v_mfma_f32_16x16x32_bf16 v[76:79], a[244:247], v[36:39], v[76:79]
    ds_read_b128 v[28:31], v10 offset:0
    v_mfma_f32_16x16x32_bf16 v[80:83], a[244:247], v[40:43], v[80:83]
    ds_read_b128 v[32:35], v11 offset:0
    s_waitcnt lgkmcnt(4)
    v_mfma_f32_16x16x32_bf16 v[68:71], a[248:251], v[44:47], v[68:71]
    s_add_u32 m0, s67, 81920
    s_add_u32 s57, s57, s55
    v_mfma_f32_16x16x32_bf16 v[72:75], a[248:251], v[48:51], v[72:75]
    buffer_load_dwordx4 v95, s[48:51], s57 offen lds
    v_mfma_f32_16x16x32_bf16 v[76:79], a[252:255], v[44:47], v[76:79]
    ds_read_b128 v[36:39], v8 offset:4096
    v_mfma_f32_16x16x32_bf16 v[80:83], a[252:255], v[48:51], v[80:83]
    ds_read_b128 v[40:43], v9 offset:4096
    s_cmp_lt_u32 s60, s61
    s_cbranch_scc1 L_ws_E1s
    v_mul_f32 v68, s62, v68
    v_mul_f32 v69, s62, v69
    v_mul_f32 v70, s62, v70
    v_mul_f32 v71, s62, v71
    v_mul_f32 v76, s62, v76
    v_mul_f32 v77, s62, v77
    v_mul_f32 v78, s62, v78
    v_mul_f32 v79, s62, v79
    v_cvt_pk_bf16_f32 v84, v68, v69
    v_cvt_pk_bf16_f32 v85, v70, v71
    v_cvt_pk_bf16_f32 v86, v76, v77
    v_cvt_pk_bf16_f32 v87, v78, v79
    v_mul_f32 v72, s62, v72
    v_mul_f32 v73, s62, v73
    v_mul_f32 v74, s62, v74
    v_mul_f32 v75, s62, v75
    v_mul_f32 v80, s62, v80
    v_mul_f32 v81, s62, v81
    v_mul_f32 v82, s62, v82
    v_mul_f32 v83, s62, v83
    v_cvt_pk_bf16_f32 v88, v72, v73
    v_cvt_pk_bf16_f32 v89, v74, v75
    v_cvt_pk_bf16_f32 v90, v80, v81
    v_cvt_pk_bf16_f32 v91, v82, v83
    buffer_store_dwordx4 v[84:87], v16, s[32:35], s58 offen sc1
    buffer_store_dwordx4 v[88:91], v19, s[32:35], s58 offen sc1
    s_waitcnt vmcnt(0) lgkmcnt(0)
    v_mov_b32 v18, s60
    buffer_store_dword v18, v94, s[32:35], 0 offen sc1
    s_barrier
    s_branch L_p1done
L_gE1:
    s_mov_b32 s58, 0x7fff0000
    s_mov_b32 s60, 0
    s_waitcnt vmcnt(13)
    s_barrier
    ds_read_b128 v[20:23], v8 offset:0
    ds_read_b128 v[24:27], v9 offset:0
    ds_read_b128 v[28:31], v10 offset:0
    ds_read_b128 v[32:35], v11 offset:0
    ds_read_b128 v[36:39], v8 offset:4096
    ds_read_b128 v[40:43], v9 offset:4096
L_ws_E1:
    s_waitcnt lgkmcnt(4)
    v_mfma_f32_16x16x32_bf16 v[52:55], a[0:3], v[20:23], 0
    s_add_u32 m0, s67, 86016
    s_add_u32 s57, s57, s55
    v_mfma_f32_16x16x32_bf16 v[56:59], a[0:3], v[24:27], 0
    buffer_load_dwordx4 v95, s[48:51], s57 offen lds
    v_mfma_f32_16x16x32_bf16 v[60:63], a[4:7], v[20:23], 0
    ds_read_b128 v[44:47], v10 offset:4096
    v_mfma_f32_16x16x32_bf16 v[64:67], a[4:7], v[24:27], 0
    ds_read_b128 v[48:51], v11 offset:4096
    s_waitcnt lgkmcnt(4)
    v_mfma_f32_16x16x32_bf16 v[52:55], a[8:11], v[28:31], v[52:55]
    s_add_u32 m0, s67, 90112
    s_add_u32 s57, s57, s55
    v_mfma_f32_16x16x32_bf16 v[56:59], a[8:11], v[32:35], v[56:59]
    buffer_load_dwordx4 v95, s[48:51], s57 offen lds
    v_mfma_f32_16x16x32_bf16 v[60:63], a[12:15], v[28:31], v[60:63]
    ds_read_b128 v[20:23], v8 offset:8192
    v_mfma_f32_16x16x32_bf16 v[64:67], a[12:15], v[32:35], v[64:67]
    ds_read_b128 v[24:27], v9 offset:8192
    s_waitcnt lgkmcnt(4)
    v_mfma_f32_16x16x32_bf16 v[52:55], a[16:19], v[36:39], v[52:55]
    s_add_u32 m0, s67, 94208
    s_add_u32 s57, s57, s55
    v_mfma_f32_16x16x32_bf16 v[56:59], a[16:19], v[40:43], v[56:59]
    buffer_load_dwordx4 v95, s[48:51], s57 offen lds
    v_mfma_f32_16x16x32_bf16 v[60:63], a[20:23], v[36:39], v[60:63]
    ds_read_b128 v[28:31], v10 offset:8192
    v_mfma_f32_16x16x32_bf16 v[64:67], a[20:23], v[40:43], v[64:67]
    ds_read_b128 v[32:35], v11 offset:8192
    s_waitcnt lgkmcnt(4)
    v_mfma_f32_16x16x32_bf16 v[52:55], a[24:27], v[44:47], v[52:55]
    v_cvt_pk_bf16_f32 v84, v68, v69
    v_cvt_pk_bf16_f32 v85, v70, v71
    v_mfma_f32_16x16x32_bf16 v[56:59], a[24:27], v[48:51], v[56:59]
    v_mfma_f32_16x16x32_bf16 v[60:63], a[28:31], v[44:47], v[60:63]
    ds_read_b128 v[36:39], v8 offset:12288
    v_mfma_f32_16x16x32_bf16 v[64:67], a[28:31], v[48:51], v[64:67]
    ds_read_b128 v[40:43], v9 offset:12288
    s_waitcnt lgkmcnt(4)
    v_mfma_f32_16x16x32_bf16 v[52:55], a[32:35], v[20:23], v[52:55]
    v_cvt_pk_bf16_f32 v86, v76, v77
    v_cvt_pk_bf16_f32 v87, v78, v79
    v_mfma_f32_16x16x32_bf16 v[56:59], a[32:35], v[24:27], v[56:59]
    v_mfma_f32_16x16x32_bf16 v[60:63], a[36:39], v[20:23], v[60:63]
    ds_read_b128 v[44:47], v10 offset:12288
    v_mfma_f32_16x16x32_bf16 v[64:67], a[36:39], v[24:27], v[64:67]
    ds_read_b128 v[48:51], v11 offset:12288
    s_waitcnt lgkmcnt(4)
    v_mfma_f32_16x16x32_bf16 v[52:55], a[40:43], v[28:31], v[52:55]
    v_cvt_pk_bf16_f32 v88, v72, v73
    v_cvt_pk_bf16_f32 v89, v74, v75
    v_mfma_f32_16x16x32_bf16 v[56:59], a[40:43], v[32:35], v[56:59]
    v_mfma_f32_16x16x32_bf16 v[60:63], a[44:47], v[28:31], v[60:63]
    ds_read_b128 v[20:23], v8 offset:16384
    v_mfma_f32_16x16x32_bf16 v[64:67], a[44:47], v[32:35], v[64:67]
    ds_read_b128 v[24:27], v9 offset:16384
    s_waitcnt lgkmcnt(4)
    v_mfma_f32_16x16x32_bf16 v[52:55], a[48:51], v[36:39], v[52:55]
    v_cvt_pk_bf16_f32 v90, v80, v81
    v_cvt_pk_bf16_f32 v91, v82, v83
    v_mfma_f32_16x16x32_bf16 v[56:59], a[48:51], v[40:43], v[56:59]
    v_mfma_f32_16x16x32_bf16 v[60:63], a[52:55], v[36:39], v[60:63]
    ds_read_b128 v[28:31], v10 offset:16384
    v_mfma_f32_16x16x32_bf16 v[64:67], a[52:55], v[40:43], v[64:67]
    ds_read_b128 v[32:35], v11 offset:16384
    s_waitcnt lgkmcnt(4)
    v_mfma_f32_16x16x32_bf16 v[52:55], a[56:59], v[44:47], v[52:55]
    v_mfma_f32_16x16x32_bf16 v[56:59], a[56:59], v[48:51], v[56:59]
    v_mfma_f32_16x16x32_bf16 v[60:63], a[60:63], v[44:47], v[60:63]
    ds_read_b128 v[36:39], v8 offset:20480
    v_mfma_f32_16x16x32_bf16 v[64:67], a[60:63], v[48:51], v[64:67]
    ds_read_b128 v[40:43], v9 offset:20480
    s_waitcnt lgkmcnt(4)
    v_mfma_f32_16x16x32_bf16 v[52:55], a[64:67], v[20:23], v[52:55]
    v_mfma_f32_16x16x32_bf16 v[56:59], a[64:67], v[24:27], v[56:59]
    v_mfma_f32_16x16x32_bf16 v[60:63], a[68:71], v[20:23], v[60:63]
    ds_read_b128 v[44:47], v10 offset:20480
    v_mfma_f32_16x16x32_bf16 v[64:67], a[68:71], v[24:27], v[64:67]
    ds_read_b128 v[48:51], v11 offset:20480
    s_waitcnt lgkmcnt(4)
    v_mfma_f32_16x16x32_bf16 v[52:55], a[72:75], v[28:31], v[52:55]
    buffer_store_dwordx4 v[84:87], v16, s[32:35], s58 offen sc1
    v_mfma_f32_16x16x32_bf16 v[56:59], a[72:75], v[32:35], v[56:59]
    s_sub_u32 s89, s60, 1
    s_max_i32 s89, s89, 0
    v_mfma_f32_16x16x32_bf16 v[60:63], a[76:79], v[28:31], v[60:63]
    ds_read_b128 v[20:23], v8 offset:24576
    v_mfma_f32_16x16x32_bf16 v[64:67], a[76:79], v[32:35], v[64:67]
    ds_read_b128 v[24:27], v9 offset:24576
    s_waitcnt lgkmcnt(4)
    v_mfma_f32_16x16x32_bf16 v[52:55], a[80:83], v[36:39], v[52:55]
    buffer_store_dwordx4 v[88:91], v19, s[32:35], s58 offen sc1
    v_mfma_f32_16x16x32_bf16 v[56:59], a[80:83], v[40:43], v[56:59]
    s_mov_b32 s58, s66
    s_add_u32 s66, s66, s59
    v_mfma_f32_16x16x32_bf16 v[60:63], a[84:87], v[36:39], v[60:63]
    ds_read_b128 v[28:31], v10 offset:24576
    v_mov_b32 v18, s89
    v_mfma_f32_16x16x32_bf16 v[64:67], a[84:87], v[40:43], v[64:67]
    ds_read_b128 v[32:35], v11 offset:24576
    s_waitcnt lgkmcnt(4)
    v_mfma_f32_16x16x32_bf16 v[52:55], a[88:91], v[44:47], v[52:55]
    s_waitcnt vmcnt(10)
    s_barrier
    v_mfma_f32_16x16x32_bf16 v[56:59], a[88:91], v[48:51], v[56:59]
    s_add_u32 m0, s67, 98304
    s_add_u32 s57, s57, s84
    buffer_load_dwordx4 v95, s[48:51], s57 offen lds
    v_mfma_f32_16x16x32_bf16 v[60:63], a[92:95], v[44:47], v[60:63]
    ds_read_b128 v[36:39], v8 offset:28672
    v_mfma_f32_16x16x32_bf16 v[64:67], a[92:95], v[48:51], v[64:67]
    ds_read_b128 v[40:43], v9 offset:28672
    s_waitcnt lgkmcnt(4)
    v_mfma_f32_16x16x32_bf16 v[52:55], a[96:99], v[20:23], v[52:55]
    buffer_store_dword v18, v17, s[32:35], 0 offen sc1
    v_mfma_f32_16x16x32_bf16 v[56:59], a[96:99], v[24:27], v[56:59]
    s_add_u32 m0, s67, 102400
    s_add_u32 s57, s57, s55
    buffer_load_dwordx4 v95, s[48:51], s57 offen lds
    v_mfma_f32_16x16x32_bf16 v[60:63], a[100:103], v[20:23], v[60:63]
    ds_read_b128 v[44:47], v10 offset:28672
    v_mfma_f32_16x16x32_bf16 v[64:67], a[100:103], v[24:27], v[64:67]
    ds_read_b128 v[48:51], v11 offset:28672
    s_waitcnt lgkmcnt(4)
    v_mfma_f32_16x16x32_bf16 v[52:55], a[104:107], v[28:31], v[52:55]
    s_add_u32 m0, s67, 106496
    s_add_u32 s57, s57, s55
    v_mfma_f32_16x16x32_bf16 v[56:59], a[104:107], v[32:35], v[56:59]
    buffer_load_dwordx4 v95, s[48:51], s57 offen lds
    v_mfma_f32_16x16x32_bf16 v[60:63], a[108:111], v[28:31], v[60:63]
    ds_read_b128 v[20:23], v8 offset:32768
    v_mfma_f32_16x16x32_bf16 v[64:67], a[108:111], v[32:35], v[64:67]
    ds_read_b128 v[24:27], v9 offset:32768
    s_waitcnt lgkmcnt(4)
    v_mfma_f32_16x16x32_bf16 v[52:55], a[112:115], v[36:39], v[52:55]
    s_add_u32 m0, s67, 110592
    s_add_u32 s57, s57, s55
    v_mfma_f32_16x16x32_bf16 v[56:59], a[112:115], v[40:43], v[56:59]
    buffer_load_dwordx4 v95, s[48:51], s57 offen lds
    v_mfma_f32_16x16x32_bf16 v[60:63], a[116:119], v[36:39], v[60:63]
    ds_read_b128 v[28:31], v10 offset:32768
    v_mfma_f32_16x16x32_bf16 v[64:67], a[116:119], v[40:43], v[64:67]
    ds_read_b128 v[32:35], v11 offset:32768
    s_waitcnt lgkmcnt(4)
    v_mfma_f32_16x16x32_bf16 v[52:55], a[120:123], v[44:47], v[52:55]
    s_add_u32 m0, s67, 114688
    s_add_u32 s57, s57, s55
    v_mfma_f32_16x16x32_bf16 v[56:59], a[120:123], v[48:51], v[56:59]
    buffer_load_dwordx4 v95, s[48:51], s57 offen lds
    v_mfma_f32_16x16x32_bf16 v[60:63], a[124:127], v[44:47], v[60:63]
    ds_read_b128 v[36:39], v8 offset:36864
    v_mfma_f32_16x16x32_bf16 v[64:67], a[124:127], v[48:51], v[64:67]
    ds_read_b128 v[40:43], v9 offset:36864
    s_waitcnt lgkmcnt(4)
    v_mfma_f32_16x16x32_bf16 v[52:55], a[128:131], v[20:23], v[52:55]
    s_add_u32 m0, s67, 118784
    s_add_u32 s57, s57, s55
    v_mfma_f32_16x16x32_bf16 v[56:59], a[128:131], v[24:27], v[56:59]
    buffer_load_dwordx4 v95, s[48:51], s57 offen lds
    v_mfma_f32_16x16x32_bf16 v[60:63], a[132:135], v[20:23], v[60:63]
    ds_read_b128 v[44:47], v10 offset:36864
    v_mfma_f32_16x16x32_bf16 v[64:67], a[132:135], v[24:27], v[64:67]
    ds_read_b128 v[48:51], v11 offset:36864
    s_waitcnt lgkmcnt(4)
    v_mfma_f32_16x16x32_bf16 v[52:55], a[136:139], v[28:31], v[52:55]
    s_add_u32 m0, s67, 122880
    s_add_u32 s57, s57, s55
    v_mfma_f32_16x16x32_bf16 v[56:59], a[136:139], v[32:35], v[56:59]
    buffer_load_dwordx4 v95, s[48:51], s57 offen lds
    v_mfma_f32_16x16x32_bf16 v[60:63], a[140:143], v[28:31], v[60:63]
    ds_read_b128 v[20:23], v8 offset:40960
    v_mfma_f32_16x16x32_bf16 v[64:67], a[140:143], v[32:35], v[64:67]
    ds_read_b128 v[24:27], v9 offset:40960
    s_waitcnt lgkmcnt(4)
    v_mfma_f32_16x16x32_bf16 v[52:55], a[144:147], v[36:39], v[52:55]
    s_add_u32 m0, s67, 126976
    s_add_u32 s57, s57, s55
    v_mfma_f32_16x16x32_bf16 v[56:59], a[144:147], v[40:43], v[56:59]
    buffer_load_dwordx4 v95, s[48:51], s57 offen lds
    v_mfma_f32_16x16x32_bf16 v[60:63], a[148:151], v[36:39], v[60:63]
    ds_read_b128 v[28:31], v10 offset:40960
    v_mfma_f32_16x16x32_bf16 v[64:67], a[148:151], v[40:43], v[64:67]
    ds_read_b128 v[32:35], v11 offset:40960
    s_waitcnt lgkmcnt(4)
    v_mfma_f32_16x16x32_bf16 v[52:55], a[152:155], v[44:47], v[52:55]
    v_mfma_f32_16x16x32_bf16 v[56:59], a[152:155], v[48:51], v[56:59]
    v_mfma_f32_16x16x32_bf16 v[60:63], a[156:159], v[44:47], v[60:63]
    ds_read_b128 v[36:39], v8 offset:45056
    v_mfma_f32_16x16x32_bf16 v[64:67], a[156:159], v[48:51], v[64:67]
    ds_read_b128 v[40:43], v9 offset:45056
    s_waitcnt lgkmcnt(4)
    v_mfma_f32_16x16x32_bf16 v[52:55], a[160:163], v[20:23], v[52:55]
    v_mfma_f32_16x16x32_bf16 v[56:59], a[160:163], v[24:27], v[56:59]
    v_mfma_f32_16x16x32_bf16 v[60:63], a[164:167], v[20:23], v[60:63]
    ds_read_b128 v[44:47], v10 offset:45056
    v_mfma_f32_16x16x32_bf16 v[64:67], a[164:167], v[24:27], v[64:67]
    ds_read_b128 v[48:51], v11 offset:45056
    s_waitcnt lgkmcnt(4)
    v_mfma_f32_16x16x32_bf16 v[52:55], a[168:171], v[28:31], v[52:55]
    v_mfma_f32_16x16x32_bf16 v[56:59], a[168:171], v[32:35], v[56:59]
    v_mfma_f32_16x16x32_bf16 v[60:63], a[172:175], v[28:31], v[60:63]
    ds_read_b128 v[20:23], v8 offset:49152
    v_mfma_f32_16x16x32_bf16 v[64:67], a[172:175], v[32:35], v[64:67]
    ds_read_b128 v[24:27], v9 offset:49152
    s_waitcnt lgkmcnt(4)
    v_mfma_f32_16x16x32_bf16 v[52:55], a[176:179], v[36:39], v[52:55]
    v_mfma_f32_16x16x32_bf16 v[56:59], a[176:179], v[40:43], v[56:59]
    v_mfma_f32_16x16x32_bf16 v[60:63], a[180:183], v[36:39], v[60:63]
    ds_read_b128 v[28:31], v10 offset:49152
    v_mfma_f32_16x16x32_bf16 v[64:67], a[180:183], v[40:43], v[64:67]
    ds_read_b128 v[32:35], v11 offset:49152
    s_waitcnt lgkmcnt(4)
    v_mfma_f32_16x16x32_bf16 v[52:55], a[184:187], v[44:47], v[52:55]
    v_mfma_f32_16x16x32_bf16 v[56:59], a[184:187], v[48:51], v[56:59]
    v_mfma_f32_16x16x32_bf16 v[60:63], a[188:191], v[44:47], v[60:63]
    ds_read_b128 v[36:39], v8 offset:53248
    v_mfma_f32_16x16x32_bf16 v[64:67], a[188:191], v[48:51], v[64:67]
    ds_read_b128 v[40:43], v9 offset:53248
    s_waitcnt lgkmcnt(4)
    v_mfma_f32_16x16x32_bf16 v[52:55], a[192:195], v[20:23], v[52:55]
    v_mfma_f32_16x16x32_bf16 v[56:59], a[192:195], v[24:27], v[56:59]
    v_mfma_f32_16x16x32_bf16 v[60:63], a[196:199], v[20:23], v[60:63]
    ds_read_b128 v[44:47], v10 offset:53248
    v_mfma_f32_16x16x32_bf16 v[64:67], a[196:199], v[24:27], v[64:67]
    ds_read_b128 v[48:51], v11 offset:53248
    s_waitcnt lgkmcnt(4)
    v_mfma_f32_16x16x32_bf16 v[52:55], a[200:203], v[28:31], v[52:55]
    v_mfma_f32_16x16x32_bf16 v[56:59], a[200:203], v[32:35], v[56:59]
    v_mfma_f32_16x16x32_bf16 v[60:63], a[204:207], v[28:31], v[60:63]
    ds_read_b128 v[20:23], v8 offset:57344
    v_mfma_f32_16x16x32_bf16 v[64:67], a[204:207], v[32:35], v[64:67]
    ds_read_b128 v[24:27], v9 offset:57344
    s_waitcnt lgkmcnt(4)
    v_mfma_f32_16x16x32_bf16 v[52:55], a[208:211], v[36:39], v[52:55]
    v_mfma_f32_16x16x32_bf16 v[56:59], a[208:211], v[40:43], v[56:59]
    v_mfma_f32_16x16x32_bf16 v[60:63], a[212:215], v[36:39], v[60:63]
    ds_read_b128 v[28:31], v10 offset:57344
    v_mfma_f32_16x16x32_bf16 v[64:67], a[212:215], v[40:43], v[64:67]
    ds_read_b128 v[32:35], v11 offset:57344
    s_waitcnt lgkmcnt(4)
    v_mfma_f32_16x16x32_bf16 v[52:55], a[216:219], v[44:47], v[52:55]
    s_waitcnt vmcnt(11)
    s_barrier
    v_mfma_f32_16x16x32_bf16 v[56:59], a[216:219], v[48:51], v[56:59]
    s_add_u32 m0, s67, 0
    s_add_u32 s57, s57, s85
    buffer_load_dwordx4 v95, s[48:51], s57 offen lds
    v_mfma_f32_16x16x32_bf16 v[60:63], a[220:223], v[44:47], v[60:63]
    ds_read_b128 v[36:39], v8 offset:61440
    v_mfma_f32_16x16x32_bf16 v[64:67], a[220:223], v[48:51], v[64:67]
    ds_read_b128 v[40:43], v9 offset:61440
    s_waitcnt lgkmcnt(4)
    v_mfma_f32_16x16x32_bf16 v[52:55], a[224:227], v[20:23], v[52:55]
    s_add_u32 m0, s67, 4096
    s_add_u32 s57, s57, s55
    v_mfma_f32_16x16x32_bf16 v[56:59], a[224:227], v[24:27], v[56:59]
    buffer_load_dwordx4 v95, s[48:51], s57 offen lds
    v_mfma_f32_16x16x32_bf16 v[60:63], a[228:231], v[20:23], v[60:63]
    ds_read_b128 v[44:47], v10 offset:61440
    v_mfma_f32_16x16x32_bf16 v[64:67], a[228:231], v[24:27], v[64:67]
    ds_read_b128 v[48:51], v11 offset:61440
    s_waitcnt lgkmcnt(4)
    v_mfma_f32_16x16x32_bf16 v[52:55], a[232:235], v[28:31], v[52:55]
    s_add_u32 m0, s67, 8192
    s_add_u32 s57, s57, s55
    v_mfma_f32_16x16x32_bf16 v[56:59], a[232:235], v[32:35], v[56:59]
    buffer_load_dwordx4 v95, s[48:51], s57 offen lds
    v_mfma_f32_16x16x32_bf16 v[60:63], a[236:239], v[28:31], v[60:63]
    ds_read_b128 v[20:23], v12 offset:0
    v_mfma_f32_16x16x32_bf16 v[64:67], a[236:239], v[32:35], v[64:67]
    ds_read_b128 v[24:27], v13 offset:0
    s_waitcnt lgkmcnt(4)
    v_mfma_f32_16x16x32_bf16 v[52:55], a[240:243], v[36:39], v[52:55]
    s_add_u32 s60, s60, 1
    s_add_u32 m0, s67, 12288
    v_mfma_f32_16x16x32_bf16 v[56:59], a[240:243], v[40:43], v[56:59]
    s_add_u32 s57, s57, s55
    buffer_load_dwordx4 v95, s[48:51], s57 offen lds
    v_mfma_f32_16x16x32_bf16 v[60:63], a[244:247], v[36:39], v[60:63]
    ds_read_b128 v[28:31], v14 offset:0
    v_mfma_f32_16x16x32_bf16 v[64:67], a[244:247], v[40:43], v[64:67]
    ds_read_b128 v[32:35], v15 offset:0
    s_waitcnt lgkmcnt(4)
    v_mfma_f32_16x16x32_bf16 v[52:55], a[248:251], v[44:47], v[52:55]
    s_add_u32 m0, s67, 16384
    s_add_u32 s57, s57, s55
    v_mfma_f32_16x16x32_bf16 v[56:59], a[248:251], v[48:51], v[56:59]
    buffer_load_dwordx4 v95, s[48:51], s57 offen lds
    v_mfma_f32_16x16x32_bf16 v[60:63], a[252:255], v[44:47], v[60:63]
    ds_read_b128 v[36:39], v12 offset:4096
    v_mfma_f32_16x16x32_bf16 v[64:67], a[252:255], v[48:51], v[64:67]
    ds_read_b128 v[40:43], v13 offset:4096
    s_waitcnt lgkmcnt(4)
    v_mfma_f32_16x16x32_bf16 v[68:71], a[0:3], v[20:23], 0
    s_add_u32 m0, s67, 20480
    s_add_u32 s57, s57, s55
    v_mfma_f32_16x16x32_bf16 v[72:75], a[0:3], v[24:27], 0
    buffer_load_dwordx4 v95, s[48:51], s57 offen lds
    v_mfma_f32_16x16x32_bf16 v[76:79], a[4:7], v[20:23], 0
    ds_read_b128 v[44:47], v14 offset:4096
    v_mfma_f32_16x16x32_bf16 v[80:83], a[4:7], v[24:27], 0
    ds_read_b128 v[48:51], v15 offset:4096
    s_waitcnt lgkmcnt(4)
    v_mfma_f32_16x16x32_bf16 v[68:71], a[8:11], v[28:31], v[68:71]
    s_add_u32 m0, s67, 24576
    s_add_u32 s57, s57, s55
    v_mfma_f32_16x16x32_bf16 v[72:75], a[8:11], v[32:35], v[72:75]
    buffer_load_dwordx4 v95, s[48:51], s57 offen lds
    v_mfma_f32_16x16x32_bf16 v[76:79], a[12:15], v[28:31], v[76:79]
    ds_read_b128 v[20:23], v12 offset:8192
    v_mfma_f32_16x16x32_bf16 v[80:83], a[12:15], v[32:35], v[80:83]
    ds_read_b128 v[24:27], v13 offset:8192
    s_waitcnt lgkmcnt(4)
    v_mfma_f32_16x16x32_bf16 v[68:71], a[16:19], v[36:39], v[68:71]
    s_add_u32 m0, s67, 28672
    s_add_u32 s57, s57, s55
    v_mfma_f32_16x16x32_bf16 v[72:75], a[16:19], v[40:43], v[72:75]
    buffer_load_dwordx4 v95, s[48:51], s57 offen lds
    v_mfma_f32_16x16x32_bf16 v[76:79], a[20:23], v[36:39], v[76:79]
    ds_read_b128 v[28:31], v14 offset:8192
    v_mfma_f32_16x16x32_bf16 v[80:83], a[20:23], v[40:43], v[80:83]
    ds_read_b128 v[32:35], v15 offset:8192
    s_waitcnt lgkmcnt(4)
    v_mfma_f32_16x16x32_bf16 v[68:71], a[24:27], v[44:47], v[68:71]
    v_cvt_pk_bf16_f32 v84, v52, v53
    v_cvt_pk_bf16_f32 v85, v54, v55
    v_mfma_f32_16x16x32_bf16 v[72:75], a[24:27], v[48:51], v[72:75]
    v_mfma_f32_16x16x32_bf16 v[76:79], a[28:31], v[44:47], v[76:79]
    ds_read_b128 v[36:39], v12 offset:12288
    v_mfma_f32_16x16x32_bf16 v[80:83], a[28:31], v[48:51], v[80:83]
    ds_read_b128 v[40:43], v13 offset:12288
    s_waitcnt lgkmcnt(4)
    v_mfma_f32_16x16x32_bf16 v[68:71], a[32:35], v[20:23], v[68:71]
    v_cvt_pk_bf16_f32 v86, v60, v61
    v_cvt_pk_bf16_f32 v87, v62, v63
    v_mfma_f32_16x16x32_bf16 v[72:75], a[32:35], v[24:27], v[72:75]
    v_mfma_f32_16x16x32_bf16 v[76:79], a[36:39], v[20:23], v[76:79]
    ds_read_b128 v[44:47], v14 offset:12288
    v_mfma_f32_16x16x32_bf16 v[80:83], a[36:39], v[24:27], v[80:83]
    ds_read_b128 v[48:51], v15 offset:12288
    s_waitcnt lgkmcnt(4)
    v_mfma_f32_16x16x32_bf16 v[68:71], a[40:43], v[28:31], v[68:71]
    v_cvt_pk_bf16_f32 v88, v56, v57
    v_cvt_pk_bf16_f32 v89, v58, v59
    v_mfma_f32_16x16x32_bf16 v[72:75], a[40:43], v[32:35], v[72:75]
    v_mfma_f32_16x16x32_bf16 v[76:79], a[44:47], v[28:31], v[76:79]
    ds_read_b128 v[20:23], v12 offset:16384
    v_mfma_f32_16x16x32_bf16 v[80:83], a[44:47], v[32:35], v[80:83]
    ds_read_b128 v[24:27], v13 offset:16384
    s_waitcnt lgkmcnt(4)
    v_mfma_f32_16x16x32_bf16 v[68:71], a[48:51], v[36:39], v[68:71]
    v_cvt_pk_bf16_f32 v90, v64, v65
    v_cvt_pk_bf16_f32 v91, v66, v67
    v_mfma_f32_16x16x32_bf16 v[72:75], a[48:51], v[40:43], v[72:75]
    v_mfma_f32_16x16x32_bf16 v[76:79], a[52:55], v[36:39], v[76:79]
    ds_read_b128 v[28:31], v14 offset:16384
    v_mfma_f32_16x16x32_bf16 v[80:83], a[52:55], v[40:43], v[80:83]
    ds_read_b128 v[32:35], v15 offset:16384
    s_waitcnt lgkmcnt(4)
    v_mfma_f32_16x16x32_bf16 v[68:71], a[56:59], v[44:47], v[68:71]
    v_mfma_f32_16x16x32_bf16 v[72:75], a[56:59], v[48:51], v[72:75]
    v_mfma_f32_16x16x32_bf16 v[76:79], a[60:63], v[44:47], v[76:79]
    ds_read_b128 v[36:39], v12 offset:20480
    v_mfma_f32_16x16x32_bf16 v[80:83], a[60:63], v[48:51], v[80:83]
    ds_read_b128 v[40:43], v13 offset:20480
    s_waitcnt lgkmcnt(4)
    v_mfma_f32_16x16x32_bf16 v[68:71], a[64:67], v[20:23], v[68:71]
    v_mfma_f32_16x16x32_bf16 v[72:75], a[64:67], v[24:27], v[72:75]
    v_mfma_f32_16x16x32_bf16 v[76:79], a[68:71], v[20:23], v[76:79]
    ds_read_b128 v[44:47], v14 offset:20480
    v_mfma_f32_16x16x32_bf16 v[80:83], a[68:71], v[24:27], v[80:83]
    ds_read_b128 v[48:51], v15 offset:20480
    s_waitcnt lgkmcnt(4)
    v_mfma_f32_16x16x32_bf16 v[68:71], a[72:75], v[28:31], v[68:71]
    buffer_store_dwordx4 v[84:87], v16, s[32:35], s58 offen sc1
    v_mfma_f32_16x16x32_bf16 v[72:75], a[72:75], v[32:35], v[72:75]
    s_sub_u32 s89, s60, 1
    s_max_i32 s89, s89, 0
    v_mfma_f32_16x16x32_bf16 v[76:79], a[76:79], v[28:31], v[76:79]
    ds_read_b128 v[20:23], v12 offset:24576
    v_mfma_f32_16x16x32_bf16 v[80:83], a[76:79], v[32:35], v[80:83]
    ds_read_b128 v[24:27], v13 offset:24576
    s_waitcnt lgkmcnt(4)
    v_mfma_f32_16x16x32_bf16 v[68:71], a[80:83], v[36:39], v[68:71]
    buffer_store_dwordx4 v[88:91], v19, s[32:35], s58 offen sc1
    v_mfma_f32_16x16x32_bf16 v[72:75], a[80:83], v[40:43], v[72:75]
    s_mov_b32 s58, s66
    s_add_u32 s66, s66, s59
    v_mfma_f32_16x16x32_bf16 v[76:79], a[84:87], v[36:39], v[76:79]
    ds_read_b128 v[28:31], v14 offset:24576
    v_mov_b32 v18, s89
    v_mfma_f32_16x16x32_bf16 v[80:83], a[84:87], v[40:43], v[80:83]
    ds_read_b128 v[32:35], v15 offset:24576
    s_waitcnt lgkmcnt(4)
    v_mfma_f32_16x16x32_bf16 v[68:71], a[88:91], v[44:47], v[68:71]
    s_waitcnt vmcnt(10)
    s_barrier
    v_mfma_f32_16x16x32_bf16 v[72:75], a[88:91], v[48:51], v[72:75]
    s_add_u32 m0, s67, 32768
    s_add_u32 s57, s57, s84
    buffer_load_dwordx4 v95, s[48:51], s57 offen lds
    v_mfma_f32_16x16x32_bf16 v[76:79], a[92:95], v[44:47], v[76:79]
    ds_read_b128 v[36:39], v12 offset:28672
    v_mfma_f32_16x16x32_bf16 v[80:83], a[92:95], v[48:51], v[80:83]
    ds_read_b128 v[40:43], v13 offset:28672
    s_waitcnt lgkmcnt(4)
    v_mfma_f32_16x16x32_bf16 v[68:71], a[96:99], v[20:23], v[68:71]
    buffer_store_dword v18, v17, s[32:35], 0 offen sc1
    v_mfma_f32_16x16x32_bf16 v[72:75], a[96:99], v[24:27], v[72:75]
    s_add_u32 m0, s67, 36864
    s_add_u32 s57, s57, s55
    buffer_load_dwordx4 v95, s[48:51], s57 offen lds
    v_mfma_f32_16x16x32_bf16 v[76:79], a[100:103], v[20:23], v[76:79]
    ds_read_b128 v[44:47], v14 offset:28672
    v_mfma_f32_16x16x32_bf16 v[80:83], a[100:103], v[24:27], v[80:83]
    ds_read_b128 v[48:51], v15 offset:28672
    s_waitcnt lgkmcnt(4)
    v_mfma_f32_16x16x32_bf16 v[68:71], a[104:107], v[28:31], v[68:71]
    s_add_u32 m0, s67, 40960
    s_add_u32 s57, s57, s55
    v_mfma_f32_16x16x32_bf16 v[72:75], a[104:107], v[32:35], v[72:75]
    buffer_load_dwordx4 v95, s[48:51], s57 offen lds
    v_mfma_f32_16x16x32_bf16 v[76:79], a[108:111], v[28:31], v[76:79]
    ds_read_b128 v[20:23], v12 offset:32768
    v_mfma_f32_16x16x32_bf16 v[80:83], a[108:111], v[32:35], v[80:83]
    ds_read_b128 v[24:27], v13 offset:32768
    s_waitcnt lgkmcnt(4)
    v_mfma_f32_16x16x32_bf16 v[68:71], a[112:115], v[36:39], v[68:71]
    s_add_u32 m0, s67, 45056
    s_add_u32 s57, s57, s55
    v_mfma_f32_16x16x32_bf16 v[72:75], a[112:115], v[40:43], v[72:75]
    buffer_load_dwordx4 v95, s[48:51], s57 offen lds
    v_mfma_f32_16x16x32_bf16 v[76:79], a[116:119], v[36:39], v[76:79]
    ds_read_b128 v[28:31], v14 offset:32768
    v_mfma_f32_16x16x32_bf16 v[80:83], a[116:119], v[40:43], v[80:83]
    ds_read_b128 v[32:35], v15 offset:32768
    s_waitcnt lgkmcnt(4)
    v_mfma_f32_16x16x32_bf16 v[68:71], a[120:123], v[44:47], v[68:71]
    s_add_u32 m0, s67, 49152
    s_add_u32 s57, s57, s55
    v_mfma_f32_16x16x32_bf16 v[72:75], a[120:123], v[48:51], v[72:75]
    buffer_load_dwordx4 v95, s[48:51], s57 offen lds
    v_mfma_f32_16x16x32_bf16 v[76:79], a[124:127], v[44:47], v[76:79]
    ds_read_b128 v[36:39], v12 offset:36864
    v_mfma_f32_16x16x32_bf16 v[80:83], a[124:127], v[48:51], v[80:83]
    ds_read_b128 v[40:43], v13 offset:36864
    s_waitcnt lgkmcnt(4)
    v_mfma_f32_16x16x32_bf16 v[68:71], a[128:131], v[20:23], v[68:71]
    s_add_u32 m0, s67, 53248
    s_add_u32 s57, s57, s55
    v_mfma_f32_16x16x32_bf16 v[72:75], a[128:131], v[24:27], v[72:75]
    buffer_load_dwordx4 v95, s[48:51], s57 offen lds
    v_mfma_f32_16x16x32_bf16 v[76:79], a[132:135], v[20:23], v[76:79]
    ds_read_b128 v[44:47], v14 offset:36864
    v_mfma_f32_16x16x32_bf16 v[80:83], a[132:135], v[24:27], v[80:83]
    ds_read_b128 v[48:51], v15 offset:36864
    s_waitcnt lgkmcnt(4)
    v_mfma_f32_16x16x32_bf16 v[68:71], a[136:139], v[28:31], v[68:71]
    s_add_u32 m0, s67, 57344
    s_add_u32 s57, s57, s55
    v_mfma_f32_16x16x32_bf16 v[72:75], a[136:139], v[32:35], v[72:75]
    buffer_load_dwordx4 v95, s[48:51], s57 offen lds
    v_mfma_f32_16x16x32_bf16 v[76:79], a[140:143], v[28:31], v[76:79]
    ds_read_b128 v[20:23], v12 offset:40960
    v_mfma_f32_16x16x32_bf16 v[80:83], a[140:143], v[32:35], v[80:83]
    ds_read_b128 v[24:27], v13 offset:40960
    s_waitcnt lgkmcnt(4)
    v_mfma_f32_16x16x32_bf16 v[68:71], a[144:147], v[36:39], v[68:71]
    s_add_u32 m0, s67, 61440
    s_add_u32 s57, s57, s55
    v_mfma_f32_16x16x32_bf16 v[72:75], a[144:147], v[40:43], v[72:75]
    buffer_load_dwordx4 v95, s[48:51], s57 offen lds
    v_mfma_f32_16x16x32_bf16 v[76:79], a[148:151], v[36:39], v[76:79]
    ds_read_b128 v[28:31], v14 offset:40960
    v_mfma_f32_16x16x32_bf16 v[80:83], a[148:151], v[40:43], v[80:83]
    ds_read_b128 v[32:35], v15 offset:40960
    s_waitcnt lgkmcnt(4)
    v_mfma_f32_16x16x32_bf16 v[68:71], a[152:155], v[44:47], v[68:71]
    v_mfma_f32_16x16x32_bf16 v[72:75], a[152:155], v[48:51], v[72:75]
    v_mfma_f32_16x16x32_bf16 v[76:79], a[156:159], v[44:47], v[76:79]
    ds_read_b128 v[36:39], v12 offset:45056
    v_mfma_f32_16x16x32_bf16 v[80:83], a[156:159], v[48:51], v[80:83]
    ds_read_b128 v[40:43], v13 offset:45056
    s_waitcnt lgkmcnt(4)
    v_mfma_f32_16x16x32_bf16 v[68:71], a[160:163], v[20:23], v[68:71]
    v_mfma_f32_16x16x32_bf16 v[72:75], a[160:163], v[24:27], v[72:75]
    v_mfma_f32_16x16x32_bf16 v[76:79], a[164:167], v[20:23], v[76:79]
    ds_read_b128 v[44:47], v14 offset:45056
    v_mfma_f32_16x16x32_bf16 v[80:83], a[164:167], v[24:27], v[80:83]
    ds_read_b128 v[48:51], v15 offset:45056
    s_waitcnt lgkmcnt(4)
    v_mfma_f32_16x16x32_bf16 v[68:71], a[168:171], v[28:31], v[68:71]
    v_mfma_f32_16x16x32_bf16 v[72:75], a[168:171], v[32:35], v[72:75]
    v_mfma_f32_16x16x32_bf16 v[76:79], a[172:175], v[28:31], v[76:79]
    ds_read_b128 v[20:23], v12 offset:49152
    v_mfma_f32_16x16x32_bf16 v[80:83], a[172:175], v[32:35], v[80:83]
    ds_read_b128 v[24:27], v13 offset:49152
    s_waitcnt lgkmcnt(4)
    v_mfma_f32_16x16x32_bf16 v[68:71], a[176:179], v[36:39], v[68:71]
    v_mfma_f32_16x16x32_bf16 v[72:75], a[176:179], v[40:43], v[72:75]
    v_mfma_f32_16x16x32_bf16 v[76:79], a[180:183], v[36:39], v[76:79]
    ds_read_b128 v[28:31], v14 offset:49152
    v_mfma_f32_16x16x32_bf16 v[80:83], a[180:183], v[40:43], v[80:83]
    ds_read_b128 v[32:35], v15 offset:49152
    s_waitcnt lgkmcnt(4)
    v_mfma_f32_16x16x32_bf16 v[68:71], a[184:187], v[44:47], v[68:71]
    v_mfma_f32_16x16x32_bf16 v[72:75], a[184:187], v[48:51], v[72:75]
    v_mfma_f32_16x16x32_bf16 v[76:79], a[188:191], v[44:47], v[76:79]
    ds_read_b128 v[36:39], v12 offset:53248
    v_mfma_f32_16x16x32_bf16 v[80:83], a[188:191], v[48:51], v[80:83]
    ds_read_b128 v[40:43], v13 offset:53248
    s_waitcnt lgkmcnt(4)
    v_mfma_f32_16x16x32_bf16 v[68:71], a[192:195], v[20:23], v[68:71]
    v_mfma_f32_16x16x32_bf16 v[72:75], a[192:195], v[24:27], v[72:75]
    v_mfma_f32_16x16x32_bf16 v[76:79], a[196:199], v[20:23], v[76:79]
    ds_read_b128 v[44:47], v14 offset:53248
    v_mfma_f32_16x16x32_bf16 v[80:83], a[196:199], v[24:27], v[80:83]
    ds_read_b128 v[48:51], v15 offset:53248
    s_waitcnt lgkmcnt(4)
    v_mfma_f32_16x16x32_bf16 v[68:71], a[200:203], v[28:31], v[68:71]
    v_mfma_f32_16x16x32_bf16 v[72:75], a[200:203], v[32:35], v[72:75]
    v_mfma_f32_16x16x32_bf16 v[76:79], a[204:207], v[28:31], v[76:79]
    ds_read_b128 v[20:23], v12 offset:57344
    v_mfma_f32_16x16x32_bf16 v[80:83], a[204:207], v[32:35], v[80:83]
    ds_read_b128 v[24:27], v13 offset:57344
    s_waitcnt lgkmcnt(4)
    v_mfma_f32_16x16x32_bf16 v[68:71], a[208:211], v[36:39], v[68:71]
    v_mfma_f32_16x16x32_bf16 v[72:75], a[208:211], v[40:43], v[72:75]
    v_mfma_f32_16x16x32_bf16 v[76:79], a[212:215], v[36:39], v[76:79]
    ds_read_b128 v[28:31], v14 offset:57344
    v_mfma_f32_16x16x32_bf16 v[80:83], a[212:215], v[40:43], v[80:83]
    ds_read_b128 v[32:35], v15 offset:57344
    s_waitcnt lgkmcnt(4)
    v_mfma_f32_16x16x32_bf16 v[68:71], a[216:219], v[44:47], v[68:71]
    s_waitcnt vmcnt(11)
    s_barrier
    s_cmp_lg_u32 s60, 1
    s_cbranch_scc1 L_ws_nf_E1
    v_mov_b32 v18, 1
    s_waitcnt vmcnt(9)
    buffer_store_dword v18, v17, s[32:35], 0 offen sc1
L_ws_nf_E1:
    v_mfma_f32_16x16x32_bf16 v[72:75], a[216:219], v[48:51], v[72:75]
    s_add_u32 m0, s67, 65536
    s_add_u32 s57, s57, s85
    buffer_load_dwordx4 v95, s[48:51], s57 offen lds
    v_mfma_f32_16x16x32_bf16 v[76:79], a[220:223], v[44:47], v[76:79]
    ds_read_b128 v[36:39], v12 offset:61440
    v_mfma_f32_16x16x32_bf16 v[80:83], a[220:223], v[48:51], v[80:83]
    ds_read_b128 v[40:43], v13 offset:61440
    s_waitcnt lgkmcnt(4)
    v_mfma_f32_16x16x32_bf16 v[68:71], a[224:227], v[20:23], v[68:71]
    s_add_u32 m0, s67, 69632
    s_add_u32 s57, s57, s55
    v_mfma_f32_16x16x32_bf16 v[72:75], a[224:227], v[24:27], v[72:75]
    buffer_load_dwordx4 v95, s[48:51], s57 offen lds
    v_mfma_f32_16x16x32_bf16 v[76:79], a[228:231], v[20:23], v[76:79]
    ds_read_b128 v[44:47], v14 offset:61440
    v_mfma_f32_16x16x32_bf16 v[80:83], a[228:231], v[24:27], v[80:83]
    ds_read_b128 v[48:51], v15 offset:61440
    s_waitcnt lgkmcnt(4)
    v_mfma_f32_16x16x32_bf16 v[68:71], a[232:235], v[28:31], v[68:71]
    s_add_u32 m0, s67, 73728
    s_add_u32 s57, s57, s55
    v_mfma_f32_16x16x32_bf16 v[72:75], a[232:235], v[32:35], v[72:75]
    buffer_load_dwordx4 v95, s[48:51], s57 offen lds
    v_mfma_f32_16x16x32_bf16 v[76:79], a[236:239], v[28:31], v[76:79]
    ds_read_b128 v[20:23], v8 offset:0
    v_mfma_f32_16x16x32_bf16 v[80:83], a[236:239], v[32:35], v[80:83]
    ds_read_b128 v[24:27], v9 offset:0
    s_waitcnt lgkmcnt(4)
    v_mfma_f32_16x16x32_bf16 v[68:71], a[240:243], v[36:39], v[68:71]
    s_add_u32 s60, s60, 1
    s_add_u32 m0, s67, 77824
    v_mfma_f32_16x16x32_bf16 v[72:75], a[240:243], v[40:43], v[72:75]
    s_add_u32 s57, s57, s55
    buffer_load_dwordx4 v95, s[48:51], s57 offen lds
    v_mfma_f32_16x16x32_bf16 v[76:79], a[244:247], v[36:39], v[76:79]
    ds_read_b128 v[28:31], v10 offset:0
    v_mfma_f32_16x16x32_bf16 v[80:83], a[244:247], v[40:43], v[80:83]
    ds_read_b128 v[32:35], v11 offset:0
    s_waitcnt lgkmcnt(4)
    v_mfma_f32_16x16x32_bf16 v[68:71], a[248:251], v[44:47], v[68:71]
    s_add_u32 m0, s67, 81920
    s_add_u32 s57, s57, s55
    v_mfma_f32_16x16x32_bf16 v[72:75], a[248:251], v[48:51], v[72:75]
    buffer_load_dwordx4 v95, s[48:51], s57 offen lds
    v_mfma_f32_16x16x32_bf16 v[76:79], a[252:255], v[44:47], v[76:79]
    ds_read_b128 v[36:39], v8 offset:4096
    v_mfma_f32_16x16x32_bf16 v[80:83], a[252:255], v[48:51], v[80:83]
    ds_read_b128 v[40:43], v9 offset:4096
    s_cmp_lt_u32 s60, s61
    s_cbranch_scc1 L_ws_E1
    v_cvt_pk_bf16_f32 v84, v68, v69
    v_cvt_pk_bf16_f32 v85, v70, v71
    s_nop 0
    v_cvt_pk_bf16_f32 v86, v76, v77
    v_cvt_pk_bf16_f32 v87, v78, v79
    v_cvt_pk_bf16_f32 v88, v72, v73
    v_cvt_pk_bf16_f32 v89, v74, v75
    v_cvt_pk_bf16_f32 v90, v80, v81
    v_cvt_pk_bf16_f32 v91, v82, v83
    buffer_store_dwordx4 v[84:87], v16, s[32:35], s58 offen sc1
    buffer_store_dwordx4 v[88:91], v19, s[32:35], s58 offen sc1
    s_waitcnt vmcnt(0) lgkmcnt(0)
    v_mov_b32 v18, s60
    buffer_store_dword v18, v94, s[32:35], 0 offen sc1
    s_barrier
    s_branch L_p1done
L_gE2:
    s_mov_b32 s58, 0x7fff0000
    s_mov_b32 s60, 0
    s_waitcnt vmcnt(13)
    s_barrier
    ds_read_b128 v[20:23], v8 offset:0
    ds_read_b128 v[24:27], v9 offset:0
    ds_read_b128 v[28:31], v10 offset:0
    ds_read_b128 v[32:35], v11 offset:0
    ds_read_b128 v[36:39], v8 offset:4096
    ds_read_b128 v[40:43], v9 offset:4096
L_ws_E2:
    s_waitcnt lgkmcnt(4)
    v_mfma_f32_16x16x32_bf16 v[52:55], v[20:23], a[0:3], 0
    s_add_u32 m0, s67, 86016
    s_add_u32 s57, s57, s55
    v_mfma_f32_16x16x32_bf16 v[56:59], v[24:27], a[0:3], 0
    buffer_load_dwordx4 v95, s[48:51], s57 offen lds
    v_mfma_f32_16x16x32_bf16 v[60:63], v[20:23], a[4:7], 0
    ds_read_b128 v[44:47], v10 offset:4096
    v_mfma_f32_16x16x32_bf16 v[64:67], v[24:27], a[4:7], 0
    ds_read_b128 v[48:51], v11 offset:4096
    s_waitcnt lgkmcnt(4)
    v_mfma_f32_16x16x32_bf16 v[52:55], v[28:31], a[8:11], v[52:55]
    s_add_u32 m0, s67, 90112
    s_add_u32 s57, s57, s55
    v_mfma_f32_16x16x32_bf16 v[56:59], v[32:35], a[8:11], v[56:59]
    buffer_load_dwordx4 v95, s[48:51], s57 offen lds
    v_mfma_f32_16x16x32_bf16 v[60:63], v[28:31], a[12:15], v[60:63]
    ds_read_b128 v[20:23], v8 offset:8192
    v_mfma_f32_16x16x32_bf16 v[64:67], v[32:35], a[12:15], v[64:67]
    ds_read_b128 v[24:27], v9 offset:8192
    s_waitcnt lgkmcnt(4)
    v_mfma_f32_16x16x32_bf16 v[52:55], v[36:39], a[16:19], v[52:55]
    s_add_u32 m0, s67, 94208
    s_add_u32 s57, s57, s55
    v_mfma_f32_16x16x32_bf16 v[56:59], v[40:43], a[16:19], v[56:59]
    buffer_load_dwordx4 v95, s[48:51], s57 offen lds
    v_mfma_f32_16x16x32_bf16 v[60:63], v[36:39], a[20:23], v[60:63]
    ds_read_b128 v[28:31], v10 offset:8192
    v_mfma_f32_16x16x32_bf16 v[64:67], v[40:43], a[20:23], v[64:67]
    ds_read_b128 v[32:35], v11 offset:8192
    s_waitcnt lgkmcnt(4)
    v_mfma_f32_16x16x32_bf16 v[52:55], v[44:47], a[24:27], v[52:55]
    v_cvt_pk_bf16_f32 v84, v68, v69
    v_cvt_pk_bf16_f32 v85, v70, v71
    v_mfma_f32_16x16x32_bf16 v[56:59], v[48:51], a[24:27], v[56:59]
    v_mfma_f32_16x16x32_bf16 v[60:63], v[44:47], a[28:31], v[60:63]
    ds_read_b128 v[36:39], v8 offset:12288
    v_mfma_f32_16x16x32_bf16 v[64:67], v[48:51], a[28:31], v[64:67]
    ds_read_b128 v[40:43], v9 offset:12288
    s_waitcnt lgkmcnt(4)
    v_mfma_f32_16x16x32_bf16 v[52:55], v[20:23], a[32:35], v[52:55]
    v_cvt_pk_bf16_f32 v86, v72, v73
    v_cvt_pk_bf16_f32 v87, v74, v75
    v_mfma_f32_16x16x32_bf16 v[56:59], v[24:27], a[32:35], v[56:59]
    v_mfma_f32_16x16x32_bf16 v[60:63], v[20:23], a[36:39], v[60:63]
    ds_read_b128 v[44:47], v10 offset:12288
    v_mfma_f32_16x16x32_bf16 v[64:67], v[24:27], a[36:39], v[64:67]
    ds_read_b128 v[48:51], v11 offset:12288
    s_waitcnt lgkmcnt(4)
    v_mfma_f32_16x16x32_bf16 v[52:55], v[28:31], a[40:43], v[52:55]
    v_cvt_pk_bf16_f32 v88, v76, v77
    v_cvt_pk_bf16_f32 v89, v78, v79
    v_mfma_f32_16x16x32_bf16 v[56:59], v[32:35], a[40:43], v[56:59]
    v_mfma_f32_16x16x32_bf16 v[60:63], v[28:31], a[44:47], v[60:63]
    ds_read_b128 v[20:23], v8 offset:16384
    v_mfma_f32_16x16x32_bf16 v[64:67], v[32:35], a[44:47], v[64:67]
    ds_read_b128 v[24:27], v9 offset:16384
    s_waitcnt lgkmcnt(4)
    v_mfma_f32_16x16x32_bf16 v[52:55], v[36:39], a[48:51], v[52:55]
    v_cvt_pk_bf16_f32 v90, v80, v81
    v_cvt_pk_bf16_f32 v91, v82, v83
    v_mfma_f32_16x16x32_bf16 v[56:59], v[40:43], a[48:51], v[56:59]
    v_mfma_f32_16x16x32_bf16 v[60:63], v[36:39], a[52:55], v[60:63]
    ds_read_b128 v[28:31], v10 offset:16384
    v_mfma_f32_16x16x32_bf16 v[64:67], v[40:43], a[52:55], v[64:67]
    ds_read_b128 v[32:35], v11 offset:16384
    s_waitcnt lgkmcnt(4)
    v_mfma_f32_16x16x32_bf16 v[52:55], v[44:47], a[56:59], v[52:55]
    v_mfma_f32_16x16x32_bf16 v[56:59], v[48:51], a[56:59], v[56:59]
    v_mfma_f32_16x16x32_bf16 v[60:63], v[44:47], a[60:63], v[60:63]
    ds_read_b128 v[36:39], v8 offset:20480
    v_mfma_f32_16x16x32_bf16 v[64:67], v[48:51], a[60:63], v[64:67]
    ds_read_b128 v[40:43], v9 offset:20480
    s_waitcnt lgkmcnt(4)
    v_mfma_f32_16x16x32_bf16 v[52:55], v[20:23], a[64:67], v[52:55]
    v_mfma_f32_16x16x32_bf16 v[56:59], v[24:27], a[64:67], v[56:59]
    v_mfma_f32_16x16x32_bf16 v[60:63], v[20:23], a[68:71], v[60:63]
    ds_read_b128 v[44:47], v10 offset:20480
    v_mfma_f32_16x16x32_bf16 v[64:67], v[24:27], a[68:71], v[64:67]
    ds_read_b128 v[48:51], v11 offset:20480
    s_waitcnt lgkmcnt(4)
    v_mfma_f32_16x16x32_bf16 v[52:55], v[28:31], a[72:75], v[52:55]
    buffer_store_dwordx4 v[84:87], v16, s[32:35], s58 offen sc1
    v_mfma_f32_16x16x32_bf16 v[56:59], v[32:35], a[72:75], v[56:59]
    s_sub_u32 s89, s60, 1
    s_max_i32 s89, s89, 0
    v_mfma_f32_16x16x32_bf16 v[60:63], v[28:31], a[76:79], v[60:63]
    ds_read_b128 v[20:23], v8 offset:24576
    v_mfma_f32_16x16x32_bf16 v[64:67], v[32:35], a[76:79], v[64:67]
    ds_read_b128 v[24:27], v9 offset:24576
    s_waitcnt lgkmcnt(4)
    v_mfma_f32_16x16x32_bf16 v[52:55], v[36:39], a[80:83], v[52:55]
    buffer_store_dwordx4 v[88:91], v19, s[32:35], s58 offen sc1
    v_mfma_f32_16x16x32_bf16 v[56:59], v[40:43], a[80:83], v[56:59]
    s_mov_b32 s58, s66
    s_add_u32 s66, s66, s59
    v_mfma_f32_16x16x32_bf16 v[60:63], v[36:39], a[84:87], v[60:63]
    ds_read_b128 v[28:31], v10 offset:24576
    v_mov_b32 v18, s89
    v_mfma_f32_16x16x32_bf16 v[64:67], v[40:43], a[84:87], v[64:67]
    ds_read_b128 v[32:35], v11 offset:24576
    s_waitcnt lgkmcnt(4)
    v_mfma_f32_16x16x32_bf16 v[52:55], v[44:47], a[88:91], v[52:55]
    s_waitcnt vmcnt(10)
    s_barrier
    v_mfma_f32_16x16x32_bf16 v[56:59], v[48:51], a[88:91], v[56:59]
    s_add_u32 m0, s67, 98304
    s_add_u32 s57, s57, s84
    buffer_load_dwordx4 v95, s[48:51], s57 offen lds
    v_mfma_f32_16x16x32_bf16 v[60:63], v[44:47], a[92:95], v[60:63]
    ds_read_b128 v[36:39], v8 offset:28672
    v_mfma_f32_16x16x32_bf16 v[64:67], v[48:51], a[92:95], v[64:67]
    ds_read_b128 v[40:43], v9 offset:28672
    s_waitcnt lgkmcnt(4)
    v_mfma_f32_16x16x32_bf16 v[52:55], v[20:23], a[96:99], v[52:55]
    buffer_store_dword v18, v17, s[32:35], 0 offen sc1
    v_mfma_f32_16x16x32_bf16 v[56:59], v[24:27], a[96:99], v[56:59]
    s_add_u32 m0, s67, 102400
    s_add_u32 s57, s57, s55
    buffer_load_dwordx4 v95, s[48:51], s57 offen lds
    v_mfma_f32_16x16x32_bf16 v[60:63], v[20:23], a[100:103], v[60:63]
    ds_read_b128 v[44:47], v10 offset:28672
    v_mfma_f32_16x16x32_bf16 v[64:67], v[24:27], a[100:103], v[64:67]
    ds_read_b128 v[48:51], v11 offset:28672
    s_waitcnt lgkmcnt(4)
    v_mfma_f32_16x16x32_bf16 v[52:55], v[28:31], a[104:107], v[52:55]
    s_add_u32 m0, s67, 106496
    s_add_u32 s57, s57, s55
    v_mfma_f32_16x16x32_bf16 v[56:59], v[32:35], a[104:107], v[56:59]
    buffer_load_dwordx4 v95, s[48:51], s57 offen lds
    v_mfma_f32_16x16x32_bf16 v[60:63], v[28:31], a[108:111], v[60:63]
    ds_read_b128 v[20:23], v8 offset:32768
    v_mfma_f32_16x16x32_bf16 v[64:67], v[32:35], a[108:111], v[64:67]
    ds_read_b128 v[24:27], v9 offset:32768
    s_waitcnt lgkmcnt(4)
    v_mfma_f32_16x16x32_bf16 v[52:55], v[36:39], a[112:115], v[52:55]
    s_add_u32 m0, s67, 110592
    s_add_u32 s57, s57, s55
    v_mfma_f32_16x16x32_bf16 v[56:59], v[40:43], a[112:115], v[56:59]
    buffer_load_dwordx4 v95, s[48:51], s57 offen lds
    v_mfma_f32_16x16x32_bf16 v[60:63], v[36:39], a[116:119], v[60:63]
    ds_read_b128 v[28:31], v10 offset:32768
    v_mfma_f32_16x16x32_bf16 v[64:67], v[40:43], a[116:119], v[64:67]
    ds_read_b128 v[32:35], v11 offset:32768
    s_waitcnt lgkmcnt(4)
    v_mfma_f32_16x16x32_bf16 v[52:55], v[44:47], a[120:123], v[52:55]
    s_add_u32 m0, s67, 114688
    s_add_u32 s57, s57, s55
    v_mfma_f32_16x16x32_bf16 v[56:59], v[48:51], a[120:123], v[56:59]
    buffer_load_dwordx4 v95, s[48:51], s57 offen lds
    v_mfma_f32_16x16x32_bf16 v[60:63], v[44:47], a[124:127], v[60:63]
    ds_read_b128 v[36:39], v8 offset:36864
    v_mfma_f32_16x16x32_bf16 v[64:67], v[48:51], a[124:127], v[64:67]
    ds_read_b128 v[40:43], v9 offset:36864
    s_waitcnt lgkmcnt(4)
    v_mfma_f32_16x16x32_bf16 v[52:55], v[20:23], a[128:131], v[52:55]
    s_add_u32 m0, s67, 118784
    s_add_u32 s57, s57, s55
    v_mfma_f32_16x16x32_bf16 v[56:59], v[24:27], a[128:131], v[56:59]
    buffer_load_dwordx4 v95, s[48:51], s57 offen lds
    v_mfma_f32_16x16x32_bf16 v[60:63], v[20:23], a[132:135], v[60:63]
    ds_read_b128 v[44:47], v10 offset:36864
    v_mfma_f32_16x16x32_bf16 v[64:67], v[24:27], a[132:135], v[64:67]
    ds_read_b128 v[48:51], v11 offset:36864
    s_waitcnt lgkmcnt(4)
    v_mfma_f32_16x16x32_bf16 v[52:55], v[28:31], a[136:139], v[52:55]
    s_add_u32 m0, s67, 122880
    s_add_u32 s57, s57, s55
    v_mfma_f32_16x16x32_bf16 v[56:59], v[32:35], a[136:139], v[56:59]
    buffer_load_dwordx4 v95, s[48:51], s57 offen lds
    v_mfma_f32_16x16x32_bf16 v[60:63], v[28:31], a[140:143], v[60:63]
    ds_read_b128 v[20:23], v8 offset:40960
    v_mfma_f32_16x16x32_bf16 v[64:67], v[32:35], a[140:143], v[64:67]
    ds_read_b128 v[24:27], v9 offset:40960
    s_waitcnt lgkmcnt(4)
    v_mfma_f32_16x16x32_bf16 v[52:55], v[36:39], a[144:147], v[52:55]
    s_add_u32 m0, s67, 126976
    s_add_u32 s57, s57, s55
    v_mfma_f32_16x16x32_bf16 v[56:59], v[40:43], a[144:147], v[56:59]
    buffer_load_dwordx4 v95, s[48:51], s57 offen lds
    v_mfma_f32_16x16x32_bf16 v[60:63], v[36:39], a[148:151], v[60:63]
    ds_read_b128 v[28:31], v10 offset:40960
    v_mfma_f32_16x16x32_bf16 v[64:67], v[40:43], a[148:151], v[64:67]
    ds_read_b128 v[32:35], v11 offset:40960
    s_waitcnt lgkmcnt(4)
    v_mfma_f32_16x16x32_bf16 v[52:55], v[44:47], a[152:155], v[52:55]
    v_mfma_f32_16x16x32_bf16 v[56:59], v[48:51], a[152:155], v[56:59]
    v_mfma_f32_16x16x32_bf16 v[60:63], v[44:47], a[156:159], v[60:63]
    ds_read_b128 v[36:39], v8 offset:45056
    v_mfma_f32_16x16x32_bf16 v[64:67], v[48:51], a[156:159], v[64:67]
    ds_read_b128 v[40:43], v9 offset:45056
    s_waitcnt lgkmcnt(4)
    v_mfma_f32_16x16x32_bf16 v[52:55], v[20:23], a[160:163], v[52:55]
    v_mfma_f32_16x16x32_bf16 v[56:59], v[24:27], a[160:163], v[56:59]
    v_mfma_f32_16x16x32_bf16 v[60:63], v[20:23], a[164:167], v[60:63]
    ds_read_b128 v[44:47], v10 offset:45056
    v_mfma_f32_16x16x32_bf16 v[64:67], v[24:27], a[164:167], v[64:67]
    ds_read_b128 v[48:51], v11 offset:45056
    s_waitcnt lgkmcnt(4)
    v_mfma_f32_16x16x32_bf16 v[52:55], v[28:31], a[168:171], v[52:55]
    v_mfma_f32_16x16x32_bf16 v[56:59], v[32:35], a[168:171], v[56:59]
    v_mfma_f32_16x16x32_bf16 v[60:63], v[28:31], a[172:175], v[60:63]
    ds_read_b128 v[20:23], v8 offset:49152
    v_mfma_f32_16x16x32_bf16 v[64:67], v[32:35], a[172:175], v[64:67]
    ds_read_b128 v[24:27], v9 offset:49152
    s_waitcnt lgkmcnt(4)
    v_mfma_f32_16x16x32_bf16 v[52:55], v[36:39], a[176:179], v[52:55]
    v_mfma_f32_16x16x32_bf16 v[56:59], v[40:43], a[176:179], v[56:59]
    v_mfma_f32_16x16x32_bf16 v[60:63], v[36:39], a[180:183], v[60:63]
    ds_read_b128 v[28:31], v10 offset:49152
    v_mfma_f32_16x16x32_bf16 v[64:67], v[40:43], a[180:183], v[64:67]
    ds_read_b128 v[32:35], v11 offset:49152
    s_waitcnt lgkmcnt(4)
    v_mfma_f32_16x16x32_bf16 v[52:55], v[44:47], a[184:187], v[52:55]
    v_mfma_f32_16x16x32_bf16 v[56:59], v[48:51], a[184:187], v[56:59]
    v_mfma_f32_16x16x32_bf16 v[60:63], v[44:47], a[188:191], v[60:63]
    ds_read_b128 v[36:39], v8 offset:53248
    v_mfma_f32_16x16x32_bf16 v[64:67], v[48:51], a[188:191], v[64:67]
    ds_read_b128 v[40:43], v9 offset:53248
    s_waitcnt lgkmcnt(4)
    v_mfma_f32_16x16x32_bf16 v[52:55], v[20:23], a[192:195], v[52:55]
    v_mfma_f32_16x16x32_bf16 v[56:59], v[24:27], a[192:195], v[56:59]
    v_mfma_f32_16x16x32_bf16 v[60:63], v[20:23], a[196:199], v[60:63]
    ds_read_b128 v[44:47], v10 offset:53248
    v_mfma_f32_16x16x32_bf16 v[64:67], v[24:27], a[196:199], v[64:67]
    ds_read_b128 v[48:51], v11 offset:53248
    s_waitcnt lgkmcnt(4)
    v_mfma_f32_16x16x32_bf16 v[52:55], v[28:31], a[200:203], v[52:55]
    v_mfma_f32_16x16x32_bf16 v[56:59], v[32:35], a[200:203], v[56:59]
    v_mfma_f32_16x16x32_bf16 v[60:63], v[28:31], a[204:207], v[60:63]
    ds_read_b128 v[20:23], v8 offset:57344
    v_mfma_f32_16x16x32_bf16 v[64:67], v[32:35], a[204:207], v[64:67]
    ds_read_b128 v[24:27], v9 offset:57344
    s_waitcnt lgkmcnt(4)
    v_mfma_f32_16x16x32_bf16 v[52:55], v[36:39], a[208:211], v[52:55]
    v_mfma_f32_16x16x32_bf16 v[56:59], v[40:43], a[208:211], v[56:59]
    v_mfma_f32_16x16x32_bf16 v[60:63], v[36:39], a[212:215], v[60:63]
    ds_read_b128 v[28:31], v10 offset:57344
    v_mfma_f32_16x16x32_bf16 v[64:67], v[40:43], a[212:215], v[64:67]
    ds_read_b128 v[32:35], v11 offset:57344
    s_waitcnt lgkmcnt(4)
    v_mfma_f32_16x16x32_bf16 v[52:55], v[44:47], a[216:219], v[52:55]
    s_waitcnt vmcnt(11)
    s_barrier
    v_mfma_f32_16x16x32_bf16 v[56:59], v[48:51], a[216:219], v[56:59]
    s_add_u32 m0, s67, 0
    s_add_u32 s57, s57, s85
    buffer_load_dwordx4 v95, s[48:51], s57 offen lds
    v_mfma_f32_16x16x32_bf16 v[60:63], v[44:47], a[220:223], v[60:63]
    ds_read_b128 v[36:39], v8 offset:61440
    v_mfma_f32_16x16x32_bf16 v[64:67], v[48:51], a[220:223], v[64:67]
    ds_read_b128 v[40:43], v9 offset:61440
    s_waitcnt lgkmcnt(4)
    v_mfma_f32_16x16x32_bf16 v[52:55], v[20:23], a[224:227], v[52:55]
    s_add_u32 m0, s67, 4096
    s_add_u32 s57, s57, s55
    v_mfma_f32_16x16x32_bf16 v[56:59], v[24:27], a[224:227], v[56:59]
    buffer_load_dwordx4 v95, s[48:51], s57 offen lds
    v_mfma_f32_16x16x32_bf16 v[60:63], v[20:23], a[228:231], v[60:63]
    ds_read_b128 v[44:47], v10 offset:61440
    v_mfma_f32_16x16x32_bf16 v[64:67], v[24:27], a[228:231], v[64:67]
    ds_read_b128 v[48:51], v11 offset:61440
    s_waitcnt lgkmcnt(4)
    v_mfma_f32_16x16x32_bf16 v[52:55], v[28:31], a[232:235], v[52:55]
    s_add_u32 m0, s67, 8192
    s_add_u32 s57, s57, s55
    v_mfma_f32_16x16x32_bf16 v[56:59], v[32:35], a[232:235], v[56:59]
    buffer_load_dwordx4 v95, s[48:51], s57 offen lds
    v_mfma_f32_16x16x32_bf16 v[60:63], v[28:31], a[236:239], v[60:63]
    ds_read_b128 v[20:23], v12 offset:0
    v_mfma_f32_16x16x32_bf16 v[64:67], v[32:35], a[236:239], v[64:67]
    ds_read_b128 v[24:27], v13 offset:0
    s_waitcnt lgkmcnt(4)
    v_mfma_f32_16x16x32_bf16 v[52:55], v[36:39], a[240:243], v[52:55]
    s_add_u32 s60, s60, 1
    s_add_u32 m0, s67, 12288
    v_mfma_f32_16x16x32_bf16 v[56:59], v[40:43], a[240:243], v[56:59]
    s_add_u32 s57, s57, s55
    buffer_load_dwordx4 v95, s[48:51], s57 offen lds
    v_mfma_f32_16x16x32_bf16 v[60:63], v[36:39], a[244:247], v[60:63]
    ds_read_b128 v[28:31], v14 offset:0
    v_mfma_f32_16x16x32_bf16 v[64:67], v[40:43], a[244:247], v[64:67]
    ds_read_b128 v[32:35], v15 offset:0
    s_waitcnt lgkmcnt(4)
    v_mfma_f32_16x16x32_bf16 v[52:55], v[44:47], a[248:251], v[52:55]
    s_add_u32 m0, s67, 16384
    s_add_u32 s57, s57, s55
    v_mfma_f32_16x16x32_bf16 v[56:59], v[48:51], a[248:251], v[56:59]
    buffer_load_dwordx4 v95, s[48:51], s57 offen lds
    v_mfma_f32_16x16x32_bf16 v[60:63], v[44:47], a[252:255], v[60:63]
    ds_read_b128 v[36:39], v12 offset:4096
    v_mfma_f32_16x16x32_bf16 v[64:67], v[48:51], a[252:255], v[64:67]
    ds_read_b128 v[40:43], v13 offset:4096
    s_waitcnt lgkmcnt(4)
    v_mfma_f32_16x16x32_bf16 v[68:71], v[20:23], a[0:3], 0
    s_add_u32 m0, s67, 20480
    s_add_u32 s57, s57, s55
    v_mfma_f32_16x16x32_bf16 v[72:75], v[24:27], a[0:3], 0
    buffer_load_dwordx4 v95, s[48:51], s57 offen lds
    v_mfma_f32_16x16x32_bf16 v[76:79], v[20:23], a[4:7], 0
    ds_read_b128 v[44:47], v14 offset:4096
    v_mfma_f32_16x16x32_bf16 v[80:83], v[24:27], a[4:7], 0
    ds_read_b128 v[48:51], v15 offset:4096
    s_waitcnt lgkmcnt(4)
    v_mfma_f32_16x16x32_bf16 v[68:71], v[28:31], a[8:11], v[68:71]
    s_add_u32 m0, s67, 24576
    s_add_u32 s57, s57, s55
    v_mfma_f32_16x16x32_bf16 v[72:75], v[32:35], a[8:11], v[72:75]
    buffer_load_dwordx4 v95, s[48:51], s57 offen lds
    v_mfma_f32_16x16x32_bf16 v[76:79], v[28:31], a[12:15], v[76:79]
    ds_read_b128 v[20:23], v12 offset:8192
    v_mfma_f32_16x16x32_bf16 v[80:83], v[32:35], a[12:15], v[80:83]
    ds_read_b128 v[24:27], v13 offset:8192
    s_waitcnt lgkmcnt(4)
    v_mfma_f32_16x16x32_bf16 v[68:71], v[36:39], a[16:19], v[68:71]
    s_add_u32 m0, s67, 28672
    s_add_u32 s57, s57, s55
    v_mfma_f32_16x16x32_bf16 v[72:75], v[40:43], a[16:19], v[72:75]
    buffer_load_dwordx4 v95, s[48:51], s57 offen lds
    v_mfma_f32_16x16x32_bf16 v[76:79], v[36:39], a[20:23], v[76:79]
    ds_read_b128 v[28:31], v14 offset:8192
    v_mfma_f32_16x16x32_bf16 v[80:83], v[40:43], a[20:23], v[80:83]
    ds_read_b128 v[32:35], v15 offset:8192
    s_waitcnt lgkmcnt(4)
    v_mfma_f32_16x16x32_bf16 v[68:71], v[44:47], a[24:27], v[68:71]
    v_cvt_pk_bf16_f32 v84, v52, v53
    v_cvt_pk_bf16_f32 v85, v54, v55
    v_mfma_f32_16x16x32_bf16 v[72:75], v[48:51], a[24:27], v[72:75]
    v_mfma_f32_16x16x32_bf16 v[76:79], v[44:47], a[28:31], v[76:79]
    ds_read_b128 v[36:39], v12 offset:12288
    v_mfma_f32_16x16x32_bf16 v[80:83], v[48:51], a[28:31], v[80:83]
    ds_read_b128 v[40:43], v13 offset:12288
    s_waitcnt lgkmcnt(4)
    v_mfma_f32_16x16x32_bf16 v[68:71], v[20:23], a[32:35], v[68:71]
    v_cvt_pk_bf16_f32 v86, v56, v57
    v_cvt_pk_bf16_f32 v87, v58, v59
    v_mfma_f32_16x16x32_bf16 v[72:75], v[24:27], a[32:35], v[72:75]
    v_mfma_f32_16x16x32_bf16 v[76:79], v[20:23], a[36:39], v[76:79]
    ds_read_b128 v[44:47], v14 offset:12288
    v_mfma_f32_16x16x32_bf16 v[80:83], v[24:27], a[36:39], v[80:83]
    ds_read_b128 v[48:51], v15 offset:12288
    s_waitcnt lgkmcnt(4)
    v_mfma_f32_16x16x32_bf16 v[68:71], v[28:31], a[40:43], v[68:71]
    v_cvt_pk_bf16_f32 v88, v60, v61
    v_cvt_pk_bf16_f32 v89, v62, v63
    v_mfma_f32_16x16x32_bf16 v[72:75], v[32:35], a[40:43], v[72:75]
    v_mfma_f32_16x16x32_bf16 v[76:79], v[28:31], a[44:47], v[76:79]
    ds_read_b128 v[20:23], v12 offset:16384
    v_mfma_f32_16x16x32_bf16 v[80:83], v[32:35], a[44:47], v[80:83]
    ds_read_b128 v[24:27], v13 offset:16384
    s_waitcnt lgkmcnt(4)
    v_mfma_f32_16x16x32_bf16 v[68:71], v[36:39], a[48:51], v[68:71]
    v_cvt_pk_bf16_f32 v90, v64, v65
    v_cvt_pk_bf16_f32 v91, v66, v67
    v_mfma_f32_16x16x32_bf16 v[72:75], v[40:43], a[48:51], v[72:75]
    v_mfma_f32_16x16x32_bf16 v[76:79], v[36:39], a[52:55], v[76:79]
    ds_read_b128 v[28:31], v14 offset:16384
    v_mfma_f32_16x16x32_bf16 v[80:83], v[40:43], a[52:55], v[80:83]
    ds_read_b128 v[32:35], v15 offset:16384
    s_waitcnt lgkmcnt(4)
    v_mfma_f32_16x16x32_bf16 v[68:71], v[44:47], a[56:59], v[68:71]
    v_mfma_f32_16x16x32_bf16 v[72:75], v[48:51], a[56:59], v[72:75]
    v_mfma_f32_16x16x32_bf16 v[76:79], v[44:47], a[60:63], v[76:79]
    ds_read_b128 v[36:39], v12 offset:20480
    v_mfma_f32_16x16x32_bf16 v[80:83], v[48:51], a[60:63], v[80:83]
    ds_read_b128 v[40:43], v13 offset:20480
    s_waitcnt lgkmcnt(4)
    v_mfma_f32_16x16x32_bf16 v[68:71], v[20:23], a[64:67], v[68:71]
    v_mfma_f32_16x16x32_bf16 v[72:75], v[24:27], a[64:67], v[72:75]
    v_mfma_f32_16x16x32_bf16 v[76:79], v[20:23], a[68:71], v[76:79]
    ds_read_b128 v[44:47], v14 offset:20480
    v_mfma_f32_16x16x32_bf16 v[80:83], v[24:27], a[68:71], v[80:83]
    ds_read_b128 v[48:51], v15 offset:20480
    s_waitcnt lgkmcnt(4)
    v_mfma_f32_16x16x32_bf16 v[68:71], v[28:31], a[72:75], v[68:71]
    buffer_store_dwordx4 v[84:87], v16, s[32:35], s58 offen sc1
    v_mfma_f32_16x16x32_bf16 v[72:75], v[32:35], a[72:75], v[72:75]
    s_sub_u32 s89, s60, 1
    s_max_i32 s89, s89, 0
    v_mfma_f32_16x16x32_bf16 v[76:79], v[28:31], a[76:79], v[76:79]
    ds_read_b128 v[20:23], v12 offset:24576
    v_mfma_f32_16x16x32_bf16 v[80:83], v[32:35], a[76:79], v[80:83]
    ds_read_b128 v[24:27], v13 offset:24576
    s_waitcnt lgkmcnt(4)
    v_mfma_f32_16x16x32_bf16 v[68:71], v[36:39], a[80:83], v[68:71]
    buffer_store_dwordx4 v[88:91], v19, s[32:35], s58 offen sc1
    v_mfma_f32_16x16x32_bf16 v[72:75], v[40:43], a[80:83], v[72:75]
    s_mov_b32 s58, s66
    s_add_u32 s66, s66, s59
    v_mfma_f32_16x16x32_bf16 v[76:79], v[36:39], a[84:87], v[76:79]
    ds_read_b128 v[28:31], v14 offset:24576
    v_mov_b32 v18, s89
    v_mfma_f32_16x16x32_bf16 v[80:83], v[40:43], a[84:87], v[80:83]
    ds_read_b128 v[32:35], v15 offset:24576
    s_waitcnt lgkmcnt(4)
    v_mfma_f32_16x16x32_bf16 v[68:71], v[44:47], a[88:91], v[68:71]
    s_waitcnt vmcnt(10)
    s_barrier
    v_mfma_f32_16x16x32_bf16 v[72:75], v[48:51], a[88:91], v[72:75]
    s_add_u32 m0, s67, 32768
    s_add_u32 s57, s57, s84
    buffer_load_dwordx4 v95, s[48:51], s57 offen lds
    v_mfma_f32_16x16x32_bf16 v[76:79], v[44:47], a[92:95], v[76:79]
    ds_read_b128 v[36:39], v12 offset:28672
    v_mfma_f32_16x16x32_bf16 v[80:83], v[48:51], a[92:95], v[80:83]
    ds_read_b128 v[40:43], v13 offset:28672
    s_waitcnt lgkmcnt(4)
    v_mfma_f32_16x16x32_bf16 v[68:71], v[20:23], a[96:99], v[68:71]
    buffer_store_dword v18, v17, s[32:35], 0 offen sc1
    v_mfma_f32_16x16x32_bf16 v[72:75], v[24:27], a[96:99], v[72:75]
    s_add_u32 m0, s67, 36864
    s_add_u32 s57, s57, s55
    buffer_load_dwordx4 v95, s[48:51], s57 offen lds
    v_mfma_f32_16x16x32_bf16 v[76:79], v[20:23], a[100:103], v[76:79]
    ds_read_b128 v[44:47], v14 offset:28672
    v_mfma_f32_16x16x32_bf16 v[80:83], v[24:27], a[100:103], v[80:83]
    ds_read_b128 v[48:51], v15 offset:28672
    s_waitcnt lgkmcnt(4)
    v_mfma_f32_16x16x32_bf16 v[68:71], v[28:31], a[104:107], v[68:71]
    s_add_u32 m0, s67, 40960
    s_add_u32 s57, s57, s55
    v_mfma_f32_16x16x32_bf16 v[72:75], v[32:35], a[104:107], v[72:75]
    buffer_load_dwordx4 v95, s[48:51], s57 offen lds
    v_mfma_f32_16x16x32_bf16 v[76:79], v[28:31], a[108:111], v[76:79]
    ds_read_b128 v[20:23], v12 offset:32768
    v_mfma_f32_16x16x32_bf16 v[80:83], v[32:35], a[108:111], v[80:83]
    ds_read_b128 v[24:27], v13 offset:32768
    s_waitcnt lgkmcnt(4)
    v_mfma_f32_16x16x32_bf16 v[68:71], v[36:39], a[112:115], v[68:71]
    s_add_u32 m0, s67, 45056
    s_add_u32 s57, s57, s55
    v_mfma_f32_16x16x32_bf16 v[72:75], v[40:43], a[112:115], v[72:75]
    buffer_load_dwordx4 v95, s[48:51], s57 offen lds
    v_mfma_f32_16x16x32_bf16 v[76:79], v[36:39], a[116:119], v[76:79]
    ds_read_b128 v[28:31], v14 offset:32768
    v_mfma_f32_16x16x32_bf16 v[80:83], v[40:43], a[116:119], v[80:83]
    ds_read_b128 v[32:35], v15 offset:32768
    s_waitcnt lgkmcnt(4)
    v_mfma_f32_16x16x32_bf16 v[68:71], v[44:47], a[120:123], v[68:71]
    s_add_u32 m0, s67, 49152
    s_add_u32 s57, s57, s55
    v_mfma_f32_16x16x32_bf16 v[72:75], v[48:51], a[120:123], v[72:75]
    buffer_load_dwordx4 v95, s[48:51], s57 offen lds
    v_mfma_f32_16x16x32_bf16 v[76:79], v[44:47], a[124:127], v[76:79]
    ds_read_b128 v[36:39], v12 offset:36864
    v_mfma_f32_16x16x32_bf16 v[80:83], v[48:51], a[124:127], v[80:83]
    ds_read_b128 v[40:43], v13 offset:36864
    s_waitcnt lgkmcnt(4)
    v_mfma_f32_16x16x32_bf16 v[68:71], v[20:23], a[128:131], v[68:71]
    s_add_u32 m0, s67, 53248
    s_add_u32 s57, s57, s55
    v_mfma_f32_16x16x32_bf16 v[72:75], v[24:27], a[128:131], v[72:75]
    buffer_load_dwordx4 v95, s[48:51], s57 offen lds
    v_mfma_f32_16x16x32_bf16 v[76:79], v[20:23], a[132:135], v[76:79]
    ds_read_b128 v[44:47], v14 offset:36864
    v_mfma_f32_16x16x32_bf16 v[80:83], v[24:27], a[132:135], v[80:83]
    ds_read_b128 v[48:51], v15 offset:36864
    s_waitcnt lgkmcnt(4)
    v_mfma_f32_16x16x32_bf16 v[68:71], v[28:31], a[136:139], v[68:71]
    s_add_u32 m0, s67, 57344
    s_add_u32 s57, s57, s55
    v_mfma_f32_16x16x32_bf16 v[72:75], v[32:35], a[136:139], v[72:75]
    buffer_load_dwordx4 v95, s[48:51], s57 offen lds
    v_mfma_f32_16x16x32_bf16 v[76:79], v[28:31], a[140:143], v[76:79]
    ds_read_b128 v[20:23], v12 offset:40960
    v_mfma_f32_16x16x32_bf16 v[80:83], v[32:35], a[140:143], v[80:83]
    ds_read_b128 v[24:27], v13 offset:40960
    s_waitcnt lgkmcnt(4)
    v_mfma_f32_16x16x32_bf16 v[68:71], v[36:39], a[144:147], v[68:71]
    s_add_u32 m0, s67, 61440
    s_add_u32 s57, s57, s55
    v_mfma_f32_16x16x32_bf16 v[72:75], v[40:43], a[144:147], v[72:75]
    buffer_load_dwordx4 v95, s[48:51], s57 offen lds
    v_mfma_f32_16x16x32_bf16 v[76:79], v[36:39], a[148:151], v[76:79]
    ds_read_b128 v[28:31], v14 offset:40960
    v_mfma_f32_16x16x32_bf16 v[80:83], v[40:43], a[148:151], v[80:83]
    ds_read_b128 v[32:35], v15 offset:40960
    s_waitcnt lgkmcnt(4)
    v_mfma_f32_16x16x32_bf16 v[68:71], v[44:47], a[152:155], v[68:71]
    v_mfma_f32_16x16x32_bf16 v[72:75], v[48:51], a[152:155], v[72:75]
    v_mfma_f32_16x16x32_bf16 v[76:79], v[44:47], a[156:159], v[76:79]
    ds_read_b128 v[36:39], v12 offset:45056
    v_mfma_f32_16x16x32_bf16 v[80:83], v[48:51], a[156:159], v[80:83]
    ds_read_b128 v[40:43], v13 offset:45056
    s_waitcnt lgkmcnt(4)
    v_mfma_f32_16x16x32_bf16 v[68:71], v[20:23], a[160:163], v[68:71]
    v_mfma_f32_16x16x32_bf16 v[72:75], v[24:27], a[160:163], v[72:75]
    v_mfma_f32_16x16x32_bf16 v[76:79], v[20:23], a[164:167], v[76:79]
    ds_read_b128 v[44:47], v14 offset:45056
    v_mfma_f32_16x16x32_bf16 v[80:83], v[24:27], a[164:167], v[80:83]
    ds_read_b128 v[48:51], v15 offset:45056
    s_waitcnt lgkmcnt(4)
    v_mfma_f32_16x16x32_bf16 v[68:71], v[28:31], a[168:171], v[68:71]
    v_mfma_f32_16x16x32_bf16 v[72:75], v[32:35], a[168:171], v[72:75]
    v_mfma_f32_16x16x32_bf16 v[76:79], v[28:31], a[172:175], v[76:79]
    ds_read_b128 v[20:23], v12 offset:49152
    v_mfma_f32_16x16x32_bf16 v[80:83], v[32:35], a[172:175], v[80:83]
    ds_read_b128 v[24:27], v13 offset:49152
    s_waitcnt lgkmcnt(4)
    v_mfma_f32_16x16x32_bf16 v[68:71], v[36:39], a[176:179], v[68:71]
    v_mfma_f32_16x16x32_bf16 v[72:75], v[40:43], a[176:179], v[72:75]
    v_mfma_f32_16x16x32_bf16 v[76:79], v[36:39], a[180:183], v[76:79]
    ds_read_b128 v[28:31], v14 offset:49152
    v_mfma_f32_16x16x32_bf16 v[80:83], v[40:43], a[180:183], v[80:83]
    ds_read_b128 v[32:35], v15 offset:49152
    s_waitcnt lgkmcnt(4)
    v_mfma_f32_16x16x32_bf16 v[68:71], v[44:47], a[184:187], v[68:71]
    v_mfma_f32_16x16x32_bf16 v[72:75], v[48:51], a[184:187], v[72:75]
    v_mfma_f32_16x16x32_bf16 v[76:79], v[44:47], a[188:191], v[76:79]
    ds_read_b128 v[36:39], v12 offset:53248
    v_mfma_f32_16x16x32_bf16 v[80:83], v[48:51], a[188:191], v[80:83]
    ds_read_b128 v[40:43], v13 offset:53248
    s_waitcnt lgkmcnt(4)
    v_mfma_f32_16x16x32_bf16 v[68:71], v[20:23], a[192:195], v[68:71]
    v_mfma_f32_16x16x32_bf16 v[72:75], v[24:27], a[192:195], v[72:75]
    v_mfma_f32_16x16x32_bf16 v[76:79], v[20:23], a[196:199], v[76:79]
    ds_read_b128 v[44:47], v14 offset:53248
    v_mfma_f32_16x16x32_bf16 v[80:83], v[24:27], a[196:199], v[80:83]
    ds_read_b128 v[48:51], v15 offset:53248
    s_waitcnt lgkmcnt(4)
    v_mfma_f32_16x16x32_bf16 v[68:71], v[28:31], a[200:203], v[68:71]
    v_mfma_f32_16x16x32_bf16 v[72:75], v[32:35], a[200:203], v[72:75]
    v_mfma_f32_16x16x32_bf16 v[76:79], v[28:31], a[204:207], v[76:79]
    ds_read_b128 v[20:23], v12 offset:57344
    v_mfma_f32_16x16x32_bf16 v[80:83], v[32:35], a[204:207], v[80:83]
    ds_read_b128 v[24:27], v13 offset:57344
    s_waitcnt lgkmcnt(4)
    v_mfma_f32_16x16x32_bf16 v[68:71], v[36:39], a[208:211], v[68:71]
    v_mfma_f32_16x16x32_bf16 v[72:75], v[40:43], a[208:211], v[72:75]
    v_mfma_f32_16x16x32_bf16 v[76:79], v[36:39], a[212:215], v[76:79]
    ds_read_b128 v[28:31], v14 offset:57344
    v_mfma_f32_16x16x32_bf16 v[80:83], v[40:43], a[212:215], v[80:83]
    ds_read_b128 v[32:35], v15 offset:57344
    s_waitcnt lgkmcnt(4)
    v_mfma_f32_16x16x32_bf16 v[68:71], v[44:47], a[216:219], v[68:71]
    s_waitcnt vmcnt(11)
    s_barrier
    s_cmp_lg_u32 s60, 1
    s_cbranch_scc1 L_ws_nf_E2
    v_mov_b32 v18, 1
    s_waitcnt vmcnt(9)
    buffer_store_dword v18, v17, s[32:35], 0 offen sc1
L_ws_nf_E2:
    v_mfma_f32_16x16x32_bf16 v[72:75], v[48:51], a[216:219], v[72:75]
    s_add_u32 m0, s67, 65536
    s_add_u32 s57, s57, s85
    buffer_load_dwordx4 v95, s[48:51], s57 offen lds
    v_mfma_f32_16x16x32_bf16 v[76:79], v[44:47], a[220:223], v[76:79]
    ds_read_b128 v[36:39], v12 offset:61440
    v_mfma_f32_16x16x32_bf16 v[80:83], v[48:51], a[220:223], v[80:83]
    ds_read_b128 v[40:43], v13 offset:61440
    s_waitcnt lgkmcnt(4)
    v_mfma_f32_16x16x32_bf16 v[68:71], v[20:23], a[224:227], v[68:71]
    s_add_u32 m0, s67, 69632
    s_add_u32 s57, s57, s55
    v_mfma_f32_16x16x32_bf16 v[72:75], v[24:27], a[224:227], v[72:75]
    buffer_load_dwordx4 v95, s[48:51], s57 offen lds
    v_mfma_f32_16x16x32_bf16 v[76:79], v[20:23], a[228:231], v[76:79]
    ds_read_b128 v[44:47], v14 offset:61440
    v_mfma_f32_16x16x32_bf16 v[80:83], v[24:27], a[228:231], v[80:83]
    ds_read_b128 v[48:51], v15 offset:61440
    s_waitcnt lgkmcnt(4)
    v_mfma_f32_16x16x32_bf16 v[68:71], v[28:31], a[232:235], v[68:71]
    s_add_u32 m0, s67, 73728
    s_add_u32 s57, s57, s55
    v_mfma_f32_16x16x32_bf16 v[72:75], v[32:35], a[232:235], v[72:75]
    buffer_load_dwordx4 v95, s[48:51], s57 offen lds
    v_mfma_f32_16x16x32_bf16 v[76:79], v[28:31], a[236:239], v[76:79]
    ds_read_b128 v[20:23], v8 offset:0
    v_mfma_f32_16x16x32_bf16 v[80:83], v[32:35], a[236:239], v[80:83]
    ds_read_b128 v[24:27], v9 offset:0
    s_waitcnt lgkmcnt(4)
    v_mfma_f32_16x16x32_bf16 v[68:71], v[36:39], a[240:243], v[68:71]
    s_add_u32 s60, s60, 1
    s_add_u32 m0, s67, 77824
    v_mfma_f32_16x16x32_bf16 v[72:75], v[40:43], a[240:243], v[72:75]
    s_add_u32 s57, s57, s55
    buffer_load_dwordx4 v95, s[48:51], s57 offen lds
    v_mfma_f32_16x16x32_bf16 v[76:79], v[36:39], a[244:247], v[76:79]
    ds_read_b128 v[28:31], v10 offset:0
    v_mfma_f32_16x16x32_bf16 v[80:83], v[40:43], a[244:247], v[80:83]
    ds_read_b128 v[32:35], v11 offset:0
    s_waitcnt lgkmcnt(4)
    v_mfma_f32_16x16x32_bf16 v[68:71], v[44:47], a[248:251], v[68:71]
    s_add_u32 m0, s67, 81920
    s_add_u32 s57, s57, s55
    v_mfma_f32_16x16x32_bf16 v[72:75], v[48:51], a[248:251], v[72:75]
    buffer_load_dwordx4 v95, s[48:51], s57 offen lds
    v_mfma_f32_16x16x32_bf16 v[76:79], v[44:47], a[252:255], v[76:79]
    ds_read_b128 v[36:39], v8 offset:4096
    v_mfma_f32_16x16x32_bf16 v[80:83], v[48:51], a[252:255], v[80:83]
    ds_read_b128 v[40:43], v9 offset:4096
    s_cmp_lt_u32 s60, s61
    s_cbranch_scc1 L_ws_E2
    v_cvt_pk_bf16_f32 v84, v68, v69
    v_cvt_pk_bf16_f32 v85, v70, v71
    v_cvt_pk_bf16_f32 v86, v72, v73
    v_cvt_pk_bf16_f32 v87, v74, v75
    v_cvt_pk_bf16_f32 v88, v76, v77
    v_cvt_pk_bf16_f32 v89, v78, v79
    v_cvt_pk_bf16_f32 v90, v80, v81
    v_cvt_pk_bf16_f32 v91, v82, v83
    buffer_store_dwordx4 v[84:87], v16, s[32:35], s58 offen sc1
    buffer_store_dwordx4 v[88:91], v19, s[32:35], s58 offen sc1
    s_waitcnt vmcnt(0) lgkmcnt(0)
    v_mov_b32 v18, s60
    buffer_store_dword v18, v94, s[32:35], 0 offen sc1
    s_barrier
    s_branch L_p1done
L_gE3:
    s_mov_b32 s58, 0x7fff0000
    s_mov_b32 s60, 0
    s_waitcnt vmcnt(13)
    s_barrier
    ds_read_b128 v[20:23], v8 offset:0
    ds_read_b128 v[24:27], v9 offset:0
    ds_read_b128 v[28:31], v10 offset:0
    ds_read_b128 v[32:35], v11 offset:0
    ds_read_b128 v[36:39], v8 offset:4096
    ds_read_b128 v[40:43], v9 offset:4096
L_ws_E3:
    s_waitcnt lgkmcnt(4)
    v_mfma_f32_16x16x32_bf16 v[52:55], v[20:23], a[0:3], 0
    s_add_u32 m0, s67, 86016
    s_add_u32 s57, s57, s55
    v_mfma_f32_16x16x32_bf16 v[56:59], v[24:27], a[0:3], 0
    buffer_load_dwordx4 v95, s[48:51], s57 offen lds
    v_mfma_f32_16x16x32_bf16 v[60:63], v[20:23], a[4:7], 0
    ds_read_b128 v[44:47], v10 offset:4096
    v_mfma_f32_16x16x32_bf16 v[64:67], v[24:27], a[4:7], 0
    ds_read_b128 v[48:51], v11 offset:4096
    s_waitcnt lgkmcnt(4)
    v_mfma_f32_16x16x32_bf16 v[52:55], v[28:31], a[8:11], v[52:55]
    s_add_u32 m0, s67, 90112
    s_add_u32 s57, s57, s55
    v_mfma_f32_16x16x32_bf16 v[56:59], v[32:35], a[8:11], v[56:59]
    buffer_load_dwordx4 v95, s[48:51], s57 offen lds
    v_mfma_f32_16x16x32_bf16 v[60:63], v[28:31], a[12:15], v[60:63]
    ds_read_b128 v[20:23], v8 offset:8192
    v_mfma_f32_16x16x32_bf16 v[64:67], v[32:35], a[12:15], v[64:67]
    ds_read_b128 v[24:27], v9 offset:8192
    s_waitcnt lgkmcnt(4)
    v_mfma_f32_16x16x32_bf16 v[52:55], v[36:39], a[16:19], v[52:55]
    s_add_u32 m0, s67, 94208
    s_add_u32 s57, s57, s55
    v_mfma_f32_16x16x32_bf16 v[56:59], v[40:43], a[16:19], v[56:59]
    buffer_load_dwordx4 v95, s[48:51], s57 offen lds
    v_mfma_f32_16x16x32_bf16 v[60:63], v[36:39], a[20:23], v[60:63]
    ds_read_b128 v[28:31], v10 offset:8192
    v_mfma_f32_16x16x32_bf16 v[64:67], v[40:43], a[20:23], v[64:67]
    ds_read_b128 v[32:35], v11 offset:8192
    s_waitcnt lgkmcnt(4)
    v_mfma_f32_16x16x32_bf16 v[52:55], v[44:47], a[24:27], v[52:55]
    v_cvt_pk_bf16_f32 v84, v68, v69
    v_cvt_pk_bf16_f32 v85, v70, v71
    v_mfma_f32_16x16x32_bf16 v[56:59], v[48:51], a[24:27], v[56:59]
    v_mfma_f32_16x16x32_bf16 v[60:63], v[44:47], a[28:31], v[60:63]
    ds_read_b128 v[36:39], v8 offset:12288
    v_mfma_f32_16x16x32_bf16 v[64:67], v[48:51], a[28:31], v[64:67]
    ds_read_b128 v[40:43], v9 offset:12288
    s_waitcnt lgkmcnt(4)
    v_mfma_f32_16x16x32_bf16 v[52:55], v[20:23], a[32:35], v[52:55]
    v_cvt_pk_bf16_f32 v86, v72, v73
    v_cvt_pk_bf16_f32 v87, v74, v75
    v_mfma_f32_16x16x32_bf16 v[56:59], v[24:27], a[32:35], v[56:59]
    v_mfma_f32_16x16x32_bf16 v[60:63], v[20:23], a[36:39], v[60:63]
    ds_read_b128 v[44:47], v10 offset:12288
    v_mfma_f32_16x16x32_bf16 v[64:67], v[24:27], a[36:39], v[64:67]
    ds_read_b128 v[48:51], v11 offset:12288
    s_waitcnt lgkmcnt(4)
    v_mfma_f32_16x16x32_bf16 v[52:55], v[28:31], a[40:43], v[52:55]
    v_permlane32_swap_b32 v84, v86
    v_permlane32_swap_b32 v85, v87
    v_mfma_f32_16x16x32_bf16 v[56:59], v[32:35], a[40:43], v[56:59]
    v_mfma_f32_16x16x32_bf16 v[60:63], v[28:31], a[44:47], v[60:63]
    ds_read_b128 v[20:23], v8 offset:16384
    v_mfma_f32_16x16x32_bf16 v[64:67], v[32:35], a[44:47], v[64:67]
    ds_read_b128 v[24:27], v9 offset:16384
    s_waitcnt lgkmcnt(4)
    v_mfma_f32_16x16x32_bf16 v[52:55], v[36:39], a[48:51], v[52:55]
    v_cvt_pk_bf16_f32 v88, v76, v77
    v_cvt_pk_bf16_f32 v89, v78, v79
    v_mfma_f32_16x16x32_bf16 v[56:59], v[40:43], a[48:51], v[56:59]
    v_mfma_f32_16x16x32_bf16 v[60:63], v[36:39], a[52:55], v[60:63]
    ds_read_b128 v[28:31], v10 offset:16384
    v_mfma_f32_16x16x32_bf16 v[64:67], v[40:43], a[52:55], v[64:67]
    ds_read_b128 v[32:35], v11 offset:16384
    s_waitcnt lgkmcnt(4)
    v_mfma_f32_16x16x32_bf16 v[52:55], v[44:47], a[56:59], v[52:55]
    v_cvt_pk_bf16_f32 v90, v80, v81
    v_cvt_pk_bf16_f32 v91, v82, v83
    v_mfma_f32_16x16x32_bf16 v[56:59], v[48:51], a[56:59], v[56:59]
    v_mfma_f32_16x16x32_bf16 v[60:63], v[44:47], a[60:63], v[60:63]
    ds_read_b128 v[36:39], v8 offset:20480
    v_mfma_f32_16x16x32_bf16 v[64:67], v[48:51], a[60:63], v[64:67]
    ds_read_b128 v[40:43], v9 offset:20480
    s_waitcnt lgkmcnt(4)
    v_mfma_f32_16x16x32_bf16 v[52:55], v[20:23], a[64:67], v[52:55]
    v_permlane32_swap_b32 v88, v90
    v_permlane32_swap_b32 v89, v91
    v_mfma_f32_16x16x32_bf16 v[56:59], v[24:27], a[64:67], v[56:59]
    v_mfma_f32_16x16x32_bf16 v[60:63], v[20:23], a[68:71], v[60:63]
    ds_read_b128 v[44:47], v10 offset:20480
    v_mfma_f32_16x16x32_bf16 v[64:67], v[24:27], a[68:71], v[64:67]
    ds_read_b128 v[48:51], v11 offset:20480
    s_waitcnt lgkmcnt(4)
    v_mfma_f32_16x16x32_bf16 v[52:55], v[28:31], a[72:75], v[52:55]
    buffer_store_dwordx4 v[84:87], v16, s[32:35], s58 offen sc1
    v_mfma_f32_16x16x32_bf16 v[56:59], v[32:35], a[72:75], v[56:59]
    s_sub_u32 s89, s60, 1
    s_max_i32 s89, s89, 0
    v_mfma_f32_16x16x32_bf16 v[60:63], v[28:31], a[76:79], v[60:63]
    ds_read_b128 v[20:23], v8 offset:24576
    v_mfma_f32_16x16x32_bf16 v[64:67], v[32:35], a[76:79], v[64:67]
    ds_read_b128 v[24:27], v9 offset:24576
    s_waitcnt lgkmcnt(4)
    v_mfma_f32_16x16x32_bf16 v[52:55], v[36:39], a[80:83], v[52:55]
    buffer_store_dwordx4 v[88:91], v19, s[32:35], s58 offen sc1
    v_mfma_f32_16x16x32_bf16 v[56:59], v[40:43], a[80:83], v[56:59]
    s_mov_b32 s58, s66
    s_add_u32 s66, s66, s59
    v_mfma_f32_16x16x32_bf16 v[60:63], v[36:39], a[84:87], v[60:63]
    ds_read_b128 v[28:31], v10 offset:24576
    v_mov_b32 v18, s89
    v_mfma_f32_16x16x32_bf16 v[64:67], v[40:43], a[84:87], v[64:67]
    ds_read_b128 v[32:35], v11 offset:24576
    s_waitcnt lgkmcnt(4)
    v_mfma_f32_16x16x32_bf16 v[52:55], v[44:47], a[88:91], v[52:55]
    s_waitcnt vmcnt(10)
    s_barrier
    v_mfma_f32_16x16x32_bf16 v[56:59], v[48:51], a[88:91], v[56:59]
    s_add_u32 m0, s67, 98304
    s_add_u32 s57, s57, s84
    buffer_load_dwordx4 v95, s[48:51], s57 offen lds
    v_mfma_f32_16x16x32_bf16 v[60:63], v[44:47], a[92:95], v[60:63]
    ds_read_b128 v[36:39], v8 offset:28672
    v_mfma_f32_16x16x32_bf16 v[64:67], v[48:51], a[92:95], v[64:67]
    ds_read_b128 v[40:43], v9 offset:28672
    s_waitcnt lgkmcnt(4)
    v_mfma_f32_16x16x32_bf16 v[52:55], v[20:23], a[96:99], v[52:55]
    buffer_store_dword v18, v17, s[32:35], 0 offen sc1
    v_mfma_f32_16x16x32_bf16 v[56:59], v[24:27], a[96:99], v[56:59]
    s_add_u32 m0, s67, 102400
    s_add_u32 s57, s57, s55
    buffer_load_dwordx4 v95, s[48:51], s57 offen lds
    v_mfma_f32_16x16x32_bf16 v[60:63], v[20:23], a[100:103], v[60:63]
    ds_read_b128 v[44:47], v10 offset:28672
    v_mfma_f32_16x16x32_bf16 v[64:67], v[24:27], a[100:103], v[64:67]
    ds_read_b128 v[48:51], v11 offset:28672
    s_waitcnt lgkmcnt(4)
    v_mfma_f32_16x16x32_bf16 v[52:55], v[28:31], a[104:107], v[52:55]
    s_add_u32 m0, s67, 106496
    s_add_u32 s57, s57, s55
    v_mfma_f32_16x16x32_bf16 v[56:59], v[32:35], a[104:107], v[56:59]
    buffer_load_dwordx4 v95, s[48:51], s57 offen lds
    v_mfma_f32_16x16x32_bf16 v[60:63], v[28:31], a[108:111], v[60:63]
    ds_read_b128 v[20:23], v8 offset:32768
    v_mfma_f32_16x16x32_bf16 v[64:67], v[32:35], a[108:111], v[64:67]
    ds_read_b128 v[24:27], v9 offset:32768
    s_waitcnt lgkmcnt(4)
    v_mfma_f32_16x16x32_bf16 v[52:55], v[36:39], a[112:115], v[52:55]
    s_add_u32 m0, s67, 110592
    s_add_u32 s57, s57, s55
    v_mfma_f32_16x16x32_bf16 v[56:59], v[40:43], a[112:115], v[56:59]
    buffer_load_dwordx4 v95, s[48:51], s57 offen lds
    v_mfma_f32_16x16x32_bf16 v[60:63], v[36:39], a[116:119], v[60:63]
    ds_read_b128 v[28:31], v10 offset:32768
    v_mfma_f32_16x16x32_bf16 v[64:67], v[40:43], a[116:119], v[64:67]
    ds_read_b128 v[32:35], v11 offset:32768
    s_waitcnt lgkmcnt(4)
    v_mfma_f32_16x16x32_bf16 v[52:55], v[44:47], a[120:123], v[52:55]
    s_add_u32 m0, s67, 114688
    s_add_u32 s57, s57, s55
    v_mfma_f32_16x16x32_bf16 v[56:59], v[48:51], a[120:123], v[56:59]
    buffer_load_dwordx4 v95, s[48:51], s57 offen lds
    v_mfma_f32_16x16x32_bf16 v[60:63], v[44:47], a[124:127], v[60:63]
    ds_read_b128 v[36:39], v8 offset:36864
    v_mfma_f32_16x16x32_bf16 v[64:67], v[48:51], a[124:127], v[64:67]
    ds_read_b128 v[40:43], v9 offset:36864
    s_waitcnt lgkmcnt(4)
    v_mfma_f32_16x16x32_bf16 v[52:55], v[20:23], a[128:131], v[52:55]
    s_add_u32 m0, s67, 118784
    s_add_u32 s57, s57, s55
    v_mfma_f32_16x16x32_bf16 v[56:59], v[24:27], a[128:131], v[56:59]
    buffer_load_dwordx4 v95, s[48:51], s57 offen lds
    v_mfma_f32_16x16x32_bf16 v[60:63], v[20:23], a[132:135], v[60:63]
    ds_read_b128 v[44:47], v10 offset:36864
    v_mfma_f32_16x16x32_bf16 v[64:67], v[24:27], a[132:135], v[64:67]
    ds_read_b128 v[48:51], v11 offset:36864
    s_waitcnt lgkmcnt(4)
    v_mfma_f32_16x16x32_bf16 v[52:55], v[28:31], a[136:139], v[52:55]
    s_add_u32 m0, s67, 122880
    s_add_u32 s57, s57, s55
    v_mfma_f32_16x16x32_bf16 v[56:59], v[32:35], a[136:139], v[56:59]
    buffer_load_dwordx4 v95, s[48:51], s57 offen lds
    v_mfma_f32_16x16x32_bf16 v[60:63], v[28:31], a[140:143], v[60:63]
    ds_read_b128 v[20:23], v8 offset:40960
    v_mfma_f32_16x16x32_bf16 v[64:67], v[32:35], a[140:143], v[64:67]
    ds_read_b128 v[24:27], v9 offset:40960
    s_waitcnt lgkmcnt(4)
    v_mfma_f32_16x16x32_bf16 v[52:55], v[36:39], a[144:147], v[52:55]
    s_add_u32 m0, s67, 126976
    s_add_u32 s57, s57, s55
    v_mfma_f32_16x16x32_bf16 v[56:59], v[40:43], a[144:147], v[56:59]
    buffer_load_dwordx4 v95, s[48:51], s57 offen lds
    v_mfma_f32_16x16x32_bf16 v[60:63], v[36:39], a[148:151], v[60:63]
    ds_read_b128 v[28:31], v10 offset:40960
    v_mfma_f32_16x16x32_bf16 v[64:67], v[40:43], a[148:151], v[64:67]
    ds_read_b128 v[32:35], v11 offset:40960
    s_waitcnt lgkmcnt(4)
    v_mfma_f32_16x16x32_bf16 v[52:55], v[44:47], a[152:155], v[52:55]
    v_mfma_f32_16x16x32_bf16 v[56:59], v[48:51], a[152:155], v[56:59]
    v_mfma_f32_16x16x32_bf16 v[60:63], v[44:47], a[156:159], v[60:63]
    ds_read_b128 v[36:39], v8 offset:45056
    v_mfma_f32_16x16x32_bf16 v[64:67], v[48:51], a[156:159], v[64:67]
    ds_read_b128 v[40:43], v9 offset:45056
    s_waitcnt lgkmcnt(4)
    v_mfma_f32_16x16x32_bf16 v[52:55], v[20:23], a[160:163], v[52:55]
    v_mfma_f32_16x16x32_bf16 v[56:59], v[24:27], a[160:163], v[56:59]
    v_mfma_f32_16x16x32_bf16 v[60:63], v[20:23], a[164:167], v[60:63]
    ds_read_b128 v[44:47], v10 offset:45056
    v_mfma_f32_16x16x32_bf16 v[64:67], v[24:27], a[164:167], v[64:67]
    ds_read_b128 v[48:51], v11 offset:45056
    s_waitcnt lgkmcnt(4)
    v_mfma_f32_16x16x32_bf16 v[52:55], v[28:31], a[168:171], v[52:55]
    v_mfma_f32_16x16x32_bf16 v[56:59], v[32:35], a[168:171], v[56:59]
    v_mfma_f32_16x16x32_bf16 v[60:63], v[28:31], a[172:175], v[60:63]
    ds_read_b128 v[20:23], v8 offset:49152
    v_mfma_f32_16x16x32_bf16 v[64:67], v[32:35], a[172:175], v[64:67]
    ds_read_b128 v[24:27], v9 offset:49152
    s_waitcnt lgkmcnt(4)
    v_mfma_f32_16x16x32_bf16 v[52:55], v[36:39], a[176:179], v[52:55]
    v_mfma_f32_16x16x32_bf16 v[56:59], v[40:43], a[176:179], v[56:59]
    v_mfma_f32_16x16x32_bf16 v[60:63], v[36:39], a[180:183], v[60:63]
    ds_read_b128 v[28:31], v10 offset:49152
    v_mfma_f32_16x16x32_bf16 v[64:67], v[40:43], a[180:183], v[64:67]
    ds_read_b128 v[32:35], v11 offset:49152
    s_waitcnt lgkmcnt(4)
    v_mfma_f32_16x16x32_bf16 v[52:55], v[44:47], a[184:187], v[52:55]
    v_mfma_f32_16x16x32_bf16 v[56:59], v[48:51], a[184:187], v[56:59]
    v_mfma_f32_16x16x32_bf16 v[60:63], v[44:47], a[188:191], v[60:63]
    ds_read_b128 v[36:39], v8 offset:53248
    v_mfma_f32_16x16x32_bf16 v[64:67], v[48:51], a[188:191], v[64:67]
    ds_read_b128 v[40:43], v9 offset:53248
    s_waitcnt lgkmcnt(4)
    v_mfma_f32_16x16x32_bf16 v[52:55], v[20:23], a[192:195], v[52:55]
    v_mfma_f32_16x16x32_bf16 v[56:59], v[24:27], a[192:195], v[56:59]
    v_mfma_f32_16x16x32_bf16 v[60:63], v[20:23], a[196:199], v[60:63]
    ds_read_b128 v[44:47], v10 offset:53248
    v_mfma_f32_16x16x32_bf16 v[64:67], v[24:27], a[196:199], v[64:67]
    ds_read_b128 v[48:51], v11 offset:53248
    s_waitcnt lgkmcnt(4)
    v_mfma_f32_16x16x32_bf16 v[52:55], v[28:31], a[200:203], v[52:55]
    v_mfma_f32_16x16x32_bf16 v[56:59], v[32:35], a[200:203], v[56:59]
    v_mfma_f32_16x16x32_bf16 v[60:63], v[28:31], a[204:207], v[60:63]
    ds_read_b128 v[20:23], v8 offset:57344
    v_mfma_f32_16x16x32_bf16 v[64:67], v[32:35], a[204:207], v[64:67]
    ds_read_b128 v[24:27], v9 offset:57344
    s_waitcnt lgkmcnt(4)
    v_mfma_f32_16x16x32_bf16 v[52:55], v[36:39], a[208:211], v[52:55]
    v_mfma_f32_16x16x32_bf16 v[56:59], v[40:43], a[208:211], v[56:59]
    v_mfma_f32_16x16x32_bf16 v[60:63], v[36:39], a[212:215], v[60:63]
    ds_read_b128 v[28:31], v10 offset:57344
    v_mfma_f32_16x16x32_bf16 v[64:67], v[40:43], a[212:215], v[64:67]
    ds_read_b128 v[32:35], v11 offset:57344
    s_waitcnt lgkmcnt(4)
    v_mfma_f32_16x16x32_bf16 v[52:55], v[44:47], a[216:219], v[52:55]
    s_waitcnt vmcnt(11)
    s_barrier
    v_mfma_f32_16x16x32_bf16 v[56:59], v[48:51], a[216:219], v[56:59]
    s_add_u32 m0, s67, 0
    s_add_u32 s57, s57, s85
    buffer_load_dwordx4 v95, s[48:51], s57 offen lds
    v_mfma_f32_16x16x32_bf16 v[60:63], v[44:47], a[220:223], v[60:63]
    ds_read_b128 v[36:39], v8 offset:61440
    v_mfma_f32_16x16x32_bf16 v[64:67], v[48:51], a[220:223], v[64:67]
    ds_read_b128 v[40:43], v9 offset:61440
    s_waitcnt lgkmcnt(4)
    v_mfma_f32_16x16x32_bf16 v[52:55], v[20:23], a[224:227], v[52:55]
    s_add_u32 m0, s67, 4096
    s_add_u32 s57, s57, s55
    v_mfma_f32_16x16x32_bf16 v[56:59], v[24:27], a[224:227], v[56:59]
    buffer_load_dwordx4 v95, s[48:51], s57 offen lds
    v_mfma_f32_16x16x32_bf16 v[60:63], v[20:23], a[228:231], v[60:63]
    ds_read_b128 v[44:47], v10 offset:61440
    v_mfma_f32_16x16x32_bf16 v[64:67], v[24:27], a[228:231], v[64:67]
    ds_read_b128 v[48:51], v11 offset:61440
    s_waitcnt lgkmcnt(4)
    v_mfma_f32_16x16x32_bf16 v[52:55], v[28:31], a[232:235], v[52:55]
    s_add_u32 m0, s67, 8192
    s_add_u32 s57, s57, s55
    v_mfma_f32_16x16x32_bf16 v[56:59], v[32:35], a[232:235], v[56:59]
    buffer_load_dwordx4 v95, s[48:51], s57 offen lds
    v_mfma_f32_16x16x32_bf16 v[60:63], v[28:31], a[236:239], v[60:63]
    ds_read_b128 v[20:23], v12 offset:0
    v_mfma_f32_16x16x32_bf16 v[64:67], v[32:35], a[236:239], v[64:67]
    ds_read_b128 v[24:27], v13 offset:0
    s_waitcnt lgkmcnt(4)
    v_mfma_f32_16x16x32_bf16 v[52:55], v[36:39], a[240:243], v[52:55]
    s_add_u32 s60, s60, 1
    s_add_u32 m0, s67, 12288
    v_mfma_f32_16x16x32_bf16 v[56:59], v[40:43], a[240:243], v[56:59]
    s_add_u32 s57, s57, s55
    buffer_load_dwordx4 v95, s[48:51], s57 offen lds
    v_mfma_f32_16x16x32_bf16 v[60:63], v[36:39], a[244:247], v[60:63]
    ds_read_b128 v[28:31], v14 offset:0
    v_mfma_f32_16x16x32_bf16 v[64:67], v[40:43], a[244:247], v[64:67]
    ds_read_b128 v[32:35], v15 offset:0
    s_waitcnt lgkmcnt(4)
    v_mfma_f32_16x16x32_bf16 v[52:55], v[44:47], a[248:251], v[52:55]
    s_add_u32 m0, s67, 16384
    s_add_u32 s57, s57, s55
    v_mfma_f32_16x16x32_bf16 v[56:59], v[48:51], a[248:251], v[56:59]
    buffer_load_dwordx4 v95, s[48:51], s57 offen lds
    v_mfma_f32_16x16x32_bf16 v[60:63], v[44:47], a[252:255], v[60:63]
    ds_read_b128 v[36:39], v12 offset:4096
    v_mfma_f32_16x16x32_bf16 v[64:67], v[48:51], a[252:255], v[64:67]
    ds_read_b128 v[40:43], v13 offset:4096
    s_waitcnt lgkmcnt(4)
    v_mfma_f32_16x16x32_bf16 v[68:71], v[20:23], a[0:3], 0
    s_add_u32 m0, s67, 20480
    s_add_u32 s57, s57, s55
    v_mfma_f32_16x16x32_bf16 v[72:75], v[24:27], a[0:3], 0
    buffer_load_dwordx4 v95, s[48:51], s57 offen lds
    v_mfma_f32_16x16x32_bf16 v[76:79], v[20:23], a[4:7], 0
    ds_read_b128 v[44:47], v14 offset:4096
    v_mfma_f32_16x16x32_bf16 v[80:83], v[24:27], a[4:7], 0
    ds_read_b128 v[48:51], v15 offset:4096
    s_waitcnt lgkmcnt(4)
    v_mfma_f32_16x16x32_bf16 v[68:71], v[28:31], a[8:11], v[68:71]
    s_add_u32 m0, s67, 24576
    s_add_u32 s57, s57, s55
    v_mfma_f32_16x16x32_bf16 v[72:75], v[32:35], a[8:11], v[72:75]
    buffer_load_dwordx4 v95, s[48:51], s57 offen lds
    v_mfma_f32_16x16x32_bf16 v[76:79], v[28:31], a[12:15], v[76:79]
    ds_read_b128 v[20:23], v12 offset:8192
    v_mfma_f32_16x16x32_bf16 v[80:83], v[32:35], a[12:15], v[80:83]
    ds_read_b128 v[24:27], v13 offset:8192
    s_waitcnt lgkmcnt(4)
    v_mfma_f32_16x16x32_bf16 v[68:71], v[36:39], a[16:19], v[68:71]
    s_add_u32 m0, s67, 28672
    s_add_u32 s57, s57, s55
    v_mfma_f32_16x16x32_bf16 v[72:75], v[40:43], a[16:19], v[72:75]
    buffer_load_dwordx4 v95, s[48:51], s57 offen lds
    v_mfma_f32_16x16x32_bf16 v[76:79], v[36:39], a[20:23], v[76:79]
    ds_read_b128 v[28:31], v14 offset:8192
    v_mfma_f32_16x16x32_bf16 v[80:83], v[40:43], a[20:23], v[80:83]
    ds_read_b128 v[32:35], v15 offset:8192
    s_waitcnt lgkmcnt(4)
    v_mfma_f32_16x16x32_bf16 v[68:71], v[44:47], a[24:27], v[68:71]
    v_cvt_pk_bf16_f32 v84, v52, v53
    v_cvt_pk_bf16_f32 v85, v54, v55
    v_mfma_f32_16x16x32_bf16 v[72:75], v[48:51], a[24:27], v[72:75]
    v_mfma_f32_16x16x32_bf16 v[76:79], v[44:47], a[28:31], v[76:79]
    ds_read_b128 v[36:39], v12 offset:12288
    v_mfma_f32_16x16x32_bf16 v[80:83], v[48:51], a[28:31], v[80:83]
    ds_read_b128 v[40:43], v13 offset:12288
    s_waitcnt lgkmcnt(4)
    v_mfma_f32_16x16x32_bf16 v[68:71], v[20:23], a[32:35], v[68:71]
    v_cvt_pk_bf16_f32 v86, v56, v57
    v_cvt_pk_bf16_f32 v87, v58, v59
    v_mfma_f32_16x16x32_bf16 v[72:75], v[24:27], a[32:35], v[72:75]
    v_mfma_f32_16x16x32_bf16 v[76:79], v[20:23], a[36:39], v[76:79]
    ds_read_b128 v[44:47], v14 offset:12288
    v_mfma_f32_16x16x32_bf16 v[80:83], v[24:27], a[36:39], v[80:83]
    ds_read_b128 v[48:51], v15 offset:12288
    s_waitcnt lgkmcnt(4)
    v_mfma_f32_16x16x32_bf16 v[68:71], v[28:31], a[40:43], v[68:71]
    v_permlane32_swap_b32 v84, v86
    v_permlane32_swap_b32 v85, v87
    v_mfma_f32_16x16x32_bf16 v[72:75], v[32:35], a[40:43], v[72:75]
    v_mfma_f32_16x16x32_bf16 v[76:79], v[28:31], a[44:47], v[76:79]
    ds_read_b128 v[20:23], v12 offset:16384
    v_mfma_f32_16x16x32_bf16 v[80:83], v[32:35], a[44:47], v[80:83]
    ds_read_b128 v[24:27], v13 offset:16384
    s_waitcnt lgkmcnt(4)
    v_mfma_f32_16x16x32_bf16 v[68:71], v[36:39], a[48:51], v[68:71]
    v_cvt_pk_bf16_f32 v88, v60, v61
    v_cvt_pk_bf16_f32 v89, v62, v63
    v_mfma_f32_16x16x32_bf16 v[72:75], v[40:43], a[48:51], v[72:75]
    v_mfma_f32_16x16x32_bf16 v[76:79], v[36:39], a[52:55], v[76:79]
    ds_read_b128 v[28:31], v14 offset:16384
    v_mfma_f32_16x16x32_bf16 v[80:83], v[40:43], a[52:55], v[80:83]
    ds_read_b128 v[32:35], v15 offset:16384
    s_waitcnt lgkmcnt(4)
    v_mfma_f32_16x16x32_bf16 v[68:71], v[44:47], a[56:59], v[68:71]
    v_cvt_pk_bf16_f32 v90, v64, v65
    v_cvt_pk_bf16_f32 v91, v66, v67
    v_mfma_f32_16x16x32_bf16 v[72:75], v[48:51], a[56:59], v[72:75]
    v_mfma_f32_16x16x32_bf16 v[76:79], v[44:47], a[60:63], v[76:79]
    ds_read_b128 v[36:39], v12 offset:20480
    v_mfma_f32_16x16x32_bf16 v[80:83], v[48:51], a[60:63], v[80:83]
    ds_read_b128 v[40:43], v13 offset:20480
    s_waitcnt lgkmcnt(4)
    v_mfma_f32_16x16x32_bf16 v[68:71], v[20:23], a[64:67], v[68:71]
    v_permlane32_swap_b32 v88, v90
    v_permlane32_swap_b32 v89, v91
    v_mfma_f32_16x16x32_bf16 v[72:75], v[24:27], a[64:67], v[72:75]
    v_mfma_f32_16x16x32_bf16 v[76:79], v[20:23], a[68:71], v[76:79]
    ds_read_b128 v[44:47], v14 offset:20480
    v_mfma_f32_16x16x32_bf16 v[80:83], v[24:27], a[68:71], v[80:83]
    ds_read_b128 v[48:51], v15 offset:20480
    s_waitcnt lgkmcnt(4)
    v_mfma_f32_16x16x32_bf16 v[68:71], v[28:31], a[72:75], v[68:71]
    buffer_store_dwordx4 v[84:87], v16, s[32:35], s58 offen sc1
    v_mfma_f32_16x16x32_bf16 v[72:75], v[32:35], a[72:75], v[72:75]
    s_sub_u32 s89, s60, 1
    s_max_i32 s89, s89, 0
    v_mfma_f32_16x16x32_bf16 v[76:79], v[28:31], a[76:79], v[76:79]
    ds_read_b128 v[20:23], v12 offset:24576
    v_mfma_f32_16x16x32_bf16 v[80:83], v[32:35], a[76:79], v[80:83]
    ds_read_b128 v[24:27], v13 offset:24576
    s_waitcnt lgkmcnt(4)
    v_mfma_f32_16x16x32_bf16 v[68:71], v[36:39], a[80:83], v[68:71]
    buffer_store_dwordx4 v[88:91], v19, s[32:35], s58 offen sc1
    v_mfma_f32_16x16x32_bf16 v[72:75], v[40:43], a[80:83], v[72:75]
    s_mov_b32 s58, s66
    s_add_u32 s66, s66, s59
    v_mfma_f32_16x16x32_bf16 v[76:79], v[36:39], a[84:87], v[76:79]
    ds_read_b128 v[28:31], v14 offset:24576
    v_mov_b32 v18, s89
    v_mfma_f32_16x16x32_bf16 v[80:83], v[40:43], a[84:87], v[80:83]
    ds_read_b128 v[32:35], v15 offset:24576
    s_waitcnt lgkmcnt(4)
    v_mfma_f32_16x16x32_bf16 v[68:71], v[44:47], a[88:91], v[68:71]
    s_waitcnt vmcnt(10)
    s_barrier
    v_mfma_f32_16x16x32_bf16 v[72:75], v[48:51], a[88:91], v[72:75]
    s_add_u32 m0, s67, 32768
    s_add_u32 s57, s57, s84
    buffer_load_dwordx4 v95, s[48:51], s57 offen lds
    v_mfma_f32_16x16x32_bf16 v[76:79], v[44:47], a[92:95], v[76:79]
    ds_read_b128 v[36:39], v12 offset:28672
    v_mfma_f32_16x16x32_bf16 v[80:83], v[48:51], a[92:95], v[80:83]
    ds_read_b128 v[40:43], v13 offset:28672
    s_waitcnt lgkmcnt(4)
    v_mfma_f32_16x16x32_bf16 v[68:71], v[20:23], a[96:99], v[68:71]
    buffer_store_dword v18, v17, s[32:35], 0 offen sc1
    v_mfma_f32_16x16x32_bf16 v[72:75], v[24:27], a[96:99], v[72:75]
    s_add_u32 m0, s67, 36864
    s_add_u32 s57, s57, s55
    buffer_load_dwordx4 v95, s[48:51], s57 offen lds
    v_mfma_f32_16x16x32_bf16 v[76:79], v[20:23], a[100:103], v[76:79]
    ds_read_b128 v[44:47], v14 offset:28672
    v_mfma_f32_16x16x32_bf16 v[80:83], v[24:27], a[100:103], v[80:83]
    ds_read_b128 v[48:51], v15 offset:28672
    s_waitcnt lgkmcnt(4)
    v_mfma_f32_16x16x32_bf16 v[68:71], v[28:31], a[104:107], v[68:71]
    s_add_u32 m0, s67, 40960
    s_add_u32 s57, s57, s55
    v_mfma_f32_16x16x32_bf16 v[72:75], v[32:35], a[104:107], v[72:75]
    buffer_load_dwordx4 v95, s[48:51], s57 offen lds
    v_mfma_f32_16x16x32_bf16 v[76:79], v[28:31], a[108:111], v[76:79]
    ds_read_b128 v[20:23], v12 offset:32768
    v_mfma_f32_16x16x32_bf16 v[80:83], v[32:35], a[108:111], v[80:83]
    ds_read_b128 v[24:27], v13 offset:32768
    s_waitcnt lgkmcnt(4)
    v_mfma_f32_16x16x32_bf16 v[68:71], v[36:39], a[112:115], v[68:71]
    s_add_u32 m0, s67, 45056
    s_add_u32 s57, s57, s55
    v_mfma_f32_16x16x32_bf16 v[72:75], v[40:43], a[112:115], v[72:75]
    buffer_load_dwordx4 v95, s[48:51], s57 offen lds
    v_mfma_f32_16x16x32_bf16 v[76:79], v[36:39], a[116:119], v[76:79]
    ds_read_b128 v[28:31], v14 offset:32768
    v_mfma_f32_16x16x32_bf16 v[80:83], v[40:43], a[116:119], v[80:83]
    ds_read_b128 v[32:35], v15 offset:32768
    s_waitcnt lgkmcnt(4)
    v_mfma_f32_16x16x32_bf16 v[68:71], v[44:47], a[120:123], v[68:71]
    s_add_u32 m0, s67, 49152
    s_add_u32 s57, s57, s55
    v_mfma_f32_16x16x32_bf16 v[72:75], v[48:51], a[120:123], v[72:75]
    buffer_load_dwordx4 v95, s[48:51], s57 offen lds
    v_mfma_f32_16x16x32_bf16 v[76:79], v[44:47], a[124:127], v[76:79]
    ds_read_b128 v[36:39], v12 offset:36864
    v_mfma_f32_16x16x32_bf16 v[80:83], v[48:51], a[124:127], v[80:83]
    ds_read_b128 v[40:43], v13 offset:36864
    s_waitcnt lgkmcnt(4)
    v_mfma_f32_16x16x32_bf16 v[68:71], v[20:23], a[128:131], v[68:71]
    s_add_u32 m0, s67, 53248
    s_add_u32 s57, s57, s55
    v_mfma_f32_16x16x32_bf16 v[72:75], v[24:27], a[128:131], v[72:75]
    buffer_load_dwordx4 v95, s[48:51], s57 offen lds
    v_mfma_f32_16x16x32_bf16 v[76:79], v[20:23], a[132:135], v[76:79]
    ds_read_b128 v[44:47], v14 offset:36864
    v_mfma_f32_16x16x32_bf16 v[80:83], v[24:27], a[132:135], v[80:83]
    ds_read_b128 v[48:51], v15 offset:36864
    s_waitcnt lgkmcnt(4)
    v_mfma_f32_16x16x32_bf16 v[68:71], v[28:31], a[136:139], v[68:71]
    s_add_u32 m0, s67, 57344
    s_add_u32 s57, s57, s55
    v_mfma_f32_16x16x32_bf16 v[72:75], v[32:35], a[136:139], v[72:75]
    buffer_load_dwordx4 v95, s[48:51], s57 offen lds
    v_mfma_f32_16x16x32_bf16 v[76:79], v[28:31], a[140:143], v[76:79]
    ds_read_b128 v[20:23], v12 offset:40960
    v_mfma_f32_16x16x32_bf16 v[80:83], v[32:35], a[140:143], v[80:83]
    ds_read_b128 v[24:27], v13 offset:40960
    s_waitcnt lgkmcnt(4)
    v_mfma_f32_16x16x32_bf16 v[68:71], v[36:39], a[144:147], v[68:71]
    s_add_u32 m0, s67, 61440
    s_add_u32 s57, s57, s55
    v_mfma_f32_16x16x32_bf16 v[72:75], v[40:43], a[144:147], v[72:75]
    buffer_load_dwordx4 v95, s[48:51], s57 offen lds
    v_mfma_f32_16x16x32_bf16 v[76:79], v[36:39], a[148:151], v[76:79]
    ds_read_b128 v[28:31], v14 offset:40960
    v_mfma_f32_16x16x32_bf16 v[80:83], v[40:43], a[148:151], v[80:83]
    ds_read_b128 v[32:35], v15 offset:40960
    s_waitcnt lgkmcnt(4)
    v_mfma_f32_16x16x32_bf16 v[68:71], v[44:47], a[152:155], v[68:71]
    v_mfma_f32_16x16x32_bf16 v[72:75], v[48:51], a[152:155], v[72:75]
    v_mfma_f32_16x16x32_bf16 v[76:79], v[44:47], a[156:159], v[76:79]
    ds_read_b128 v[36:39], v12 offset:45056
    v_mfma_f32_16x16x32_bf16 v[80:83], v[48:51], a[156:159], v[80:83]
    ds_read_b128 v[40:43], v13 offset:45056
    s_waitcnt lgkmcnt(4)
    v_mfma_f32_16x16x32_bf16 v[68:71], v[20:23], a[160:163], v[68:71]
    v_mfma_f32_16x16x32_bf16 v[72:75], v[24:27], a[160:163], v[72:75]
    v_mfma_f32_16x16x32_bf16 v[76:79], v[20:23], a[164:167], v[76:79]
    ds_read_b128 v[44:47], v14 offset:45056
    v_mfma_f32_16x16x32_bf16 v[80:83], v[24:27], a[164:167], v[80:83]
    ds_read_b128 v[48:51], v15 offset:45056
    s_waitcnt lgkmcnt(4)
    v_mfma_f32_16x16x32_bf16 v[68:71], v[28:31], a[168:171], v[68:71]
    v_mfma_f32_16x16x32_bf16 v[72:75], v[32:35], a[168:171], v[72:75]
    v_mfma_f32_16x16x32_bf16 v[76:79], v[28:31], a[172:175], v[76:79]
    ds_read_b128 v[20:23], v12 offset:49152
    v_mfma_f32_16x16x32_bf16 v[80:83], v[32:35], a[172:175], v[80:83]
    ds_read_b128 v[24:27], v13 offset:49152
    s_waitcnt lgkmcnt(4)
    v_mfma_f32_16x16x32_bf16 v[68:71], v[36:39], a[176:179], v[68:71]
    v_mfma_f32_16x16x32_bf16 v[72:75], v[40:43], a[176:179], v[72:75]
    v_mfma_f32_16x16x32_bf16 v[76:79], v[36:39], a[180:183], v[76:79]
    ds_read_b128 v[28:31], v14 offset:49152
    v_mfma_f32_16x16x32_bf16 v[80:83], v[40:43], a[180:183], v[80:83]
    ds_read_b128 v[32:35], v15 offset:49152
    s_waitcnt lgkmcnt(4)
    v_mfma_f32_16x16x32_bf16 v[68:71], v[44:47], a[184:187], v[68:71]
    v_mfma_f32_16x16x32_bf16 v[72:75], v[48:51], a[184:187], v[72:75]
    v_mfma_f32_16x16x32_bf16 v[76:79], v[44:47], a[188:191], v[76:79]
    ds_read_b128 v[36:39], v12 offset:53248
    v_mfma_f32_16x16x32_bf16 v[80:83], v[48:51], a[188:191], v[80:83]
    ds_read_b128 v[40:43], v13 offset:53248
    s_waitcnt lgkmcnt(4)
    v_mfma_f32_16x16x32_bf16 v[68:71], v[20:23], a[192:195], v[68:71]
    v_mfma_f32_16x16x32_bf16 v[72:75], v[24:27], a[192:195], v[72:75]
    v_mfma_f32_16x16x32_bf16 v[76:79], v[20:23], a[196:199], v[76:79]
    ds_read_b128 v[44:47], v14 offset:53248
    v_mfma_f32_16x16x32_bf16 v[80:83], v[24:27], a[196:199], v[80:83]
    ds_read_b128 v[48:51], v15 offset:53248
    s_waitcnt lgkmcnt(4)
    v_mfma_f32_16x16x32_bf16 v[68:71], v[28:31], a[200:203], v[68:71]
    v_mfma_f32_16x16x32_bf16 v[72:75], v[32:35], a[200:203], v[72:75]
    v_mfma_f32_16x16x32_bf16 v[76:79], v[28:31], a[204:207], v[76:79]
    ds_read_b128 v[20:23], v12 offset:57344
    v_mfma_f32_16x16x32_bf16 v[80:83], v[32:35], a[204:207], v[80:83]
    ds_read_b128 v[24:27], v13 offset:57344
    s_waitcnt lgkmcnt(4)
    v_mfma_f32_16x16x32_bf16 v[68:71], v[36:39], a[208:211], v[68:71]
    v_mfma_f32_16x16x32_bf16 v[72:75], v[40:43], a[208:211], v[72:75]
    v_mfma_f32_16x16x32_bf16 v[76:79], v[36:39], a[212:215], v[76:79]
    ds_read_b128 v[28:31], v14 offset:57344
    v_mfma_f32_16x16x32_bf16 v[80:83], v[40:43], a[212:215], v[80:83]
    ds_read_b128 v[32:35], v15 offset:57344
    s_waitcnt lgkmcnt(4)
    v_mfma_f32_16x16x32_bf16 v[68:71], v[44:47], a[216:219], v[68:71]
    s_waitcnt vmcnt(11)
    s_barrier
    s_cmp_lg_u32 s60, 1
    s_cbranch_scc1 L_ws_nf_E3
    v_mov_b32 v18, 1
    s_waitcnt vmcnt(9)
    buffer_store_dword v18, v17, s[32:35], 0 offen sc1
L_ws_nf_E3:
    v_mfma_f32_16x16x32_bf16 v[72:75], v[48:51], a[216:219], v[72:75]
    s_add_u32 m0, s67, 65536
    s_add_u32 s57, s57, s85
    buffer_load_dwordx4 v95, s[48:51], s57 offen lds
    v_mfma_f32_16x16x32_bf16 v[76:79], v[44:47], a[220:223], v[76:79]
    ds_read_b128 v[36:39], v12 offset:61440
    v_mfma_f32_16x16x32_bf16 v[80:83], v[48:51], a[220:223], v[80:83]
    ds_read_b128 v[40:43], v13 offset:61440
    s_waitcnt lgkmcnt(4)
    v_mfma_f32_16x16x32_bf16 v[68:71], v[20:23], a[224:227], v[68:71]
    s_add_u32 m0, s67, 69632
    s_add_u32 s57, s57, s55
    v_mfma_f32_16x16x32_bf16 v[72:75], v[24:27], a[224:227], v[72:75]
    buffer_load_dwordx4 v95, s[48:51], s57 offen lds
    v_mfma_f32_16x16x32_bf16 v[76:79], v[20:23], a[228:231], v[76:79]
    ds_read_b128 v[44:47], v14 offset:61440
    v_mfma_f32_16x16x32_bf16 v[80:83], v[24:27], a[228:231], v[80:83]
    ds_read_b128 v[48:51], v15 offset:61440
    s_waitcnt lgkmcnt(4)
    v_mfma_f32_16x16x32_bf16 v[68:71], v[28:31], a[232:235], v[68:71]
    s_add_u32 m0, s67, 73728
    s_add_u32 s57, s57, s55
    v_mfma_f32_16x16x32_bf16 v[72:75], v[32:35], a[232:235], v[72:75]
    buffer_load_dwordx4 v95, s[48:51], s57 offen lds
    v_mfma_f32_16x16x32_bf16 v[76:79], v[28:31], a[236:239], v[76:79]
    ds_read_b128 v[20:23], v8 offset:0
    v_mfma_f32_16x16x32_bf16 v[80:83], v[32:35], a[236:239], v[80:83]
    ds_read_b128 v[24:27], v9 offset:0
    s_waitcnt lgkmcnt(4)
    v_mfma_f32_16x16x32_bf16 v[68:71], v[36:39], a[240:243], v[68:71]
    s_add_u32 s60, s60, 1
    s_add_u32 m0, s67, 77824
    v_mfma_f32_16x16x32_bf16 v[72:75], v[40:43], a[240:243], v[72:75]
    s_add_u32 s57, s57, s55
    buffer_load_dwordx4 v95, s[48:51], s57 offen lds
    v_mfma_f32_16x16x32_bf16 v[76:79], v[36:39], a[244:247], v[76:79]
    ds_read_b128 v[28:31], v10 offset:0
    v_mfma_f32_16x16x32_bf16 v[80:83], v[40:43], a[244:247], v[80:83]
    ds_read_b128 v[32:35], v11 offset:0
    s_waitcnt lgkmcnt(4)
    v_mfma_f32_16x16x32_bf16 v[68:71], v[44:47], a[248:251], v[68:71]
    s_add_u32 m0, s67, 81920
    s_add_u32 s57, s57, s55
    v_mfma_f32_16x16x32_bf16 v[72:75], v[48:51], a[248:251], v[72:75]
    buffer_load_dwordx4 v95, s[48:51], s57 offen lds
    v_mfma_f32_16x16x32_bf16 v[76:79], v[44:47], a[252:255], v[76:79]
    ds_read_b128 v[36:39], v8 offset:4096
    v_mfma_f32_16x16x32_bf16 v[80:83], v[48:51], a[252:255], v[80:83]
    ds_read_b128 v[40:43], v9 offset:4096
    s_cmp_lt_u32 s60, s61
    s_cbranch_scc1 L_ws_E3
    v_cvt_pk_bf16_f32 v84, v68, v69
    v_cvt_pk_bf16_f32 v85, v70, v71
    v_cvt_pk_bf16_f32 v86, v72, v73
    v_cvt_pk_bf16_f32 v87, v74, v75
    s_nop 0
    v_permlane32_swap_b32 v84, v86
    v_permlane32_swap_b32 v85, v87
    v_cvt_pk_bf16_f32 v88, v76, v77
    v_cvt_pk_bf16_f32 v89, v78, v79
    v_cvt_pk_bf16_f32 v90, v80, v81
    v_cvt_pk_bf16_f32 v91, v82, v83
    s_nop 0
    v_permlane32_swap_b32 v88, v90
    v_permlane32_swap_b32 v89, v91
    buffer_store_dwordx4 v[84:87], v16, s[32:35], s58 offen sc1
    buffer_store_dwordx4 v[88:91], v19, s[32:35], s58 offen sc1
    s_waitcnt vmcnt(0) lgkmcnt(0)
    v_mov_b32 v18, s60
    buffer_store_dword v18, v94, s[32:35], 0 offen sc1
    s_barrier
    s_branch L_p1done
L_spare:
    s_cmp_lg_u32 s52, 2
    s_cbranch_scc1 L_cfd_19
    s_mov_b32 s88, 0
    v_mov_b32 v246, 128
L_cf_18:
    s_add_u32 s88, s88, 1
    s_mov_b32 s89, 1
    s_cmp_ge_u32 s88, 262144
    s_cbranch_scc1 L_abort
    buffer_load_dword v247, v246, s[36:39], 0 offen sc1
    s_waitcnt vmcnt(0)
    v_readfirstlane_b32 s52, v247
    s_cmp_le_u32 s52, s2
    s_cbranch_scc1 L_cf_18
    s_and_b32 s52, s52, 3
    s_sub_u32 s52, s52, 1
    s_cmp_eq_u32 s52, 0
    s_cbranch_scc1 L_cfd_19
    s_mov_b32 s52, 1
    s_mov_b32 s31, s83
    s_waitcnt vmcnt(0) lgkmcnt(0)
    s_barrier
    s_branch L_dispatch
L_cfd_19:
    s_lshl_b32 s68, s77, 2
    s_add_u32 s68, s68, s30
    s_cmp_lg_u32 s68, 481
    s_cbranch_scc1 L_noprobe
    s_add_u32 s53, s94, 1048576
    s_add_u32 s54, s94, 1056768
    v_and_b32 v3, 7, v1
    v_lshlrev_b32 v3, 2, v3
    v_mov_b32 v2, 0
    s_mov_b32 s62, 0
    s_mov_b32 s63, -1
    s_mov_b32 s64, -1
L_p_probe:
    buffer_store_dword v2, v3, s[32:35], s53 offen sc1
    buffer_store_dword v2, v3, s[32:35], s54 offen sc1
    s_waitcnt vmcnt(0)
    s_memtime s[56:57]
    s_waitcnt lgkmcnt(0)
    buffer_load_dword v4, v3, s[32:35], s53 offen sc1
    s_waitcnt vmcnt(0)
    s_memtime s[58:59]
    s_waitcnt lgkmcnt(0)
    buffer_load_dword v4, v3, s[32:35], s54 offen sc1
    s_waitcnt vmcnt(0)
    s_memtime s[60:61]
    s_waitcnt lgkmcnt(0)
    s_sub_u32 s60, s60, s58
    s_sub_u32 s58, s58, s56
    s_min_u32 s63, s63, s58
    s_min_u32 s64, s64, s60
    s_add_u32 s62, s62, 1
    s_cmp_ge_u32 s62, 6
    s_cbranch_scc1 L_p_probed
    s_min_u32 s65, s63, s64
    s_max_u32 s66, s63, s64
    s_sub_u32 s66, s66, s65
    s_cmp_ge_u32 s65, 600
    s_cbranch_scc1 L_p_probe
    s_cmp_lt_u32 s66, 150
    s_cbranch_scc1 L_p_probe
L_p_probed:
    s_cmp_lt_u32 s64, s63
    s_cselect_b32 s55, 1, 0
    s_lshr_b32 s56, s3, 2
    s_and_b32 s56, s56, 1
    s_xor_b32 s55, s55, s56
    s_add_u32 s55, s55, 1
    s_or_b32 s55, s55, s2
    v_mov_b32 v4, s55
    v_mov_b32 v3, 0x7fff0000
    v_mov_b32 v5, 132
    v_cmp_eq_u32 vcc, 0, v1
    s_nop 1
    v_cndmask_b32 v3, v3, v5, vcc
    buffer_store_dword v4, v3, s[36:39], 0 offen sc1
L_noprobe:
    s_barrier
    s_cmp_lg_u32 s52, 2
    s_cbranch_scc1 L_cfd_21
    s_mov_b32 s88, 0
    v_mov_b32 v246, 128
L_cf_20:
    s_add_u32 s88, s88, 1
    s_mov_b32 s89, 1
    s_cmp_ge_u32 s88, 262144
    s_cbranch_scc1 L_abort
    buffer_load_dword v247, v246, s[36:39], 0 offen sc1
    s_waitcnt vmcnt(0)
    v_readfirstlane_b32 s52, v247
    s_cmp_le_u32 s52, s2
    s_cbranch_scc1 L_cf_20
    s_and_b32 s52, s52, 3
    s_sub_u32 s52, s52, 1
    s_cmp_eq_u32 s52, 0
    s_cbranch_scc1 L_cfd_21
    s_mov_b32 s52, 1
    s_mov_b32 s31, s83
    s_waitcnt vmcnt(0) lgkmcnt(0)
    s_barrier
    s_branch L_dispatch
L_cfd_21:
    s_mov_b32 s88, 0
    v_mov_b32 v246, 132
L_side_22:
    s_add_u32 s88, s88, 1
    s_mov_b32 s89, 18
    s_cmp_ge_u32 s88, 262144
    s_cbranch_scc1 L_abort
    buffer_load_dword v247, v246, s[36:39], 0 offen sc1
    s_waitcnt vmcnt(0)
    v_readfirstlane_b32 s95, v247
    s_cmp_le_u32 s95, s2
    s_cbranch_scc1 L_side_22
    s_sub_u32 s95, s95, 1
    s_and_b32 s95, s95, 1
    s_lshl_b32 s95, s95, 13
    s_sub_u32 s68, s77, 120
    s_lshl_b32 s68, s68, 13
    v_lshlrev_b32 v2, 4, v0
    v_mov_b32 v4, 0
    v_mov_b32 v5, 0
    v_mov_b32 v6, 0
    v_mov_b32 v7, 0
    buffer_store_dwordx4 v[4:7], v2, s[32:35], s68 offen sc1
    s_add_u32 s68, s68, 4096
    buffer_store_dwordx4 v[4:7], v2, s[32:35], s68 offen sc1
    s_add_u32 s68, s94, s95
    s_add_u32 s68, s68, 1114112
    s_sub_u32 s69, s77, 120
    s_lshl_b32 s70, s69, 14
    s_add_u32 s70, s70, s68
    buffer_store_dwordx4 v[4:7], v2, s[32:35], s70 offen sc1
    s_add_u32 s70, s70, 4096
    buffer_store_dwordx4 v[4:7], v2, s[32:35], s70 offen sc1
    s_add_u32 s70, s70, 4096
    s_lshl_b32 s70, s69, 11
    s_and_b32 s71, s70, 0x2000
    s_add_u32 s70, s70, s71
    s_add_u32 s70, s70, s68
    s_add_u32 s70, s70, 131072
    v_mov_b32 v3, 0x7fff0000
    v_cmp_gt_u32 vcc, 128, v0
    s_nop 1
    v_cndmask_b32 v3, v3, v2, vcc
    buffer_store_dwordx4 v[4:7], v3, s[32:35], s70 offen sc1
    s_waitcnt vmcnt(0)
    s_barrier
    s_cmp_lg_u32 s30, 0
    s_cbranch_scc1 L_sr_23
    v_mov_b32 v246, 0x7fff0000
    v_mov_b32 v247, 72
    v_cmp_eq_u32 vcc, 0, v1
    s_nop 1
    v_cndmask_b32 v246, v246, v247, vcc
    v_mov_b32 v247, 1
    buffer_atomic_add v247, v246, s[36:39], 0 offen
L_sr_23:
    s_mov_b32 s44, s10
    s_and_b32 s45, s11, 0xffff
    s_mov_b32 s46, 0x400000
    s_mov_b32 s47, 0x00020000
    s_mov_b32 s48, s4
    s_and_b32 s49, s5, 0xffff
    s_mov_b32 s50, 0x400000
    s_mov_b32 s51, 0x00020000
    s_sub_u32 s68, s77, 120
    s_lshl_b32 s68, s68, 2
    s_add_u32 s68, s68, s30
    s_lshl_b32 s68, s68, 13
    v_lshlrev_b32 v2, 7, v1
    buffer_load_dword v4, v2, s[44:47], s68 offen
    buffer_load_dword v5, v2, s[48:51], s68 offen
    s_add_u32 s68, s68, 0x40000
    s_waitcnt vmcnt(2)
    buffer_load_dword v6, v2, s[44:47], s68 offen
    buffer_load_dword v7, v2, s[48:51], s68 offen
    s_add_u32 s68, s68, 0x40000
    s_waitcnt vmcnt(2)
    buffer_load_dword v4, v2, s[44:47], s68 offen
    buffer_load_dword v5, v2, s[48:51], s68 offen
    s_add_u32 s68, s68, 0x40000
    s_waitcnt vmcnt(2)
    buffer_load_dword v6, v2, s[44:47], s68 offen
    buffer_load_dword v7, v2, s[48:51], s68 offen
    s_add_u32 s68, s68, 0x40000
    s_waitcnt vmcnt(2)
    buffer_load_dword v4, v2, s[44:47], s68 offen
    buffer_load_dword v5, v2, s[48:51], s68 offen
    s_add_u32 s68, s68, 0x40000
    s_waitcnt vmcnt(2)
    buffer_load_dword v6, v2, s[44:47], s68 offen
    buffer_load_dword v7, v2, s[48:51], s68 offen
    s_add_u32 s68, s68, 0x40000
    s_waitcnt vmcnt(2)
    buffer_load_dword v4, v2, s[44:47], s68 offen
    buffer_load_dword v5, v2, s[48:51], s68 offen
    s_add_u32 s68, s68, 0x40000
    s_waitcnt vmcnt(2)
    buffer_load_dword v6, v2, s[44:47], s68 offen
    buffer_load_dword v7, v2, s[48:51], s68 offen
    s_add_u32 s68, s68, 0x40000
    s_waitcnt vmcnt(2)
    buffer_load_dword v4, v2, s[44:47], s68 offen
    buffer_load_dword v5, v2, s[48:51], s68 offen
    s_add_u32 s68, s68, 0x40000
    s_waitcnt vmcnt(2)
    buffer_load_dword v6, v2, s[44:47], s68 offen
    buffer_load_dword v7, v2, s[48:51], s68 offen
    s_add_u32 s68, s68, 0x40000
    s_waitcnt vmcnt(2)
    buffer_load_dword v4, v2, s[44:47], s68 offen
    buffer_load_dword v5, v2, s[48:51], s68 offen
    s_add_u32 s68, s68, 0x40000
    s_waitcnt vmcnt(2)
    buffer_load_dword v6, v2, s[44:47], s68 offen
    buffer_load_dword v7, v2, s[48:51], s68 offen
    s_add_u32 s68, s68, 0x40000
    s_waitcnt vmcnt(2)
    buffer_load_dword v4, v2, s[44:47], s68 offen
    buffer_load_dword v5, v2, s[48:51], s68 offen
    s_add_u32 s68, s68, 0x40000
    s_waitcnt vmcnt(2)
    buffer_load_dword v6, v2, s[44:47], s68 offen
    buffer_load_dword v7, v2, s[48:51], s68 offen
    s_add_u32 s68, s68, 0x40000
    s_waitcnt vmcnt(2)
    buffer_load_dword v4, v2, s[44:47], s68 offen
    buffer_load_dword v5, v2, s[48:51], s68 offen
    s_add_u32 s68, s68, 0x40000
    s_waitcnt vmcnt(2)
    buffer_load_dword v6, v2, s[44:47], s68 offen
    buffer_load_dword v7, v2, s[48:51], s68 offen
    s_add_u32 s68, s68, 0x40000
    s_waitcnt vmcnt(2)
    s_waitcnt vmcnt(0)
    s_mov_b32 s88, 0
    v_mov_b32 v246, 72
L_rdy_24:
    s_add_u32 s88, s88, 1
    s_mov_b32 s89, 10
    s_cmp_ge_u32 s88, 262144
    s_cbranch_scc1 L_abort
    buffer_load_dword v247, v246, s[36:39], 0 offen sc1
    s_mul_i32 s89, s2, 34
    s_add_u32 s89, s89, 136
    s_waitcnt vmcnt(0)
    v_cmp_gt_u32 vcc, s89, v247
    s_cbranch_vccnz L_rdy_24
L_p1done:
    s_sub_u32 s77, s31, 128
    s_and_b32 s53, s77, 31
    s_lshr_b32 s54, s77, 5
    s_lshl_b32 s54, s54, 2
    s_add_u32 s54, s54, s30
    v_bfe_i32 v240, v1, 0, 1
    v_bfe_i32 v241, v1, 1, 1
    v_bfe_i32 v242, v1, 2, 1
    v_bfe_i32 v243, v1, 3, 1
    v_bfe_i32 v244, v1, 4, 1
    v_bfe_i32 v245, v1, 5, 1
    v_mov_b32 v2, 0x0
    v_and_b32 v246, 0x10, v240
    v_xor_b32 v2, v2, v246
    v_and_b32 v246, 0x20, v241
    v_xor_b32 v2, v2, v246
    v_and_b32 v246, 0x40, v242
    v_xor_b32 v2, v2, v246
    v_and_b32 v246, 0x80, v243
    v_xor_b32 v2, v2, v246
    v_and_b32 v246, 0x100, v244
    v_xor_b32 v2, v2, v246
    v_and_b32 v246, 0x200, v245
    v_xor_b32 v2, v2, v246
    v_mov_b32 v4, 0x4444
    s_mov_b32 s86, 0xaaaaaaaa
    s_mov_b32 s87, 0xaaaaaaaa
    v_mov_b32 v246, 0xeeee
    v_cndmask_b32 v4, v4, v246, s[86:87]
    v_mov_b32 v5, 0x0
    s_mov_b32 s86, 0x33
    s_mov_b32 s87, 0x33
    v_mov_b32 v246, 0x3f803f80
    v_cndmask_b32 v5, v5, v246, s[86:87]
    v_accvgpr_write_b32 a112, v5
    v_accvgpr_write_b32 a113, v5
    v_accvgpr_write_b32 a114, v5
    v_accvgpr_write_b32 a115, v5
    v_mov_b32 v5, 0x0
    s_mov_b32 s86, 0xcc
    s_mov_b32 s87, 0xcc
    v_mov_b32 v246, 0x3f803f80
    v_cndmask_b32 v5, v5, v246, s[86:87]
    v_accvgpr_write_b32 a116, v5
    v_accvgpr_write_b32 a117, v5
    v_accvgpr_write_b32 a118, v5
    v_accvgpr_write_b32 a119, v5
    v_mov_b32 v5, 0x0
    s_mov_b32 s86, 0x3300
    s_mov_b32 s87, 0x3300
    v_mov_b32 v246, 0x3f803f80
    v_cndmask_b32 v5, v5, v246, s[86:87]
    v_accvgpr_write_b32 a120, v5
    v_accvgpr_write_b32 a121, v5
    v_accvgpr_write_b32 a122, v5
    v_accvgpr_write_b32 a123, v5
    v_mov_b32 v5, 0x0
    s_mov_b32 s86, 0xcc00
    s_mov_b32 s87, 0xcc00
    v_mov_b32 v246, 0x3f803f80
    v_cndmask_b32 v5, v5, v246, s[86:87]
    v_accvgpr_write_b32 a124, v5
    v_accvgpr_write_b32 a125, v5
    v_accvgpr_write_b32 a126, v5
    v_accvgpr_write_b32 a127, v5
    v_accvgpr_write_b32 a0, 0
    v_accvgpr_write_b32 a1, 0
    v_accvgpr_write_b32 a2, 0
    v_accvgpr_write_b32 a3, 0
    v_accvgpr_write_b32 a4, 0
    v_accvgpr_write_b32 a5, 0
    v_accvgpr_write_b32 a6, 0
    v_accvgpr_write_b32 a7, 0
    v_accvgpr_write_b32 a8, 0
    v_accvgpr_write_b32 a9, 0
    v_accvgpr_write_b32 a10, 0
    v_accvgpr_write_b32 a11, 0
    v_accvgpr_write_b32 a12, 0
    v_accvgpr_write_b32 a13, 0
    v_accvgpr_write_b32 a14, 0
    v_accvgpr_write_b32 a15, 0
    v_accvgpr_write_b32 a16, 0
    v_accvgpr_write_b32 a17, 0
    v_accvgpr_write_b32 a18, 0
    v_accvgpr_write_b32 a19, 0
    v_accvgpr_write_b32 a20, 0
    v_accvgpr_write_b32 a21, 0
    v_accvgpr_write_b32 a22, 0
    v_accvgpr_write_b32 a23, 0
    v_accvgpr_write_b32 a24, 0
    v_accvgpr_write_b32 a25, 0
    v_accvgpr_write_b32 a26, 0
    v_accvgpr_write_b32 a27, 0
    v_accvgpr_write_b32 a28, 0
    v_accvgpr_write_b32 a29, 0
    v_accvgpr_write_b32 a30, 0
    v_accvgpr_write_b32 a31, 0
    v_accvgpr_write_b32 a32, 0
    v_accvgpr_write_b32 a33, 0
    v_accvgpr_write_b32 a34, 0
    v_accvgpr_write_b32 a35, 0
    v_accvgpr_write_b32 a36, 0
    v_accvgpr_write_b32 a37, 0
    v_accvgpr_write_b32 a38, 0
    v_accvgpr_write_b32 a39, 0
    v_accvgpr_write_b32 a40, 0
    v_accvgpr_write_b32 a41, 0
    v_accvgpr_write_b32 a42, 0
    v_accvgpr_write_b32 a43, 0
    v_accvgpr_write_b32 a44, 0
    v_accvgpr_write_b32 a45, 0
    v_accvgpr_write_b32 a46, 0
    v_accvgpr_write_b32 a47, 0
    v_accvgpr_write_b32 a48, 0
    v_accvgpr_write_b32 a49, 0
    v_accvgpr_write_b32 a50, 0
    v_accvgpr_write_b32 a51, 0
    v_accvgpr_write_b32 a52, 0
    v_accvgpr_write_b32 a53, 0
    v_accvgpr_write_b32 a54, 0
    v_accvgpr_write_b32 a55, 0
    v_accvgpr_write_b32 a56, 0
    v_accvgpr_write_b32 a57, 0
    v_accvgpr_write_b32 a58, 0
    v_accvgpr_write_b32 a59, 0
    v_accvgpr_write_b32 a60, 0
    v_accvgpr_write_b32 a61, 0
    v_accvgpr_write_b32 a62, 0
    v_accvgpr_write_b32 a63, 0
    v_accvgpr_write_b32 a64, 0
    v_accvgpr_write_b32 a65, 0
    v_accvgpr_write_b32 a66, 0
    v_accvgpr_write_b32 a67, 0
    v_accvgpr_write_b32 a68, 0
    v_accvgpr_write_b32 a69, 0
    v_accvgpr_write_b32 a70, 0
    v_accvgpr_write_b32 a71, 0
    v_accvgpr_write_b32 a72, 0
    v_accvgpr_write_b32 a73, 0
    v_accvgpr_write_b32 a74, 0
    v_accvgpr_write_b32 a75, 0
    v_accvgpr_write_b32 a76, 0
    v_accvgpr_write_b32 a77, 0
    v_accvgpr_write_b32 a78, 0
    v_accvgpr_write_b32 a79, 0
    v_accvgpr_write_b32 a184, 0
    v_accvgpr_write_b32 a185, 0
    v_accvgpr_write_b32 a186, 0
    v_accvgpr_write_b32 a187, 0
    v_accvgpr_write_b32 a188, 0
    v_accvgpr_write_b32 a189, 0
    v_accvgpr_write_b32 a190, 0
    v_accvgpr_write_b32 a191, 0
    s_lshl_b32 s58, s53, 4
    v_mov_b32 v3, 0x1000
    v_and_b32 v246, 0x4, v240
    v_xor_b32 v3, v3, v246
    v_and_b32 v246, 0x8, v241
    v_xor_b32 v3, v3, v246
    v_add_u32 v3, s58, v3
    s_mov_b32 s86, 0x77777777
    s_mov_b32 s87, 0x77777777
    v_add_u32 v5, -4, v3
    v_cndmask_b32 v3, v5, v3, s[86:87]
    s_mov_b32 s88, 0
L_wf_25:
    s_add_u32 s88, s88, 1
    s_mov_b32 s89, 12
    s_cmp_ge_u32 s88, 262144
    s_cbranch_scc1 L_abort
    buffer_load_dword v247, v3, s[32:35], 0 offen sc1
    s_waitcnt vmcnt(0)
    v_cmp_gt_u32 vcc, 64, v247
    s_cbranch_vccnz L_wf_25
    s_lshl_b32 s68, s77, 2
    s_add_u32 s68, s68, s30
    s_cmp_lg_u32 s68, 124
    s_cbranch_scc1 L_t5_nodec
    s_add_u32 s68, s94, s95
    s_add_u32 s68, s68, 1245184
    v_mov_b32 v6, s68
    buffer_load_dword v7, v6, s[32:35], 0 offen sc1
    s_waitcnt vmcnt(0)
    v_readfirstlane_b32 s68, v7
    s_cmp_lt_u32 s68, 36
    s_cselect_b32 s69, 2, 1
    s_cmp_lt_u32 s68, 33
    s_cselect_b32 s68, 3, s69
    s_or_b32 s68, s68, s2
    v_mov_b32 v7, s68
    v_mov_b32 v6, 0x7fff0000
    v_mov_b32 v8, 144
    v_cmp_eq_u32 vcc, 0, v1
    s_nop 1
    v_cndmask_b32 v6, v6, v8, vcc
    buffer_store_dword v7, v6, s[36:39], 0 offen sc1
L_t5_nodec:
    s_lshl_b32 s58, s53, 17
    s_add_u32 s61, s58, 8388608
    s_add_u32 s62, s58, 12582912
    s_lshl_b32 s59, s54, 13
    s_add_u32 s58, s58, s59
    s_add_u32 s58, s58, 4194304
    buffer_load_dwordx4 a[80:83], v2, s[32:35], s58 offen offset:0
    buffer_load_dwordx4 a[84:87], v2, s[32:35], s58 offen offset:1024
    buffer_load_dwordx4 a[88:91], v2, s[32:35], s58 offen offset:2048
    buffer_load_dwordx4 a[92:95], v2, s[32:35], s58 offen offset:3072
    s_add_u32 s58, s58, 4096
    buffer_load_dwordx4 a[96:99], v2, s[32:35], s58 offen offset:0
    buffer_load_dwordx4 a[100:103], v2, s[32:35], s58 offen offset:1024
    buffer_load_dwordx4 a[104:107], v2, s[32:35], s58 offen offset:2048
    buffer_load_dwordx4 a[108:111], v2, s[32:35], s58 offen offset:3072
    s_mov_b32 s55, s61
    s_mov_b32 s56, s62
    buffer_load_dwordx4 a[128:131], v2, s[32:35], s55 offen offset:0
    buffer_load_dwordx4 a[132:135], v2, s[32:35], s55 offen offset:1024
    buffer_load_dwordx4 a[136:139], v2, s[32:35], s55 offen offset:2048
    buffer_load_dwordx4 a[140:143], v2, s[32:35], s55 offen offset:3072
    buffer_load_dwordx4 a[160:163], v2, s[32:35], s56 offen offset:0
    buffer_load_dwordx4 a[164:167], v2, s[32:35], s56 offen offset:1024
    buffer_load_dwordx4 a[168:171], v2, s[32:35], s56 offen offset:2048
    buffer_load_dwordx4 a[172:175], v2, s[32:35], s56 offen offset:3072
    s_add_u32 s55, s55, 4096
    s_add_u32 s56, s56, 4096
    s_lshl_b32 s59, s54, 18
    s_lshl_b32 s58, s53, 11
    s_add_u32 s59, s59, s58
    s_add_u32 s59, s59, 16777216
    s_waitcnt vmcnt(0)
    v_mfma_f32_32x32x16_bf16 v[80:95], a[128:131], a[80:83], 0
    v_mfma_f32_32x32x16_bf16 v[80:95], a[132:135], a[84:87], v[80:95]
    s_nop 11
    v_max3_f32 v5, v80, v81, v82
    v_max3_f32 v5, v5, v83, v84
    v_max3_f32 v5, v5, v85, v86
    v_max3_f32 v5, v5, v87, v88
    v_max3_f32 v5, v5, v89, v90
    v_max3_f32 v5, v5, v91, v92
    v_max3_f32 v5, v5, v93, v94
    v_max_f32 v5, v5, v95
    v_mov_b32 v6, v5
    s_nop 1
    v_permlane32_swap_b32 v5, v6
    v_max_f32 v5, v5, v6
    v_sub_f32 v16, 0, v5
    v_sub_f32 v17, 0, v5
    v_sub_f32 v18, 0, v5
    v_sub_f32 v19, 0, v5
    v_sub_f32 v20, 0, v5
    v_sub_f32 v21, 0, v5
    v_sub_f32 v22, 0, v5
    v_sub_f32 v23, 0, v5
    v_sub_f32 v24, 0, v5
    v_sub_f32 v25, 0, v5
    v_sub_f32 v26, 0, v5
    v_sub_f32 v27, 0, v5
    v_sub_f32 v28, 0, v5
    v_sub_f32 v29, 0, v5
    v_sub_f32 v30, 0, v5
    v_sub_f32 v31, 0, v5
    v_mfma_f32_32x32x16_bf16 v[96:111], a[128:131], a[88:91], 0
    v_mfma_f32_32x32x16_bf16 v[96:111], a[132:135], a[92:95], v[96:111]
    s_nop 11
    v_max3_f32 v5, v96, v97, v98
    v_max3_f32 v5, v5, v99, v100
    v_max3_f32 v5, v5, v101, v102
    v_max3_f32 v5, v5, v103, v104
    v_max3_f32 v5, v5, v105, v106
    v_max3_f32 v5, v5, v107, v108
    v_max3_f32 v5, v5, v109, v110
    v_max_f32 v5, v5, v111
    v_mov_b32 v6, v5
    s_nop 1
    v_permlane32_swap_b32 v5, v6
    v_max_f32 v5, v5, v6
    v_sub_f32 v32, 0, v5
    v_sub_f32 v33, 0, v5
    v_sub_f32 v34, 0, v5
    v_sub_f32 v35, 0, v5
    v_sub_f32 v36, 0, v5
    v_sub_f32 v37, 0, v5
    v_sub_f32 v38, 0, v5
    v_sub_f32 v39, 0, v5
    v_sub_f32 v40, 0, v5
    v_sub_f32 v41, 0, v5
    v_sub_f32 v42, 0, v5
    v_sub_f32 v43, 0, v5
    v_sub_f32 v44, 0, v5
    v_sub_f32 v45, 0, v5
    v_sub_f32 v46, 0, v5
    v_sub_f32 v47, 0, v5
    v_mfma_f32_32x32x16_bf16 v[80:95], a[128:131], a[96:99], 0
    v_mfma_f32_32x32x16_bf16 v[80:95], a[132:135], a[100:103], v[80:95]
    s_nop 11
    v_max3_f32 v5, v80, v81, v82
    v_max3_f32 v5, v5, v83, v84
    v_max3_f32 v5, v5, v85, v86
    v_max3_f32 v5, v5, v87, v88
    v_max3_f32 v5, v5, v89, v90
    v_max3_f32 v5, v5, v91, v92
    v_max3_f32 v5, v5, v93, v94
    v_max_f32 v5, v5, v95
    v_mov_b32 v6, v5
    s_nop 1
    v_permlane32_swap_b32 v5, v6
    v_max_f32 v5, v5, v6
    v_sub_f32 v48, 0, v5
    v_sub_f32 v49, 0, v5
    v_sub_f32 v50, 0, v5
    v_sub_f32 v51, 0, v5
    v_sub_f32 v52, 0, v5
    v_sub_f32 v53, 0, v5
    v_sub_f32 v54, 0, v5
    v_sub_f32 v55, 0, v5
    v_sub_f32 v56, 0, v5
    v_sub_f32 v57, 0, v5
    v_sub_f32 v58, 0, v5
    v_sub_f32 v59, 0, v5
    v_sub_f32 v60, 0, v5
    v_sub_f32 v61, 0, v5
    v_sub_f32 v62, 0, v5
    v_sub_f32 v63, 0, v5
    v_mfma_f32_32x32x16_bf16 v[96:111], a[128:131], a[104:107], 0
    v_mfma_f32_32x32x16_bf16 v[96:111], a[132:135], a[108:111], v[96:111]
    s_nop 11
    v_max3_f32 v5, v96, v97, v98
    v_max3_f32 v5, v5, v99, v100
    v_max3_f32 v5, v5, v101, v102
    v_max3_f32 v5, v5, v103, v104
    v_max3_f32 v5, v5, v105, v106
    v_max3_f32 v5, v5, v107, v108
    v_max3_f32 v5, v5, v109, v110
    v_max_f32 v5, v5, v111
    v_mov_b32 v6, v5
    s_nop 1
    v_permlane32_swap_b32 v5, v6
    v_max_f32 v5, v5, v6
    v_sub_f32 v64, 0, v5
    v_sub_f32 v65, 0, v5
    v_sub_f32 v66, 0, v5
    v_sub_f32 v67, 0, v5
    v_sub_f32 v68, 0, v5
    v_sub_f32 v69, 0, v5
    v_sub_f32 v70, 0, v5
    v_sub_f32 v71, 0, v5
    v_sub_f32 v72, 0, v5
    v_sub_f32 v73, 0, v5
    v_sub_f32 v74, 0, v5
    v_sub_f32 v75, 0, v5
    v_sub_f32 v76, 0, v5
    v_sub_f32 v77, 0, v5
    v_sub_f32 v78, 0, v5
    v_sub_f32 v79, 0, v5
    v_mfma_f32_32x32x16_bf16 v[80:95], a[128:131], a[80:83], v[16:31]
    v_mfma_f32_32x32x16_bf16 v[80:95], a[132:135], a[84:87], v[80:95]
    v_mov_b32 v120, 0
    v_mov_b32 v121, 0
    v_mov_b32 v122, 0
    v_mov_b32 v123, 0
    v_mov_b32 v124, 0
    v_mov_b32 v125, 0
    v_mov_b32 v126, 0
    v_mov_b32 v127, 0
    s_mov_b32 s57, 0
    v_mov_b32 v13, 144
L_t4:
    v_mfma_f32_32x32x16_bf16 v[96:111], a[128:131], a[88:91], v[32:47]
    s_nop 0
    v_exp_f32 v80, v80
    v_exp_f32 v81, v81
    v_exp_f32 v82, v82
    buffer_load_dwordx4 a[144:147], v2, s[32:35], s55 offen offset:0
    v_mfma_f32_32x32x16_bf16 v[96:111], a[132:135], a[92:95], v[96:111]
    v_exp_f32 v83, v83
    v_exp_f32 v84, v84
    v_exp_f32 v85, v85
    v_cvt_pk_bf16_f32 v112, v80, v81
    buffer_load_dwordx4 a[148:151], v2, s[32:35], s55 offen offset:1024
    s_add_u32 s55, s55, 2048
    v_mfma_f32_32x32x16_bf16 a[48:63], a[184:187], v[120:123], a[48:63]
    v_exp_f32 v86, v86
    v_exp_f32 v87, v87
    v_cvt_pk_bf16_f32 v113, v82, v83
    v_exp_f32 v88, v88
    v_cvt_pk_bf16_f32 v114, v84, v85
    v_mfma_f32_32x32x16_bf16 a[48:63], a[188:191], v[124:127], a[48:63]
    v_exp_f32 v89, v89
    v_exp_f32 v90, v90
    v_cvt_pk_bf16_f32 v115, v86, v87
    v_exp_f32 v91, v91
    v_cvt_pk_bf16_f32 v116, v88, v89
    buffer_load_dword v12, v13, s[36:39], 0 offen sc1
    v_smfmac_f32_32x32x32_bf16 a[64:79], a[124:127], v[120:127], v4
    v_exp_f32 v92, v92
    v_exp_f32 v93, v93
    v_cvt_pk_bf16_f32 v117, v90, v91
    v_exp_f32 v94, v94
    v_exp_f32 v95, v95
    v_cvt_pk_bf16_f32 v118, v92, v93
    v_cvt_pk_bf16_f32 v119, v94, v95
    s_waitcnt vmcnt(6)
    v_mfma_f32_32x32x16_bf16 v[80:95], a[128:131], a[96:99], v[48:63]
    v_exp_f32 v96, v96
    v_exp_f32 v97, v97
    v_exp_f32 v98, v98
    buffer_load_dwordx4 a[176:179], v2, s[32:35], s56 offen offset:0
    v_mfma_f32_32x32x16_bf16 v[80:95], a[132:135], a[100:103], v[80:95]
    v_exp_f32 v99, v99
    v_exp_f32 v100, v100
    v_exp_f32 v101, v101
    v_cvt_pk_bf16_f32 v120, v96, v97
    buffer_load_dwordx4 a[180:183], v2, s[32:35], s56 offen offset:1024
    s_add_u32 s56, s56, 2048
    v_mfma_f32_32x32x16_bf16 a[0:15], a[160:163], v[112:115], a[0:15]
    v_exp_f32 v102, v102
    v_exp_f32 v103, v103
    v_cvt_pk_bf16_f32 v121, v98, v99
    v_exp_f32 v104, v104
    v_cvt_pk_bf16_f32 v122, v100, v101
    v_mfma_f32_32x32x16_bf16 a[0:15], a[164:167], v[116:119], a[0:15]
    v_exp_f32 v105, v105
    v_exp_f32 v106, v106
    v_cvt_pk_bf16_f32 v123, v102, v103
    v_exp_f32 v107, v107
    v_cvt_pk_bf16_f32 v124, v104, v105
    v_smfmac_f32_32x32x32_bf16 a[64:79], a[112:115], v[112:119], v4
    v_exp_f32 v108, v108
    v_exp_f32 v109, v109
    v_cvt_pk_bf16_f32 v125, v106, v107
    v_exp_f32 v110, v110
    v_exp_f32 v111, v111
    v_cvt_pk_bf16_f32 v126, v108, v109
    v_cvt_pk_bf16_f32 v127, v110, v111
    v_mfma_f32_32x32x16_bf16 v[96:111], a[128:131], a[104:107], v[64:79]
    v_exp_f32 v80, v80
    v_exp_f32 v81, v81
    v_exp_f32 v82, v82
    v_mfma_f32_32x32x16_bf16 v[96:111], a[132:135], a[108:111], v[96:111]
    v_exp_f32 v83, v83
    v_exp_f32 v84, v84
    v_exp_f32 v85, v85
    v_cvt_pk_bf16_f32 v112, v80, v81
    v_mfma_f32_32x32x16_bf16 a[16:31], a[160:163], v[120:123], a[16:31]
    v_exp_f32 v86, v86
    v_exp_f32 v87, v87
    v_cvt_pk_bf16_f32 v113, v82, v83
    v_exp_f32 v88, v88
    v_cvt_pk_bf16_f32 v114, v84, v85
    v_mfma_f32_32x32x16_bf16 a[16:31], a[164:167], v[124:127], a[16:31]
    v_exp_f32 v89, v89
    v_exp_f32 v90, v90
    v_cvt_pk_bf16_f32 v115, v86, v87
    v_exp_f32 v91, v91
    v_cvt_pk_bf16_f32 v116, v88, v89
    v_smfmac_f32_32x32x32_bf16 a[64:79], a[116:119], v[120:127], v4
    v_exp_f32 v92, v92
    v_exp_f32 v93, v93
    v_cvt_pk_bf16_f32 v117, v90, v91
    v_exp_f32 v94, v94
    v_exp_f32 v95, v95
    v_cvt_pk_bf16_f32 v118, v92, v93
    v_cvt_pk_bf16_f32 v119, v94, v95
    s_waitcnt vmcnt(6)
    v_mfma_f32_32x32x16_bf16 v[80:95], a[136:139], a[80:83], v[16:31]
    v_exp_f32 v96, v96
    v_exp_f32 v97, v97
    v_exp_f32 v98, v98
    v_mfma_f32_32x32x16_bf16 v[80:95], a[140:143], a[84:87], v[80:95]
    v_exp_f32 v99, v99
    v_exp_f32 v100, v100
    v_exp_f32 v101, v101
    v_cvt_pk_bf16_f32 v120, v96, v97
    v_mfma_f32_32x32x16_bf16 a[32:47], a[160:163], v[112:115], a[32:47]
    v_exp_f32 v102, v102
    v_exp_f32 v103, v103
    v_cvt_pk_bf16_f32 v121, v98, v99
    v_exp_f32 v104, v104
    v_cvt_pk_bf16_f32 v122, v100, v101
    v_mfma_f32_32x32x16_bf16 a[32:47], a[164:167], v[116:119], a[32:47]
    v_exp_f32 v105, v105
    v_exp_f32 v106, v106
    v_cvt_pk_bf16_f32 v123, v102, v103
    v_exp_f32 v107, v107
    v_cvt_pk_bf16_f32 v124, v104, v105
    v_smfmac_f32_32x32x32_bf16 a[64:79], a[120:123], v[112:119], v4
    v_exp_f32 v108, v108
    v_exp_f32 v109, v109
    v_cvt_pk_bf16_f32 v125, v106, v107
    v_exp_f32 v110, v110
    v_exp_f32 v111, v111
    v_cvt_pk_bf16_f32 v126, v108, v109
    v_cvt_pk_bf16_f32 v127, v110, v111
    v_mfma_f32_32x32x16_bf16 v[96:111], a[136:139], a[88:91], v[32:47]
    v_exp_f32 v80, v80
    v_exp_f32 v81, v81
    v_exp_f32 v82, v82
    buffer_load_dwordx4 a[152:155], v2, s[32:35], s55 offen offset:0
    v_mfma_f32_32x32x16_bf16 v[96:111], a[140:143], a[92:95], v[96:111]
    v_exp_f32 v83, v83
    v_exp_f32 v84, v84
    v_exp_f32 v85, v85
    v_cvt_pk_bf16_f32 v112, v80, v81
    buffer_load_dwordx4 a[156:159], v2, s[32:35], s55 offen offset:1024
    s_add_u32 s55, s55, 2048
    v_mfma_f32_32x32x16_bf16 a[48:63], a[160:163], v[120:123], a[48:63]
    v_exp_f32 v86, v86
    v_exp_f32 v87, v87
    v_cvt_pk_bf16_f32 v113, v82, v83
    v_exp_f32 v88, v88
    v_cvt_pk_bf16_f32 v114, v84, v85
    v_mfma_f32_32x32x16_bf16 a[48:63], a[164:167], v[124:127], a[48:63]
    v_exp_f32 v89, v89
    v_exp_f32 v90, v90
    v_cvt_pk_bf16_f32 v115, v86, v87
    v_exp_f32 v91, v91
    v_cvt_pk_bf16_f32 v116, v88, v89
    v_smfmac_f32_32x32x32_bf16 a[64:79], a[124:127], v[120:127], v4
    v_exp_f32 v92, v92
    v_exp_f32 v93, v93
    v_cvt_pk_bf16_f32 v117, v90, v91
    v_exp_f32 v94, v94
    v_exp_f32 v95, v95
    v_cvt_pk_bf16_f32 v118, v92, v93
    v_cvt_pk_bf16_f32 v119, v94, v95
    s_waitcnt vmcnt(6)
    v_mfma_f32_32x32x16_bf16 v[80:95], a[136:139], a[96:99], v[48:63]
    v_exp_f32 v96, v96
    v_exp_f32 v97, v97
    v_exp_f32 v98, v98
    buffer_load_dwordx4 a[184:187], v2, s[32:35], s56 offen offset:0
    v_mfma_f32_32x32x16_bf16 v[80:95], a[140:143], a[100:103], v[80:95]
    v_exp_f32 v99, v99
    v_exp_f32 v100, v100
    v_exp_f32 v101, v101
    v_cvt_pk_bf16_f32 v120, v96, v97
    buffer_load_dwordx4 a[188:191], v2, s[32:35], s56 offen offset:1024
    s_add_u32 s56, s56, 2048
    v_mfma_f32_32x32x16_bf16 a[0:15], a[168:171], v[112:115], a[0:15]
    v_exp_f32 v102, v102
    v_exp_f32 v103, v103
    v_cvt_pk_bf16_f32 v121, v98, v99
    v_exp_f32 v104, v104
    v_cvt_pk_bf16_f32 v122, v100, v101
    v_mfma_f32_32x32x16_bf16 a[0:15], a[172:175], v[116:119], a[0:15]
    v_exp_f32 v105, v105
    v_exp_f32 v106, v106
    v_cvt_pk_bf16_f32 v123, v102, v103
    v_exp_f32 v107, v107
    v_cvt_pk_bf16_f32 v124, v104, v105
    v_smfmac_f32_32x32x32_bf16 a[64:79], a[112:115], v[112:119], v4
    v_exp_f32 v108, v108
    v_exp_f32 v109, v109
    v_cvt_pk_bf16_f32 v125, v106, v107
    v_exp_f32 v110, v110
    v_exp_f32 v111, v111
    v_cvt_pk_bf16_f32 v126, v108, v109
    v_cvt_pk_bf16_f32 v127, v110, v111
    v_mfma_f32_32x32x16_bf16 v[96:111], a[136:139], a[104:107], v[64:79]
    v_exp_f32 v80, v80
    v_exp_f32 v81, v81
    v_exp_f32 v82, v82
    v_mfma_f32_32x32x16_bf16 v[96:111], a[140:143], a[108:111], v[96:111]
    v_exp_f32 v83, v83
    v_exp_f32 v84, v84
    v_exp_f32 v85, v85
    v_cvt_pk_bf16_f32 v112, v80, v81
    v_mfma_f32_32x32x16_bf16 a[16:31], a[168:171], v[120:123], a[16:31]
    v_exp_f32 v86, v86
    v_exp_f32 v87, v87
    v_cvt_pk_bf16_f32 v113, v82, v83
    v_exp_f32 v88, v88
    v_cvt_pk_bf16_f32 v114, v84, v85
    v_mfma_f32_32x32x16_bf16 a[16:31], a[172:175], v[124:127], a[16:31]
    v_exp_f32 v89, v89
    v_exp_f32 v90, v90
    v_cvt_pk_bf16_f32 v115, v86, v87
    v_exp_f32 v91, v91
    v_cvt_pk_bf16_f32 v116, v88, v89
    v_smfmac_f32_32x32x32_bf16 a[64:79], a[116:119], v[120:127], v4
    v_exp_f32 v92, v92
    v_exp_f32 v93, v93
    v_cvt_pk_bf16_f32 v117, v90, v91
    v_exp_f32 v94, v94
    v_exp_f32 v95, v95
    v_cvt_pk_bf16_f32 v118, v92, v93
    v_cvt_pk_bf16_f32 v119, v94, v95
    s_waitcnt vmcnt(6)
    v_mfma_f32_32x32x16_bf16 v[80:95], a[144:147], a[80:83], v[16:31]
    v_exp_f32 v96, v96
    v_exp_f32 v97, v97
    v_exp_f32 v98, v98
    v_mfma_f32_32x32x16_bf16 v[80:95], a[148:151], a[84:87], v[80:95]
    v_exp_f32 v99, v99
    v_exp_f32 v100, v100
    v_exp_f32 v101, v101
    v_cvt_pk_bf16_f32 v120, v96, v97
    v_mfma_f32_32x32x16_bf16 a[32:47], a[168:171], v[112:115], a[32:47]
    v_exp_f32 v102, v102
    v_exp_f32 v103, v103
    v_cvt_pk_bf16_f32 v121, v98, v99
    v_exp_f32 v104, v104
    v_cvt_pk_bf16_f32 v122, v100, v101
    v_mfma_f32_32x32x16_bf16 a[32:47], a[172:175], v[116:119], a[32:47]
    v_exp_f32 v105, v105
    v_exp_f32 v106, v106
    v_cvt_pk_bf16_f32 v123, v102, v103
    v_exp_f32 v107, v107
    v_cvt_pk_bf16_f32 v124, v104, v105
    v_smfmac_f32_32x32x32_bf16 a[64:79], a[120:123], v[112:119], v4
    v_exp_f32 v108, v108
    v_exp_f32 v109, v109
    v_cvt_pk_bf16_f32 v125, v106, v107
    v_exp_f32 v110, v110
    v_exp_f32 v111, v111
    v_cvt_pk_bf16_f32 v126, v108, v109
    v_cvt_pk_bf16_f32 v127, v110, v111
    v_mfma_f32_32x32x16_bf16 v[96:111], a[144:147], a[88:91], v[32:47]
    v_exp_f32 v80, v80
    v_exp_f32 v81, v81
    v_exp_f32 v82, v82
    buffer_load_dwordx4 a[128:131], v2, s[32:35], s55 offen offset:0
    v_mfma_f32_32x32x16_bf16 v[96:111], a[148:151], a[92:95], v[96:111]
    v_exp_f32 v83, v83
    v_exp_f32 v84, v84
    v_exp_f32 v85, v85
    v_cvt_pk_bf16_f32 v112, v80, v81
    buffer_load_dwordx4 a[132:135], v2, s[32:35], s55 offen offset:1024
    s_add_u32 s55, s55, 2048
    v_mfma_f32_32x32x16_bf16 a[48:63], a[168:171], v[120:123], a[48:63]
    v_exp_f32 v86, v86
    v_exp_f32 v87, v87
    v_cvt_pk_bf16_f32 v113, v82, v83
    v_exp_f32 v88, v88
    v_cvt_pk_bf16_f32 v114, v84, v85
    v_mfma_f32_32x32x16_bf16 a[48:63], a[172:175], v[124:127], a[48:63]
    v_exp_f32 v89, v89
    v_exp_f32 v90, v90
    v_cvt_pk_bf16_f32 v115, v86, v87
    v_exp_f32 v91, v91
    v_cvt_pk_bf16_f32 v116, v88, v89
    v_smfmac_f32_32x32x32_bf16 a[64:79], a[124:127], v[120:127], v4
    v_exp_f32 v92, v92
    v_exp_f32 v93, v93
    v_cvt_pk_bf16_f32 v117, v90, v91
    v_exp_f32 v94, v94
    v_exp_f32 v95, v95
    v_cvt_pk_bf16_f32 v118, v92, v93
    v_cvt_pk_bf16_f32 v119, v94, v95
    s_waitcnt vmcnt(6)
    v_mfma_f32_32x32x16_bf16 v[80:95], a[144:147], a[96:99], v[48:63]
    v_exp_f32 v96, v96
    v_exp_f32 v97, v97
    v_exp_f32 v98, v98
    buffer_load_dwordx4 a[160:163], v2, s[32:35], s56 offen offset:0
    v_mfma_f32_32x32x16_bf16 v[80:95], a[148:151], a[100:103], v[80:95]
    v_exp_f32 v99, v99
    v_exp_f32 v100, v100
    v_exp_f32 v101, v101
    v_cvt_pk_bf16_f32 v120, v96, v97
    buffer_load_dwordx4 a[164:167], v2, s[32:35], s56 offen offset:1024
    s_add_u32 s56, s56, 2048
    v_mfma_f32_32x32x16_bf16 a[0:15], a[176:179], v[112:115], a[0:15]
    v_exp_f32 v102, v102
    v_exp_f32 v103, v103
    v_cvt_pk_bf16_f32 v121, v98, v99
    v_exp_f32 v104, v104
    v_cvt_pk_bf16_f32 v122, v100, v101
    v_mfma_f32_32x32x16_bf16 a[0:15], a[180:183], v[116:119], a[0:15]
    v_exp_f32 v105, v105
    v_exp_f32 v106, v106
    v_cvt_pk_bf16_f32 v123, v102, v103
    v_exp_f32 v107, v107
    v_cvt_pk_bf16_f32 v124, v104, v105
    v_smfmac_f32_32x32x32_bf16 a[64:79], a[112:115], v[112:119], v4
    v_exp_f32 v108, v108
    v_exp_f32 v109, v109
    v_cvt_pk_bf16_f32 v125, v106, v107
    v_exp_f32 v110, v110
    v_exp_f32 v111, v111
    v_cvt_pk_bf16_f32 v126, v108, v109
    v_cvt_pk_bf16_f32 v127, v110, v111
    v_mfma_f32_32x32x16_bf16 v[96:111], a[144:147], a[104:107], v[64:79]
    v_exp_f32 v80, v80
    v_exp_f32 v81, v81
    v_exp_f32 v82, v82
    v_mfma_f32_32x32x16_bf16 v[96:111], a[148:151], a[108:111], v[96:111]
    v_exp_f32 v83, v83
    v_exp_f32 v84, v84
    v_exp_f32 v85, v85
    v_cvt_pk_bf16_f32 v112, v80, v81
    v_mfma_f32_32x32x16_bf16 a[16:31], a[176:179], v[120:123], a[16:31]
    v_exp_f32 v86, v86
    v_exp_f32 v87, v87
    v_cvt_pk_bf16_f32 v113, v82, v83
    v_exp_f32 v88, v88
    v_cvt_pk_bf16_f32 v114, v84, v85
    v_mfma_f32_32x32x16_bf16 a[16:31], a[180:183], v[124:127], a[16:31]
    v_exp_f32 v89, v89
    v_exp_f32 v90, v90
    v_cvt_pk_bf16_f32 v115, v86, v87
    v_exp_f32 v91, v91
    v_cvt_pk_bf16_f32 v116, v88, v89
    v_smfmac_f32_32x32x32_bf16 a[64:79], a[116:119], v[120:127], v4
    v_exp_f32 v92, v92
    v_exp_f32 v93, v93
    v_cvt_pk_bf16_f32 v117, v90, v91
    v_exp_f32 v94, v94
    v_exp_f32 v95, v95
    v_cvt_pk_bf16_f32 v118, v92, v93
    v_cvt_pk_bf16_f32 v119, v94, v95
    s_waitcnt vmcnt(6)
    v_mfma_f32_32x32x16_bf16 v[80:95], a[152:155], a[80:83], v[16:31]
    v_exp_f32 v96, v96
    v_exp_f32 v97, v97
    v_exp_f32 v98, v98
    v_mfma_f32_32x32x16_bf16 v[80:95], a[156:159], a[84:87], v[80:95]
    v_exp_f32 v99, v99
    v_exp_f32 v100, v100
    v_exp_f32 v101, v101
    v_cvt_pk_bf16_f32 v120, v96, v97
    v_mfma_f32_32x32x16_bf16 a[32:47], a[176:179], v[112:115], a[32:47]
    v_exp_f32 v102, v102
    v_exp_f32 v103, v103
    v_cvt_pk_bf16_f32 v121, v98, v99
    v_exp_f32 v104, v104
    v_cvt_pk_bf16_f32 v122, v100, v101
    v_mfma_f32_32x32x16_bf16 a[32:47], a[180:183], v[116:119], a[32:47]
    v_exp_f32 v105, v105
    v_exp_f32 v106, v106
    v_cvt_pk_bf16_f32 v123, v102, v103
    v_exp_f32 v107, v107
    v_cvt_pk_bf16_f32 v124, v104, v105
    v_smfmac_f32_32x32x32_bf16 a[64:79], a[120:123], v[112:119], v4
    v_exp_f32 v108, v108
    v_exp_f32 v109, v109
    v_cvt_pk_bf16_f32 v125, v106, v107
    v_exp_f32 v110, v110
    v_exp_f32 v111, v111
    v_cvt_pk_bf16_f32 v126, v108, v109
    v_cvt_pk_bf16_f32 v127, v110, v111
    v_mfma_f32_32x32x16_bf16 v[96:111], a[152:155], a[88:91], v[32:47]
    v_exp_f32 v80, v80
    v_exp_f32 v81, v81
    v_exp_f32 v82, v82
    buffer_load_dwordx4 a[136:139], v2, s[32:35], s55 offen offset:0
    v_mfma_f32_32x32x16_bf16 v[96:111], a[156:159], a[92:95], v[96:111]
    v_exp_f32 v83, v83
    v_exp_f32 v84, v84
    v_exp_f32 v85, v85
    v_cvt_pk_bf16_f32 v112, v80, v81
    buffer_load_dwordx4 a[140:143], v2, s[32:35], s55 offen offset:1024
    s_add_u32 s55, s55, 2048
    v_mfma_f32_32x32x16_bf16 a[48:63], a[176:179], v[120:123], a[48:63]
    v_exp_f32 v86, v86
    v_exp_f32 v87, v87
    v_cvt_pk_bf16_f32 v113, v82, v83
    v_exp_f32 v88, v88
    v_cvt_pk_bf16_f32 v114, v84, v85
    v_mfma_f32_32x32x16_bf16 a[48:63], a[180:183], v[124:127], a[48:63]
    v_exp_f32 v89, v89
    v_exp_f32 v90, v90
    v_cvt_pk_bf16_f32 v115, v86, v87
    v_exp_f32 v91, v91
    v_cvt_pk_bf16_f32 v116, v88, v89
    v_smfmac_f32_32x32x32_bf16 a[64:79], a[124:127], v[120:127], v4
    v_exp_f32 v92, v92
    v_exp_f32 v93, v93
    v_cvt_pk_bf16_f32 v117, v90, v91
    v_exp_f32 v94, v94
    v_exp_f32 v95, v95
    v_cvt_pk_bf16_f32 v118, v92, v93
    v_cvt_pk_bf16_f32 v119, v94, v95
    s_waitcnt vmcnt(6)
    v_mfma_f32_32x32x16_bf16 v[80:95], a[152:155], a[96:99], v[48:63]
    v_exp_f32 v96, v96
    v_exp_f32 v97, v97
    v_exp_f32 v98, v98
    buffer_load_dwordx4 a[168:171], v2, s[32:35], s56 offen offset:0
    v_mfma_f32_32x32x16_bf16 v[80:95], a[156:159], a[100:103], v[80:95]
    v_exp_f32 v99, v99
    v_exp_f32 v100, v100
    v_exp_f32 v101, v101
    v_cvt_pk_bf16_f32 v120, v96, v97
    buffer_load_dwordx4 a[172:175], v2, s[32:35], s56 offen offset:1024
    s_add_u32 s56, s56, 2048
    v_mfma_f32_32x32x16_bf16 a[0:15], a[184:187], v[112:115], a[0:15]
    v_exp_f32 v102, v102
    v_exp_f32 v103, v103
    v_cvt_pk_bf16_f32 v121, v98, v99
    v_exp_f32 v104, v104
    v_cvt_pk_bf16_f32 v122, v100, v101
    v_mfma_f32_32x32x16_bf16 a[0:15], a[188:191], v[116:119], a[0:15]
    v_exp_f32 v105, v105
    v_exp_f32 v106, v106
    v_cvt_pk_bf16_f32 v123, v102, v103
    v_exp_f32 v107, v107
    v_cvt_pk_bf16_f32 v124, v104, v105
    v_smfmac_f32_32x32x32_bf16 a[64:79], a[112:115], v[112:119], v4
    v_exp_f32 v108, v108
    v_exp_f32 v109, v109
    v_cvt_pk_bf16_f32 v125, v106, v107
    v_exp_f32 v110, v110
    v_exp_f32 v111, v111
    v_cvt_pk_bf16_f32 v126, v108, v109
    v_cvt_pk_bf16_f32 v127, v110, v111
    v_mfma_f32_32x32x16_bf16 v[96:111], a[152:155], a[104:107], v[64:79]
    v_exp_f32 v80, v80
    v_exp_f32 v81, v81
    v_exp_f32 v82, v82
    v_mfma_f32_32x32x16_bf16 v[96:111], a[156:159], a[108:111], v[96:111]
    v_exp_f32 v83, v83
    v_exp_f32 v84, v84
    v_exp_f32 v85, v85
    v_cvt_pk_bf16_f32 v112, v80, v81
    v_mfma_f32_32x32x16_bf16 a[16:31], a[184:187], v[120:123], a[16:31]
    v_exp_f32 v86, v86
    v_exp_f32 v87, v87
    v_cvt_pk_bf16_f32 v113, v82, v83
    v_exp_f32 v88, v88
    v_cvt_pk_bf16_f32 v114, v84, v85
    v_mfma_f32_32x32x16_bf16 a[16:31], a[188:191], v[124:127], a[16:31]
    v_exp_f32 v89, v89
    v_exp_f32 v90, v90
    v_cvt_pk_bf16_f32 v115, v86, v87
    v_exp_f32 v91, v91
    v_cvt_pk_bf16_f32 v116, v88, v89
    v_smfmac_f32_32x32x32_bf16 a[64:79], a[116:119], v[120:127], v4
    v_exp_f32 v92, v92
    v_exp_f32 v93, v93
    v_cvt_pk_bf16_f32 v117, v90, v91
    v_exp_f32 v94, v94
    v_exp_f32 v95, v95
    v_cvt_pk_bf16_f32 v118, v92, v93
    v_cvt_pk_bf16_f32 v119, v94, v95
    s_waitcnt vmcnt(6)
    v_mfma_f32_32x32x16_bf16 v[80:95], a[128:131], a[80:83], v[16:31]
    v_exp_f32 v96, v96
    v_exp_f32 v97, v97
    v_exp_f32 v98, v98
    v_mfma_f32_32x32x16_bf16 v[80:95], a[132:135], a[84:87], v[80:95]
    v_exp_f32 v99, v99
    v_exp_f32 v100, v100
    v_exp_f32 v101, v101
    v_cvt_pk_bf16_f32 v120, v96, v97
    v_mfma_f32_32x32x16_bf16 a[32:47], a[184:187], v[112:115], a[32:47]
    v_exp_f32 v102, v102
    v_exp_f32 v103, v103
    v_cvt_pk_bf16_f32 v121, v98, v99
    v_exp_f32 v104, v104
    v_cvt_pk_bf16_f32 v122, v100, v101
    v_mfma_f32_32x32x16_bf16 a[32:47], a[188:191], v[116:119], a[32:47]
    v_exp_f32 v105, v105
    v_exp_f32 v106, v106
    v_cvt_pk_bf16_f32 v123, v102, v103
    v_exp_f32 v107, v107
    v_cvt_pk_bf16_f32 v124, v104, v105
    v_smfmac_f32_32x32x32_bf16 a[64:79], a[120:123], v[112:119], v4
    v_exp_f32 v108, v108
    v_exp_f32 v109, v109
    v_cvt_pk_bf16_f32 v125, v106, v107
    v_exp_f32 v110, v110
    v_exp_f32 v111, v111
    v_cvt_pk_bf16_f32 v126, v108, v109
    v_cvt_pk_bf16_f32 v127, v110, v111
    s_add_u32 s57, s57, 1
    s_cmp_lt_u32 s57, 15
    s_cbranch_scc1 L_t4
    v_readfirstlane_b32 s75, v12
    s_mov_b32 s99, 0
    s_cmp_le_u32 s75, s2
    s_cbranch_scc1 L_t4_plain
    s_mov_b32 s99, 1
    s_and_b32 s75, s75, 3
    s_cmp_eq_u32 s75, 1
    s_cselect_b32 s70, s20, s8
    s_cselect_b32 s71, s21, s9
    s_cselect_b32 s72, 4, 1
    s_lshl_b32 s72, s72, 21
    s_mov_b32 s44, s70
    s_and_b32 s45, s71, 0xffff
    s_mov_b32 s46, 0x0
    s_mov_b32 s47, 0x00020000
    s_mov_b32 s46, s72
    s_lshr_b32 s73, s77, 5
    s_lshl_b32 s73, s73, 21
    s_cmp_eq_u32 s75, 1
    s_cselect_b32 s73, s73, 0
    s_and_b32 s74, s77, 7
    s_lshl_b32 s74, s74, 8
    s_add_u32 s73, s73, s74
    s_lshl_b32 s74, s30, 16
    s_add_u32 s73, s73, s74
    v_mov_b32 v14, 0x0
    v_and_b32 v246, 0x10, v240
    v_xor_b32 v14, v14, v246
    v_and_b32 v246, 0x20, v241
    v_xor_b32 v14, v14, v246
    v_and_b32 v246, 0x40, v242
    v_xor_b32 v14, v14, v246
    v_and_b32 v246, 0x80, v243
    v_xor_b32 v14, v14, v246
    v_and_b32 v246, 0x840, v244
    v_xor_b32 v14, v14, v246
    v_and_b32 v246, 0x1080, v245
    v_xor_b32 v14, v14, v246
    v_add_u32 v14, s73, v14
    s_lshl_b32 s74, s30, 13
    v_mfma_f32_32x32x16_bf16 v[96:111], a[128:131], a[88:91], v[32:47]
    v_exp_f32 v80, v80
    v_exp_f32 v81, v81
    v_exp_f32 v82, v82
    buffer_load_dwordx4 a[144:147], v2, s[32:35], s55 offen offset:0
    v_mfma_f32_32x32x16_bf16 v[96:111], a[132:135], a[92:95], v[96:111]
    v_exp_f32 v83, v83
    v_exp_f32 v84, v84
    v_exp_f32 v85, v85
    v_cvt_pk_bf16_f32 v112, v80, v81
    buffer_load_dwordx4 a[148:151], v2, s[32:35], s55 offen offset:1024
    s_add_u32 s55, s55, 2048
    v_mfma_f32_32x32x16_bf16 a[48:63], a[184:187], v[120:123], a[48:63]
    v_exp_f32 v86, v86
    v_exp_f32 v87, v87
    v_cvt_pk_bf16_f32 v113, v82, v83
    v_exp_f32 v88, v88
    v_cvt_pk_bf16_f32 v114, v84, v85
    s_add_u32 m0, s74, 0
    s_mov_b32 s73, 0
    buffer_load_dwordx4 v14, s[44:47], s73 offen lds
    v_mfma_f32_32x32x16_bf16 a[48:63], a[188:191], v[124:127], a[48:63]
    v_exp_f32 v89, v89
    v_exp_f32 v90, v90
    v_cvt_pk_bf16_f32 v115, v86, v87
    v_exp_f32 v91, v91
    v_cvt_pk_bf16_f32 v116, v88, v89
    s_add_u32 m0, s74, 1024
    s_mov_b32 s73, 8192
    buffer_load_dwordx4 v14, s[44:47], s73 offen lds
    v_smfmac_f32_32x32x32_bf16 a[64:79], a[124:127], v[120:127], v4
    v_exp_f32 v92, v92
    v_exp_f32 v93, v93
    v_cvt_pk_bf16_f32 v117, v90, v91
    v_exp_f32 v94, v94
    v_exp_f32 v95, v95
    v_cvt_pk_bf16_f32 v118, v92, v93
    v_cvt_pk_bf16_f32 v119, v94, v95
    s_waitcnt vmcnt(8)
    v_mfma_f32_32x32x16_bf16 v[80:95], a[128:131], a[96:99], v[48:63]
    v_exp_f32 v96, v96
    v_exp_f32 v97, v97
    v_exp_f32 v98, v98
    buffer_load_dwordx4 a[176:179], v2, s[32:35], s56 offen offset:0
    v_mfma_f32_32x32x16_bf16 v[80:95], a[132:135], a[100:103], v[80:95]
    v_exp_f32 v99, v99
    v_exp_f32 v100, v100
    v_exp_f32 v101, v101
    v_cvt_pk_bf16_f32 v120, v96, v97
    buffer_load_dwordx4 a[180:183], v2, s[32:35], s56 offen offset:1024
    s_add_u32 s56, s56, 2048
    v_mfma_f32_32x32x16_bf16 a[0:15], a[160:163], v[112:115], a[0:15]
    v_exp_f32 v102, v102
    v_exp_f32 v103, v103
    v_cvt_pk_bf16_f32 v121, v98, v99
    v_exp_f32 v104, v104
    v_cvt_pk_bf16_f32 v122, v100, v101
    s_add_u32 m0, s74, 2048
    s_mov_b32 s73, 16384
    buffer_load_dwordx4 v14, s[44:47], s73 offen lds
    v_mfma_f32_32x32x16_bf16 a[0:15], a[164:167], v[116:119], a[0:15]
    v_exp_f32 v105, v105
    v_exp_f32 v106, v106
    v_cvt_pk_bf16_f32 v123, v102, v103
    v_exp_f32 v107, v107
    v_cvt_pk_bf16_f32 v124, v104, v105
    s_add_u32 m0, s74, 3072
    s_mov_b32 s73, 24576
    buffer_load_dwordx4 v14, s[44:47], s73 offen lds
    v_smfmac_f32_32x32x32_bf16 a[64:79], a[112:115], v[112:119], v4
    v_exp_f32 v108, v108
    v_exp_f32 v109, v109
    v_cvt_pk_bf16_f32 v125, v106, v107
    v_exp_f32 v110, v110
    v_exp_f32 v111, v111
    v_cvt_pk_bf16_f32 v126, v108, v109
    v_cvt_pk_bf16_f32 v127, v110, v111
    v_mfma_f32_32x32x16_bf16 v[96:111], a[128:131], a[104:107], v[64:79]
    v_exp_f32 v80, v80
    v_exp_f32 v81, v81
    v_exp_f32 v82, v82
    v_mfma_f32_32x32x16_bf16 v[96:111], a[132:135], a[108:111], v[96:111]
    v_exp_f32 v83, v83
    v_exp_f32 v84, v84
    v_exp_f32 v85, v85
    v_cvt_pk_bf16_f32 v112, v80, v81
    v_mfma_f32_32x32x16_bf16 a[16:31], a[160:163], v[120:123], a[16:31]
    v_exp_f32 v86, v86
    v_exp_f32 v87, v87
    v_cvt_pk_bf16_f32 v113, v82, v83
    v_exp_f32 v88, v88
    v_cvt_pk_bf16_f32 v114, v84, v85
    s_add_u32 m0, s74, 4096
    s_mov_b32 s73, 32768
    buffer_load_dwordx4 v14, s[44:47], s73 offen lds
    v_mfma_f32_32x32x16_bf16 a[16:31], a[164:167], v[124:127], a[16:31]
    v_exp_f32 v89, v89
    v_exp_f32 v90, v90
    v_cvt_pk_bf16_f32 v115, v86, v87
    v_exp_f32 v91, v91
    v_cvt_pk_bf16_f32 v116, v88, v89
    s_add_u32 m0, s74, 5120
    s_mov_b32 s73, 40960
    buffer_load_dwordx4 v14, s[44:47], s73 offen lds
    v_smfmac_f32_32x32x32_bf16 a[64:79], a[116:119], v[120:127], v4
    v_exp_f32 v92, v92
    v_exp_f32 v93, v93
    v_cvt_pk_bf16_f32 v117, v90, v91
    v_exp_f32 v94, v94
    v_exp_f32 v95, v95
    v_cvt_pk_bf16_f32 v118, v92, v93
    v_cvt_pk_bf16_f32 v119, v94, v95
    s_waitcnt vmcnt(12)
    v_mfma_f32_32x32x16_bf16 v[80:95], a[136:139], a[80:83], v[16:31]
    v_exp_f32 v96, v96
    v_exp_f32 v97, v97
    v_exp_f32 v98, v98
    v_mfma_f32_32x32x16_bf16 v[80:95], a[140:143], a[84:87], v[80:95]
    v_exp_f32 v99, v99
    v_exp_f32 v100, v100
    v_exp_f32 v101, v101
    v_cvt_pk_bf16_f32 v120, v96, v97
    v_mfma_f32_32x32x16_bf16 a[32:47], a[160:163], v[112:115], a[32:47]
    v_exp_f32 v102, v102
    v_exp_f32 v103, v103
    v_cvt_pk_bf16_f32 v121, v98, v99
    v_exp_f32 v104, v104
    v_cvt_pk_bf16_f32 v122, v100, v101
    s_add_u32 m0, s74, 6144
    s_mov_b32 s73, 49152
    buffer_load_dwordx4 v14, s[44:47], s73 offen lds
    v_mfma_f32_32x32x16_bf16 a[32:47], a[164:167], v[116:119], a[32:47]
    v_exp_f32 v105, v105
    v_exp_f32 v106, v106
    v_cvt_pk_bf16_f32 v123, v102, v103
    v_exp_f32 v107, v107
    v_cvt_pk_bf16_f32 v124, v104, v105
    s_add_u32 m0, s74, 7168
    s_mov_b32 s73, 57344
    buffer_load_dwordx4 v14, s[44:47], s73 offen lds
    v_smfmac_f32_32x32x32_bf16 a[64:79], a[120:123], v[112:119], v4
    v_exp_f32 v108, v108
    v_exp_f32 v109, v109
    v_cvt_pk_bf16_f32 v125, v106, v107
    v_exp_f32 v110, v110
    v_exp_f32 v111, v111
    v_cvt_pk_bf16_f32 v126, v108, v109
    v_cvt_pk_bf16_f32 v127, v110, v111
    v_mfma_f32_32x32x16_bf16 v[96:111], a[136:139], a[88:91], v[32:47]
    v_exp_f32 v80, v80
    v_exp_f32 v81, v81
    v_exp_f32 v82, v82
    buffer_load_dwordx4 a[152:155], v2, s[32:35], s55 offen offset:0
    v_mfma_f32_32x32x16_bf16 v[96:111], a[140:143], a[92:95], v[96:111]
    v_exp_f32 v83, v83
    v_exp_f32 v84, v84
    v_exp_f32 v85, v85
    v_cvt_pk_bf16_f32 v112, v80, v81
    buffer_load_dwordx4 a[156:159], v2, s[32:35], s55 offen offset:1024
    s_add_u32 s55, s55, 2048
    v_mfma_f32_32x32x16_bf16 a[48:63], a[160:163], v[120:123], a[48:63]
    v_exp_f32 v86, v86
    v_exp_f32 v87, v87
    v_cvt_pk_bf16_f32 v113, v82, v83
    v_exp_f32 v88, v88
    v_cvt_pk_bf16_f32 v114, v84, v85
    s_add_u32 m0, s74, 32768
    s_mov_b32 s73, 262144
    buffer_load_dwordx4 v14, s[44:47], s73 offen lds
    v_mfma_f32_32x32x16_bf16 a[48:63], a[164:167], v[124:127], a[48:63]
    v_exp_f32 v89, v89
    v_exp_f32 v90, v90
    v_cvt_pk_bf16_f32 v115, v86, v87
    v_exp_f32 v91, v91
    v_cvt_pk_bf16_f32 v116, v88, v89
    s_add_u32 m0, s74, 33792
    s_mov_b32 s73, 270336
    buffer_load_dwordx4 v14, s[44:47], s73 offen lds
    v_smfmac_f32_32x32x32_bf16 a[64:79], a[124:127], v[120:127], v4
    v_exp_f32 v92, v92
    v_exp_f32 v93, v93
    v_cvt_pk_bf16_f32 v117, v90, v91
    v_exp_f32 v94, v94
    v_exp_f32 v95, v95
    v_cvt_pk_bf16_f32 v118, v92, v93
    v_cvt_pk_bf16_f32 v119, v94, v95
    s_waitcnt vmcnt(16)
    v_mfma_f32_32x32x16_bf16 v[80:95], a[136:139], a[96:99], v[48:63]
    v_exp_f32 v96, v96
    v_exp_f32 v97, v97
    v_exp_f32 v98, v98
    buffer_load_dwordx4 a[184:187], v2, s[32:35], s56 offen offset:0
    v_mfma_f32_32x32x16_bf16 v[80:95], a[140:143], a[100:103], v[80:95]
    v_exp_f32 v99, v99
    v_exp_f32 v100, v100
    v_exp_f32 v101, v101
    v_cvt_pk_bf16_f32 v120, v96, v97
    buffer_load_dwordx4 a[188:191], v2, s[32:35], s56 offen offset:1024
    s_add_u32 s56, s56, 2048
    v_mfma_f32_32x32x16_bf16 a[0:15], a[168:171], v[112:115], a[0:15]
    v_exp_f32 v102, v102
    v_exp_f32 v103, v103
    v_cvt_pk_bf16_f32 v121, v98, v99
    v_exp_f32 v104, v104
    v_cvt_pk_bf16_f32 v122, v100, v101
    s_add_u32 m0, s74, 34816
    s_mov_b32 s73, 278528
    buffer_load_dwordx4 v14, s[44:47], s73 offen lds
    v_mfma_f32_32x32x16_bf16 a[0:15], a[172:175], v[116:119], a[0:15]
    v_exp_f32 v105, v105
    v_exp_f32 v106, v106
    v_cvt_pk_bf16_f32 v123, v102, v103
    v_exp_f32 v107, v107
    v_cvt_pk_bf16_f32 v124, v104, v105
    s_add_u32 m0, s74, 35840
    s_mov_b32 s73, 286720
    buffer_load_dwordx4 v14, s[44:47], s73 offen lds
    v_smfmac_f32_32x32x32_bf16 a[64:79], a[112:115], v[112:119], v4
    v_exp_f32 v108, v108
    v_exp_f32 v109, v109
    v_cvt_pk_bf16_f32 v125, v106, v107
    v_exp_f32 v110, v110
    v_exp_f32 v111, v111
    v_cvt_pk_bf16_f32 v126, v108, v109
    v_cvt_pk_bf16_f32 v127, v110, v111
    v_mfma_f32_32x32x16_bf16 v[96:111], a[136:139], a[104:107], v[64:79]
    v_exp_f32 v80, v80
    v_exp_f32 v81, v81
    v_exp_f32 v82, v82
    v_mfma_f32_32x32x16_bf16 v[96:111], a[140:143], a[108:111], v[96:111]
    v_exp_f32 v83, v83
    v_exp_f32 v84, v84
    v_exp_f32 v85, v85
    v_cvt_pk_bf16_f32 v112, v80, v81
    v_mfma_f32_32x32x16_bf16 a[16:31], a[168:171], v[120:123], a[16:31]
    v_exp_f32 v86, v86
    v_exp_f32 v87, v87
    v_cvt_pk_bf16_f32 v113, v82, v83
    v_exp_f32 v88, v88
    v_cvt_pk_bf16_f32 v114, v84, v85
    s_add_u32 m0, s74, 36864
    s_mov_b32 s73, 294912
    buffer_load_dwordx4 v14, s[44:47], s73 offen lds
    v_mfma_f32_32x32x16_bf16 a[16:31], a[172:175], v[124:127], a[16:31]
    v_exp_f32 v89, v89
    v_exp_f32 v90, v90
    v_cvt_pk_bf16_f32 v115, v86, v87
    v_exp_f32 v91, v91
    v_cvt_pk_bf16_f32 v116, v88, v89
    s_add_u32 m0, s74, 37888
    s_mov_b32 s73, 303104
    buffer_load_dwordx4 v14, s[44:47], s73 offen lds
    v_smfmac_f32_32x32x32_bf16 a[64:79], a[116:119], v[120:127], v4
    v_exp_f32 v92, v92
    v_exp_f32 v93, v93
    v_cvt_pk_bf16_f32 v117, v90, v91
    v_exp_f32 v94, v94
    v_exp_f32 v95, v95
    v_cvt_pk_bf16_f32 v118, v92, v93
    v_cvt_pk_bf16_f32 v119, v94, v95
    s_waitcnt vmcnt(20)
    v_mfma_f32_32x32x16_bf16 v[80:95], a[144:147], a[80:83], v[16:31]
    v_exp_f32 v96, v96
    v_exp_f32 v97, v97
    v_exp_f32 v98, v98
    v_mfma_f32_32x32x16_bf16 v[80:95], a[148:151], a[84:87], v[80:95]
    v_exp_f32 v99, v99
    v_exp_f32 v100, v100
    v_exp_f32 v101, v101
    v_cvt_pk_bf16_f32 v120, v96, v97
    v_mfma_f32_32x32x16_bf16 a[32:47], a[168:171], v[112:115], a[32:47]
    v_exp_f32 v102, v102
    v_exp_f32 v103, v103
    v_cvt_pk_bf16_f32 v121, v98, v99
    v_exp_f32 v104, v104
    v_cvt_pk_bf16_f32 v122, v100, v101
    s_add_u32 m0, s74, 38912
    s_mov_b32 s73, 311296
    buffer_load_dwordx4 v14, s[44:47], s73 offen lds
    v_mfma_f32_32x32x16_bf16 a[32:47], a[172:175], v[116:119], a[32:47]
    v_exp_f32 v105, v105
    v_exp_f32 v106, v106
    v_cvt_pk_bf16_f32 v123, v102, v103
    v_exp_f32 v107, v107
    v_cvt_pk_bf16_f32 v124, v104, v105
    s_add_u32 m0, s74, 39936
    s_mov_b32 s73, 319488
    buffer_load_dwordx4 v14, s[44:47], s73 offen lds
    v_smfmac_f32_32x32x32_bf16 a[64:79], a[120:123], v[112:119], v4
    v_exp_f32 v108, v108
    v_exp_f32 v109, v109
    v_cvt_pk_bf16_f32 v125, v106, v107
    v_exp_f32 v110, v110
    v_exp_f32 v111, v111
    v_cvt_pk_bf16_f32 v126, v108, v109
    v_cvt_pk_bf16_f32 v127, v110, v111
    v_mfma_f32_32x32x16_bf16 v[96:111], a[144:147], a[88:91], v[32:47]
    v_exp_f32 v80, v80
    v_exp_f32 v81, v81
    v_exp_f32 v82, v82
    v_mfma_f32_32x32x16_bf16 v[96:111], a[148:151], a[92:95], v[96:111]
    v_exp_f32 v83, v83
    v_exp_f32 v84, v84
    v_exp_f32 v85, v85
    v_cvt_pk_bf16_f32 v112, v80, v81
    v_mfma_f32_32x32x16_bf16 a[48:63], a[168:171], v[120:123], a[48:63]
    v_exp_f32 v86, v86
    v_exp_f32 v87, v87
    v_cvt_pk_bf16_f32 v113, v82, v83
    v_exp_f32 v88, v88
    v_cvt_pk_bf16_f32 v114, v84, v85
    s_add_u32 m0, s74, 65536
    s_mov_b32 s73, 524288
    buffer_load_dwordx4 v14, s[44:47], s73 offen lds
    v_mfma_f32_32x32x16_bf16 a[48:63], a[172:175], v[124:127], a[48:63]
    v_exp_f32 v89, v89
    v_exp_f32 v90, v90
    v_cvt_pk_bf16_f32 v115, v86, v87
    v_exp_f32 v91, v91
    v_cvt_pk_bf16_f32 v116, v88, v89
    s_add_u32 m0, s74, 66560
    s_mov_b32 s73, 532480
    buffer_load_dwordx4 v14, s[44:47], s73 offen lds
    v_smfmac_f32_32x32x32_bf16 a[64:79], a[124:127], v[120:127], v4
    v_exp_f32 v92, v92
    v_exp_f32 v93, v93
    v_cvt_pk_bf16_f32 v117, v90, v91
    v_exp_f32 v94, v94
    v_exp_f32 v95, v95
    v_cvt_pk_bf16_f32 v118, v92, v93
    v_cvt_pk_bf16_f32 v119, v94, v95
    s_waitcnt vmcnt(20)
    v_mfma_f32_32x32x16_bf16 v[80:95], a[144:147], a[96:99], v[48:63]
    v_exp_f32 v96, v96
    v_exp_f32 v97, v97
    v_exp_f32 v98, v98
    v_mfma_f32_32x32x16_bf16 v[80:95], a[148:151], a[100:103], v[80:95]
    v_exp_f32 v99, v99
    v_exp_f32 v100, v100
    v_exp_f32 v101, v101
    v_cvt_pk_bf16_f32 v120, v96, v97
    v_mfma_f32_32x32x16_bf16 a[0:15], a[176:179], v[112:115], a[0:15]
    v_exp_f32 v102, v102
    v_exp_f32 v103, v103
    v_cvt_pk_bf16_f32 v121, v98, v99
    v_exp_f32 v104, v104
    v_cvt_pk_bf16_f32 v122, v100, v101
    s_add_u32 m0, s74, 67584
    s_mov_b32 s73, 540672
    buffer_load_dwordx4 v14, s[44:47], s73 offen lds
    v_mfma_f32_32x32x16_bf16 a[0:15], a[180:183], v[116:119], a[0:15]
    v_exp_f32 v105, v105
    v_exp_f32 v106, v106
    v_cvt_pk_bf16_f32 v123, v102, v103
    v_exp_f32 v107, v107
    v_cvt_pk_bf16_f32 v124, v104, v105
    s_add_u32 m0, s74, 68608
    s_mov_b32 s73, 548864
    buffer_load_dwordx4 v14, s[44:47], s73 offen lds
    v_smfmac_f32_32x32x32_bf16 a[64:79], a[112:115], v[112:119], v4
    v_exp_f32 v108, v108
    v_exp_f32 v109, v109
    v_cvt_pk_bf16_f32 v125, v106, v107
    v_exp_f32 v110, v110
    v_exp_f32 v111, v111
    v_cvt_pk_bf16_f32 v126, v108, v109
    v_cvt_pk_bf16_f32 v127, v110, v111
    v_mfma_f32_32x32x16_bf16 v[96:111], a[144:147], a[104:107], v[64:79]
    v_exp_f32 v80, v80
    v_exp_f32 v81, v81
    v_exp_f32 v82, v82
    v_mfma_f32_32x32x16_bf16 v[96:111], a[148:151], a[108:111], v[96:111]
    v_exp_f32 v83, v83
    v_exp_f32 v84, v84
    v_exp_f32 v85, v85
    v_cvt_pk_bf16_f32 v112, v80, v81
    v_mfma_f32_32x32x16_bf16 a[16:31], a[176:179], v[120:123], a[16:31]
    v_exp_f32 v86, v86
    v_exp_f32 v87, v87
    v_cvt_pk_bf16_f32 v113, v82, v83
    v_exp_f32 v88, v88
    v_cvt_pk_bf16_f32 v114, v84, v85
    s_add_u32 m0, s74, 69632
    s_mov_b32 s73, 557056
    buffer_load_dwordx4 v14, s[44:47], s73 offen lds
    v_mfma_f32_32x32x16_bf16 a[16:31], a[180:183], v[124:127], a[16:31]
    v_exp_f32 v89, v89
    v_exp_f32 v90, v90
    v_cvt_pk_bf16_f32 v115, v86, v87
    v_exp_f32 v91, v91
    v_cvt_pk_bf16_f32 v116, v88, v89
    s_add_u32 m0, s74, 70656
    s_mov_b32 s73, 565248
    buffer_load_dwordx4 v14, s[44:47], s73 offen lds
    v_smfmac_f32_32x32x32_bf16 a[64:79], a[116:119], v[120:127], v4
    v_exp_f32 v92, v92
    v_exp_f32 v93, v93
    v_cvt_pk_bf16_f32 v117, v90, v91
    v_exp_f32 v94, v94
    v_exp_f32 v95, v95
    v_cvt_pk_bf16_f32 v118, v92, v93
    v_cvt_pk_bf16_f32 v119, v94, v95
    s_waitcnt vmcnt(16)
    v_mfma_f32_32x32x16_bf16 v[80:95], a[152:155], a[80:83], v[16:31]
    v_exp_f32 v96, v96
    v_exp_f32 v97, v97
    v_exp_f32 v98, v98
    v_mfma_f32_32x32x16_bf16 v[80:95], a[156:159], a[84:87], v[80:95]
    v_exp_f32 v99, v99
    v_exp_f32 v100, v100
    v_exp_f32 v101, v101
    v_cvt_pk_bf16_f32 v120, v96, v97
    v_mfma_f32_32x32x16_bf16 a[32:47], a[176:179], v[112:115], a[32:47]
    v_exp_f32 v102, v102
    v_exp_f32 v103, v103
    v_cvt_pk_bf16_f32 v121, v98, v99
    v_exp_f32 v104, v104
    v_cvt_pk_bf16_f32 v122, v100, v101
    s_add_u32 m0, s74, 71680
    s_mov_b32 s73, 573440
    buffer_load_dwordx4 v14, s[44:47], s73 offen lds
    v_mfma_f32_32x32x16_bf16 a[32:47], a[180:183], v[116:119], a[32:47]
    v_exp_f32 v105, v105
    v_exp_f32 v106, v106
    v_cvt_pk_bf16_f32 v123, v102, v103
    v_exp_f32 v107, v107
    v_cvt_pk_bf16_f32 v124, v104, v105
    s_add_u32 m0, s74, 72704
    s_mov_b32 s73, 581632
    buffer_load_dwordx4 v14, s[44:47], s73 offen lds
    v_smfmac_f32_32x32x32_bf16 a[64:79], a[120:123], v[112:119], v4
    v_exp_f32 v108, v108
    v_exp_f32 v109, v109
    v_cvt_pk_bf16_f32 v125, v106, v107
    v_exp_f32 v110, v110
    v_exp_f32 v111, v111
    v_cvt_pk_bf16_f32 v126, v108, v109
    v_cvt_pk_bf16_f32 v127, v110, v111
    v_mfma_f32_32x32x16_bf16 v[96:111], a[152:155], a[88:91], v[32:47]
    v_exp_f32 v80, v80
    v_exp_f32 v81, v81
    v_exp_f32 v82, v82
    v_mfma_f32_32x32x16_bf16 v[96:111], a[156:159], a[92:95], v[96:111]
    v_exp_f32 v83, v83
    v_exp_f32 v84, v84
    v_exp_f32 v85, v85
    v_cvt_pk_bf16_f32 v112, v80, v81
    v_mfma_f32_32x32x16_bf16 a[48:63], a[176:179], v[120:123], a[48:63]
    v_exp_f32 v86, v86
    v_exp_f32 v87, v87
    v_cvt_pk_bf16_f32 v113, v82, v83
    v_exp_f32 v88, v88
    v_cvt_pk_bf16_f32 v114, v84, v85
    s_add_u32 m0, s74, 98304
    s_mov_b32 s73, 786432
    buffer_load_dwordx4 v14, s[44:47], s73 offen lds
    v_mfma_f32_32x32x16_bf16 a[48:63], a[180:183], v[124:127], a[48:63]
    v_exp_f32 v89, v89
    v_exp_f32 v90, v90
    v_cvt_pk_bf16_f32 v115, v86, v87
    v_exp_f32 v91, v91
    v_cvt_pk_bf16_f32 v116, v88, v89
    s_add_u32 m0, s74, 99328
    s_mov_b32 s73, 794624
    buffer_load_dwordx4 v14, s[44:47], s73 offen lds
    v_smfmac_f32_32x32x32_bf16 a[64:79], a[124:127], v[120:127], v4
    v_exp_f32 v92, v92
    v_exp_f32 v93, v93
    v_cvt_pk_bf16_f32 v117, v90, v91
    v_exp_f32 v94, v94
    v_exp_f32 v95, v95
    v_cvt_pk_bf16_f32 v118, v92, v93
    v_cvt_pk_bf16_f32 v119, v94, v95
    s_waitcnt vmcnt(16)
    v_mfma_f32_32x32x16_bf16 v[80:95], a[152:155], a[96:99], v[48:63]
    v_exp_f32 v96, v96
    v_exp_f32 v97, v97
    v_exp_f32 v98, v98
    v_mfma_f32_32x32x16_bf16 v[80:95], a[156:159], a[100:103], v[80:95]
    v_exp_f32 v99, v99
    v_exp_f32 v100, v100
    v_exp_f32 v101, v101
    v_cvt_pk_bf16_f32 v120, v96, v97
    v_mfma_f32_32x32x16_bf16 a[0:15], a[184:187], v[112:115], a[0:15]
    v_exp_f32 v102, v102
    v_exp_f32 v103, v103
    v_cvt_pk_bf16_f32 v121, v98, v99
    v_exp_f32 v104, v104
    v_cvt_pk_bf16_f32 v122, v100, v101
    s_add_u32 m0, s74, 100352
    s_mov_b32 s73, 802816
    buffer_load_dwordx4 v14, s[44:47], s73 offen lds
    v_mfma_f32_32x32x16_bf16 a[0:15], a[188:191], v[116:119], a[0:15]
    v_exp_f32 v105, v105
    v_exp_f32 v106, v106
    v_cvt_pk_bf16_f32 v123, v102, v103
    v_exp_f32 v107, v107
    v_cvt_pk_bf16_f32 v124, v104, v105
    s_add_u32 m0, s74, 101376
    s_mov_b32 s73, 811008
    buffer_load_dwordx4 v14, s[44:47], s73 offen lds
    v_smfmac_f32_32x32x32_bf16 a[64:79], a[112:115], v[112:119], v4
    v_exp_f32 v108, v108
    v_exp_f32 v109, v109
    v_cvt_pk_bf16_f32 v125, v106, v107
    v_exp_f32 v110, v110
    v_exp_f32 v111, v111
    v_cvt_pk_bf16_f32 v126, v108, v109
    v_cvt_pk_bf16_f32 v127, v110, v111
    v_mfma_f32_32x32x16_bf16 v[96:111], a[152:155], a[104:107], v[64:79]
    v_exp_f32 v80, v80
    v_exp_f32 v81, v81
    v_exp_f32 v82, v82
    v_mfma_f32_32x32x16_bf16 v[96:111], a[156:159], a[108:111], v[96:111]
    v_exp_f32 v83, v83
    v_exp_f32 v84, v84
    v_exp_f32 v85, v85
    v_cvt_pk_bf16_f32 v112, v80, v81
    v_mfma_f32_32x32x16_bf16 a[16:31], a[184:187], v[120:123], a[16:31]
    v_exp_f32 v86, v86
    v_exp_f32 v87, v87
    v_cvt_pk_bf16_f32 v113, v82, v83
    v_exp_f32 v88, v88
    v_cvt_pk_bf16_f32 v114, v84, v85
    s_add_u32 m0, s74, 102400
    s_mov_b32 s73, 819200
    buffer_load_dwordx4 v14, s[44:47], s73 offen lds
    v_mfma_f32_32x32x16_bf16 a[16:31], a[188:191], v[124:127], a[16:31]
    v_exp_f32 v89, v89
    v_exp_f32 v90, v90
    v_cvt_pk_bf16_f32 v115, v86, v87
    v_exp_f32 v91, v91
    v_cvt_pk_bf16_f32 v116, v88, v89
    s_add_u32 m0, s74, 103424
    s_mov_b32 s73, 827392
    buffer_load_dwordx4 v14, s[44:47], s73 offen lds
    v_smfmac_f32_32x32x32_bf16 a[64:79], a[116:119], v[120:127], v4
    v_exp_f32 v92, v92
    v_exp_f32 v93, v93
    v_cvt_pk_bf16_f32 v117, v90, v91
    v_exp_f32 v94, v94
    v_exp_f32 v95, v95
    v_cvt_pk_bf16_f32 v118, v92, v93
    v_cvt_pk_bf16_f32 v119, v94, v95
    s_waitcnt vmcnt(63)
    v_mfma_f32_32x32x16_bf16 v[80:95], a[128:131], a[80:83], v[16:31]
    v_exp_f32 v96, v96
    v_exp_f32 v97, v97
    v_exp_f32 v98, v98
    v_mfma_f32_32x32x16_bf16 v[80:95], a[132:135], a[84:87], v[80:95]
    v_exp_f32 v99, v99
    v_exp_f32 v100, v100
    v_exp_f32 v101, v101
    v_cvt_pk_bf16_f32 v120, v96, v97
    v_mfma_f32_32x32x16_bf16 a[32:47], a[184:187], v[112:115], a[32:47]
    v_exp_f32 v102, v102
    v_exp_f32 v103, v103
    v_cvt_pk_bf16_f32 v121, v98, v99
    v_exp_f32 v104, v104
    v_cvt_pk_bf16_f32 v122, v100, v101
    s_add_u32 m0, s74, 104448
    s_mov_b32 s73, 835584
    buffer_load_dwordx4 v14, s[44:47], s73 offen lds
    v_mfma_f32_32x32x16_bf16 a[32:47], a[188:191], v[116:119], a[32:47]
    v_exp_f32 v105, v105
    v_exp_f32 v106, v106
    v_cvt_pk_bf16_f32 v123, v102, v103
    v_exp_f32 v107, v107
    v_cvt_pk_bf16_f32 v124, v104, v105
    s_add_u32 m0, s74, 105472
    s_mov_b32 s73, 843776
    buffer_load_dwordx4 v14, s[44:47], s73 offen lds
    v_smfmac_f32_32x32x32_bf16 a[64:79], a[120:123], v[112:119], v4
    v_exp_f32 v108, v108
    v_exp_f32 v109, v109
    v_cvt_pk_bf16_f32 v125, v106, v107
    v_exp_f32 v110, v110
    v_exp_f32 v111, v111
    v_cvt_pk_bf16_f32 v126, v108, v109
    v_cvt_pk_bf16_f32 v127, v110, v111
    s_branch L_t4_end
L_t4_plain:
    v_mfma_f32_32x32x16_bf16 v[96:111], a[128:131], a[88:91], v[32:47]
    v_exp_f32 v80, v80
    v_exp_f32 v81, v81
    v_exp_f32 v82, v82
    buffer_load_dwordx4 a[144:147], v2, s[32:35], s55 offen offset:0
    v_mfma_f32_32x32x16_bf16 v[96:111], a[132:135], a[92:95], v[96:111]
    v_exp_f32 v83, v83
    v_exp_f32 v84, v84
    v_exp_f32 v85, v85
    v_cvt_pk_bf16_f32 v112, v80, v81
    buffer_load_dwordx4 a[148:151], v2, s[32:35], s55 offen offset:1024
    s_add_u32 s55, s55, 2048
    v_mfma_f32_32x32x16_bf16 a[48:63], a[184:187], v[120:123], a[48:63]
    v_exp_f32 v86, v86
    v_exp_f32 v87, v87
    v_cvt_pk_bf16_f32 v113, v82, v83
    v_exp_f32 v88, v88
    v_cvt_pk_bf16_f32 v114, v84, v85
    v_mfma_f32_32x32x16_bf16 a[48:63], a[188:191], v[124:127], a[48:63]
    v_exp_f32 v89, v89
    v_exp_f32 v90, v90
    v_cvt_pk_bf16_f32 v115, v86, v87
    v_exp_f32 v91, v91
    v_cvt_pk_bf16_f32 v116, v88, v89
    v_smfmac_f32_32x32x32_bf16 a[64:79], a[124:127], v[120:127], v4
    v_exp_f32 v92, v92
    v_exp_f32 v93, v93
    v_cvt_pk_bf16_f32 v117, v90, v91
    v_exp_f32 v94, v94
    v_exp_f32 v95, v95
    v_cvt_pk_bf16_f32 v118, v92, v93
    v_cvt_pk_bf16_f32 v119, v94, v95
    s_waitcnt vmcnt(6)
    v_mfma_f32_32x32x16_bf16 v[80:95], a[128:131], a[96:99], v[48:63]
    v_exp_f32 v96, v96
    v_exp_f32 v97, v97
    v_exp_f32 v98, v98
    buffer_load_dwordx4 a[176:179], v2, s[32:35], s56 offen offset:0
    v_mfma_f32_32x32x16_bf16 v[80:95], a[132:135], a[100:103], v[80:95]
    v_exp_f32 v99, v99
    v_exp_f32 v100, v100
    v_exp_f32 v101, v101
    v_cvt_pk_bf16_f32 v120, v96, v97
    buffer_load_dwordx4 a[180:183], v2, s[32:35], s56 offen offset:1024
    s_add_u32 s56, s56, 2048
    v_mfma_f32_32x32x16_bf16 a[0:15], a[160:163], v[112:115], a[0:15]
    v_exp_f32 v102, v102
    v_exp_f32 v103, v103
    v_cvt_pk_bf16_f32 v121, v98, v99
    v_exp_f32 v104, v104
    v_cvt_pk_bf16_f32 v122, v100, v101
    v_mfma_f32_32x32x16_bf16 a[0:15], a[164:167], v[116:119], a[0:15]
    v_exp_f32 v105, v105
    v_exp_f32 v106, v106
    v_cvt_pk_bf16_f32 v123, v102, v103
    v_exp_f32 v107, v107
    v_cvt_pk_bf16_f32 v124, v104, v105
    v_smfmac_f32_32x32x32_bf16 a[64:79], a[112:115], v[112:119], v4
    v_exp_f32 v108, v108
    v_exp_f32 v109, v109
    v_cvt_pk_bf16_f32 v125, v106, v107
    v_exp_f32 v110, v110
    v_exp_f32 v111, v111
    v_cvt_pk_bf16_f32 v126, v108, v109
    v_cvt_pk_bf16_f32 v127, v110, v111
    v_mfma_f32_32x32x16_bf16 v[96:111], a[128:131], a[104:107], v[64:79]
    v_exp_f32 v80, v80
    v_exp_f32 v81, v81
    v_exp_f32 v82, v82
    v_mfma_f32_32x32x16_bf16 v[96:111], a[132:135], a[108:111], v[96:111]
    v_exp_f32 v83, v83
    v_exp_f32 v84, v84
    v_exp_f32 v85, v85
    v_cvt_pk_bf16_f32 v112, v80, v81
    v_mfma_f32_32x32x16_bf16 a[16:31], a[160:163], v[120:123], a[16:31]
    v_exp_f32 v86, v86
    v_exp_f32 v87, v87
    v_cvt_pk_bf16_f32 v113, v82, v83
    v_exp_f32 v88, v88
    v_cvt_pk_bf16_f32 v114, v84, v85
    v_mfma_f32_32x32x16_bf16 a[16:31], a[164:167], v[124:127], a[16:31]
    v_exp_f32 v89, v89
    v_exp_f32 v90, v90
    v_cvt_pk_bf16_f32 v115, v86, v87
    v_exp_f32 v91, v91
    v_cvt_pk_bf16_f32 v116, v88, v89
    v_smfmac_f32_32x32x32_bf16 a[64:79], a[116:119], v[120:127], v4
    v_exp_f32 v92, v92
    v_exp_f32 v93, v93
    v_cvt_pk_bf16_f32 v117, v90, v91
    v_exp_f32 v94, v94
    v_exp_f32 v95, v95
    v_cvt_pk_bf16_f32 v118, v92, v93
    v_cvt_pk_bf16_f32 v119, v94, v95
    s_waitcnt vmcnt(6)
    v_mfma_f32_32x32x16_bf16 v[80:95], a[136:139], a[80:83], v[16:31]
    v_exp_f32 v96, v96
    v_exp_f32 v97, v97
    v_exp_f32 v98, v98
    v_mfma_f32_32x32x16_bf16 v[80:95], a[140:143], a[84:87], v[80:95]
    v_exp_f32 v99, v99
    v_exp_f32 v100, v100
    v_exp_f32 v101, v101
    v_cvt_pk_bf16_f32 v120, v96, v97
    v_mfma_f32_32x32x16_bf16 a[32:47], a[160:163], v[112:115], a[32:47]
    v_exp_f32 v102, v102
    v_exp_f32 v103, v103
    v_cvt_pk_bf16_f32 v121, v98, v99
    v_exp_f32 v104, v104
    v_cvt_pk_bf16_f32 v122, v100, v101
    v_mfma_f32_32x32x16_bf16 a[32:47], a[164:167], v[116:119], a[32:47]
    v_exp_f32 v105, v105
    v_exp_f32 v106, v106
    v_cvt_pk_bf16_f32 v123, v102, v103
    v_exp_f32 v107, v107
    v_cvt_pk_bf16_f32 v124, v104, v105
    v_smfmac_f32_32x32x32_bf16 a[64:79], a[120:123], v[112:119], v4
    v_exp_f32 v108, v108
    v_exp_f32 v109, v109
    v_cvt_pk_bf16_f32 v125, v106, v107
    v_exp_f32 v110, v110
    v_exp_f32 v111, v111
    v_cvt_pk_bf16_f32 v126, v108, v109
    v_cvt_pk_bf16_f32 v127, v110, v111
    v_mfma_f32_32x32x16_bf16 v[96:111], a[136:139], a[88:91], v[32:47]
    v_exp_f32 v80, v80
    v_exp_f32 v81, v81
    v_exp_f32 v82, v82
    buffer_load_dwordx4 a[152:155], v2, s[32:35], s55 offen offset:0
    v_mfma_f32_32x32x16_bf16 v[96:111], a[140:143], a[92:95], v[96:111]
    v_exp_f32 v83, v83
    v_exp_f32 v84, v84
    v_exp_f32 v85, v85
    v_cvt_pk_bf16_f32 v112, v80, v81
    buffer_load_dwordx4 a[156:159], v2, s[32:35], s55 offen offset:1024
    s_add_u32 s55, s55, 2048
    v_mfma_f32_32x32x16_bf16 a[48:63], a[160:163], v[120:123], a[48:63]
    v_exp_f32 v86, v86
    v_exp_f32 v87, v87
    v_cvt_pk_bf16_f32 v113, v82, v83
    v_exp_f32 v88, v88
    v_cvt_pk_bf16_f32 v114, v84, v85
    v_mfma_f32_32x32x16_bf16 a[48:63], a[164:167], v[124:127], a[48:63]
    v_exp_f32 v89, v89
    v_exp_f32 v90, v90
    v_cvt_pk_bf16_f32 v115, v86, v87
    v_exp_f32 v91, v91
    v_cvt_pk_bf16_f32 v116, v88, v89
    v_smfmac_f32_32x32x32_bf16 a[64:79], a[124:127], v[120:127], v4
    v_exp_f32 v92, v92
    v_exp_f32 v93, v93
    v_cvt_pk_bf16_f32 v117, v90, v91
    v_exp_f32 v94, v94
    v_exp_f32 v95, v95
    v_cvt_pk_bf16_f32 v118, v92, v93
    v_cvt_pk_bf16_f32 v119, v94, v95
    s_waitcnt vmcnt(6)
    v_mfma_f32_32x32x16_bf16 v[80:95], a[136:139], a[96:99], v[48:63]
    v_exp_f32 v96, v96
    v_exp_f32 v97, v97
    v_exp_f32 v98, v98
    buffer_load_dwordx4 a[184:187], v2, s[32:35], s56 offen offset:0
    v_mfma_f32_32x32x16_bf16 v[80:95], a[140:143], a[100:103], v[80:95]
    v_exp_f32 v99, v99
    v_exp_f32 v100, v100
    v_exp_f32 v101, v101
    v_cvt_pk_bf16_f32 v120, v96, v97
    buffer_load_dwordx4 a[188:191], v2, s[32:35], s56 offen offset:1024
    s_add_u32 s56, s56, 2048
    v_mfma_f32_32x32x16_bf16 a[0:15], a[168:171], v[112:115], a[0:15]
    v_exp_f32 v102, v102
    v_exp_f32 v103, v103
    v_cvt_pk_bf16_f32 v121, v98, v99
    v_exp_f32 v104, v104
    v_cvt_pk_bf16_f32 v122, v100, v101
    v_mfma_f32_32x32x16_bf16 a[0:15], a[172:175], v[116:119], a[0:15]
    v_exp_f32 v105, v105
    v_exp_f32 v106, v106
    v_cvt_pk_bf16_f32 v123, v102, v103
    v_exp_f32 v107, v107
    v_cvt_pk_bf16_f32 v124, v104, v105
    v_smfmac_f32_32x32x32_bf16 a[64:79], a[112:115], v[112:119], v4
    v_exp_f32 v108, v108
    v_exp_f32 v109, v109
    v_cvt_pk_bf16_f32 v125, v106, v107
    v_exp_f32 v110, v110
    v_exp_f32 v111, v111
    v_cvt_pk_bf16_f32 v126, v108, v109
    v_cvt_pk_bf16_f32 v127, v110, v111
    v_mfma_f32_32x32x16_bf16 v[96:111], a[136:139], a[104:107], v[64:79]
    v_exp_f32 v80, v80
    v_exp_f32 v81, v81
    v_exp_f32 v82, v82
    v_mfma_f32_32x32x16_bf16 v[96:111], a[140:143], a[108:111], v[96:111]
    v_exp_f32 v83, v83
    v_exp_f32 v84, v84
    v_exp_f32 v85, v85
    v_cvt_pk_bf16_f32 v112, v80, v81
    v_mfma_f32_32x32x16_bf16 a[16:31], a[168:171], v[120:123], a[16:31]
    v_exp_f32 v86, v86
    v_exp_f32 v87, v87
    v_cvt_pk_bf16_f32 v113, v82, v83
    v_exp_f32 v88, v88
    v_cvt_pk_bf16_f32 v114, v84, v85
    v_mfma_f32_32x32x16_bf16 a[16:31], a[172:175], v[124:127], a[16:31]
    v_exp_f32 v89, v89
    v_exp_f32 v90, v90
    v_cvt_pk_bf16_f32 v115, v86, v87
    v_exp_f32 v91, v91
    v_cvt_pk_bf16_f32 v116, v88, v89
    v_smfmac_f32_32x32x32_bf16 a[64:79], a[116:119], v[120:127], v4
    v_exp_f32 v92, v92
    v_exp_f32 v93, v93
    v_cvt_pk_bf16_f32 v117, v90, v91
    v_exp_f32 v94, v94
    v_exp_f32 v95, v95
    v_cvt_pk_bf16_f32 v118, v92, v93
    v_cvt_pk_bf16_f32 v119, v94, v95
    s_waitcnt vmcnt(6)
    v_mfma_f32_32x32x16_bf16 v[80:95], a[144:147], a[80:83], v[16:31]
    v_exp_f32 v96, v96
    v_exp_f32 v97, v97
    v_exp_f32 v98, v98
    v_mfma_f32_32x32x16_bf16 v[80:95], a[148:151], a[84:87], v[80:95]
    v_exp_f32 v99, v99
    v_exp_f32 v100, v100
    v_exp_f32 v101, v101
    v_cvt_pk_bf16_f32 v120, v96, v97
    v_mfma_f32_32x32x16_bf16 a[32:47], a[168:171], v[112:115], a[32:47]
    v_exp_f32 v102, v102
    v_exp_f32 v103, v103
    v_cvt_pk_bf16_f32 v121, v98, v99
    v_exp_f32 v104, v104
    v_cvt_pk_bf16_f32 v122, v100, v101
    v_mfma_f32_32x32x16_bf16 a[32:47], a[172:175], v[116:119], a[32:47]
    v_exp_f32 v105, v105
    v_exp_f32 v106, v106
    v_cvt_pk_bf16_f32 v123, v102, v103
    v_exp_f32 v107, v107
    v_cvt_pk_bf16_f32 v124, v104, v105
    v_smfmac_f32_32x32x32_bf16 a[64:79], a[120:123], v[112:119], v4
    v_exp_f32 v108, v108
    v_exp_f32 v109, v109
    v_cvt_pk_bf16_f32 v125, v106, v107
    v_exp_f32 v110, v110
    v_exp_f32 v111, v111
    v_cvt_pk_bf16_f32 v126, v108, v109
    v_cvt_pk_bf16_f32 v127, v110, v111
    v_mfma_f32_32x32x16_bf16 v[96:111], a[144:147], a[88:91], v[32:47]
    v_exp_f32 v80, v80
    v_exp_f32 v81, v81
    v_exp_f32 v82, v82
    v_mfma_f32_32x32x16_bf16 v[96:111], a[148:151], a[92:95], v[96:111]
    v_exp_f32 v83, v83
    v_exp_f32 v84, v84
    v_exp_f32 v85, v85
    v_cvt_pk_bf16_f32 v112, v80, v81
    v_mfma_f32_32x32x16_bf16 a[48:63], a[168:171], v[120:123], a[48:63]
    v_exp_f32 v86, v86
    v_exp_f32 v87, v87
    v_cvt_pk_bf16_f32 v113, v82, v83
    v_exp_f32 v88, v88
    v_cvt_pk_bf16_f32 v114, v84, v85
    v_mfma_f32_32x32x16_bf16 a[48:63], a[172:175], v[124:127], a[48:63]
    v_exp_f32 v89, v89
    v_exp_f32 v90, v90
    v_cvt_pk_bf16_f32 v115, v86, v87
    v_exp_f32 v91, v91
    v_cvt_pk_bf16_f32 v116, v88, v89
    v_smfmac_f32_32x32x32_bf16 a[64:79], a[124:127], v[120:127], v4
    v_exp_f32 v92, v92
    v_exp_f32 v93, v93
    v_cvt_pk_bf16_f32 v117, v90, v91
    v_exp_f32 v94, v94
    v_exp_f32 v95, v95
    v_cvt_pk_bf16_f32 v118, v92, v93
    v_cvt_pk_bf16_f32 v119, v94, v95
    s_waitcnt vmcnt(4)
    v_mfma_f32_32x32x16_bf16 v[80:95], a[144:147], a[96:99], v[48:63]
    v_exp_f32 v96, v96
    v_exp_f32 v97, v97
    v_exp_f32 v98, v98
    v_mfma_f32_32x32x16_bf16 v[80:95], a[148:151], a[100:103], v[80:95]
    v_exp_f32 v99, v99
    v_exp_f32 v100, v100
    v_exp_f32 v101, v101
    v_cvt_pk_bf16_f32 v120, v96, v97
    v_mfma_f32_32x32x16_bf16 a[0:15], a[176:179], v[112:115], a[0:15]
    v_exp_f32 v102, v102
    v_exp_f32 v103, v103
    v_cvt_pk_bf16_f32 v121, v98, v99
    v_exp_f32 v104, v104
    v_cvt_pk_bf16_f32 v122, v100, v101
    v_mfma_f32_32x32x16_bf16 a[0:15], a[180:183], v[116:119], a[0:15]
    v_exp_f32 v105, v105
    v_exp_f32 v106, v106
    v_cvt_pk_bf16_f32 v123, v102, v103
    v_exp_f32 v107, v107
    v_cvt_pk_bf16_f32 v124, v104, v105
    v_smfmac_f32_32x32x32_bf16 a[64:79], a[112:115], v[112:119], v4
    v_exp_f32 v108, v108
    v_exp_f32 v109, v109
    v_cvt_pk_bf16_f32 v125, v106, v107
    v_exp_f32 v110, v110
    v_exp_f32 v111, v111
    v_cvt_pk_bf16_f32 v126, v108, v109
    v_cvt_pk_bf16_f32 v127, v110, v111
    v_mfma_f32_32x32x16_bf16 v[96:111], a[144:147], a[104:107], v[64:79]
    v_exp_f32 v80, v80
    v_exp_f32 v81, v81
    v_exp_f32 v82, v82
    v_mfma_f32_32x32x16_bf16 v[96:111], a[148:151], a[108:111], v[96:111]
    v_exp_f32 v83, v83
    v_exp_f32 v84, v84
    v_exp_f32 v85, v85
    v_cvt_pk_bf16_f32 v112, v80, v81
    v_mfma_f32_32x32x16_bf16 a[16:31], a[176:179], v[120:123], a[16:31]
    v_exp_f32 v86, v86
    v_exp_f32 v87, v87
    v_cvt_pk_bf16_f32 v113, v82, v83
    v_exp_f32 v88, v88
    v_cvt_pk_bf16_f32 v114, v84, v85
    v_mfma_f32_32x32x16_bf16 a[16:31], a[180:183], v[124:127], a[16:31]
    v_exp_f32 v89, v89
    v_exp_f32 v90, v90
    v_cvt_pk_bf16_f32 v115, v86, v87
    v_exp_f32 v91, v91
    v_cvt_pk_bf16_f32 v116, v88, v89
    v_smfmac_f32_32x32x32_bf16 a[64:79], a[116:119], v[120:127], v4
    v_exp_f32 v92, v92
    v_exp_f32 v93, v93
    v_cvt_pk_bf16_f32 v117, v90, v91
    v_exp_f32 v94, v94
    v_exp_f32 v95, v95
    v_cvt_pk_bf16_f32 v118, v92, v93
    v_cvt_pk_bf16_f32 v119, v94, v95
    s_waitcnt vmcnt(2)
    v_mfma_f32_32x32x16_bf16 v[80:95], a[152:155], a[80:83], v[16:31]
    v_exp_f32 v96, v96
    v_exp_f32 v97, v97
    v_exp_f32 v98, v98
    v_mfma_f32_32x32x16_bf16 v[80:95], a[156:159], a[84:87], v[80:95]
    v_exp_f32 v99, v99
    v_exp_f32 v100, v100
    v_exp_f32 v101, v101
    v_cvt_pk_bf16_f32 v120, v96, v97
    v_mfma_f32_32x32x16_bf16 a[32:47], a[176:179], v[112:115], a[32:47]
    v_exp_f32 v102, v102
    v_exp_f32 v103, v103
    v_cvt_pk_bf16_f32 v121, v98, v99
    v_exp_f32 v104, v104
    v_cvt_pk_bf16_f32 v122, v100, v101
    v_mfma_f32_32x32x16_bf16 a[32:47], a[180:183], v[116:119], a[32:47]
    v_exp_f32 v105, v105
    v_exp_f32 v106, v106
    v_cvt_pk_bf16_f32 v123, v102, v103
    v_exp_f32 v107, v107
    v_cvt_pk_bf16_f32 v124, v104, v105
    v_smfmac_f32_32x32x32_bf16 a[64:79], a[120:123], v[112:119], v4
    v_exp_f32 v108, v108
    v_exp_f32 v109, v109
    v_cvt_pk_bf16_f32 v125, v106, v107
    v_exp_f32 v110, v110
    v_exp_f32 v111, v111
    v_cvt_pk_bf16_f32 v126, v108, v109
    v_cvt_pk_bf16_f32 v127, v110, v111
    v_mfma_f32_32x32x16_bf16 v[96:111], a[152:155], a[88:91], v[32:47]
    v_exp_f32 v80, v80
    v_exp_f32 v81, v81
    v_exp_f32 v82, v82
    v_mfma_f32_32x32x16_bf16 v[96:111], a[156:159], a[92:95], v[96:111]
    v_exp_f32 v83, v83
    v_exp_f32 v84, v84
    v_exp_f32 v85, v85
    v_cvt_pk_bf16_f32 v112, v80, v81
    v_mfma_f32_32x32x16_bf16 a[48:63], a[176:179], v[120:123], a[48:63]
    v_exp_f32 v86, v86
    v_exp_f32 v87, v87
    v_cvt_pk_bf16_f32 v113, v82, v83
    v_exp_f32 v88, v88
    v_cvt_pk_bf16_f32 v114, v84, v85
    v_mfma_f32_32x32x16_bf16 a[48:63], a[180:183], v[124:127], a[48:63]
    v_exp_f32 v89, v89
    v_exp_f32 v90, v90
    v_cvt_pk_bf16_f32 v115, v86, v87
    v_exp_f32 v91, v91
    v_cvt_pk_bf16_f32 v116, v88, v89
    v_smfmac_f32_32x32x32_bf16 a[64:79], a[124:127], v[120:127], v4
    v_exp_f32 v92, v92
    v_exp_f32 v93, v93
    v_cvt_pk_bf16_f32 v117, v90, v91
    v_exp_f32 v94, v94
    v_exp_f32 v95, v95
    v_cvt_pk_bf16_f32 v118, v92, v93
    v_cvt_pk_bf16_f32 v119, v94, v95
    s_waitcnt vmcnt(0)
    v_mfma_f32_32x32x16_bf16 v[80:95], a[152:155], a[96:99], v[48:63]
    v_exp_f32 v96, v96
    v_exp_f32 v97, v97
    v_exp_f32 v98, v98
    v_mfma_f32_32x32x16_bf16 v[80:95], a[156:159], a[100:103], v[80:95]
    v_exp_f32 v99, v99
    v_exp_f32 v100, v100
    v_exp_f32 v101, v101
    v_cvt_pk_bf16_f32 v120, v96, v97
    v_mfma_f32_32x32x16_bf16 a[0:15], a[184:187], v[112:115], a[0:15]
    v_exp_f32 v102, v102
    v_exp_f32 v103, v103
    v_cvt_pk_bf16_f32 v121, v98, v99
    v_exp_f32 v104, v104
    v_cvt_pk_bf16_f32 v122, v100, v101
    v_mfma_f32_32x32x16_bf16 a[0:15], a[188:191], v[116:119], a[0:15]
    v_exp_f32 v105, v105
    v_exp_f32 v106, v106
    v_cvt_pk_bf16_f32 v123, v102, v103
    v_exp_f32 v107, v107
    v_cvt_pk_bf16_f32 v124, v104, v105
    v_smfmac_f32_32x32x32_bf16 a[64:79], a[112:115], v[112:119], v4
    v_exp_f32 v108, v108
    v_exp_f32 v109, v109
    v_cvt_pk_bf16_f32 v125, v106, v107
    v_exp_f32 v110, v110
    v_exp_f32 v111, v111
    v_cvt_pk_bf16_f32 v126, v108, v109
    v_cvt_pk_bf16_f32 v127, v110, v111
    v_mfma_f32_32x32x16_bf16 v[96:111], a[152:155], a[104:107], v[64:79]
    v_exp_f32 v80, v80
    v_exp_f32 v81, v81
    v_exp_f32 v82, v82
    v_mfma_f32_32x32x16_bf16 v[96:111], a[156:159], a[108:111], v[96:111]
    v_exp_f32 v83, v83
    v_exp_f32 v84, v84
    v_exp_f32 v85, v85
    v_cvt_pk_bf16_f32 v112, v80, v81
    v_mfma_f32_32x32x16_bf16 a[16:31], a[184:187], v[120:123], a[16:31]
    v_exp_f32 v86, v86
    v_exp_f32 v87, v87
    v_cvt_pk_bf16_f32 v113, v82, v83
    v_exp_f32 v88, v88
    v_cvt_pk_bf16_f32 v114, v84, v85
    v_mfma_f32_32x32x16_bf16 a[16:31], a[188:191], v[124:127], a[16:31]
    v_exp_f32 v89, v89
    v_exp_f32 v90, v90
    v_cvt_pk_bf16_f32 v115, v86, v87
    v_exp_f32 v91, v91
    v_cvt_pk_bf16_f32 v116, v88, v89
    v_smfmac_f32_32x32x32_bf16 a[64:79], a[116:119], v[120:127], v4
    v_exp_f32 v92, v92
    v_exp_f32 v93, v93
    v_cvt_pk_bf16_f32 v117, v90, v91
    v_exp_f32 v94, v94
    v_exp_f32 v95, v95
    v_cvt_pk_bf16_f32 v118, v92, v93
    v_cvt_pk_bf16_f32 v119, v94, v95
    s_waitcnt vmcnt(63)
    v_mfma_f32_32x32x16_bf16 v[80:95], a[128:131], a[80:83], v[16:31]
    v_exp_f32 v96, v96
    v_exp_f32 v97, v97
    v_exp_f32 v98, v98
    v_mfma_f32_32x32x16_bf16 v[80:95], a[132:135], a[84:87], v[80:95]
    v_exp_f32 v99, v99
    v_exp_f32 v100, v100
    v_exp_f32 v101, v101
    v_cvt_pk_bf16_f32 v120, v96, v97
    v_mfma_f32_32x32x16_bf16 a[32:47], a[184:187], v[112:115], a[32:47]
    v_exp_f32 v102, v102
    v_exp_f32 v103, v103
    v_cvt_pk_bf16_f32 v121, v98, v99
    v_exp_f32 v104, v104
    v_cvt_pk_bf16_f32 v122, v100, v101
    v_mfma_f32_32x32x16_bf16 a[32:47], a[188:191], v[116:119], a[32:47]
    v_exp_f32 v105, v105
    v_exp_f32 v106, v106
    v_cvt_pk_bf16_f32 v123, v102, v103
    v_exp_f32 v107, v107
    v_cvt_pk_bf16_f32 v124, v104, v105
    v_smfmac_f32_32x32x32_bf16 a[64:79], a[120:123], v[112:119], v4
    v_exp_f32 v108, v108
    v_exp_f32 v109, v109
    v_cvt_pk_bf16_f32 v125, v106, v107
    v_exp_f32 v110, v110
    v_exp_f32 v111, v111
    v_cvt_pk_bf16_f32 v126, v108, v109
    v_cvt_pk_bf16_f32 v127, v110, v111
L_t4_end:
    v_mfma_f32_32x32x16_bf16 a[48:63], a[184:187], v[120:123], a[48:63]
    s_nop 0
    v_mfma_f32_32x32x16_bf16 a[48:63], a[188:191], v[124:127], a[48:63]
    v_smfmac_f32_32x32x32_bf16 a[64:79], a[124:127], v[120:127], v4
    s_waitcnt vmcnt(0)
    s_mov_b32 s60, 0x53800000
    s_nop 9
    v_accvgpr_read_b32 v5, a64
    v_accvgpr_read_b32 v6, a65
    v_add_f32 v16, v5, v6
    v_accvgpr_read_b32 v5, a66
    v_accvgpr_read_b32 v6, a67
    v_add_f32 v17, v5, v6
    v_accvgpr_read_b32 v5, a68
    v_accvgpr_read_b32 v6, a69
    v_add_f32 v18, v5, v6
    v_accvgpr_read_b32 v5, a70
    v_accvgpr_read_b32 v6, a71
    v_add_f32 v19, v5, v6
    v_max3_f32 v5, v16, v17, v18
    v_max_f32 v5, v5, v19
    v_add_f32 v6, v16, v17
    v_add_f32 v6, v6, v18
    v_add_f32 v6, v6, v19
    v_cmp_nle_f32 vcc, v5, s60
    s_cbranch_vccnz L_t4_slow
    v_cmp_u_f32 vcc, v6, v6
    s_cbranch_vccnz L_t4_slow
    v_rcp_f32 v5, v16
    v_accvgpr_read_b32 v128, a0
    v_accvgpr_read_b32 v129, a1
    v_accvgpr_read_b32 v130, a2
    v_accvgpr_read_b32 v131, a3
    v_accvgpr_read_b32 v132, a4
    v_accvgpr_read_b32 v133, a5
    v_accvgpr_read_b32 v134, a6
    v_accvgpr_read_b32 v135, a7
    v_accvgpr_read_b32 v136, a8
    v_accvgpr_read_b32 v137, a9
    v_accvgpr_read_b32 v138, a10
    v_accvgpr_read_b32 v139, a11
    v_accvgpr_read_b32 v140, a12
    v_accvgpr_read_b32 v141, a13
    v_accvgpr_read_b32 v142, a14
    v_accvgpr_read_b32 v143, a15
    v_mul_f32 v128, v128, v5
    v_mul_f32 v129, v129, v5
    v_mul_f32 v130, v130, v5
    v_mul_f32 v131, v131, v5
    v_mul_f32 v132, v132, v5
    v_mul_f32 v133, v133, v5
    v_mul_f32 v134, v134, v5
    v_mul_f32 v135, v135, v5
    v_mul_f32 v136, v136, v5
    v_mul_f32 v137, v137, v5
    v_mul_f32 v138, v138, v5
    v_mul_f32 v139, v139, v5
    v_mul_f32 v140, v140, v5
    v_mul_f32 v141, v141, v5
    v_mul_f32 v142, v142, v5
    v_mul_f32 v143, v143, v5
    v_mul_f32 v6, 0, v128
    v_fma_f32 v6, v129, 0, v6
    v_fma_f32 v6, v130, 0, v6
    v_fma_f32 v6, v131, 0, v6
    v_fma_f32 v6, v132, 0, v6
    v_fma_f32 v6, v133, 0, v6
    v_fma_f32 v6, v134, 0, v6
    v_fma_f32 v6, v135, 0, v6
    v_fma_f32 v6, v136, 0, v6
    v_fma_f32 v6, v137, 0, v6
    v_fma_f32 v6, v138, 0, v6
    v_fma_f32 v6, v139, 0, v6
    v_fma_f32 v6, v140, 0, v6
    v_fma_f32 v6, v141, 0, v6
    v_fma_f32 v6, v142, 0, v6
    v_fma_f32 v6, v143, 0, v6
    v_cmp_u_f32 vcc, v6, v6
    s_cbranch_vccnz L_t4_slow
    v_cvt_pk_bf16_f32 v80, v128, v129
    v_cvt_pk_bf16_f32 v81, v130, v131
    v_cvt_pk_bf16_f32 v82, v132, v133
    v_cvt_pk_bf16_f32 v83, v134, v135
    v_cvt_pk_bf16_f32 v84, v136, v137
    v_cvt_pk_bf16_f32 v85, v138, v139
    v_cvt_pk_bf16_f32 v86, v140, v141
    v_cvt_pk_bf16_f32 v87, v142, v143
    s_add_u32 s58, s59, 0
    buffer_store_dwordx4 v[80:83], v2, s[32:35], s58 offen offset:0 sc1
    buffer_store_dwordx4 v[84:87], v2, s[32:35], s58 offen offset:1024 sc1
    v_rcp_f32 v5, v17
    v_accvgpr_read_b32 v128, a16
    v_accvgpr_read_b32 v129, a17
    v_accvgpr_read_b32 v130, a18
    v_accvgpr_read_b32 v131, a19
    v_accvgpr_read_b32 v132, a20
    v_accvgpr_read_b32 v133, a21
    v_accvgpr_read_b32 v134, a22
    v_accvgpr_read_b32 v135, a23
    v_accvgpr_read_b32 v136, a24
    v_accvgpr_read_b32 v137, a25
    v_accvgpr_read_b32 v138, a26
    v_accvgpr_read_b32 v139, a27
    v_accvgpr_read_b32 v140, a28
    v_accvgpr_read_b32 v141, a29
    v_accvgpr_read_b32 v142, a30
    v_accvgpr_read_b32 v143, a31
    v_mul_f32 v128, v128, v5
    v_mul_f32 v129, v129, v5
    v_mul_f32 v130, v130, v5
    v_mul_f32 v131, v131, v5
    v_mul_f32 v132, v132, v5
    v_mul_f32 v133, v133, v5
    v_mul_f32 v134, v134, v5
    v_mul_f32 v135, v135, v5
    v_mul_f32 v136, v136, v5
    v_mul_f32 v137, v137, v5
    v_mul_f32 v138, v138, v5
    v_mul_f32 v139, v139, v5
    v_mul_f32 v140, v140, v5
    v_mul_f32 v141, v141, v5
    v_mul_f32 v142, v142, v5
    v_mul_f32 v143, v143, v5
    v_mul_f32 v6, 0, v128
    v_fma_f32 v6, v129, 0, v6
    v_fma_f32 v6, v130, 0, v6
    v_fma_f32 v6, v131, 0, v6
    v_fma_f32 v6, v132, 0, v6
    v_fma_f32 v6, v133, 0, v6
    v_fma_f32 v6, v134, 0, v6
    v_fma_f32 v6, v135, 0, v6
    v_fma_f32 v6, v136, 0, v6
    v_fma_f32 v6, v137, 0, v6
    v_fma_f32 v6, v138, 0, v6
    v_fma_f32 v6, v139, 0, v6
    v_fma_f32 v6, v140, 0, v6
    v_fma_f32 v6, v141, 0, v6
    v_fma_f32 v6, v142, 0, v6
    v_fma_f32 v6, v143, 0, v6
    v_cmp_u_f32 vcc, v6, v6
    s_cbranch_vccnz L_t4_slow
    v_cvt_pk_bf16_f32 v88, v128, v129
    v_cvt_pk_bf16_f32 v89, v130, v131
    v_cvt_pk_bf16_f32 v90, v132, v133
    v_cvt_pk_bf16_f32 v91, v134, v135
    v_cvt_pk_bf16_f32 v92, v136, v137
    v_cvt_pk_bf16_f32 v93, v138, v139
    v_cvt_pk_bf16_f32 v94, v140, v141
    v_cvt_pk_bf16_f32 v95, v142, v143
    s_add_u32 s58, s59, 65536
    buffer_store_dwordx4 v[88:91], v2, s[32:35], s58 offen offset:0 sc1
    buffer_store_dwordx4 v[92:95], v2, s[32:35], s58 offen offset:1024 sc1
    v_rcp_f32 v5, v18
    v_accvgpr_read_b32 v128, a32
    v_accvgpr_read_b32 v129, a33
    v_accvgpr_read_b32 v130, a34
    v_accvgpr_read_b32 v131, a35
    v_accvgpr_read_b32 v132, a36
    v_accvgpr_read_b32 v133, a37
    v_accvgpr_read_b32 v134, a38
    v_accvgpr_read_b32 v135, a39
    v_accvgpr_read_b32 v136, a40
    v_accvgpr_read_b32 v137, a41
    v_accvgpr_read_b32 v138, a42
    v_accvgpr_read_b32 v139, a43
    v_accvgpr_read_b32 v140, a44
    v_accvgpr_read_b32 v141, a45
    v_accvgpr_read_b32 v142, a46
    v_accvgpr_read_b32 v143, a47
    v_mul_f32 v128, v128, v5
    v_mul_f32 v129, v129, v5
    v_mul_f32 v130, v130, v5
    v_mul_f32 v131, v131, v5
    v_mul_f32 v132, v132, v5
    v_mul_f32 v133, v133, v5
    v_mul_f32 v134, v134, v5
    v_mul_f32 v135, v135, v5
    v_mul_f32 v136, v136, v5
    v_mul_f32 v137, v137, v5
    v_mul_f32 v138, v138, v5
    v_mul_f32 v139, v139, v5
    v_mul_f32 v140, v140, v5
    v_mul_f32 v141, v141, v5
    v_mul_f32 v142, v142, v5
    v_mul_f32 v143, v143, v5
    v_mul_f32 v6, 0, v128
    v_fma_f32 v6, v129, 0, v6
    v_fma_f32 v6, v130, 0, v6
    v_fma_f32 v6, v131, 0, v6
    v_fma_f32 v6, v132, 0, v6
    v_fma_f32 v6, v133, 0, v6
    v_fma_f32 v6, v134, 0, v6
    v_fma_f32 v6, v135, 0, v6
    v_fma_f32 v6, v136, 0, v6
    v_fma_f32 v6, v137, 0, v6
    v_fma_f32 v6, v138, 0, v6
    v_fma_f32 v6, v139, 0, v6
    v_fma_f32 v6, v140, 0, v6
    v_fma_f32 v6, v141, 0, v6
    v_fma_f32 v6, v142, 0, v6
    v_fma_f32 v6, v143, 0, v6
    v_cmp_u_f32 vcc, v6, v6
    s_cbranch_vccnz L_t4_slow
    v_cvt_pk_bf16_f32 v96, v128, v129
    v_cvt_pk_bf16_f32 v97, v130, v131
    v_cvt_pk_bf16_f32 v98, v132, v133
    v_cvt_pk_bf16_f32 v99, v134, v135
    v_cvt_pk_bf16_f32 v100, v136, v137
    v_cvt_pk_bf16_f32 v101, v138, v139
    v_cvt_pk_bf16_f32 v102, v140, v141
    v_cvt_pk_bf16_f32 v103, v142, v143
    s_add_u32 s58, s59, 131072
    buffer_store_dwordx4 v[96:99], v2, s[32:35], s58 offen offset:0 sc1
    buffer_store_dwordx4 v[100:103], v2, s[32:35], s58 offen offset:1024 sc1
    v_rcp_f32 v5, v19
    v_accvgpr_read_b32 v128, a48
    v_accvgpr_read_b32 v129, a49
    v_accvgpr_read_b32 v130, a50
    v_accvgpr_read_b32 v131, a51
    v_accvgpr_read_b32 v132, a52
    v_accvgpr_read_b32 v133, a53
    v_accvgpr_read_b32 v134, a54
    v_accvgpr_read_b32 v135, a55
    v_accvgpr_read_b32 v136, a56
    v_accvgpr_read_b32 v137, a57
    v_accvgpr_read_b32 v138, a58
    v_accvgpr_read_b32 v139, a59
    v_accvgpr_read_b32 v140, a60
    v_accvgpr_read_b32 v141, a61
    v_accvgpr_read_b32 v142, a62
    v_accvgpr_read_b32 v143, a63
    v_mul_f32 v128, v128, v5
    v_mul_f32 v129, v129, v5
    v_mul_f32 v130, v130, v5
    v_mul_f32 v131, v131, v5
    v_mul_f32 v132, v132, v5
    v_mul_f32 v133, v133, v5
    v_mul_f32 v134, v134, v5
    v_mul_f32 v135, v135, v5
    v_mul_f32 v136, v136, v5
    v_mul_f32 v137, v137, v5
    v_mul_f32 v138, v138, v5
    v_mul_f32 v139, v139, v5
    v_mul_f32 v140, v140, v5
    v_mul_f32 v141, v141, v5
    v_mul_f32 v142, v142, v5
    v_mul_f32 v143, v143, v5
    v_mul_f32 v6, 0, v128
    v_fma_f32 v6, v129, 0, v6
    v_fma_f32 v6, v130, 0, v6
    v_fma_f32 v6, v131, 0, v6
    v_fma_f32 v6, v132, 0, v6
    v_fma_f32 v6, v133, 0, v6
    v_fma_f32 v6, v134, 0, v6
    v_fma_f32 v6, v135, 0, v6
    v_fma_f32 v6, v136, 0, v6
    v_fma_f32 v6, v137, 0, v6
    v_fma_f32 v6, v138, 0, v6
    v_fma_f32 v6, v139, 0, v6
    v_fma_f32 v6, v140, 0, v6
    v_fma_f32 v6, v141, 0, v6
    v_fma_f32 v6, v142, 0, v6
    v_fma_f32 v6, v143, 0, v6
    v_cmp_u_f32 vcc, v6, v6
    s_cbranch_vccnz L_t4_slow
    v_cvt_pk_bf16_f32 v104, v128, v129
    v_cvt_pk_bf16_f32 v105, v130, v131
    v_cvt_pk_bf16_f32 v106, v132, v133
    v_cvt_pk_bf16_f32 v107, v134, v135
    v_cvt_pk_bf16_f32 v108, v136, v137
    v_cvt_pk_bf16_f32 v109, v138, v139
    v_cvt_pk_bf16_f32 v110, v140, v141
    v_cvt_pk_bf16_f32 v111, v142, v143
    s_add_u32 s58, s59, 196608
    buffer_store_dwordx4 v[104:107], v2, s[32:35], s58 offen offset:0 sc1
    buffer_store_dwordx4 v[108:111], v2, s[32:35], s58 offen offset:1024 sc1
    s_waitcnt vmcnt(0)
    s_branch L_t4_done
L_t4_slow:
    s_waitcnt vmcnt(0)
    s_mov_b32 s63, 0
L_t4_sq:
    s_lshl_b32 s58, s53, 17
    s_lshl_b32 s57, s54, 2
    s_add_u32 s57, s57, s63
    s_lshl_b32 s57, s57, 11
    s_add_u32 s58, s58, s57
    s_add_u32 s58, s58, 4194304
    buffer_load_dwordx4 a[80:83], v2, s[32:35], s58 offen offset:0
    buffer_load_dwordx4 a[84:87], v2, s[32:35], s58 offen offset:1024
    v_mov_b32 v128, 0
    v_mov_b32 v129, 0
    v_mov_b32 v130, 0
    v_mov_b32 v131, 0
    v_mov_b32 v132, 0
    v_mov_b32 v133, 0
    v_mov_b32 v134, 0
    v_mov_b32 v135, 0
    v_mov_b32 v136, 0
    v_mov_b32 v137, 0
    v_mov_b32 v138, 0
    v_mov_b32 v139, 0
    v_mov_b32 v140, 0
    v_mov_b32 v141, 0
    v_mov_b32 v142, 0
    v_mov_b32 v143, 0
    v_mov_b32 v5, 0xff800000
    v_mov_b32 v6, 0
    s_mov_b32 s55, s61
    s_mov_b32 s56, s62
    s_mov_b32 s57, 0
L_t4_sk:
    buffer_load_dwordx4 a[128:131], v2, s[32:35], s55 offen offset:0
    buffer_load_dwordx4 a[132:135], v2, s[32:35], s55 offen offset:1024
    buffer_load_dwordx4 a[160:163], v2, s[32:35], s56 offen offset:0
    buffer_load_dwordx4 a[164:167], v2, s[32:35], s56 offen offset:1024
    s_waitcnt vmcnt(0)
    v_mfma_f32_32x32x16_bf16 v[80:95], a[128:131], a[80:83], 0
    v_mfma_f32_32x32x16_bf16 v[80:95], a[132:135], a[84:87], v[80:95]
    s_nop 11
    v_max3_f32 v8, v80, v81, v82
    v_max3_f32 v8, v8, v83, v84
    v_max3_f32 v8, v8, v85, v86
    v_max3_f32 v8, v8, v87, v88
    v_max3_f32 v8, v8, v89, v90
    v_max3_f32 v8, v8, v91, v92
    v_max3_f32 v8, v8, v93, v94
    v_max3_f32 v8, v8, v95, v5
    v_mov_b32 v9, v8
    s_nop 1
    v_permlane32_swap_b32 v8, v9
    v_max_f32 v8, v8, v9
    v_sub_f32 v7, v5, v8
    v_exp_f32 v7, v7
    v_mov_b32 v5, v8
    v_sub_f32 v80, v80, v5
    v_sub_f32 v81, v81, v5
    v_sub_f32 v82, v82, v5
    v_sub_f32 v83, v83, v5
    v_sub_f32 v84, v84, v5
    v_sub_f32 v85, v85, v5
    v_sub_f32 v86, v86, v5
    v_sub_f32 v87, v87, v5
    v_sub_f32 v88, v88, v5
    v_sub_f32 v89, v89, v5
    v_sub_f32 v90, v90, v5
    v_sub_f32 v91, v91, v5
    v_sub_f32 v92, v92, v5
    v_sub_f32 v93, v93, v5
    v_sub_f32 v94, v94, v5
    v_sub_f32 v95, v95, v5
    v_exp_f32 v80, v80
    v_exp_f32 v81, v81
    v_exp_f32 v82, v82
    v_exp_f32 v83, v83
    v_exp_f32 v84, v84
    v_exp_f32 v85, v85
    v_exp_f32 v86, v86
    v_exp_f32 v87, v87
    v_exp_f32 v88, v88
    v_exp_f32 v89, v89
    v_exp_f32 v90, v90
    v_exp_f32 v91, v91
    v_exp_f32 v92, v92
    v_exp_f32 v93, v93
    v_exp_f32 v94, v94
    v_exp_f32 v95, v95
    v_mul_f32 v6, v6, v7
    v_mul_f32 v128, v128, v7
    v_mul_f32 v129, v129, v7
    v_mul_f32 v130, v130, v7
    v_mul_f32 v131, v131, v7
    v_mul_f32 v132, v132, v7
    v_mul_f32 v133, v133, v7
    v_mul_f32 v134, v134, v7
    v_mul_f32 v135, v135, v7
    v_mul_f32 v136, v136, v7
    v_mul_f32 v137, v137, v7
    v_mul_f32 v138, v138, v7
    v_mul_f32 v139, v139, v7
    v_mul_f32 v140, v140, v7
    v_mul_f32 v141, v141, v7
    v_mul_f32 v142, v142, v7
    v_mul_f32 v143, v143, v7
    v_cvt_pk_bf16_f32 v112, v80, v81
    v_cvt_pk_bf16_f32 v113, v82, v83
    v_cvt_pk_bf16_f32 v114, v84, v85
    v_cvt_pk_bf16_f32 v115, v86, v87
    v_cvt_pk_bf16_f32 v116, v88, v89
    v_cvt_pk_bf16_f32 v117, v90, v91
    v_cvt_pk_bf16_f32 v118, v92, v93
    v_cvt_pk_bf16_f32 v119, v94, v95
    v_add_f32 v6, v6, v80
    v_add_f32 v6, v6, v81
    v_add_f32 v6, v6, v82
    v_add_f32 v6, v6, v83
    v_add_f32 v6, v6, v84
    v_add_f32 v6, v6, v85
    v_add_f32 v6, v6, v86
    v_add_f32 v6, v6, v87
    v_add_f32 v6, v6, v88
    v_add_f32 v6, v6, v89
    v_add_f32 v6, v6, v90
    v_add_f32 v6, v6, v91
    v_add_f32 v6, v6, v92
    v_add_f32 v6, v6, v93
    v_add_f32 v6, v6, v94
    v_add_f32 v6, v6, v95
    v_mfma_f32_32x32x16_bf16 v[128:143], a[160:163], v[112:115], v[128:143]
    v_mfma_f32_32x32x16_bf16 v[128:143], a[164:167], v[116:119], v[128:143]
    s_add_u32 s55, s55, 2048
    s_add_u32 s56, s56, 2048
    s_add_u32 s57, s57, 1
    s_cmp_lt_u32 s57, 64
    s_cbranch_scc1 L_t4_sk
    v_mov_b32 v9, v6
    s_nop 1
    v_permlane32_swap_b32 v6, v9
    v_add_f32 v6, v6, v9
    v_rcp_f32 v6, v6
    s_nop 0
    v_mul_f32 v128, v128, v6
    v_mul_f32 v129, v129, v6
    v_mul_f32 v130, v130, v6
    v_mul_f32 v131, v131, v6
    v_mul_f32 v132, v132, v6
    v_mul_f32 v133, v133, v6
    v_mul_f32 v134, v134, v6
    v_mul_f32 v135, v135, v6
    v_mul_f32 v136, v136, v6
    v_mul_f32 v137, v137, v6
    v_mul_f32 v138, v138, v6
    v_mul_f32 v139, v139, v6
    v_mul_f32 v140, v140, v6
    v_mul_f32 v141, v141, v6
    v_mul_f32 v142, v142, v6
    v_mul_f32 v143, v143, v6
    v_cvt_pk_bf16_f32 v112, v128, v129
    v_cvt_pk_bf16_f32 v113, v130, v131
    v_cvt_pk_bf16_f32 v114, v132, v133
    v_cvt_pk_bf16_f32 v115, v134, v135
    v_cvt_pk_bf16_f32 v116, v136, v137
    v_cvt_pk_bf16_f32 v117, v138, v139
    v_cvt_pk_bf16_f32 v118, v140, v141
    v_cvt_pk_bf16_f32 v119, v142, v143
    s_add_u32 s58, s59, 0
    buffer_store_dwordx4 v[112:115], v2, s[32:35], s58 offen offset:0 sc1
    buffer_store_dwordx4 v[116:119], v2, s[32:35], s58 offen offset:1024 sc1
    s_waitcnt vmcnt(0)
    s_add_u32 s59, s59, 65536
    s_add_u32 s63, s63, 1
    s_cmp_lt_u32 s63, 4
    s_cbranch_scc1 L_t4_sq
L_t4_done:
    s_lshl_b32 s58, s54, 7
    s_lshl_b32 s59, s53, 2
    s_add_u32 s58, s58, s59
    v_mov_b32 v3, 0x3000
    v_add_u32 v3, s58, v3
    s_mov_b32 s86, 0x1
    s_mov_b32 s87, 0x0
    v_mov_b32 v246, 0x7fff0000
    v_cndmask_b32 v3, v246, v3, s[86:87]
    v_mov_b32 v5, 1
    buffer_store_dword v5, v3, s[32:35], 0 offen sc1
    s_cmp_eq_u32 s99, 1
    s_cbranch_scc1 L_mode_known
    s_mov_b32 s88, 0
    v_mov_b32 v246, 144
L_t5m_26:
    s_add_u32 s88, s88, 1
    s_mov_b32 s89, 19
    s_cmp_ge_u32 s88, 262144
    s_cbranch_scc1 L_abort
    buffer_load_dword v247, v246, s[36:39], 0 offen sc1
    s_waitcnt vmcnt(0)
    v_readfirstlane_b32 s75, v247
    s_cmp_le_u32 s75, s2
    s_cbranch_scc1 L_t5m_26
    s_and_b32 s75, s75, 3
L_mode_known:
    s_cmp_eq_u32 s75, 1
    s_cbranch_scc1 L_t7
L_t5:
    v_bfe_i32 v240, v1, 0, 1
    v_bfe_i32 v241, v1, 1, 1
    v_bfe_i32 v242, v1, 2, 1
    v_bfe_i32 v243, v1, 3, 1
    v_bfe_i32 v244, v1, 4, 1
    v_bfe_i32 v245, v1, 5, 1
    s_mov_b32 s44, s8
    s_and_b32 s45, s9, 0xffff
    s_mov_b32 s46, 0x200000
    s_mov_b32 s47, 0x00020000
    s_mov_b32 s53, 2048
    s_and_b32 s68, s31, 7
    s_lshl_b32 s54, s68, 8
    s_lshr_b32 s69, s31, 3
    s_and_b32 s70, s75, 1
    s_lshl_b32 s69, s69, s70
    s_and_b32 s69, s69, 31
    v_mov_b32 v95, 0x0
    v_and_b32 v246, 0x10, v240
    v_xor_b32 v95, v95, v246
    v_and_b32 v246, 0x20, v241
    v_xor_b32 v95, v95, v246
    v_and_b32 v246, 0x40, v242
    v_xor_b32 v95, v95, v246
    v_and_b32 v246, 0x80, v243
    v_xor_b32 v95, v95, v246
    v_and_b32 v246, 0x100, v244
    v_xor_b32 v95, v95, v246
    v_and_b32 v246, 0x200, v245
    v_xor_b32 v95, v95, v246
    s_lshl_b32 s63, s30, 10
    v_add_u32 v95, s63, v95
    s_mov_b32 s55, 4096
    s_mov_b32 s56, 32768
    v_mov_b32 v8, 0x0
    v_and_b32 v246, 0x10, v240
    v_xor_b32 v8, v8, v246
    v_and_b32 v246, 0x20, v241
    v_xor_b32 v8, v8, v246
    v_and_b32 v246, 0x40, v242
    v_xor_b32 v8, v8, v246
    v_and_b32 v246, 0x80, v243
    v_xor_b32 v8, v8, v246
    v_and_b32 v246, 0x200, v244
    v_xor_b32 v8, v8, v246
    v_and_b32 v246, 0x400, v245
    v_xor_b32 v8, v8, v246
    v_mov_b32 v9, 0x100
    v_and_b32 v246, 0x10, v240
    v_xor_b32 v9, v9, v246
    v_and_b32 v246, 0x20, v241
    v_xor_b32 v9, v9, v246
    v_and_b32 v246, 0x40, v242
    v_xor_b32 v9, v9, v246
    v_and_b32 v246, 0x80, v243
    v_xor_b32 v9, v9, v246
    v_and_b32 v246, 0x200, v244
    v_xor_b32 v9, v9, v246
    v_and_b32 v246, 0x400, v245
    v_xor_b32 v9, v9, v246
    v_mov_b32 v10, 0x800
    v_and_b32 v246, 0x10, v240
    v_xor_b32 v10, v10, v246
    v_and_b32 v246, 0x20, v241
    v_xor_b32 v10, v10, v246
    v_and_b32 v246, 0x40, v242
    v_xor_b32 v10, v10, v246
    v_and_b32 v246, 0x80, v243
    v_xor_b32 v10, v10, v246
    v_and_b32 v246, 0x200, v244
    v_xor_b32 v10, v10, v246
    v_and_b32 v246, 0x400, v245
    v_xor_b32 v10, v10, v246
    v_mov_b32 v11, 0x900
    v_and_b32 v246, 0x10, v240
    v_xor_b32 v11, v11, v246
    v_and_b32 v246, 0x20, v241
    v_xor_b32 v11, v11, v246
    v_and_b32 v246, 0x40, v242
    v_xor_b32 v11, v11, v246
    v_and_b32 v246, 0x80, v243
    v_xor_b32 v11, v11, v246
    v_and_b32 v246, 0x200, v244
    v_xor_b32 v11, v11, v246
    v_and_b32 v246, 0x400, v245
    v_xor_b32 v11, v11, v246
    v_add_u32 v12, 0x10000, v8
    v_add_u32 v13, 0x10000, v9
    v_add_u32 v14, 0x10000, v10
    v_add_u32 v15, 0x10000, v11
    s_lshr_b32 s70, s69, 1
    s_lshl_b32 s70, s70, 7
    v_mov_b32 v17, 0x3000
    v_and_b32 v246, 0x4, v240
    v_xor_b32 v17, v17, v246
    v_and_b32 v246, 0x8, v241
    v_xor_b32 v17, v17, v246
    v_and_b32 v246, 0x10, v242
    v_xor_b32 v17, v17, v246
    v_and_b32 v246, 0x20, v243
    v_xor_b32 v17, v17, v246
    v_and_b32 v246, 0x40, v244
    v_xor_b32 v17, v17, v246
    v_add_u32 v17, s70, v17
    s_lshl_b32 s70, s69, 17
    s_add_u32 s70, s70, 16777216
    s_add_u32 s48, s28, s70
    s_addc_u32 s49, s29, 0
    s_and_b32 s49, s49, 0xffff
    s_and_b32 s70, s75, 1
    s_lshl_b32 s50, 0x20000, s70
    s_mov_b32 s51, 0x00020000
    s_mov_b32 s57, 0
    buffer_load_dword v18, v17, s[32:35], 0 offen sc1
    v_mov_b32 v2, 0x0
    v_and_b32 v246, 0x10, v240
    v_xor_b32 v2, v2, v246
    v_and_b32 v246, 0x20, v241
    v_xor_b32 v2, v2, v246
    v_and_b32 v246, 0x40, v242
    v_xor_b32 v2, v2, v246
    v_and_b32 v246, 0x80, v243
    v_xor_b32 v2, v2, v246
    v_and_b32 v246, 0x40, v244
    v_xor_b32 v2, v2, v246
    v_and_b32 v246, 0x80, v245
    v_xor_b32 v2, v2, v246
    v_lshrrev_b32 v3, 4, v1
    v_mul_lo_u32 v3, v3, s53
    v_add_u32 v2, v2, v3
    s_lshl_b32 s63, s30, 5
    s_mul_i32 s63, s63, s53
    s_add_u32 s63, s63, s54
    v_add_u32 v2, s63, v2
    s_lshl_b32 s65, s53, 2
    s_lshl_b32 s64, s30, 13
    s_cmp_eq_u32 s99, 1
    s_mov_b32 s99, 0
    s_cbranch_scc1 L_lw_27
    s_mul_i32 s63, s53, 0
    s_add_u32 m0, s64, 0
    s_nop 0
    buffer_load_dwordx4 v2, s[44:47], s63 offen lds
    s_add_u32 s63, s63, s65
    s_add_u32 m0, s64, 1024
    s_nop 0
    buffer_load_dwordx4 v2, s[44:47], s63 offen lds
    s_add_u32 s63, s63, s65
    s_add_u32 m0, s64, 2048
    s_nop 0
    buffer_load_dwordx4 v2, s[44:47], s63 offen lds
    s_add_u32 s63, s63, s65
    s_add_u32 m0, s64, 3072
    s_nop 0
    buffer_load_dwordx4 v2, s[44:47], s63 offen lds
    s_add_u32 s63, s63, s65
    s_add_u32 m0, s64, 4096
    s_nop 0
    buffer_load_dwordx4 v2, s[44:47], s63 offen lds
    s_add_u32 s63, s63, s65
    s_add_u32 m0, s64, 5120
    s_nop 0
    buffer_load_dwordx4 v2, s[44:47], s63 offen lds
    s_add_u32 s63, s63, s65
    s_add_u32 m0, s64, 6144
    s_nop 0
    buffer_load_dwordx4 v2, s[44:47], s63 offen lds
    s_add_u32 s63, s63, s65
    s_add_u32 m0, s64, 7168
    s_nop 0
    buffer_load_dwordx4 v2, s[44:47], s63 offen lds
    s_mul_i32 s63, s53, 128
    s_add_u32 m0, s64, 32768
    s_nop 0
    buffer_load_dwordx4 v2, s[44:47], s63 offen lds
    s_add_u32 s63, s63, s65
    s_add_u32 m0, s64, 33792
    s_nop 0
    buffer_load_dwordx4 v2, s[44:47], s63 offen lds
    s_add_u32 s63, s63, s65
    s_add_u32 m0, s64, 34816
    s_nop 0
    buffer_load_dwordx4 v2, s[44:47], s63 offen lds
    s_add_u32 s63, s63, s65
    s_add_u32 m0, s64, 35840
    s_nop 0
    buffer_load_dwordx4 v2, s[44:47], s63 offen lds
    s_add_u32 s63, s63, s65
    s_add_u32 m0, s64, 36864
    s_nop 0
    buffer_load_dwordx4 v2, s[44:47], s63 offen lds
    s_add_u32 s63, s63, s65
    s_add_u32 m0, s64, 37888
    s_nop 0
    buffer_load_dwordx4 v2, s[44:47], s63 offen lds
    s_add_u32 s63, s63, s65
    s_add_u32 m0, s64, 38912
    s_nop 0
    buffer_load_dwordx4 v2, s[44:47], s63 offen lds
    s_add_u32 s63, s63, s65
    s_add_u32 m0, s64, 39936
    s_nop 0
    buffer_load_dwordx4 v2, s[44:47], s63 offen lds
    s_mul_i32 s63, s53, 256
    s_add_u32 m0, s64, 65536
    s_nop 0
    buffer_load_dwordx4 v2, s[44:47], s63 offen lds
    s_add_u32 s63, s63, s65
    s_add_u32 m0, s64, 66560
    s_nop 0
    buffer_load_dwordx4 v2, s[44:47], s63 offen lds
    s_add_u32 s63, s63, s65
    s_add_u32 m0, s64, 67584
    s_nop 0
    buffer_load_dwordx4 v2, s[44:47], s63 offen lds
    s_add_u32 s63, s63, s65
    s_add_u32 m0, s64, 68608
    s_nop 0
    buffer_load_dwordx4 v2, s[44:47], s63 offen lds
    s_add_u32 s63, s63, s65
    s_add_u32 m0, s64, 69632
    s_nop 0
    buffer_load_dwordx4 v2, s[44:47], s63 offen lds
    s_add_u32 s63, s63, s65
    s_add_u32 m0, s64, 70656
    s_nop 0
    buffer_load_dwordx4 v2, s[44:47], s63 offen lds
    s_add_u32 s63, s63, s65
    s_add_u32 m0, s64, 71680
    s_nop 0
    buffer_load_dwordx4 v2, s[44:47], s63 offen lds
    s_add_u32 s63, s63, s65
    s_add_u32 m0, s64, 72704
    s_nop 0
    buffer_load_dwordx4 v2, s[44:47], s63 offen lds
    s_mul_i32 s63, s53, 384
    s_add_u32 m0, s64, 98304
    s_nop 0
    buffer_load_dwordx4 v2, s[44:47], s63 offen lds
    s_add_u32 s63, s63, s65
    s_add_u32 m0, s64, 99328
    s_nop 0
    buffer_load_dwordx4 v2, s[44:47], s63 offen lds
    s_add_u32 s63, s63, s65
    s_add_u32 m0, s64, 100352
    s_nop 0
    buffer_load_dwordx4 v2, s[44:47], s63 offen lds
    s_add_u32 s63, s63, s65
    s_add_u32 m0, s64, 101376
    s_nop 0
    buffer_load_dwordx4 v2, s[44:47], s63 offen lds
    s_add_u32 s63, s63, s65
    s_add_u32 m0, s64, 102400
    s_nop 0
    buffer_load_dwordx4 v2, s[44:47], s63 offen lds
    s_add_u32 s63, s63, s65
    s_add_u32 m0, s64, 103424
    s_nop 0
    buffer_load_dwordx4 v2, s[44:47], s63 offen lds
    s_add_u32 s63, s63, s65
    s_add_u32 m0, s64, 104448
    s_nop 0
    buffer_load_dwordx4 v2, s[44:47], s63 offen lds
    s_add_u32 s63, s63, s65
    s_add_u32 m0, s64, 105472
    s_nop 0
    buffer_load_dwordx4 v2, s[44:47], s63 offen lds
L_lw_27:
    s_lshl_b32 s63, s30, 6
    v_mov_b32 v228, 0x0
    v_and_b32 v246, 0x10, v240
    v_xor_b32 v228, v228, v246
    v_and_b32 v246, 0x20, v241
    v_xor_b32 v228, v228, v246
    v_and_b32 v246, 0x140, v242
    v_xor_b32 v228, v228, v246
    v_and_b32 v246, 0x280, v243
    v_xor_b32 v228, v228, v246
    v_and_b32 v246, 0x400, v244
    v_xor_b32 v228, v228, v246
    v_and_b32 v246, 0x1000, v245
    v_xor_b32 v228, v228, v246
    v_xor_b32 v228, s63, v228
    v_add_u32 v229, 2048, v228
    v_mov_b32 v230, 0x8
    v_and_b32 v246, 0x10, v240
    v_xor_b32 v230, v230, v246
    v_and_b32 v246, 0x20, v241
    v_xor_b32 v230, v230, v246
    v_and_b32 v246, 0x140, v242
    v_xor_b32 v230, v230, v246
    v_and_b32 v246, 0x280, v243
    v_xor_b32 v230, v230, v246
    v_and_b32 v246, 0x400, v244
    v_xor_b32 v230, v230, v246
    v_and_b32 v246, 0x1000, v245
    v_xor_b32 v230, v230, v246
    v_xor_b32 v230, s63, v230
    v_add_u32 v231, 2048, v230
    v_add_u32 v232, 0x10000, v228
    v_add_u32 v233, 0x10000, v229
    v_add_u32 v234, 0x10000, v230
    v_add_u32 v235, 0x10000, v231
    s_waitcnt vmcnt(24)
    s_barrier
    ds_read_b64_tr_b16 a[0:1], v228 offset:0
    ds_read_b64_tr_b16 a[2:3], v229 offset:0
    ds_read_b64_tr_b16 a[4:5], v230 offset:0
    ds_read_b64_tr_b16 a[6:7], v231 offset:0
    ds_read_b64_tr_b16 a[8:9], v228 offset:8192
    ds_read_b64_tr_b16 a[10:11], v229 offset:8192
    ds_read_b64_tr_b16 a[12:13], v230 offset:8192
    ds_read_b64_tr_b16 a[14:15], v231 offset:8192
    ds_read_b64_tr_b16 a[16:17], v228 offset:16384
    ds_read_b64_tr_b16 a[18:19], v229 offset:16384
    ds_read_b64_tr_b16 a[20:21], v230 offset:16384
    ds_read_b64_tr_b16 a[22:23], v231 offset:16384
    ds_read_b64_tr_b16 a[24:25], v228 offset:24576
    ds_read_b64_tr_b16 a[26:27], v229 offset:24576
    ds_read_b64_tr_b16 a[28:29], v230 offset:24576
    ds_read_b64_tr_b16 a[30:31], v231 offset:24576
    s_waitcnt lgkmcnt(0)
    s_barrier
    s_mul_i32 s63, s53, 512
    s_add_u32 m0, s64, 0
    s_nop 0
    buffer_load_dwordx4 v2, s[44:47], s63 offen lds
    s_add_u32 s63, s63, s65
    s_add_u32 m0, s64, 1024
    s_nop 0
    buffer_load_dwordx4 v2, s[44:47], s63 offen lds
    s_add_u32 s63, s63, s65
    s_add_u32 m0, s64, 2048
    s_nop 0
    buffer_load_dwordx4 v2, s[44:47], s63 offen lds
    s_add_u32 s63, s63, s65
    s_add_u32 m0, s64, 3072
    s_nop 0
    buffer_load_dwordx4 v2, s[44:47], s63 offen lds
    s_add_u32 s63, s63, s65
    s_add_u32 m0, s64, 4096
    s_nop 0
    buffer_load_dwordx4 v2, s[44:47], s63 offen lds
    s_add_u32 s63, s63, s65
    s_add_u32 m0, s64, 5120
    s_nop 0
    buffer_load_dwordx4 v2, s[44:47], s63 offen lds
    s_add_u32 s63, s63, s65
    s_add_u32 m0, s64, 6144
    s_nop 0
    buffer_load_dwordx4 v2, s[44:47], s63 offen lds
    s_add_u32 s63, s63, s65
    s_add_u32 m0, s64, 7168
    s_nop 0
    buffer_load_dwordx4 v2, s[44:47], s63 offen lds
    s_waitcnt vmcnt(24)
    s_barrier
    ds_read_b64_tr_b16 a[32:33], v228 offset:32768
    ds_read_b64_tr_b16 a[34:35], v229 offset:32768
    ds_read_b64_tr_b16 a[36:37], v230 offset:32768
    ds_read_b64_tr_b16 a[38:39], v231 offset:32768
    ds_read_b64_tr_b16 a[40:41], v228 offset:40960
    ds_read_b64_tr_b16 a[42:43], v229 offset:40960
    ds_read_b64_tr_b16 a[44:45], v230 offset:40960
    ds_read_b64_tr_b16 a[46:47], v231 offset:40960
    ds_read_b64_tr_b16 a[48:49], v228 offset:49152
    ds_read_b64_tr_b16 a[50:51], v229 offset:49152
    ds_read_b64_tr_b16 a[52:53], v230 offset:49152
    ds_read_b64_tr_b16 a[54:55], v231 offset:49152
    ds_read_b64_tr_b16 a[56:57], v228 offset:57344
    ds_read_b64_tr_b16 a[58:59], v229 offset:57344
    ds_read_b64_tr_b16 a[60:61], v230 offset:57344
    ds_read_b64_tr_b16 a[62:63], v231 offset:57344
    s_waitcnt lgkmcnt(0)
    s_barrier
    s_mul_i32 s63, s53, 640
    s_add_u32 m0, s64, 32768
    s_nop 0
    buffer_load_dwordx4 v2, s[44:47], s63 offen lds
    s_add_u32 s63, s63, s65
    s_add_u32 m0, s64, 33792
    s_nop 0
    buffer_load_dwordx4 v2, s[44:47], s63 offen lds
    s_add_u32 s63, s63, s65
    s_add_u32 m0, s64, 34816
    s_nop 0
    buffer_load_dwordx4 v2, s[44:47], s63 offen lds
    s_add_u32 s63, s63, s65
    s_add_u32 m0, s64, 35840
    s_nop 0
    buffer_load_dwordx4 v2, s[44:47], s63 offen lds
    s_add_u32 s63, s63, s65
    s_add_u32 m0, s64, 36864
    s_nop 0
    buffer_load_dwordx4 v2, s[44:47], s63 offen lds
    s_add_u32 s63, s63, s65
    s_add_u32 m0, s64, 37888
    s_nop 0
    buffer_load_dwordx4 v2, s[44:47], s63 offen lds
    s_add_u32 s63, s63, s65
    s_add_u32 m0, s64, 38912
    s_nop 0
    buffer_load_dwordx4 v2, s[44:47], s63 offen lds
    s_add_u32 s63, s63, s65
    s_add_u32 m0, s64, 39936
    s_nop 0
    buffer_load_dwordx4 v2, s[44:47], s63 offen lds
    s_waitcnt vmcnt(24)
    s_barrier
    ds_read_b64_tr_b16 a[64:65], v232 offset:0
    ds_read_b64_tr_b16 a[66:67], v233 offset:0
    ds_read_b64_tr_b16 a[68:69], v234 offset:0
    ds_read_b64_tr_b16 a[70:71], v235 offset:0
    ds_read_b64_tr_b16 a[72:73], v232 offset:8192
    ds_read_b64_tr_b16 a[74:75], v233 offset:8192
    ds_read_b64_tr_b16 a[76:77], v234 offset:8192
    ds_read_b64_tr_b16 a[78:79], v235 offset:8192
    ds_read_b64_tr_b16 a[80:81], v232 offset:16384
    ds_read_b64_tr_b16 a[82:83], v233 offset:16384
    ds_read_b64_tr_b16 a[84:85], v234 offset:16384
    ds_read_b64_tr_b16 a[86:87], v235 offset:16384
    ds_read_b64_tr_b16 a[88:89], v232 offset:24576
    ds_read_b64_tr_b16 a[90:91], v233 offset:24576
    ds_read_b64_tr_b16 a[92:93], v234 offset:24576
    ds_read_b64_tr_b16 a[94:95], v235 offset:24576
    s_waitcnt lgkmcnt(0)
    s_barrier
    s_mul_i32 s63, s53, 768
    s_add_u32 m0, s64, 65536
    s_nop 0
    buffer_load_dwordx4 v2, s[44:47], s63 offen lds
    s_add_u32 s63, s63, s65
    s_add_u32 m0, s64, 66560
    s_nop 0
    buffer_load_dwordx4 v2, s[44:47], s63 offen lds
    s_add_u32 s63, s63, s65
    s_add_u32 m0, s64, 67584
    s_nop 0
    buffer_load_dwordx4 v2, s[44:47], s63 offen lds
    s_add_u32 s63, s63, s65
    s_add_u32 m0, s64, 68608
    s_nop 0
    buffer_load_dwordx4 v2, s[44:47], s63 offen lds
    s_add_u32 s63, s63, s65
    s_add_u32 m0, s64, 69632
    s_nop 0
    buffer_load_dwordx4 v2, s[44:47], s63 offen lds
    s_add_u32 s63, s63, s65
    s_add_u32 m0, s64, 70656
    s_nop 0
    buffer_load_dwordx4 v2, s[44:47], s63 offen lds
    s_add_u32 s63, s63, s65
    s_add_u32 m0, s64, 71680
    s_nop 0
    buffer_load_dwordx4 v2, s[44:47], s63 offen lds
    s_add_u32 s63, s63, s65
    s_add_u32 m0, s64, 72704
    s_nop 0
    buffer_load_dwordx4 v2, s[44:47], s63 offen lds
    s_waitcnt vmcnt(24)
    s_barrier
    ds_read_b64_tr_b16 a[96:97], v232 offset:32768
    ds_read_b64_tr_b16 a[98:99], v233 offset:32768
    ds_read_b64_tr_b16 a[100:101], v234 offset:32768
    ds_read_b64_tr_b16 a[102:103], v235 offset:32768
    ds_read_b64_tr_b16 a[104:105], v232 offset:40960
    ds_read_b64_tr_b16 a[106:107], v233 offset:40960
    ds_read_b64_tr_b16 a[108:109], v234 offset:40960
    ds_read_b64_tr_b16 a[110:111], v235 offset:40960
    ds_read_b64_tr_b16 a[112:113], v232 offset:49152
    ds_read_b64_tr_b16 a[114:115], v233 offset:49152
    ds_read_b64_tr_b16 a[116:117], v234 offset:49152
    ds_read_b64_tr_b16 a[118:119], v235 offset:49152
    ds_read_b64_tr_b16 a[120:121], v232 offset:57344
    ds_read_b64_tr_b16 a[122:123], v233 offset:57344
    ds_read_b64_tr_b16 a[124:125], v234 offset:57344
    ds_read_b64_tr_b16 a[126:127], v235 offset:57344
    s_waitcnt lgkmcnt(0)
    s_barrier
    s_mul_i32 s63, s53, 896
    s_add_u32 m0, s64, 98304
    s_nop 0
    buffer_load_dwordx4 v2, s[44:47], s63 offen lds
    s_add_u32 s63, s63, s65
    s_add_u32 m0, s64, 99328
    s_nop 0
    buffer_load_dwordx4 v2, s[44:47], s63 offen lds
    s_add_u32 s63, s63, s65
    s_add_u32 m0, s64, 100352
    s_nop 0
    buffer_load_dwordx4 v2, s[44:47], s63 offen lds
    s_add_u32 s63, s63, s65
    s_add_u32 m0, s64, 101376
    s_nop 0
    buffer_load_dwordx4 v2, s[44:47], s63 offen lds
    s_add_u32 s63, s63, s65
    s_add_u32 m0, s64, 102400
    s_nop 0
    buffer_load_dwordx4 v2, s[44:47], s63 offen lds
    s_add_u32 s63, s63, s65
    s_add_u32 m0, s64, 103424
    s_nop 0
    buffer_load_dwordx4 v2, s[44:47], s63 offen lds
    s_add_u32 s63, s63, s65
    s_add_u32 m0, s64, 104448
    s_nop 0
    buffer_load_dwordx4 v2, s[44:47], s63 offen lds
    s_add_u32 s63, s63, s65
    s_add_u32 m0, s64, 105472
    s_nop 0
    buffer_load_dwordx4 v2, s[44:47], s63 offen lds
    s_waitcnt vmcnt(24)
    s_barrier
    ds_read_b64_tr_b16 a[128:129], v228 offset:0
    ds_read_b64_tr_b16 a[130:131], v229 offset:0
    ds_read_b64_tr_b16 a[132:133], v230 offset:0
    ds_read_b64_tr_b16 a[134:135], v231 offset:0
    ds_read_b64_tr_b16 a[136:137], v228 offset:8192
    ds_read_b64_tr_b16 a[138:139], v229 offset:8192
    ds_read_b64_tr_b16 a[140:141], v230 offset:8192
    ds_read_b64_tr_b16 a[142:143], v231 offset:8192
    ds_read_b64_tr_b16 a[144:145], v228 offset:16384
    ds_read_b64_tr_b16 a[146:147], v229 offset:16384
    ds_read_b64_tr_b16 a[148:149], v230 offset:16384
    ds_read_b64_tr_b16 a[150:151], v231 offset:16384
    ds_read_b64_tr_b16 a[152:153], v228 offset:24576
    ds_read_b64_tr_b16 a[154:155], v229 offset:24576
    ds_read_b64_tr_b16 a[156:157], v230 offset:24576
    ds_read_b64_tr_b16 a[158:159], v231 offset:24576
    s_waitcnt lgkmcnt(0)
    s_barrier
    v_cmp_gt_u32 vcc, 1, v18
    s_cbranch_vccz L_t5_go
    s_mov_b32 s88, 0
L_wf_28:
    s_add_u32 s88, s88, 1
    s_mov_b32 s89, 13
    s_cmp_ge_u32 s88, 262144
    s_cbranch_scc1 L_abort
    buffer_load_dword v247, v17, s[32:35], 0 offen sc1
    s_waitcnt vmcnt(0)
    v_cmp_gt_u32 vcc, 1, v247
    s_cbranch_vccnz L_wf_28
L_t5_go:
    s_lshl_b32 s67, s30, 10
    s_mul_i32 s85, s55, 7
    s_sub_u32 s84, s56, s85
    s_add_u32 s85, s85, s56
    s_sub_u32 s85, 0x10000, s85
    s_sub_u32 s57, s57, s85
    s_add_u32 m0, s67, 0
    s_add_u32 s57, s57, s85
    buffer_load_dwordx4 v95, s[48:51], s57 offen lds
    s_add_u32 m0, s67, 4096
    s_add_u32 s57, s57, s55
    buffer_load_dwordx4 v95, s[48:51], s57 offen lds
    s_add_u32 m0, s67, 8192
    s_add_u32 s57, s57, s55
    buffer_load_dwordx4 v95, s[48:51], s57 offen lds
    s_add_u32 m0, s67, 12288
    s_add_u32 s57, s57, s55
    buffer_load_dwordx4 v95, s[48:51], s57 offen lds
    s_add_u32 m0, s67, 16384
    s_add_u32 s57, s57, s55
    buffer_load_dwordx4 v95, s[48:51], s57 offen lds
    s_add_u32 m0, s67, 20480
    s_add_u32 s57, s57, s55
    buffer_load_dwordx4 v95, s[48:51], s57 offen lds
    s_add_u32 m0, s67, 24576
    s_add_u32 s57, s57, s55
    buffer_load_dwordx4 v95, s[48:51], s57 offen lds
    s_add_u32 m0, s67, 28672
    s_add_u32 s57, s57, s55
    buffer_load_dwordx4 v95, s[48:51], s57 offen lds
    s_waitcnt vmcnt(24)
    s_barrier
    ds_read_b64_tr_b16 a[160:161], v228 offset:32768
    ds_read_b64_tr_b16 a[162:163], v229 offset:32768
    ds_read_b64_tr_b16 a[164:165], v230 offset:32768
    ds_read_b64_tr_b16 a[166:167], v231 offset:32768
    ds_read_b64_tr_b16 a[168:169], v228 offset:40960
    ds_read_b64_tr_b16 a[170:171], v229 offset:40960
    ds_read_b64_tr_b16 a[172:173], v230 offset:40960
    ds_read_b64_tr_b16 a[174:175], v231 offset:40960
    ds_read_b64_tr_b16 a[176:177], v228 offset:49152
    ds_read_b64_tr_b16 a[178:179], v229 offset:49152
    ds_read_b64_tr_b16 a[180:181], v230 offset:49152
    ds_read_b64_tr_b16 a[182:183], v231 offset:49152
    ds_read_b64_tr_b16 a[184:185], v228 offset:57344
    ds_read_b64_tr_b16 a[186:187], v229 offset:57344
    ds_read_b64_tr_b16 a[188:189], v230 offset:57344
    ds_read_b64_tr_b16 a[190:191], v231 offset:57344
    s_waitcnt lgkmcnt(0)
    s_barrier
    s_add_u32 m0, s67, 32768
    s_add_u32 s57, s57, s84
    buffer_load_dwordx4 v95, s[48:51], s57 offen lds
    s_add_u32 m0, s67, 36864
    s_add_u32 s57, s57, s55
    buffer_load_dwordx4 v95, s[48:51], s57 offen lds
    s_add_u32 m0, s67, 40960
    s_add_u32 s57, s57, s55
    buffer_load_dwordx4 v95, s[48:51], s57 offen lds
    s_add_u32 m0, s67, 45056
    s_add_u32 s57, s57, s55
    buffer_load_dwordx4 v95, s[48:51], s57 offen lds
    s_add_u32 m0, s67, 49152
    s_add_u32 s57, s57, s55
    buffer_load_dwordx4 v95, s[48:51], s57 offen lds
    s_add_u32 m0, s67, 53248
    s_add_u32 s57, s57, s55
    buffer_load_dwordx4 v95, s[48:51], s57 offen lds
    s_add_u32 m0, s67, 57344
    s_add_u32 s57, s57, s55
    buffer_load_dwordx4 v95, s[48:51], s57 offen lds
    s_add_u32 m0, s67, 61440
    s_add_u32 s57, s57, s55
    buffer_load_dwordx4 v95, s[48:51], s57 offen lds
    s_waitcnt vmcnt(24)
    s_barrier
    ds_read_b64_tr_b16 a[192:193], v232 offset:0
    ds_read_b64_tr_b16 a[194:195], v233 offset:0
    ds_read_b64_tr_b16 a[196:197], v234 offset:0
    ds_read_b64_tr_b16 a[198:199], v235 offset:0
    ds_read_b64_tr_b16 a[200:201], v232 offset:8192
    ds_read_b64_tr_b16 a[202:203], v233 offset:8192
    ds_read_b64_tr_b16 a[204:205], v234 offset:8192
    ds_read_b64_tr_b16 a[206:207], v235 offset:8192
    ds_read_b64_tr_b16 a[208:209], v232 offset:16384
    ds_read_b64_tr_b16 a[210:211], v233 offset:16384
    ds_read_b64_tr_b16 a[212:213], v234 offset:16384
    ds_read_b64_tr_b16 a[214:215], v235 offset:16384
    ds_read_b64_tr_b16 a[216:217], v232 offset:24576
    ds_read_b64_tr_b16 a[218:219], v233 offset:24576
    ds_read_b64_tr_b16 a[220:221], v234 offset:24576
    ds_read_b64_tr_b16 a[222:223], v235 offset:24576
    s_waitcnt lgkmcnt(0)
    s_barrier
    s_add_u32 m0, s67, 65536
    s_add_u32 s57, s57, s85
    buffer_load_dwordx4 v95, s[48:51], s57 offen lds
    s_add_u32 m0, s67, 69632
    s_add_u32 s57, s57, s55
    buffer_load_dwordx4 v95, s[48:51], s57 offen lds
    s_add_u32 m0, s67, 73728
    s_add_u32 s57, s57, s55
    buffer_load_dwordx4 v95, s[48:51], s57 offen lds
    s_add_u32 m0, s67, 77824
    s_add_u32 s57, s57, s55
    buffer_load_dwordx4 v95, s[48:51], s57 offen lds
    s_add_u32 m0, s67, 81920
    s_add_u32 s57, s57, s55
    buffer_load_dwordx4 v95, s[48:51], s57 offen lds
    s_waitcnt vmcnt(21)
    s_barrier
    ds_read_b64_tr_b16 a[224:225], v232 offset:32768
    ds_read_b64_tr_b16 a[226:227], v233 offset:32768
    ds_read_b64_tr_b16 a[228:229], v234 offset:32768
    ds_read_b64_tr_b16 a[230:231], v235 offset:32768
    ds_read_b64_tr_b16 a[232:233], v232 offset:40960
    ds_read_b64_tr_b16 a[234:235], v233 offset:40960
    ds_read_b64_tr_b16 a[236:237], v234 offset:40960
    ds_read_b64_tr_b16 a[238:239], v235 offset:40960
    ds_read_b64_tr_b16 a[240:241], v232 offset:49152
    ds_read_b64_tr_b16 a[242:243], v233 offset:49152
    ds_read_b64_tr_b16 a[244:245], v234 offset:49152
    ds_read_b64_tr_b16 a[246:247], v235 offset:49152
    ds_read_b64_tr_b16 a[248:249], v232 offset:57344
    ds_read_b64_tr_b16 a[250:251], v233 offset:57344
    ds_read_b64_tr_b16 a[252:253], v234 offset:57344
    ds_read_b64_tr_b16 a[254:255], v235 offset:57344
    s_waitcnt lgkmcnt(0)
    s_barrier
    s_lshl_b32 s66, s69, 18
    s_lshl_b32 s70, s68, 8
    s_add_u32 s66, s66, s70
    s_lshl_b32 s70, s30, 6
    s_add_u32 s66, s66, s70
    s_mov_b32 s59, 131072
    s_and_b32 s70, s75, 1
    s_lshl_b32 s61, 2, s70
    s_mov_b32 s62, 1.0
    v_mov_b32 v16, 0x0
    v_and_b32 v246, 0x1000, v240
    v_xor_b32 v16, v16, v246
    v_and_b32 v246, 0x2000, v241
    v_xor_b32 v16, v16, v246
    v_and_b32 v246, 0x4000, v242
    v_xor_b32 v16, v16, v246
    v_and_b32 v246, 0x8000, v243
    v_xor_b32 v16, v16, v246
    v_and_b32 v246, 0x10, v244
    v_xor_b32 v16, v16, v246
    v_and_b32 v246, 0x20, v245
    v_xor_b32 v16, v16, v246
    v_add_u32 v19, 0x10000, v16
    s_mov_b32 s58, 0x7fff0000
    s_mov_b32 s60, 0
    s_waitcnt vmcnt(13)
    s_barrier
    ds_read_b128 v[20:23], v8 offset:0
    ds_read_b128 v[24:27], v9 offset:0
    ds_read_b128 v[28:31], v10 offset:0
    ds_read_b128 v[32:35], v11 offset:0
    ds_read_b128 v[36:39], v8 offset:4096
    ds_read_b128 v[40:43], v9 offset:4096
L_ws_E4:
    s_waitcnt lgkmcnt(4)
    v_mfma_f32_16x16x32_bf16 v[52:55], a[0:3], v[20:23], 0
    s_add_u32 m0, s67, 86016
    s_add_u32 s57, s57, s55
    v_mfma_f32_16x16x32_bf16 v[56:59], a[0:3], v[24:27], 0
    buffer_load_dwordx4 v95, s[48:51], s57 offen lds
    v_mfma_f32_16x16x32_bf16 v[60:63], a[4:7], v[20:23], 0
    ds_read_b128 v[44:47], v10 offset:4096
    v_mfma_f32_16x16x32_bf16 v[64:67], a[4:7], v[24:27], 0
    ds_read_b128 v[48:51], v11 offset:4096
    s_waitcnt lgkmcnt(4)
    v_mfma_f32_16x16x32_bf16 v[52:55], a[8:11], v[28:31], v[52:55]
    s_add_u32 m0, s67, 90112
    s_add_u32 s57, s57, s55
    v_mfma_f32_16x16x32_bf16 v[56:59], a[8:11], v[32:35], v[56:59]
    buffer_load_dwordx4 v95, s[48:51], s57 offen lds
    v_mfma_f32_16x16x32_bf16 v[60:63], a[12:15], v[28:31], v[60:63]
    ds_read_b128 v[20:23], v8 offset:8192
    v_mfma_f32_16x16x32_bf16 v[64:67], a[12:15], v[32:35], v[64:67]
    ds_read_b128 v[24:27], v9 offset:8192
    s_waitcnt lgkmcnt(4)
    v_mfma_f32_16x16x32_bf16 v[52:55], a[16:19], v[36:39], v[52:55]
    s_add_u32 m0, s67, 94208
    s_add_u32 s57, s57, s55
    v_mfma_f32_16x16x32_bf16 v[56:59], a[16:19], v[40:43], v[56:59]
    buffer_load_dwordx4 v95, s[48:51], s57 offen lds
    v_mfma_f32_16x16x32_bf16 v[60:63], a[20:23], v[36:39], v[60:63]
    ds_read_b128 v[28:31], v10 offset:8192
    v_mfma_f32_16x16x32_bf16 v[64:67], a[20:23], v[40:43], v[64:67]
    ds_read_b128 v[32:35], v11 offset:8192
    s_waitcnt lgkmcnt(4)
    v_mfma_f32_16x16x32_bf16 v[52:55], a[24:27], v[44:47], v[52:55]
    v_cvt_pk_bf16_f32 v84, v68, v69
    v_cvt_pk_bf16_f32 v85, v70, v71
    v_mfma_f32_16x16x32_bf16 v[56:59], a[24:27], v[48:51], v[56:59]
    v_mfma_f32_16x16x32_bf16 v[60:63], a[28:31], v[44:47], v[60:63]
    ds_read_b128 v[36:39], v8 offset:12288
    v_mfma_f32_16x16x32_bf16 v[64:67], a[28:31], v[48:51], v[64:67]
    ds_read_b128 v[40:43], v9 offset:12288
    s_waitcnt lgkmcnt(4)
    v_mfma_f32_16x16x32_bf16 v[52:55], a[32:35], v[20:23], v[52:55]
    v_cvt_pk_bf16_f32 v86, v76, v77
    v_cvt_pk_bf16_f32 v87, v78, v79
    v_mfma_f32_16x16x32_bf16 v[56:59], a[32:35], v[24:27], v[56:59]
    v_mfma_f32_16x16x32_bf16 v[60:63], a[36:39], v[20:23], v[60:63]
    ds_read_b128 v[44:47], v10 offset:12288
    v_mfma_f32_16x16x32_bf16 v[64:67], a[36:39], v[24:27], v[64:67]
    ds_read_b128 v[48:51], v11 offset:12288
    s_waitcnt lgkmcnt(4)
    v_mfma_f32_16x16x32_bf16 v[52:55], a[40:43], v[28:31], v[52:55]
    v_cvt_pk_bf16_f32 v88, v72, v73
    v_cvt_pk_bf16_f32 v89, v74, v75
    v_mfma_f32_16x16x32_bf16 v[56:59], a[40:43], v[32:35], v[56:59]
    v_mfma_f32_16x16x32_bf16 v[60:63], a[44:47], v[28:31], v[60:63]
    ds_read_b128 v[20:23], v8 offset:16384
    v_mfma_f32_16x16x32_bf16 v[64:67], a[44:47], v[32:35], v[64:67]
    ds_read_b128 v[24:27], v9 offset:16384
    s_waitcnt lgkmcnt(4)
    v_mfma_f32_16x16x32_bf16 v[52:55], a[48:51], v[36:39], v[52:55]
    v_cvt_pk_bf16_f32 v90, v80, v81
    v_cvt_pk_bf16_f32 v91, v82, v83
    v_mfma_f32_16x16x32_bf16 v[56:59], a[48:51], v[40:43], v[56:59]
    v_mfma_f32_16x16x32_bf16 v[60:63], a[52:55], v[36:39], v[60:63]
    ds_read_b128 v[28:31], v10 offset:16384
    v_mfma_f32_16x16x32_bf16 v[64:67], a[52:55], v[40:43], v[64:67]
    ds_read_b128 v[32:35], v11 offset:16384
    s_waitcnt lgkmcnt(4)
    v_mfma_f32_16x16x32_bf16 v[52:55], a[56:59], v[44:47], v[52:55]
    v_mfma_f32_16x16x32_bf16 v[56:59], a[56:59], v[48:51], v[56:59]
    v_mfma_f32_16x16x32_bf16 v[60:63], a[60:63], v[44:47], v[60:63]
    ds_read_b128 v[36:39], v8 offset:20480
    v_mfma_f32_16x16x32_bf16 v[64:67], a[60:63], v[48:51], v[64:67]
    ds_read_b128 v[40:43], v9 offset:20480
    s_waitcnt lgkmcnt(4)
    v_mfma_f32_16x16x32_bf16 v[52:55], a[64:67], v[20:23], v[52:55]
    v_mfma_f32_16x16x32_bf16 v[56:59], a[64:67], v[24:27], v[56:59]
    v_mfma_f32_16x16x32_bf16 v[60:63], a[68:71], v[20:23], v[60:63]
    ds_read_b128 v[44:47], v10 offset:20480
    v_mfma_f32_16x16x32_bf16 v[64:67], a[68:71], v[24:27], v[64:67]
    ds_read_b128 v[48:51], v11 offset:20480
    s_waitcnt lgkmcnt(4)
    v_mfma_f32_16x16x32_bf16 v[52:55], a[72:75], v[28:31], v[52:55]
    buffer_store_dwordx4 v[84:87], v16, s[40:43], s58 offen
    v_mfma_f32_16x16x32_bf16 v[56:59], a[72:75], v[32:35], v[56:59]
    v_mfma_f32_16x16x32_bf16 v[60:63], a[76:79], v[28:31], v[60:63]
    ds_read_b128 v[20:23], v8 offset:24576
    v_mfma_f32_16x16x32_bf16 v[64:67], a[76:79], v[32:35], v[64:67]
    ds_read_b128 v[24:27], v9 offset:24576
    s_waitcnt lgkmcnt(4)
    v_mfma_f32_16x16x32_bf16 v[52:55], a[80:83], v[36:39], v[52:55]
    buffer_store_dwordx4 v[88:91], v19, s[40:43], s58 offen
    v_mfma_f32_16x16x32_bf16 v[56:59], a[80:83], v[40:43], v[56:59]
    s_mov_b32 s58, s66
    s_add_u32 s66, s66, s59
    v_mfma_f32_16x16x32_bf16 v[60:63], a[84:87], v[36:39], v[60:63]
    ds_read_b128 v[28:31], v10 offset:24576
    v_mfma_f32_16x16x32_bf16 v[64:67], a[84:87], v[40:43], v[64:67]
    ds_read_b128 v[32:35], v11 offset:24576
    s_waitcnt lgkmcnt(4)
    v_mfma_f32_16x16x32_bf16 v[52:55], a[88:91], v[44:47], v[52:55]
    s_waitcnt vmcnt(10)
    s_barrier
    v_mfma_f32_16x16x32_bf16 v[56:59], a[88:91], v[48:51], v[56:59]
    s_add_u32 m0, s67, 98304
    s_add_u32 s57, s57, s84
    buffer_load_dwordx4 v95, s[48:51], s57 offen lds
    v_mfma_f32_16x16x32_bf16 v[60:63], a[92:95], v[44:47], v[60:63]
    ds_read_b128 v[36:39], v8 offset:28672
    v_mfma_f32_16x16x32_bf16 v[64:67], a[92:95], v[48:51], v[64:67]
    ds_read_b128 v[40:43], v9 offset:28672
    s_waitcnt lgkmcnt(4)
    v_mfma_f32_16x16x32_bf16 v[52:55], a[96:99], v[20:23], v[52:55]
    s_add_u32 m0, s67, 102400
    s_add_u32 s57, s57, s55
    v_mfma_f32_16x16x32_bf16 v[56:59], a[96:99], v[24:27], v[56:59]
    buffer_load_dwordx4 v95, s[48:51], s57 offen lds
    v_mfma_f32_16x16x32_bf16 v[60:63], a[100:103], v[20:23], v[60:63]
    ds_read_b128 v[44:47], v10 offset:28672
    v_mfma_f32_16x16x32_bf16 v[64:67], a[100:103], v[24:27], v[64:67]
    ds_read_b128 v[48:51], v11 offset:28672
    s_waitcnt lgkmcnt(4)
    v_mfma_f32_16x16x32_bf16 v[52:55], a[104:107], v[28:31], v[52:55]
    s_add_u32 m0, s67, 106496
    s_add_u32 s57, s57, s55
    v_mfma_f32_16x16x32_bf16 v[56:59], a[104:107], v[32:35], v[56:59]
    buffer_load_dwordx4 v95, s[48:51], s57 offen lds
    v_mfma_f32_16x16x32_bf16 v[60:63], a[108:111], v[28:31], v[60:63]
    ds_read_b128 v[20:23], v8 offset:32768
    v_mfma_f32_16x16x32_bf16 v[64:67], a[108:111], v[32:35], v[64:67]
    ds_read_b128 v[24:27], v9 offset:32768
    s_waitcnt lgkmcnt(4)
    v_mfma_f32_16x16x32_bf16 v[52:55], a[112:115], v[36:39], v[52:55]
    s_add_u32 m0, s67, 110592
    s_add_u32 s57, s57, s55
    v_mfma_f32_16x16x32_bf16 v[56:59], a[112:115], v[40:43], v[56:59]
    buffer_load_dwordx4 v95, s[48:51], s57 offen lds
    v_mfma_f32_16x16x32_bf16 v[60:63], a[116:119], v[36:39], v[60:63]
    ds_read_b128 v[28:31], v10 offset:32768
    v_mfma_f32_16x16x32_bf16 v[64:67], a[116:119], v[40:43], v[64:67]
    ds_read_b128 v[32:35], v11 offset:32768
    s_waitcnt lgkmcnt(4)
    v_mfma_f32_16x16x32_bf16 v[52:55], a[120:123], v[44:47], v[52:55]
    s_add_u32 m0, s67, 114688
    s_add_u32 s57, s57, s55
    v_mfma_f32_16x16x32_bf16 v[56:59], a[120:123], v[48:51], v[56:59]
    buffer_load_dwordx4 v95, s[48:51], s57 offen lds
    v_mfma_f32_16x16x32_bf16 v[60:63], a[124:127], v[44:47], v[60:63]
    ds_read_b128 v[36:39], v8 offset:36864
    v_mfma_f32_16x16x32_bf16 v[64:67], a[124:127], v[48:51], v[64:67]
    ds_read_b128 v[40:43], v9 offset:36864
    s_waitcnt lgkmcnt(4)
    v_mfma_f32_16x16x32_bf16 v[52:55], a[128:131], v[20:23], v[52:55]
    s_add_u32 m0, s67, 118784
    s_add_u32 s57, s57, s55
    v_mfma_f32_16x16x32_bf16 v[56:59], a[128:131], v[24:27], v[56:59]
    buffer_load_dwordx4 v95, s[48:51], s57 offen lds
    v_mfma_f32_16x16x32_bf16 v[60:63], a[132:135], v[20:23], v[60:63]
    ds_read_b128 v[44:47], v10 offset:36864
    v_mfma_f32_16x16x32_bf16 v[64:67], a[132:135], v[24:27], v[64:67]
    ds_read_b128 v[48:51], v11 offset:36864
    s_waitcnt lgkmcnt(4)
    v_mfma_f32_16x16x32_bf16 v[52:55], a[136:139], v[28:31], v[52:55]
    s_add_u32 m0, s67, 122880
    s_add_u32 s57, s57, s55
    v_mfma_f32_16x16x32_bf16 v[56:59], a[136:139], v[32:35], v[56:59]
    buffer_load_dwordx4 v95, s[48:51], s57 offen lds
    v_mfma_f32_16x16x32_bf16 v[60:63], a[140:143], v[28:31], v[60:63]
    ds_read_b128 v[20:23], v8 offset:40960
    v_mfma_f32_16x16x32_bf16 v[64:67], a[140:143], v[32:35], v[64:67]
    ds_read_b128 v[24:27], v9 offset:40960
    s_waitcnt lgkmcnt(4)
    v_mfma_f32_16x16x32_bf16 v[52:55], a[144:147], v[36:39], v[52:55]
    s_add_u32 m0, s67, 126976
    s_add_u32 s57, s57, s55
    v_mfma_f32_16x16x32_bf16 v[56:59], a[144:147], v[40:43], v[56:59]
    buffer_load_dwordx4 v95, s[48:51], s57 offen lds
    v_mfma_f32_16x16x32_bf16 v[60:63], a[148:151], v[36:39], v[60:63]
    ds_read_b128 v[28:31], v10 offset:40960
    v_mfma_f32_16x16x32_bf16 v[64:67], a[148:151], v[40:43], v[64:67]
    ds_read_b128 v[32:35], v11 offset:40960
    s_waitcnt lgkmcnt(4)
    v_mfma_f32_16x16x32_bf16 v[52:55], a[152:155], v[44:47], v[52:55]
    v_mfma_f32_16x16x32_bf16 v[56:59], a[152:155], v[48:51], v[56:59]
    v_mfma_f32_16x16x32_bf16 v[60:63], a[156:159], v[44:47], v[60:63]
    ds_read_b128 v[36:39], v8 offset:45056
    v_mfma_f32_16x16x32_bf16 v[64:67], a[156:159], v[48:51], v[64:67]
    ds_read_b128 v[40:43], v9 offset:45056
    s_waitcnt lgkmcnt(4)
    v_mfma_f32_16x16x32_bf16 v[52:55], a[160:163], v[20:23], v[52:55]
    v_mfma_f32_16x16x32_bf16 v[56:59], a[160:163], v[24:27], v[56:59]
    v_mfma_f32_16x16x32_bf16 v[60:63], a[164:167], v[20:23], v[60:63]
    ds_read_b128 v[44:47], v10 offset:45056
    v_mfma_f32_16x16x32_bf16 v[64:67], a[164:167], v[24:27], v[64:67]
    ds_read_b128 v[48:51], v11 offset:45056
    s_waitcnt lgkmcnt(4)
    v_mfma_f32_16x16x32_bf16 v[52:55], a[168:171], v[28:31], v[52:55]
    v_mfma_f32_16x16x32_bf16 v[56:59], a[168:171], v[32:35], v[56:59]
    v_mfma_f32_16x16x32_bf16 v[60:63], a[172:175], v[28:31], v[60:63]
    ds_read_b128 v[20:23], v8 offset:49152
    v_mfma_f32_16x16x32_bf16 v[64:67], a[172:175], v[32:35], v[64:67]
    ds_read_b128 v[24:27], v9 offset:49152
    s_waitcnt lgkmcnt(4)
    v_mfma_f32_16x16x32_bf16 v[52:55], a[176:179], v[36:39], v[52:55]
    v_mfma_f32_16x16x32_bf16 v[56:59], a[176:179], v[40:43], v[56:59]
    v_mfma_f32_16x16x32_bf16 v[60:63], a[180:183], v[36:39], v[60:63]
    ds_read_b128 v[28:31], v10 offset:49152
    v_mfma_f32_16x16x32_bf16 v[64:67], a[180:183], v[40:43], v[64:67]
    ds_read_b128 v[32:35], v11 offset:49152
    s_waitcnt lgkmcnt(4)
    v_mfma_f32_16x16x32_bf16 v[52:55], a[184:187], v[44:47], v[52:55]
    v_mfma_f32_16x16x32_bf16 v[56:59], a[184:187], v[48:51], v[56:59]
    v_mfma_f32_16x16x32_bf16 v[60:63], a[188:191], v[44:47], v[60:63]
    ds_read_b128 v[36:39], v8 offset:53248
    v_mfma_f32_16x16x32_bf16 v[64:67], a[188:191], v[48:51], v[64:67]
    ds_read_b128 v[40:43], v9 offset:53248
    s_waitcnt lgkmcnt(4)
    v_mfma_f32_16x16x32_bf16 v[52:55], a[192:195], v[20:23], v[52:55]
    v_mfma_f32_16x16x32_bf16 v[56:59], a[192:195], v[24:27], v[56:59]
    v_mfma_f32_16x16x32_bf16 v[60:63], a[196:199], v[20:23], v[60:63]
    ds_read_b128 v[44:47], v10 offset:53248
    v_mfma_f32_16x16x32_bf16 v[64:67], a[196:199], v[24:27], v[64:67]
    ds_read_b128 v[48:51], v11 offset:53248
    s_waitcnt lgkmcnt(4)
    v_mfma_f32_16x16x32_bf16 v[52:55], a[200:203], v[28:31], v[52:55]
    v_mfma_f32_16x16x32_bf16 v[56:59], a[200:203], v[32:35], v[56:59]
    v_mfma_f32_16x16x32_bf16 v[60:63], a[204:207], v[28:31], v[60:63]
    ds_read_b128 v[20:23], v8 offset:57344
    v_mfma_f32_16x16x32_bf16 v[64:67], a[204:207], v[32:35], v[64:67]
    ds_read_b128 v[24:27], v9 offset:57344
    s_waitcnt lgkmcnt(4)
    v_mfma_f32_16x16x32_bf16 v[52:55], a[208:211], v[36:39], v[52:55]
    v_mfma_f32_16x16x32_bf16 v[56:59], a[208:211], v[40:43], v[56:59]
    v_mfma_f32_16x16x32_bf16 v[60:63], a[212:215], v[36:39], v[60:63]
    ds_read_b128 v[28:31], v10 offset:57344
    v_mfma_f32_16x16x32_bf16 v[64:67], a[212:215], v[40:43], v[64:67]
    ds_read_b128 v[32:35], v11 offset:57344
    s_waitcnt lgkmcnt(4)
    v_mfma_f32_16x16x32_bf16 v[52:55], a[216:219], v[44:47], v[52:55]
    s_waitcnt vmcnt(10)
    s_barrier
    v_mfma_f32_16x16x32_bf16 v[56:59], a[216:219], v[48:51], v[56:59]
    s_add_u32 m0, s67, 0
    s_add_u32 s57, s57, s85
    buffer_load_dwordx4 v95, s[48:51], s57 offen lds
    v_mfma_f32_16x16x32_bf16 v[60:63], a[220:223], v[44:47], v[60:63]
    ds_read_b128 v[36:39], v8 offset:61440
    v_mfma_f32_16x16x32_bf16 v[64:67], a[220:223], v[48:51], v[64:67]
    ds_read_b128 v[40:43], v9 offset:61440
    s_waitcnt lgkmcnt(4)
    v_mfma_f32_16x16x32_bf16 v[52:55], a[224:227], v[20:23], v[52:55]
    s_add_u32 m0, s67, 4096
    s_add_u32 s57, s57, s55
    v_mfma_f32_16x16x32_bf16 v[56:59], a[224:227], v[24:27], v[56:59]
    buffer_load_dwordx4 v95, s[48:51], s57 offen lds
    v_mfma_f32_16x16x32_bf16 v[60:63], a[228:231], v[20:23], v[60:63]
    ds_read_b128 v[44:47], v10 offset:61440
    v_mfma_f32_16x16x32_bf16 v[64:67], a[228:231], v[24:27], v[64:67]
    ds_read_b128 v[48:51], v11 offset:61440
    s_waitcnt lgkmcnt(4)
    v_mfma_f32_16x16x32_bf16 v[52:55], a[232:235], v[28:31], v[52:55]
    s_add_u32 m0, s67, 8192
    s_add_u32 s57, s57, s55
    v_mfma_f32_16x16x32_bf16 v[56:59], a[232:235], v[32:35], v[56:59]
    buffer_load_dwordx4 v95, s[48:51], s57 offen lds
    v_mfma_f32_16x16x32_bf16 v[60:63], a[236:239], v[28:31], v[60:63]
    ds_read_b128 v[20:23], v12 offset:0
    v_mfma_f32_16x16x32_bf16 v[64:67], a[236:239], v[32:35], v[64:67]
    ds_read_b128 v[24:27], v13 offset:0
    s_waitcnt lgkmcnt(4)
    v_mfma_f32_16x16x32_bf16 v[52:55], a[240:243], v[36:39], v[52:55]
    s_add_u32 s60, s60, 1
    s_add_u32 m0, s67, 12288
    v_mfma_f32_16x16x32_bf16 v[56:59], a[240:243], v[40:43], v[56:59]
    s_add_u32 s57, s57, s55
    buffer_load_dwordx4 v95, s[48:51], s57 offen lds
    v_mfma_f32_16x16x32_bf16 v[60:63], a[244:247], v[36:39], v[60:63]
    ds_read_b128 v[28:31], v14 offset:0
    v_mfma_f32_16x16x32_bf16 v[64:67], a[244:247], v[40:43], v[64:67]
    ds_read_b128 v[32:35], v15 offset:0
    s_waitcnt lgkmcnt(4)
    v_mfma_f32_16x16x32_bf16 v[52:55], a[248:251], v[44:47], v[52:55]
    s_add_u32 m0, s67, 16384
    s_add_u32 s57, s57, s55
    v_mfma_f32_16x16x32_bf16 v[56:59], a[248:251], v[48:51], v[56:59]
    buffer_load_dwordx4 v95, s[48:51], s57 offen lds
    v_mfma_f32_16x16x32_bf16 v[60:63], a[252:255], v[44:47], v[60:63]
    ds_read_b128 v[36:39], v12 offset:4096
    v_mfma_f32_16x16x32_bf16 v[64:67], a[252:255], v[48:51], v[64:67]
    ds_read_b128 v[40:43], v13 offset:4096
    s_waitcnt lgkmcnt(4)
    v_mfma_f32_16x16x32_bf16 v[68:71], a[0:3], v[20:23], 0
    s_add_u32 m0, s67, 20480
    s_add_u32 s57, s57, s55
    v_mfma_f32_16x16x32_bf16 v[72:75], a[0:3], v[24:27], 0
    buffer_load_dwordx4 v95, s[48:51], s57 offen lds
    v_mfma_f32_16x16x32_bf16 v[76:79], a[4:7], v[20:23], 0
    ds_read_b128 v[44:47], v14 offset:4096
    v_mfma_f32_16x16x32_bf16 v[80:83], a[4:7], v[24:27], 0
    ds_read_b128 v[48:51], v15 offset:4096
    s_waitcnt lgkmcnt(4)
    v_mfma_f32_16x16x32_bf16 v[68:71], a[8:11], v[28:31], v[68:71]
    s_add_u32 m0, s67, 24576
    s_add_u32 s57, s57, s55
    v_mfma_f32_16x16x32_bf16 v[72:75], a[8:11], v[32:35], v[72:75]
    buffer_load_dwordx4 v95, s[48:51], s57 offen lds
    v_mfma_f32_16x16x32_bf16 v[76:79], a[12:15], v[28:31], v[76:79]
    ds_read_b128 v[20:23], v12 offset:8192
    v_mfma_f32_16x16x32_bf16 v[80:83], a[12:15], v[32:35], v[80:83]
    ds_read_b128 v[24:27], v13 offset:8192
    s_waitcnt lgkmcnt(4)
    v_mfma_f32_16x16x32_bf16 v[68:71], a[16:19], v[36:39], v[68:71]
    s_add_u32 m0, s67, 28672
    s_add_u32 s57, s57, s55
    v_mfma_f32_16x16x32_bf16 v[72:75], a[16:19], v[40:43], v[72:75]
    buffer_load_dwordx4 v95, s[48:51], s57 offen lds
    v_mfma_f32_16x16x32_bf16 v[76:79], a[20:23], v[36:39], v[76:79]
    ds_read_b128 v[28:31], v14 offset:8192
    v_mfma_f32_16x16x32_bf16 v[80:83], a[20:23], v[40:43], v[80:83]
    ds_read_b128 v[32:35], v15 offset:8192
    s_waitcnt lgkmcnt(4)
    v_mfma_f32_16x16x32_bf16 v[68:71], a[24:27], v[44:47], v[68:71]
    v_cvt_pk_bf16_f32 v84, v52, v53
    v_cvt_pk_bf16_f32 v85, v54, v55
    v_mfma_f32_16x16x32_bf16 v[72:75], a[24:27], v[48:51], v[72:75]
    v_mfma_f32_16x16x32_bf16 v[76:79], a[28:31], v[44:47], v[76:79]
    ds_read_b128 v[36:39], v12 offset:12288
    v_mfma_f32_16x16x32_bf16 v[80:83], a[28:31], v[48:51], v[80:83]
    ds_read_b128 v[40:43], v13 offset:12288
    s_waitcnt lgkmcnt(4)
    v_mfma_f32_16x16x32_bf16 v[68:71], a[32:35], v[20:23], v[68:71]
    v_cvt_pk_bf16_f32 v86, v60, v61
    v_cvt_pk_bf16_f32 v87, v62, v63
    v_mfma_f32_16x16x32_bf16 v[72:75], a[32:35], v[24:27], v[72:75]
    v_mfma_f32_16x16x32_bf16 v[76:79], a[36:39], v[20:23], v[76:79]
    ds_read_b128 v[44:47], v14 offset:12288
    v_mfma_f32_16x16x32_bf16 v[80:83], a[36:39], v[24:27], v[80:83]
    ds_read_b128 v[48:51], v15 offset:12288
    s_waitcnt lgkmcnt(4)
    v_mfma_f32_16x16x32_bf16 v[68:71], a[40:43], v[28:31], v[68:71]
    v_cvt_pk_bf16_f32 v88, v56, v57
    v_cvt_pk_bf16_f32 v89, v58, v59
    v_mfma_f32_16x16x32_bf16 v[72:75], a[40:43], v[32:35], v[72:75]
    v_mfma_f32_16x16x32_bf16 v[76:79], a[44:47], v[28:31], v[76:79]
    ds_read_b128 v[20:23], v12 offset:16384
    v_mfma_f32_16x16x32_bf16 v[80:83], a[44:47], v[32:35], v[80:83]
    ds_read_b128 v[24:27], v13 offset:16384
    s_waitcnt lgkmcnt(4)
    v_mfma_f32_16x16x32_bf16 v[68:71], a[48:51], v[36:39], v[68:71]
    v_cvt_pk_bf16_f32 v90, v64, v65
    v_cvt_pk_bf16_f32 v91, v66, v67
    v_mfma_f32_16x16x32_bf16 v[72:75], a[48:51], v[40:43], v[72:75]
    v_mfma_f32_16x16x32_bf16 v[76:79], a[52:55], v[36:39], v[76:79]
    ds_read_b128 v[28:31], v14 offset:16384
    v_mfma_f32_16x16x32_bf16 v[80:83], a[52:55], v[40:43], v[80:83]
    ds_read_b128 v[32:35], v15 offset:16384
    s_waitcnt lgkmcnt(4)
    v_mfma_f32_16x16x32_bf16 v[68:71], a[56:59], v[44:47], v[68:71]
    v_mfma_f32_16x16x32_bf16 v[72:75], a[56:59], v[48:51], v[72:75]
    v_mfma_f32_16x16x32_bf16 v[76:79], a[60:63], v[44:47], v[76:79]
    ds_read_b128 v[36:39], v12 offset:20480
    v_mfma_f32_16x16x32_bf16 v[80:83], a[60:63], v[48:51], v[80:83]
    ds_read_b128 v[40:43], v13 offset:20480
    s_waitcnt lgkmcnt(4)
    v_mfma_f32_16x16x32_bf16 v[68:71], a[64:67], v[20:23], v[68:71]
    v_mfma_f32_16x16x32_bf16 v[72:75], a[64:67], v[24:27], v[72:75]
    v_mfma_f32_16x16x32_bf16 v[76:79], a[68:71], v[20:23], v[76:79]
    ds_read_b128 v[44:47], v14 offset:20480
    v_mfma_f32_16x16x32_bf16 v[80:83], a[68:71], v[24:27], v[80:83]
    ds_read_b128 v[48:51], v15 offset:20480
    s_waitcnt lgkmcnt(4)
    v_mfma_f32_16x16x32_bf16 v[68:71], a[72:75], v[28:31], v[68:71]
    buffer_store_dwordx4 v[84:87], v16, s[40:43], s58 offen
    v_mfma_f32_16x16x32_bf16 v[72:75], a[72:75], v[32:35], v[72:75]
    v_mfma_f32_16x16x32_bf16 v[76:79], a[76:79], v[28:31], v[76:79]
    ds_read_b128 v[20:23], v12 offset:24576
    v_mfma_f32_16x16x32_bf16 v[80:83], a[76:79], v[32:35], v[80:83]
    ds_read_b128 v[24:27], v13 offset:24576
    s_waitcnt lgkmcnt(4)
    v_mfma_f32_16x16x32_bf16 v[68:71], a[80:83], v[36:39], v[68:71]
    buffer_store_dwordx4 v[88:91], v19, s[40:43], s58 offen
    v_mfma_f32_16x16x32_bf16 v[72:75], a[80:83], v[40:43], v[72:75]
    s_mov_b32 s58, s66
    s_add_u32 s66, s66, s59
    v_mfma_f32_16x16x32_bf16 v[76:79], a[84:87], v[36:39], v[76:79]
    ds_read_b128 v[28:31], v14 offset:24576
    v_mfma_f32_16x16x32_bf16 v[80:83], a[84:87], v[40:43], v[80:83]
    ds_read_b128 v[32:35], v15 offset:24576
    s_waitcnt lgkmcnt(4)
    v_mfma_f32_16x16x32_bf16 v[68:71], a[88:91], v[44:47], v[68:71]
    s_waitcnt vmcnt(10)
    s_barrier
    v_mfma_f32_16x16x32_bf16 v[72:75], a[88:91], v[48:51], v[72:75]
    s_add_u32 m0, s67, 32768
    s_add_u32 s57, s57, s84
    buffer_load_dwordx4 v95, s[48:51], s57 offen lds
    v_mfma_f32_16x16x32_bf16 v[76:79], a[92:95], v[44:47], v[76:79]
    ds_read_b128 v[36:39], v12 offset:28672
    v_mfma_f32_16x16x32_bf16 v[80:83], a[92:95], v[48:51], v[80:83]
    ds_read_b128 v[40:43], v13 offset:28672
    s_waitcnt lgkmcnt(4)
    v_mfma_f32_16x16x32_bf16 v[68:71], a[96:99], v[20:23], v[68:71]
    s_add_u32 m0, s67, 36864
    s_add_u32 s57, s57, s55
    v_mfma_f32_16x16x32_bf16 v[72:75], a[96:99], v[24:27], v[72:75]
    buffer_load_dwordx4 v95, s[48:51], s57 offen lds
    v_mfma_f32_16x16x32_bf16 v[76:79], a[100:103], v[20:23], v[76:79]
    ds_read_b128 v[44:47], v14 offset:28672
    v_mfma_f32_16x16x32_bf16 v[80:83], a[100:103], v[24:27], v[80:83]
    ds_read_b128 v[48:51], v15 offset:28672
    s_waitcnt lgkmcnt(4)
    v_mfma_f32_16x16x32_bf16 v[68:71], a[104:107], v[28:31], v[68:71]
    s_add_u32 m0, s67, 40960
    s_add_u32 s57, s57, s55
    v_mfma_f32_16x16x32_bf16 v[72:75], a[104:107], v[32:35], v[72:75]
    buffer_load_dwordx4 v95, s[48:51], s57 offen lds
    v_mfma_f32_16x16x32_bf16 v[76:79], a[108:111], v[28:31], v[76:79]
    ds_read_b128 v[20:23], v12 offset:32768
    v_mfma_f32_16x16x32_bf16 v[80:83], a[108:111], v[32:35], v[80:83]
    ds_read_b128 v[24:27], v13 offset:32768
    s_waitcnt lgkmcnt(4)
    v_mfma_f32_16x16x32_bf16 v[68:71], a[112:115], v[36:39], v[68:71]
    s_add_u32 m0, s67, 45056
    s_add_u32 s57, s57, s55
    v_mfma_f32_16x16x32_bf16 v[72:75], a[112:115], v[40:43], v[72:75]
    buffer_load_dwordx4 v95, s[48:51], s57 offen lds
    v_mfma_f32_16x16x32_bf16 v[76:79], a[116:119], v[36:39], v[76:79]
    ds_read_b128 v[28:31], v14 offset:32768
    v_mfma_f32_16x16x32_bf16 v[80:83], a[116:119], v[40:43], v[80:83]
    ds_read_b128 v[32:35], v15 offset:32768
    s_waitcnt lgkmcnt(4)
    v_mfma_f32_16x16x32_bf16 v[68:71], a[120:123], v[44:47], v[68:71]
    s_add_u32 m0, s67, 49152
    s_add_u32 s57, s57, s55
    v_mfma_f32_16x16x32_bf16 v[72:75], a[120:123], v[48:51], v[72:75]
    buffer_load_dwordx4 v95, s[48:51], s57 offen lds
    v_mfma_f32_16x16x32_bf16 v[76:79], a[124:127], v[44:47], v[76:79]
    ds_read_b128 v[36:39], v12 offset:36864
    v_mfma_f32_16x16x32_bf16 v[80:83], a[124:127], v[48:51], v[80:83]
    ds_read_b128 v[40:43], v13 offset:36864
    s_waitcnt lgkmcnt(4)
    v_mfma_f32_16x16x32_bf16 v[68:71], a[128:131], v[20:23], v[68:71]
    s_add_u32 m0, s67, 53248
    s_add_u32 s57, s57, s55
    v_mfma_f32_16x16x32_bf16 v[72:75], a[128:131], v[24:27], v[72:75]
    buffer_load_dwordx4 v95, s[48:51], s57 offen lds
    v_mfma_f32_16x16x32_bf16 v[76:79], a[132:135], v[20:23], v[76:79]
    ds_read_b128 v[44:47], v14 offset:36864
    v_mfma_f32_16x16x32_bf16 v[80:83], a[132:135], v[24:27], v[80:83]
    ds_read_b128 v[48:51], v15 offset:36864
    s_waitcnt lgkmcnt(4)
    v_mfma_f32_16x16x32_bf16 v[68:71], a[136:139], v[28:31], v[68:71]
    s_add_u32 m0, s67, 57344
    s_add_u32 s57, s57, s55
    v_mfma_f32_16x16x32_bf16 v[72:75], a[136:139], v[32:35], v[72:75]
    buffer_load_dwordx4 v95, s[48:51], s57 offen lds
    v_mfma_f32_16x16x32_bf16 v[76:79], a[140:143], v[28:31], v[76:79]
    ds_read_b128 v[20:23], v12 offset:40960
    v_mfma_f32_16x16x32_bf16 v[80:83], a[140:143], v[32:35], v[80:83]
    ds_read_b128 v[24:27], v13 offset:40960
    s_waitcnt lgkmcnt(4)
    v_mfma_f32_16x16x32_bf16 v[68:71], a[144:147], v[36:39], v[68:71]
    s_add_u32 m0, s67, 61440
    s_add_u32 s57, s57, s55
    v_mfma_f32_16x16x32_bf16 v[72:75], a[144:147], v[40:43], v[72:75]
    buffer_load_dwordx4 v95, s[48:51], s57 offen lds
    v_mfma_f32_16x16x32_bf16 v[76:79], a[148:151], v[36:39], v[76:79]
    ds_read_b128 v[28:31], v14 offset:40960
    v_mfma_f32_16x16x32_bf16 v[80:83], a[148:151], v[40:43], v[80:83]
    ds_read_b128 v[32:35], v15 offset:40960
    s_waitcnt lgkmcnt(4)
    v_mfma_f32_16x16x32_bf16 v[68:71], a[152:155], v[44:47], v[68:71]
    v_mfma_f32_16x16x32_bf16 v[72:75], a[152:155], v[48:51], v[72:75]
    v_mfma_f32_16x16x32_bf16 v[76:79], a[156:159], v[44:47], v[76:79]
    ds_read_b128 v[36:39], v12 offset:45056
    v_mfma_f32_16x16x32_bf16 v[80:83], a[156:159], v[48:51], v[80:83]
    ds_read_b128 v[40:43], v13 offset:45056
    s_waitcnt lgkmcnt(4)
    v_mfma_f32_16x16x32_bf16 v[68:71], a[160:163], v[20:23], v[68:71]
    v_mfma_f32_16x16x32_bf16 v[72:75], a[160:163], v[24:27], v[72:75]
    v_mfma_f32_16x16x32_bf16 v[76:79], a[164:167], v[20:23], v[76:79]
    ds_read_b128 v[44:47], v14 offset:45056
    v_mfma_f32_16x16x32_bf16 v[80:83], a[164:167], v[24:27], v[80:83]
    ds_read_b128 v[48:51], v15 offset:45056
    s_waitcnt lgkmcnt(4)
    v_mfma_f32_16x16x32_bf16 v[68:71], a[168:171], v[28:31], v[68:71]
    v_mfma_f32_16x16x32_bf16 v[72:75], a[168:171], v[32:35], v[72:75]
    v_mfma_f32_16x16x32_bf16 v[76:79], a[172:175], v[28:31], v[76:79]
    ds_read_b128 v[20:23], v12 offset:49152
    v_mfma_f32_16x16x32_bf16 v[80:83], a[172:175], v[32:35], v[80:83]
    ds_read_b128 v[24:27], v13 offset:49152
    s_waitcnt lgkmcnt(4)
    v_mfma_f32_16x16x32_bf16 v[68:71], a[176:179], v[36:39], v[68:71]
    v_mfma_f32_16x16x32_bf16 v[72:75], a[176:179], v[40:43], v[72:75]
    v_mfma_f32_16x16x32_bf16 v[76:79], a[180:183], v[36:39], v[76:79]
    ds_read_b128 v[28:31], v14 offset:49152
    v_mfma_f32_16x16x32_bf16 v[80:83], a[180:183], v[40:43], v[80:83]
    ds_read_b128 v[32:35], v15 offset:49152
    s_waitcnt lgkmcnt(4)
    v_mfma_f32_16x16x32_bf16 v[68:71], a[184:187], v[44:47], v[68:71]
    v_mfma_f32_16x16x32_bf16 v[72:75], a[184:187], v[48:51], v[72:75]
    v_mfma_f32_16x16x32_bf16 v[76:79], a[188:191], v[44:47], v[76:79]
    ds_read_b128 v[36:39], v12 offset:53248
    v_mfma_f32_16x16x32_bf16 v[80:83], a[188:191], v[48:51], v[80:83]
    ds_read_b128 v[40:43], v13 offset:53248
    s_waitcnt lgkmcnt(4)
    v_mfma_f32_16x16x32_bf16 v[68:71], a[192:195], v[20:23], v[68:71]
    v_mfma_f32_16x16x32_bf16 v[72:75], a[192:195], v[24:27], v[72:75]
    v_mfma_f32_16x16x32_bf16 v[76:79], a[196:199], v[20:23], v[76:79]
    ds_read_b128 v[44:47], v14 offset:53248
    v_mfma_f32_16x16x32_bf16 v[80:83], a[196:199], v[24:27], v[80:83]
    ds_read_b128 v[48:51], v15 offset:53248
    s_waitcnt lgkmcnt(4)
    v_mfma_f32_16x16x32_bf16 v[68:71], a[200:203], v[28:31], v[68:71]
    v_mfma_f32_16x16x32_bf16 v[72:75], a[200:203], v[32:35], v[72:75]
    v_mfma_f32_16x16x32_bf16 v[76:79], a[204:207], v[28:31], v[76:79]
    ds_read_b128 v[20:23], v12 offset:57344
    v_mfma_f32_16x16x32_bf16 v[80:83], a[204:207], v[32:35], v[80:83]
    ds_read_b128 v[24:27], v13 offset:57344
    s_waitcnt lgkmcnt(4)
    v_mfma_f32_16x16x32_bf16 v[68:71], a[208:211], v[36:39], v[68:71]
    v_mfma_f32_16x16x32_bf16 v[72:75], a[208:211], v[40:43], v[72:75]
    v_mfma_f32_16x16x32_bf16 v[76:79], a[212:215], v[36:39], v[76:79]
    ds_read_b128 v[28:31], v14 offset:57344
    v_mfma_f32_16x16x32_bf16 v[80:83], a[212:215], v[40:43], v[80:83]
    ds_read_b128 v[32:35], v15 offset:57344
    s_waitcnt lgkmcnt(4)
    v_mfma_f32_16x16x32_bf16 v[68:71], a[216:219], v[44:47], v[68:71]
    s_waitcnt vmcnt(10)
    s_barrier
    v_mfma_f32_16x16x32_bf16 v[72:75], a[216:219], v[48:51], v[72:75]
    s_add_u32 m0, s67, 65536
    s_add_u32 s57, s57, s85
    buffer_load_dwordx4 v95, s[48:51], s57 offen lds
    v_mfma_f32_16x16x32_bf16 v[76:79], a[220:223], v[44:47], v[76:79]
    ds_read_b128 v[36:39], v12 offset:61440
    v_mfma_f32_16x16x32_bf16 v[80:83], a[220:223], v[48:51], v[80:83]
    ds_read_b128 v[40:43], v13 offset:61440
    s_waitcnt lgkmcnt(4)
    v_mfma_f32_16x16x32_bf16 v[68:71], a[224:227], v[20:23], v[68:71]
    s_add_u32 m0, s67, 69632
    s_add_u32 s57, s57, s55
    v_mfma_f32_16x16x32_bf16 v[72:75], a[224:227], v[24:27], v[72:75]
    buffer_load_dwordx4 v95, s[48:51], s57 offen lds
    v_mfma_f32_16x16x32_bf16 v[76:79], a[228:231], v[20:23], v[76:79]
    ds_read_b128 v[44:47], v14 offset:61440
    v_mfma_f32_16x16x32_bf16 v[80:83], a[228:231], v[24:27], v[80:83]
    ds_read_b128 v[48:51], v15 offset:61440
    s_waitcnt lgkmcnt(4)
    v_mfma_f32_16x16x32_bf16 v[68:71], a[232:235], v[28:31], v[68:71]
    s_add_u32 m0, s67, 73728
    s_add_u32 s57, s57, s55
    v_mfma_f32_16x16x32_bf16 v[72:75], a[232:235], v[32:35], v[72:75]
    buffer_load_dwordx4 v95, s[48:51], s57 offen lds
    v_mfma_f32_16x16x32_bf16 v[76:79], a[236:239], v[28:31], v[76:79]
    ds_read_b128 v[20:23], v8 offset:0
    v_mfma_f32_16x16x32_bf16 v[80:83], a[236:239], v[32:35], v[80:83]
    ds_read_b128 v[24:27], v9 offset:0
    s_waitcnt lgkmcnt(4)
    v_mfma_f32_16x16x32_bf16 v[68:71], a[240:243], v[36:39], v[68:71]
    s_add_u32 s60, s60, 1
    s_add_u32 m0, s67, 77824
    v_mfma_f32_16x16x32_bf16 v[72:75], a[240:243], v[40:43], v[72:75]
    s_add_u32 s57, s57, s55
    buffer_load_dwordx4 v95, s[48:51], s57 offen lds
    v_mfma_f32_16x16x32_bf16 v[76:79], a[244:247], v[36:39], v[76:79]
    ds_read_b128 v[28:31], v10 offset:0
    v_mfma_f32_16x16x32_bf16 v[80:83], a[244:247], v[40:43], v[80:83]
    ds_read_b128 v[32:35], v11 offset:0
    s_waitcnt lgkmcnt(4)
    v_mfma_f32_16x16x32_bf16 v[68:71], a[248:251], v[44:47], v[68:71]
    s_add_u32 m0, s67, 81920
    s_add_u32 s57, s57, s55
    v_mfma_f32_16x16x32_bf16 v[72:75], a[248:251], v[48:51], v[72:75]
    buffer_load_dwordx4 v95, s[48:51], s57 offen lds
    v_mfma_f32_16x16x32_bf16 v[76:79], a[252:255], v[44:47], v[76:79]
    ds_read_b128 v[36:39], v8 offset:4096
    v_mfma_f32_16x16x32_bf16 v[80:83], a[252:255], v[48:51], v[80:83]
    ds_read_b128 v[40:43], v9 offset:4096
    s_cmp_lt_u32 s60, s61
    s_cbranch_scc1 L_ws_E4
    v_cvt_pk_bf16_f32 v84, v68, v69
    v_cvt_pk_bf16_f32 v85, v70, v71
    s_nop 0
    v_cvt_pk_bf16_f32 v86, v76, v77
    v_cvt_pk_bf16_f32 v87, v78, v79
    v_cvt_pk_bf16_f32 v88, v72, v73
    v_cvt_pk_bf16_f32 v89, v74, v75
    v_cvt_pk_bf16_f32 v90, v80, v81
    v_cvt_pk_bf16_f32 v91, v82, v83
    buffer_store_dwordx4 v[84:87], v16, s[40:43], s58 offen
    buffer_store_dwordx4 v[88:91], v19, s[40:43], s58 offen
    s_waitcnt vmcnt(0) lgkmcnt(0)
    s_barrier
    s_cmp_lt_u32 s31, 128
    s_cbranch_scc1 L_fin
L_t7:
    s_lshr_b32 s68, s77, 5
    s_and_b32 s69, s77, 7
    s_lshr_b32 s70, s77, 3
    s_and_b32 s70, s70, 3
    s_mov_b32 s44, s20
    s_and_b32 s45, s21, 0xffff
    s_mov_b32 s46, 0x800000
    s_mov_b32 s47, 0x00020000
    s_mov_b32 s53, 2048
    s_lshl_b32 s54, s68, 21
    s_lshl_b32 s80, s69, 8
    s_add_u32 s54, s54, s80
    v_mov_b32 v95, 0x0
    v_and_b32 v246, 0x10, v240
    v_xor_b32 v95, v95, v246
    v_and_b32 v246, 0x20, v241
    v_xor_b32 v95, v95, v246
    v_and_b32 v246, 0x40, v242
    v_xor_b32 v95, v95, v246
    v_and_b32 v246, 0x80, v243
    v_xor_b32 v95, v95, v246
    v_and_b32 v246, 0x100, v244
    v_xor_b32 v95, v95, v246
    v_and_b32 v246, 0x200, v245
    v_xor_b32 v95, v95, v246
    s_lshl_b32 s63, s30, 10
    v_add_u32 v95, s63, v95
    s_mov_b32 s55, 4096
    s_mov_b32 s56, 32768
    v_mov_b32 v8, 0x0
    v_and_b32 v246, 0x10, v240
    v_xor_b32 v8, v8, v246
    v_and_b32 v246, 0x20, v241
    v_xor_b32 v8, v8, v246
    v_and_b32 v246, 0x40, v242
    v_xor_b32 v8, v8, v246
    v_and_b32 v246, 0x80, v243
    v_xor_b32 v8, v8, v246
    v_and_b32 v246, 0x200, v244
    v_xor_b32 v8, v8, v246
    v_and_b32 v246, 0x400, v245
    v_xor_b32 v8, v8, v246
    v_mov_b32 v9, 0x100
    v_and_b32 v246, 0x10, v240
    v_xor_b32 v9, v9, v246
    v_and_b32 v246, 0x20, v241
    v_xor_b32 v9, v9, v246
    v_and_b32 v246, 0x40, v242
    v_xor_b32 v9, v9, v246
    v_and_b32 v246, 0x80, v243
    v_xor_b32 v9, v9, v246
    v_and_b32 v246, 0x200, v244
    v_xor_b32 v9, v9, v246
    v_and_b32 v246, 0x400, v245
    v_xor_b32 v9, v9, v246
    v_mov_b32 v10, 0x800
    v_and_b32 v246, 0x10, v240
    v_xor_b32 v10, v10, v246
    v_and_b32 v246, 0x20, v241
    v_xor_b32 v10, v10, v246
    v_and_b32 v246, 0x40, v242
    v_xor_b32 v10, v10, v246
    v_and_b32 v246, 0x80, v243
    v_xor_b32 v10, v10, v246
    v_and_b32 v246, 0x200, v244
    v_xor_b32 v10, v10, v246
    v_and_b32 v246, 0x400, v245
    v_xor_b32 v10, v10, v246
    v_mov_b32 v11, 0x900
    v_and_b32 v246, 0x10, v240
    v_xor_b32 v11, v11, v246
    v_and_b32 v246, 0x20, v241
    v_xor_b32 v11, v11, v246
    v_and_b32 v246, 0x40, v242
    v_xor_b32 v11, v11, v246
    v_and_b32 v246, 0x80, v243
    v_xor_b32 v11, v11, v246
    v_and_b32 v246, 0x200, v244
    v_xor_b32 v11, v11, v246
    v_and_b32 v246, 0x400, v245
    v_xor_b32 v11, v11, v246
    v_add_u32 v12, 0x10000, v8
    v_add_u32 v13, 0x10000, v9
    v_add_u32 v14, 0x10000, v10
    v_add_u32 v15, 0x10000, v11
    s_xor_b32 s80, s95, 8192
    s_lshl_b32 s81, s80, 1
    s_sub_u32 s81, 0x2000, s81
    s_add_u32 s71, s81, 1044480
    s_sub_u32 s72, 1044480, s81
    s_sub_u32 s73, 0xff90f000, s81
    s_lshl_b32 s57, s68, 23
    s_add_u32 s57, s57, s80
    s_add_u32 s57, s57, s94
    s_add_u32 s57, s57, 104857600
    s_lshl_b32 s80, s70, 14
    s_add_u32 s57, s57, s80
    s_sub_u32 s57, s57, s73
    s_lshl_b32 s81, s68, 5
    s_lshr_b32 s80, s81, 6
    s_lshl_b32 s80, s80, 14
    s_and_b32 s74, s81, 63
    s_lshl_b32 s74, s74, 7
    s_add_u32 s80, s80, s74
    s_add_u32 s80, s80, s94
    s_add_u32 s80, s80, s95
    s_add_u32 s80, s80, 1245184
    v_mov_b32 v166, 0x0
    v_and_b32 v246, 0x80, v240
    v_xor_b32 v166, v166, v246
    v_and_b32 v246, 0x100, v241
    v_xor_b32 v166, v166, v246
    v_and_b32 v246, 0x200, v242
    v_xor_b32 v166, v166, v246
    v_and_b32 v246, 0x400, v243
    v_xor_b32 v166, v166, v246
    v_and_b32 v246, 0x800, v244
    v_xor_b32 v166, v166, v246
    v_add_u32 v166, s80, v166
    s_and_b32 s80, s77, 31
    s_lshl_b32 s80, s80, 2
    s_add_u32 s80, s80, s30
    s_lshr_b32 s81, s80, 4
    s_and_b32 s81, s81, 1
    s_lshl_b32 s81, s81, 13
    s_xor_b32 s81, s81, s95
    s_xor_b32 s81, s81, 0x2000
    s_add_u32 s81, s81, s94
    s_add_u32 s81, s81, 138412032
    s_lshl_b32 s80, s80, 17
    s_add_u32 s80, s80, s81
    s_lshl_b32 s81, s68, 11
    v_mov_b32 v164, 0x0
    v_and_b32 v246, 0x10, v240
    v_xor_b32 v164, v164, v246
    v_and_b32 v246, 0x20, v241
    v_xor_b32 v164, v164, v246
    v_and_b32 v246, 0x40, v242
    v_xor_b32 v164, v164, v246
    v_and_b32 v246, 0x80, v243
    v_xor_b32 v164, v164, v246
    v_and_b32 v246, 0x100, v244
    v_xor_b32 v164, v164, v246
    v_and_b32 v246, 0x200, v245
    v_xor_b32 v164, v164, v246
    v_add_u32 v164, s80, v164
    v_add_u32 v164, s81, v164
    s_lshr_b32 s81, s68, 1
    s_lshl_b32 s81, s81, 10
    s_add_u32 s80, s80, s81
    s_and_b32 s81, s68, 1
    s_lshl_b32 s81, s81, 7
    v_mov_b32 v165, 0x0
    v_and_b32 v246, 0x10, v240
    v_xor_b32 v165, v165, v246
    v_and_b32 v246, 0x20, v241
    v_xor_b32 v165, v165, v246
    v_and_b32 v246, 0x40, v242
    v_xor_b32 v165, v165, v246
    v_and_b32 v246, 0x100, v243
    v_xor_b32 v165, v165, v246
    v_and_b32 v246, 0x800, v244
    v_xor_b32 v165, v165, v246
    v_and_b32 v246, 0x1000, v245
    v_xor_b32 v165, v165, v246
    v_add_u32 v165, s80, v165
    v_add_u32 v165, s81, v165
    v_mov_b32 v184, 0x0
    s_mov_b32 s86, 0x1010101
    s_mov_b32 s87, 0x1010101
    v_mov_b32 v246, 0x3f80
    v_cndmask_b32 v184, v184, v246, s[86:87]
    s_mov_b32 s86, 0x2020202
    s_mov_b32 s87, 0x2020202
    v_mov_b32 v246, 0x3f800000
    v_cndmask_b32 v184, v184, v246, s[86:87]
    v_mov_b32 v185, 0x0
    s_mov_b32 s86, 0x8080808
    s_mov_b32 s87, 0x8080808
    v_mov_b32 v246, 0x3f800000
    v_cndmask_b32 v185, v185, v246, s[86:87]
    s_mov_b32 s86, 0x4040404
    s_mov_b32 s87, 0x4040404
    v_mov_b32 v246, 0x3f80
    v_cndmask_b32 v185, v185, v246, s[86:87]
    v_mov_b32 v186, 0x0
    s_mov_b32 s86, 0x20202020
    s_mov_b32 s87, 0x20202020
    v_mov_b32 v246, 0x3f800000
    v_cndmask_b32 v186, v186, v246, s[86:87]
    s_mov_b32 s86, 0x10101010
    s_mov_b32 s87, 0x10101010
    v_mov_b32 v246, 0x3f80
    v_cndmask_b32 v186, v186, v246, s[86:87]
    v_mov_b32 v187, 0x0
    s_mov_b32 s86, 0x80808080
    s_mov_b32 s87, 0x80808080
    v_mov_b32 v246, 0x3f800000
    v_cndmask_b32 v187, v187, v246, s[86:87]
    s_mov_b32 s86, 0x40404040
    s_mov_b32 s87, 0x40404040
    v_mov_b32 v246, 0x3f80
    v_cndmask_b32 v187, v187, v246, s[86:87]
    s_and_b32 s80, s77, 31
    s_lshl_b32 s80, s80, 7
    v_mov_b32 v168, 0x8000
    v_and_b32 v246, 0x1000, v240
    v_xor_b32 v168, v168, v246
    v_and_b32 v246, 0x2000, v241
    v_xor_b32 v168, v168, v246
    v_add_u32 v168, s80, v168
    s_lshl_b32 s80, s77, 7
    s_cmp_eq_u32 s30, 0
    s_cselect_b32 s80, s80, 0x7fff0000
    v_mov_b32 v170, 0x8000
    v_add_u32 v170, s80, v170
    s_mov_b32 s86, 0x1
    s_mov_b32 s87, 0x0
    v_mov_b32 v246, 0x7fff0000
    v_cndmask_b32 v170, v246, v170, s[86:87]
    s_lshl_b32 s80, s68, 15
    s_lshl_b32 s81, s69, 8
    s_add_u32 s80, s80, s81
    s_lshl_b32 s81, s30, 6
    s_add_u32 s80, s80, s81
    s_lshl_b32 s81, s70, 17
    v_mov_b32 v171, 0x800
    v_and_b32 v246, 0x1000, v240
    v_xor_b32 v171, v171, v246
    v_and_b32 v246, 0x2000, v241
    v_xor_b32 v171, v171, v246
    v_and_b32 v246, 0x4000, v242
    v_xor_b32 v171, v171, v246
    v_and_b32 v246, 0x10, v243
    v_xor_b32 v171, v171, v246
    v_and_b32 v246, 0x8, v244
    v_xor_b32 v171, v171, v246
    v_and_b32 v246, 0x20, v245
    v_xor_b32 v171, v171, v246
    v_add_u32 v171, s80, v171
    v_add_u32 v171, s81, v171
    s_mov_b32 s61, 16
    s_add_u32 s74, s70, 5
    v_mov_b32 v188, -1
    v_mov_b32 v189, -1
    v_mov_b32 v190, -1
    v_mov_b32 v191, -1
    buffer_load_dword v167, v166, s[32:35], 0 offen sc1
    v_mov_b32 v2, 0x0
    v_and_b32 v246, 0x10, v240
    v_xor_b32 v2, v2, v246
    v_and_b32 v246, 0x20, v241
    v_xor_b32 v2, v2, v246
    v_and_b32 v246, 0x40, v242
    v_xor_b32 v2, v2, v246
    v_and_b32 v246, 0x80, v243
    v_xor_b32 v2, v2, v246
    v_and_b32 v246, 0x40, v244
    v_xor_b32 v2, v2, v246
    v_and_b32 v246, 0x80, v245
    v_xor_b32 v2, v2, v246
    v_lshrrev_b32 v3, 4, v1
    v_mul_lo_u32 v3, v3, s53
    v_add_u32 v2, v2, v3
    s_lshl_b32 s63, s30, 5
    s_mul_i32 s63, s63, s53
    s_add_u32 s63, s63, s54
    v_add_u32 v2, s63, v2
    s_lshl_b32 s65, s53, 2
    s_lshl_b32 s64, s30, 13
    s_cmp_eq_u32 s99, 1
    s_mov_b32 s99, 0
    s_cbranch_scc1 L_lw_29
    s_mul_i32 s63, s53, 0
    s_add_u32 m0, s64, 0
    s_nop 0
    buffer_load_dwordx4 v2, s[44:47], s63 offen lds
    s_add_u32 s63, s63, s65
    s_add_u32 m0, s64, 1024
    s_nop 0
    buffer_load_dwordx4 v2, s[44:47], s63 offen lds
    s_add_u32 s63, s63, s65
    s_add_u32 m0, s64, 2048
    s_nop 0
    buffer_load_dwordx4 v2, s[44:47], s63 offen lds
    s_add_u32 s63, s63, s65
    s_add_u32 m0, s64, 3072
    s_nop 0
    buffer_load_dwordx4 v2, s[44:47], s63 offen lds
    s_add_u32 s63, s63, s65
    s_add_u32 m0, s64, 4096
    s_nop 0
    buffer_load_dwordx4 v2, s[44:47], s63 offen lds
    s_add_u32 s63, s63, s65
    s_add_u32 m0, s64, 5120
    s_nop 0
    buffer_load_dwordx4 v2, s[44:47], s63 offen lds
    s_add_u32 s63, s63, s65
    s_add_u32 m0, s64, 6144
    s_nop 0
    buffer_load_dwordx4 v2, s[44:47], s63 offen lds
    s_add_u32 s63, s63, s65
    s_add_u32 m0, s64, 7168
    s_nop 0
    buffer_load_dwordx4 v2, s[44:47], s63 offen lds
    s_mul_i32 s63, s53, 128
    s_add_u32 m0, s64, 32768
    s_nop 0
    buffer_load_dwordx4 v2, s[44:47], s63 offen lds
    s_add_u32 s63, s63, s65
    s_add_u32 m0, s64, 33792
    s_nop 0
    buffer_load_dwordx4 v2, s[44:47], s63 offen lds
    s_add_u32 s63, s63, s65
    s_add_u32 m0, s64, 34816
    s_nop 0
    buffer_load_dwordx4 v2, s[44:47], s63 offen lds
    s_add_u32 s63, s63, s65
    s_add_u32 m0, s64, 35840
    s_nop 0
    buffer_load_dwordx4 v2, s[44:47], s63 offen lds
    s_add_u32 s63, s63, s65
    s_add_u32 m0, s64, 36864
    s_nop 0
    buffer_load_dwordx4 v2, s[44:47], s63 offen lds
    s_add_u32 s63, s63, s65
    s_add_u32 m0, s64, 37888
    s_nop 0
    buffer_load_dwordx4 v2, s[44:47], s63 offen lds
    s_add_u32 s63, s63, s65
    s_add_u32 m0, s64, 38912
    s_nop 0
    buffer_load_dwordx4 v2, s[44:47], s63 offen lds
    s_add_u32 s63, s63, s65
    s_add_u32 m0, s64, 39936
    s_nop 0
    buffer_load_dwordx4 v2, s[44:47], s63 offen lds
    s_mul_i32 s63, s53, 256
    s_add_u32 m0, s64, 65536
    s_nop 0
    buffer_load_dwordx4 v2, s[44:47], s63 offen lds
    s_add_u32 s63, s63, s65
    s_add_u32 m0, s64, 66560
    s_nop 0
    buffer_load_dwordx4 v2, s[44:47], s63 offen lds
    s_add_u32 s63, s63, s65
    s_add_u32 m0, s64, 67584
    s_nop 0
    buffer_load_dwordx4 v2, s[44:47], s63 offen lds
    s_add_u32 s63, s63, s65
    s_add_u32 m0, s64, 68608
    s_nop 0
    buffer_load_dwordx4 v2, s[44:47], s63 offen lds
    s_add_u32 s63, s63, s65
    s_add_u32 m0, s64, 69632
    s_nop 0
    buffer_load_dwordx4 v2, s[44:47], s63 offen lds
    s_add_u32 s63, s63, s65
    s_add_u32 m0, s64, 70656
    s_nop 0
    buffer_load_dwordx4 v2, s[44:47], s63 offen lds
    s_add_u32 s63, s63, s65
    s_add_u32 m0, s64, 71680
    s_nop 0
    buffer_load_dwordx4 v2, s[44:47], s63 offen lds
    s_add_u32 s63, s63, s65
    s_add_u32 m0, s64, 72704
    s_nop 0
    buffer_load_dwordx4 v2, s[44:47], s63 offen lds
    s_mul_i32 s63, s53, 384
    s_add_u32 m0, s64, 98304
    s_nop 0
    buffer_load_dwordx4 v2, s[44:47], s63 offen lds
    s_add_u32 s63, s63, s65
    s_add_u32 m0, s64, 99328
    s_nop 0
    buffer_load_dwordx4 v2, s[44:47], s63 offen lds
    s_add_u32 s63, s63, s65
    s_add_u32 m0, s64, 100352
    s_nop 0
    buffer_load_dwordx4 v2, s[44:47], s63 offen lds
    s_add_u32 s63, s63, s65
    s_add_u32 m0, s64, 101376
    s_nop 0
    buffer_load_dwordx4 v2, s[44:47], s63 offen lds
    s_add_u32 s63, s63, s65
    s_add_u32 m0, s64, 102400
    s_nop 0
    buffer_load_dwordx4 v2, s[44:47], s63 offen lds
    s_add_u32 s63, s63, s65
    s_add_u32 m0, s64, 103424
    s_nop 0
    buffer_load_dwordx4 v2, s[44:47], s63 offen lds
    s_add_u32 s63, s63, s65
    s_add_u32 m0, s64, 104448
    s_nop 0
    buffer_load_dwordx4 v2, s[44:47], s63 offen lds
    s_add_u32 s63, s63, s65
    s_add_u32 m0, s64, 105472
    s_nop 0
    buffer_load_dwordx4 v2, s[44:47], s63 offen lds
L_lw_29:
    s_lshl_b32 s63, s30, 6
    v_mov_b32 v228, 0x0
    v_and_b32 v246, 0x10, v240
    v_xor_b32 v228, v228, v246
    v_and_b32 v246, 0x20, v241
    v_xor_b32 v228, v228, v246
    v_and_b32 v246, 0x140, v242
    v_xor_b32 v228, v228, v246
    v_and_b32 v246, 0x280, v243
    v_xor_b32 v228, v228, v246
    v_and_b32 v246, 0x400, v244
    v_xor_b32 v228, v228, v246
    v_and_b32 v246, 0x800, v245
    v_xor_b32 v228, v228, v246
    v_xor_b32 v228, s63, v228
    v_add_u32 v229, 4096, v228
    v_mov_b32 v230, 0x8
    v_and_b32 v246, 0x10, v240
    v_xor_b32 v230, v230, v246
    v_and_b32 v246, 0x20, v241
    v_xor_b32 v230, v230, v246
    v_and_b32 v246, 0x140, v242
    v_xor_b32 v230, v230, v246
    v_and_b32 v246, 0x280, v243
    v_xor_b32 v230, v230, v246
    v_and_b32 v246, 0x400, v244
    v_xor_b32 v230, v230, v246
    v_and_b32 v246, 0x800, v245
    v_xor_b32 v230, v230, v246
    v_xor_b32 v230, s63, v230
    v_add_u32 v231, 4096, v230
    v_add_u32 v232, 0x10000, v228
    v_add_u32 v233, 0x10000, v229
    v_add_u32 v234, 0x10000, v230
    v_add_u32 v235, 0x10000, v231
    s_waitcnt vmcnt(24)
    s_barrier
    ds_read_b64_tr_b16 a[0:1], v228 offset:0
    ds_read_b64_tr_b16 a[2:3], v229 offset:0
    ds_read_b64_tr_b16 a[4:5], v230 offset:0
    ds_read_b64_tr_b16 a[6:7], v231 offset:0
    ds_read_b64_tr_b16 a[8:9], v228 offset:8192
    ds_read_b64_tr_b16 a[10:11], v229 offset:8192
    ds_read_b64_tr_b16 a[12:13], v230 offset:8192
    ds_read_b64_tr_b16 a[14:15], v231 offset:8192
    ds_read_b64_tr_b16 a[16:17], v228 offset:16384
    ds_read_b64_tr_b16 a[18:19], v229 offset:16384
    ds_read_b64_tr_b16 a[20:21], v230 offset:16384
    ds_read_b64_tr_b16 a[22:23], v231 offset:16384
    ds_read_b64_tr_b16 a[24:25], v228 offset:24576
    ds_read_b64_tr_b16 a[26:27], v229 offset:24576
    ds_read_b64_tr_b16 a[28:29], v230 offset:24576
    ds_read_b64_tr_b16 a[30:31], v231 offset:24576
    s_waitcnt lgkmcnt(0)
    s_barrier
    s_mul_i32 s63, s53, 512
    s_add_u32 m0, s64, 0
    s_nop 0
    buffer_load_dwordx4 v2, s[44:47], s63 offen lds
    s_add_u32 s63, s63, s65
    s_add_u32 m0, s64, 1024
    s_nop 0
    buffer_load_dwordx4 v2, s[44:47], s63 offen lds
    s_add_u32 s63, s63, s65
    s_add_u32 m0, s64, 2048
    s_nop 0
    buffer_load_dwordx4 v2, s[44:47], s63 offen lds
    s_add_u32 s63, s63, s65
    s_add_u32 m0, s64, 3072
    s_nop 0
    buffer_load_dwordx4 v2, s[44:47], s63 offen lds
    s_add_u32 s63, s63, s65
    s_add_u32 m0, s64, 4096
    s_nop 0
    buffer_load_dwordx4 v2, s[44:47], s63 offen lds
    s_add_u32 s63, s63, s65
    s_add_u32 m0, s64, 5120
    s_nop 0
    buffer_load_dwordx4 v2, s[44:47], s63 offen lds
    s_add_u32 s63, s63, s65
    s_add_u32 m0, s64, 6144
    s_nop 0
    buffer_load_dwordx4 v2, s[44:47], s63 offen lds
    s_add_u32 s63, s63, s65
    s_add_u32 m0, s64, 7168
    s_nop 0
    buffer_load_dwordx4 v2, s[44:47], s63 offen lds
    s_waitcnt vmcnt(24)
    s_barrier
    ds_read_b64_tr_b16 a[32:33], v228 offset:32768
    ds_read_b64_tr_b16 a[34:35], v229 offset:32768
    ds_read_b64_tr_b16 a[36:37], v230 offset:32768
    ds_read_b64_tr_b16 a[38:39], v231 offset:32768
    ds_read_b64_tr_b16 a[40:41], v228 offset:40960
    ds_read_b64_tr_b16 a[42:43], v229 offset:40960
    ds_read_b64_tr_b16 a[44:45], v230 offset:40960
    ds_read_b64_tr_b16 a[46:47], v231 offset:40960
    ds_read_b64_tr_b16 a[48:49], v228 offset:49152
    ds_read_b64_tr_b16 a[50:51], v229 offset:49152
    ds_read_b64_tr_b16 a[52:53], v230 offset:49152
    ds_read_b64_tr_b16 a[54:55], v231 offset:49152
    ds_read_b64_tr_b16 a[56:57], v228 offset:57344
    ds_read_b64_tr_b16 a[58:59], v229 offset:57344
    ds_read_b64_tr_b16 a[60:61], v230 offset:57344
    ds_read_b64_tr_b16 a[62:63], v231 offset:57344
    s_waitcnt lgkmcnt(0)
    s_barrier
    s_mul_i32 s63, s53, 640
    s_add_u32 m0, s64, 32768
    s_nop 0
    buffer_load_dwordx4 v2, s[44:47], s63 offen lds
    s_add_u32 s63, s63, s65
    s_add_u32 m0, s64, 33792
    s_nop 0
    buffer_load_dwordx4 v2, s[44:47], s63 offen lds
    s_add_u32 s63, s63, s65
    s_add_u32 m0, s64, 34816
    s_nop 0
    buffer_load_dwordx4 v2, s[44:47], s63 offen lds
    s_add_u32 s63, s63, s65
    s_add_u32 m0, s64, 35840
    s_nop 0
    buffer_load_dwordx4 v2, s[44:47], s63 offen lds
    s_add_u32 s63, s63, s65
    s_add_u32 m0, s64, 36864
    s_nop 0
    buffer_load_dwordx4 v2, s[44:47], s63 offen lds
    s_add_u32 s63, s63, s65
    s_add_u32 m0, s64, 37888
    s_nop 0
    buffer_load_dwordx4 v2, s[44:47], s63 offen lds
    s_add_u32 s63, s63, s65
    s_add_u32 m0, s64, 38912
    s_nop 0
    buffer_load_dwordx4 v2, s[44:47], s63 offen lds
    s_add_u32 s63, s63, s65
    s_add_u32 m0, s64, 39936
    s_nop 0
    buffer_load_dwordx4 v2, s[44:47], s63 offen lds
    s_waitcnt vmcnt(24)
    s_barrier
    ds_read_b64_tr_b16 a[64:65], v232 offset:0
    ds_read_b64_tr_b16 a[66:67], v233 offset:0
    ds_read_b64_tr_b16 a[68:69], v234 offset:0
    ds_read_b64_tr_b16 a[70:71], v235 offset:0
    ds_read_b64_tr_b16 a[72:73], v232 offset:8192
    ds_read_b64_tr_b16 a[74:75], v233 offset:8192
    ds_read_b64_tr_b16 a[76:77], v234 offset:8192
    ds_read_b64_tr_b16 a[78:79], v235 offset:8192
    ds_read_b64_tr_b16 a[80:81], v232 offset:16384
    ds_read_b64_tr_b16 a[82:83], v233 offset:16384
    ds_read_b64_tr_b16 a[84:85], v234 offset:16384
    ds_read_b64_tr_b16 a[86:87], v235 offset:16384
    ds_read_b64_tr_b16 a[88:89], v232 offset:24576
    ds_read_b64_tr_b16 a[90:91], v233 offset:24576
    ds_read_b64_tr_b16 a[92:93], v234 offset:24576
    ds_read_b64_tr_b16 a[94:95], v235 offset:24576
    s_waitcnt lgkmcnt(0)
    s_barrier
    s_mul_i32 s63, s53, 768
    s_add_u32 m0, s64, 65536
    s_nop 0
    buffer_load_dwordx4 v2, s[44:47], s63 offen lds
    s_add_u32 s63, s63, s65
    s_add_u32 m0, s64, 66560
    s_nop 0
    buffer_load_dwordx4 v2, s[44:47], s63 offen lds
    s_add_u32 s63, s63, s65
    s_add_u32 m0, s64, 67584
    s_nop 0
    buffer_load_dwordx4 v2, s[44:47], s63 offen lds
    s_add_u32 s63, s63, s65
    s_add_u32 m0, s64, 68608
    s_nop 0
    buffer_load_dwordx4 v2, s[44:47], s63 offen lds
    s_add_u32 s63, s63, s65
    s_add_u32 m0, s64, 69632
    s_nop 0
    buffer_load_dwordx4 v2, s[44:47], s63 offen lds
    s_add_u32 s63, s63, s65
    s_add_u32 m0, s64, 70656
    s_nop 0
    buffer_load_dwordx4 v2, s[44:47], s63 offen lds
    s_add_u32 s63, s63, s65
    s_add_u32 m0, s64, 71680
    s_nop 0
    buffer_load_dwordx4 v2, s[44:47], s63 offen lds
    s_add_u32 s63, s63, s65
    s_add_u32 m0, s64, 72704
    s_nop 0
    buffer_load_dwordx4 v2, s[44:47], s63 offen lds
    s_waitcnt vmcnt(24)
    s_barrier
    ds_read_b64_tr_b16 a[96:97], v232 offset:32768
    ds_read_b64_tr_b16 a[98:99], v233 offset:32768
    ds_read_b64_tr_b16 a[100:101], v234 offset:32768
    ds_read_b64_tr_b16 a[102:103], v235 offset:32768
    ds_read_b64_tr_b16 a[104:105], v232 offset:40960
    ds_read_b64_tr_b16 a[106:107], v233 offset:40960
    ds_read_b64_tr_b16 a[108:109], v234 offset:40960
    ds_read_b64_tr_b16 a[110:111], v235 offset:40960
    ds_read_b64_tr_b16 a[112:113], v232 offset:49152
    ds_read_b64_tr_b16 a[114:115], v233 offset:49152
    ds_read_b64_tr_b16 a[116:117], v234 offset:49152
    ds_read_b64_tr_b16 a[118:119], v235 offset:49152
    ds_read_b64_tr_b16 a[120:121], v232 offset:57344
    ds_read_b64_tr_b16 a[122:123], v233 offset:57344
    ds_read_b64_tr_b16 a[124:125], v234 offset:57344
    ds_read_b64_tr_b16 a[126:127], v235 offset:57344
    s_waitcnt lgkmcnt(0)
    s_barrier
    s_mul_i32 s63, s53, 896
    s_add_u32 m0, s64, 98304
    s_nop 0
    buffer_load_dwordx4 v2, s[44:47], s63 offen lds
    s_add_u32 s63, s63, s65
    s_add_u32 m0, s64, 99328
    s_nop 0
    buffer_load_dwordx4 v2, s[44:47], s63 offen lds
    s_add_u32 s63, s63, s65
    s_add_u32 m0, s64, 100352
    s_nop 0
    buffer_load_dwordx4 v2, s[44:47], s63 offen lds
    s_add_u32 s63, s63, s65
    s_add_u32 m0, s64, 101376
    s_nop 0
    buffer_load_dwordx4 v2, s[44:47], s63 offen lds
    s_add_u32 s63, s63, s65
    s_add_u32 m0, s64, 102400
    s_nop 0
    buffer_load_dwordx4 v2, s[44:47], s63 offen lds
    s_add_u32 s63, s63, s65
    s_add_u32 m0, s64, 103424
    s_nop 0
    buffer_load_dwordx4 v2, s[44:47], s63 offen lds
    s_add_u32 s63, s63, s65
    s_add_u32 m0, s64, 104448
    s_nop 0
    buffer_load_dwordx4 v2, s[44:47], s63 offen lds
    s_add_u32 s63, s63, s65
    s_add_u32 m0, s64, 105472
    s_nop 0
    buffer_load_dwordx4 v2, s[44:47], s63 offen lds
    s_waitcnt vmcnt(24)
    s_barrier
    ds_read_b64_tr_b16 a[128:129], v228 offset:0
    ds_read_b64_tr_b16 a[130:131], v229 offset:0
    ds_read_b64_tr_b16 a[132:133], v230 offset:0
    ds_read_b64_tr_b16 a[134:135], v231 offset:0
    ds_read_b64_tr_b16 a[136:137], v228 offset:8192
    ds_read_b64_tr_b16 a[138:139], v229 offset:8192
    ds_read_b64_tr_b16 a[140:141], v230 offset:8192
    ds_read_b64_tr_b16 a[142:143], v231 offset:8192
    ds_read_b64_tr_b16 a[144:145], v228 offset:16384
    ds_read_b64_tr_b16 a[146:147], v229 offset:16384
    ds_read_b64_tr_b16 a[148:149], v230 offset:16384
    ds_read_b64_tr_b16 a[150:151], v231 offset:16384
    ds_read_b64_tr_b16 a[152:153], v228 offset:24576
    ds_read_b64_tr_b16 a[154:155], v229 offset:24576
    ds_read_b64_tr_b16 a[156:157], v230 offset:24576
    ds_read_b64_tr_b16 a[158:159], v231 offset:24576
    s_waitcnt lgkmcnt(0)
    s_barrier
    v_cmp_gt_u32 vcc, s74, v167
    s_cbranch_vccz L_q_go
    s_mov_b32 s88, 0
L_wf_30:
    s_add_u32 s88, s88, 1
    s_mov_b32 s89, 16
    s_cmp_ge_u32 s88, 262144
    s_cbranch_scc1 L_abort
    buffer_load_dword v167, v166, s[32:35], 0 offen sc1
    s_waitcnt vmcnt(0)
    v_cmp_gt_u32 vcc, s74, v167
    s_cbranch_vccnz L_wf_30
L_q_go:
    v_min_u32_dpp v167, v167, v167 row_ror:8 row_mask:0xf bank_mask:0xf
    s_nop 1
    v_min_u32_dpp v167, v167, v167 row_ror:4 row_mask:0xf bank_mask:0xf
    s_nop 1
    v_min_u32_dpp v167, v167, v167 row_ror:2 row_mask:0xf bank_mask:0xf
    s_nop 1
    v_min_u32_dpp v167, v167, v167 row_ror:1 row_mask:0xf bank_mask:0xf
    v_mov_b32 v169, v167
    s_nop 1
    v_permlane16_swap_b32 v167, v169
    v_min_u32 v167, v167, v169
    s_nop 0
    v_readfirstlane_b32 s82, v167
    s_lshl_b32 s67, s30, 10
    s_add_u32 m0, s67, 0
    s_add_u32 s57, s57, s73
    buffer_load_dwordx4 v95, s[32:35], s57 offen lds
    s_add_u32 m0, s67, 4096
    s_add_u32 s57, s57, 4096
    buffer_load_dwordx4 v95, s[32:35], s57 offen lds
    s_add_u32 m0, s67, 8192
    s_add_u32 s57, s57, 0xff000
    buffer_load_dwordx4 v95, s[32:35], s57 offen lds
    s_add_u32 m0, s67, 12288
    s_add_u32 s57, s57, 4096
    buffer_load_dwordx4 v95, s[32:35], s57 offen lds
    s_add_u32 m0, s67, 16384
    s_add_u32 s57, s57, s71
    buffer_load_dwordx4 v95, s[32:35], s57 offen lds
    s_add_u32 m0, s67, 20480
    s_add_u32 s57, s57, 4096
    buffer_load_dwordx4 v95, s[32:35], s57 offen lds
    s_add_u32 m0, s67, 24576
    s_add_u32 s57, s57, 0xff000
    buffer_load_dwordx4 v95, s[32:35], s57 offen lds
    s_add_u32 m0, s67, 28672
    s_add_u32 s57, s57, 4096
    buffer_load_dwordx4 v95, s[32:35], s57 offen lds
    s_waitcnt vmcnt(24)
    s_barrier
    ds_read_b64_tr_b16 a[160:161], v228 offset:32768
    ds_read_b64_tr_b16 a[162:163], v229 offset:32768
    ds_read_b64_tr_b16 a[164:165], v230 offset:32768
    ds_read_b64_tr_b16 a[166:167], v231 offset:32768
    ds_read_b64_tr_b16 a[168:169], v228 offset:40960
    ds_read_b64_tr_b16 a[170:171], v229 offset:40960
    ds_read_b64_tr_b16 a[172:173], v230 offset:40960
    ds_read_b64_tr_b16 a[174:175], v231 offset:40960
    ds_read_b64_tr_b16 a[176:177], v228 offset:49152
    ds_read_b64_tr_b16 a[178:179], v229 offset:49152
    ds_read_b64_tr_b16 a[180:181], v230 offset:49152
    ds_read_b64_tr_b16 a[182:183], v231 offset:49152
    ds_read_b64_tr_b16 a[184:185], v228 offset:57344
    ds_read_b64_tr_b16 a[186:187], v229 offset:57344
    ds_read_b64_tr_b16 a[188:189], v230 offset:57344
    ds_read_b64_tr_b16 a[190:191], v231 offset:57344
    s_waitcnt lgkmcnt(0)
    s_barrier
    s_add_u32 m0, s67, 32768
    s_add_u32 s57, s57, s72
    buffer_load_dwordx4 v95, s[32:35], s57 offen lds
    s_add_u32 m0, s67, 36864
    s_add_u32 s57, s57, 4096
    buffer_load_dwordx4 v95, s[32:35], s57 offen lds
    s_add_u32 m0, s67, 40960
    s_add_u32 s57, s57, 0xff000
    buffer_load_dwordx4 v95, s[32:35], s57 offen lds
    s_add_u32 m0, s67, 45056
    s_add_u32 s57, s57, 4096
    buffer_load_dwordx4 v95, s[32:35], s57 offen lds
    s_add_u32 m0, s67, 49152
    s_add_u32 s57, s57, s71
    buffer_load_dwordx4 v95, s[32:35], s57 offen lds
    s_add_u32 m0, s67, 53248
    s_add_u32 s57, s57, 4096
    buffer_load_dwordx4 v95, s[32:35], s57 offen lds
    s_add_u32 m0, s67, 57344
    s_add_u32 s57, s57, 0xff000
    buffer_load_dwordx4 v95, s[32:35], s57 offen lds
    s_add_u32 m0, s67, 61440
    s_add_u32 s57, s57, 4096
    buffer_load_dwordx4 v95, s[32:35], s57 offen lds
    s_waitcnt vmcnt(24)
    s_barrier
    ds_read_b64_tr_b16 a[192:193], v232 offset:0
    ds_read_b64_tr_b16 a[194:195], v233 offset:0
    ds_read_b64_tr_b16 a[196:197], v234 offset:0
    ds_read_b64_tr_b16 a[198:199], v235 offset:0
    ds_read_b64_tr_b16 a[200:201], v232 offset:8192
    ds_read_b64_tr_b16 a[202:203], v233 offset:8192
    ds_read_b64_tr_b16 a[204:205], v234 offset:8192
    ds_read_b64_tr_b16 a[206:207], v235 offset:8192
    ds_read_b64_tr_b16 a[208:209], v232 offset:16384
    ds_read_b64_tr_b16 a[210:211], v233 offset:16384
    ds_read_b64_tr_b16 a[212:213], v234 offset:16384
    ds_read_b64_tr_b16 a[214:215], v235 offset:16384
    ds_read_b64_tr_b16 a[216:217], v232 offset:24576
    ds_read_b64_tr_b16 a[218:219], v233 offset:24576
    ds_read_b64_tr_b16 a[220:221], v234 offset:24576
    ds_read_b64_tr_b16 a[222:223], v235 offset:24576
    s_waitcnt lgkmcnt(0)
    s_barrier
    s_add_u32 m0, s67, 65536
    s_add_u32 s57, s57, s73
    buffer_load_dwordx4 v95, s[32:35], s57 offen lds
    s_add_u32 m0, s67, 69632
    s_add_u32 s57, s57, 4096
    buffer_load_dwordx4 v95, s[32:35], s57 offen lds
    s_add_u32 m0, s67, 73728
    s_add_u32 s57, s57, 0xff000
    buffer_load_dwordx4 v95, s[32:35], s57 offen lds
    s_add_u32 m0, s67, 77824
    s_add_u32 s57, s57, 4096
    buffer_load_dwordx4 v95, s[32:35], s57 offen lds
    s_add_u32 m0, s67, 81920
    s_add_u32 s57, s57, s71
    buffer_load_dwordx4 v95, s[32:35], s57 offen lds
    s_waitcnt vmcnt(21)
    s_barrier
    ds_read_b64_tr_b16 a[224:225], v232 offset:32768
    ds_read_b64_tr_b16 a[226:227], v233 offset:32768
    ds_read_b64_tr_b16 a[228:229], v234 offset:32768
    ds_read_b64_tr_b16 a[230:231], v235 offset:32768
    ds_read_b64_tr_b16 a[232:233], v232 offset:40960
    ds_read_b64_tr_b16 a[234:235], v233 offset:40960
    ds_read_b64_tr_b16 a[236:237], v234 offset:40960
    ds_read_b64_tr_b16 a[238:239], v235 offset:40960
    ds_read_b64_tr_b16 a[240:241], v232 offset:49152
    ds_read_b64_tr_b16 a[242:243], v233 offset:49152
    ds_read_b64_tr_b16 a[244:245], v234 offset:49152
    ds_read_b64_tr_b16 a[246:247], v235 offset:49152
    ds_read_b64_tr_b16 a[248:249], v232 offset:57344
    ds_read_b64_tr_b16 a[250:251], v233 offset:57344
    ds_read_b64_tr_b16 a[252:253], v234 offset:57344
    ds_read_b64_tr_b16 a[254:255], v235 offset:57344
    s_waitcnt lgkmcnt(0)
    s_barrier
    s_mov_b32 s58, 0x7fff0000
    s_mov_b32 s60, 0
    s_waitcnt vmcnt(13)
    s_barrier
    ds_read_b128 v[20:23], v8 offset:0
    ds_read_b128 v[24:27], v9 offset:0
    ds_read_b128 v[28:31], v10 offset:0
    ds_read_b128 v[32:35], v11 offset:0
    ds_read_b128 v[36:39], v8 offset:4096
    ds_read_b128 v[40:43], v9 offset:4096
L_ws_E5:
    s_waitcnt lgkmcnt(4)
    v_mfma_f32_16x16x32_bf16 v[52:55], a[0:3], v[20:23], 0
    s_lshl_b32 s74, s60, 2
    s_add_u32 s74, s74, s70
    v_mfma_f32_16x16x32_bf16 v[56:59], a[0:3], v[24:27], 0
    s_add_u32 s74, s74, 9
    s_add_u32 m0, s67, 86016
    v_mfma_f32_16x16x32_bf16 v[60:63], a[4:7], v[20:23], 0
    ds_read_b128 v[44:47], v10 offset:4096
    s_add_u32 s57, s57, 4096
    buffer_load_dwordx4 v95, s[32:35], s57 offen lds
    v_mfma_f32_16x16x32_bf16 v[64:67], a[4:7], v[24:27], 0
    ds_read_b128 v[48:51], v11 offset:4096
    s_waitcnt lgkmcnt(4)
    v_mfma_f32_16x16x32_bf16 v[52:55], a[8:11], v[28:31], v[52:55]
    s_cmp_lt_u32 s60, 14
    s_cselect_b32 s74, s74, 0
    v_mfma_f32_16x16x32_bf16 v[56:59], a[8:11], v[32:35], v[56:59]
    s_add_u32 m0, s67, 90112
    s_add_u32 s57, s57, 0xff000
    buffer_load_dwordx4 v95, s[32:35], s57 offen lds
    v_mfma_f32_16x16x32_bf16 v[60:63], a[12:15], v[28:31], v[60:63]
    ds_read_b128 v[20:23], v8 offset:8192
    v_mfma_f32_16x16x32_bf16 v[64:67], a[12:15], v[32:35], v[64:67]
    ds_read_b128 v[24:27], v9 offset:8192
    s_waitcnt lgkmcnt(4)
    v_mfma_f32_16x16x32_bf16 v[52:55], a[16:19], v[36:39], v[52:55]
    s_cmp_lt_u32 s82, s74
    s_cselect_b32 s83, 0, 0x40000000
    v_mfma_f32_16x16x32_bf16 v[56:59], a[16:19], v[40:43], v[56:59]
    s_add_u32 m0, s67, 94208
    s_add_u32 s57, s57, 4096
    buffer_load_dwordx4 v95, s[32:35], s57 offen lds
    v_mfma_f32_16x16x32_bf16 v[60:63], a[20:23], v[36:39], v[60:63]
    ds_read_b128 v[28:31], v10 offset:8192
    v_mfma_f32_16x16x32_bf16 v[64:67], a[20:23], v[40:43], v[64:67]
    ds_read_b128 v[32:35], v11 offset:8192
    s_waitcnt lgkmcnt(4)
    v_mfma_f32_16x16x32_bf16 v[52:55], a[24:27], v[44:47], v[52:55]
    buffer_load_dword v167, v166, s[32:35], s83 offen sc1
    v_mfma_f32_16x16x32_bf16 v[56:59], a[24:27], v[48:51], v[56:59]
    buffer_load_dword v169, v168, s[32:35], 0 offen sc1
    v_mfma_f32_16x16x32_bf16 v[60:63], a[28:31], v[44:47], v[60:63]
    ds_read_b128 v[36:39], v8 offset:12288
    v_mfma_f32_16x16x32_bf16 v[64:67], a[28:31], v[48:51], v[64:67]
    ds_read_b128 v[40:43], v9 offset:12288
    s_waitcnt lgkmcnt(4)
    v_mfma_f32_16x16x32_bf16 v[52:55], a[32:35], v[20:23], v[52:55]
    s_sub_u32 s76, s60, 1
    s_and_b32 s76, s76, 7
    v_mfma_f32_16x16x32_bf16 v[56:59], a[32:35], v[24:27], v[56:59]
    s_lshl_b32 s76, s76, 14
    s_sub_u32 s75, s60, 2
    v_mfma_f32_16x16x32_bf16 v[60:63], a[36:39], v[20:23], v[60:63]
    ds_read_b128 v[44:47], v10 offset:12288
    s_max_i32 s75, s75, 0
    v_mfma_f32_16x16x32_bf16 v[64:67], a[36:39], v[24:27], v[64:67]
    ds_read_b128 v[48:51], v11 offset:12288
    s_waitcnt lgkmcnt(4)
    v_mfma_f32_16x16x32_bf16 v[52:55], a[40:43], v[28:31], v[52:55]
    v_cvt_pk_bf16_f32 v176, v68, v69
    v_cvt_pk_bf16_f32 v177, v70, v71
    v_mfma_f32_16x16x32_bf16 v[56:59], a[40:43], v[32:35], v[56:59]
    v_cvt_pk_bf16_f32 v178, v76, v77
    v_cvt_pk_bf16_f32 v179, v78, v79
    v_mfma_f32_16x16x32_bf16 v[60:63], a[44:47], v[28:31], v[60:63]
    ds_read_b128 v[20:23], v8 offset:16384
    v_mfma_f32_16x16x32_bf16 v[64:67], a[44:47], v[32:35], v[64:67]
    ds_read_b128 v[24:27], v9 offset:16384
    s_waitcnt lgkmcnt(4)
    v_mfma_f32_16x16x32_bf16 v[52:55], a[48:51], v[36:39], v[52:55]
    v_cvt_pk_bf16_f32 v180, v72, v73
    v_cvt_pk_bf16_f32 v181, v74, v75
    v_mfma_f32_16x16x32_bf16 v[56:59], a[48:51], v[40:43], v[56:59]
    v_cvt_pk_bf16_f32 v182, v80, v81
    v_cvt_pk_bf16_f32 v183, v82, v83
    v_mfma_f32_16x16x32_bf16 v[60:63], a[52:55], v[36:39], v[60:63]
    ds_read_b128 v[28:31], v10 offset:16384
    v_mfma_f32_16x16x32_bf16 v[64:67], a[52:55], v[40:43], v[64:67]
    ds_read_b128 v[32:35], v11 offset:16384
    s_waitcnt lgkmcnt(4)
    v_mfma_f32_16x16x32_bf16 v[52:55], a[56:59], v[44:47], v[52:55]
    v_mfma_f32_16x16x32_bf16 v[56:59], a[56:59], v[48:51], v[56:59]
    v_mfma_f32_16x16x32_bf16 v[60:63], a[60:63], v[44:47], v[60:63]
    ds_read_b128 v[36:39], v8 offset:20480
    v_mfma_f32_16x16x32_bf16 v[64:67], a[60:63], v[48:51], v[64:67]
    ds_read_b128 v[40:43], v9 offset:20480
    s_waitcnt lgkmcnt(4)
    v_mfma_f32_16x16x32_bf16 v[52:55], a[64:67], v[20:23], v[52:55]
    buffer_store_dwordx4 v[176:179], v164, s[32:35], s76 offen offset:0 sc1
    v_mfma_f32_16x16x32_bf16 v[56:59], a[64:67], v[24:27], v[56:59]
    v_mfma_f32_16x16x32_bf16 v[60:63], a[68:71], v[20:23], v[60:63]
    ds_read_b128 v[44:47], v10 offset:20480
    v_mfma_f32_16x16x32_bf16 v[64:67], a[68:71], v[24:27], v[64:67]
    ds_read_b128 v[48:51], v11 offset:20480
    s_waitcnt lgkmcnt(4)
    v_mfma_f32_16x16x32_bf16 v[52:55], a[72:75], v[28:31], v[52:55]
    buffer_store_dwordx4 v[180:183], v164, s[32:35], s76 offen offset:1024 sc1
    v_mfma_f32_16x16x32_bf16 v[56:59], a[72:75], v[32:35], v[56:59]
    v_mfma_f32_16x16x32_bf16 v[60:63], a[76:79], v[28:31], v[60:63]
    ds_read_b128 v[20:23], v8 offset:24576
    v_mfma_f32_16x16x32_bf16 v[64:67], a[76:79], v[32:35], v[64:67]
    ds_read_b128 v[24:27], v9 offset:24576
    s_waitcnt lgkmcnt(4)
    v_mfma_f32_16x16x32_bf16 v[52:55], a[80:83], v[36:39], v[52:55]
    s_cmp_lg_u32 s60, 14
    s_cbranch_scc1 L_q_nc0
    s_xor_b32 s80, s76, 32768
    buffer_store_dwordx4 v[188:191], v164, s[32:35], s80 offen offset:0 sc1
    buffer_store_dwordx4 v[188:191], v164, s[32:35], s80 offen offset:1024 sc1
L_q_nc0:
    v_mfma_f32_16x16x32_bf16 v[56:59], a[80:83], v[40:43], v[56:59]
    v_mfma_f32_16x16x32_bf16 v[60:63], a[84:87], v[36:39], v[60:63]
    ds_read_b128 v[28:31], v10 offset:24576
    v_mfma_f32_16x16x32_bf16 v[64:67], a[84:87], v[40:43], v[64:67]
    ds_read_b128 v[32:35], v11 offset:24576
    s_waitcnt lgkmcnt(4)
    v_mfma_f32_16x16x32_bf16 v[52:55], a[88:91], v[44:47], v[52:55]
    s_waitcnt vmcnt(12)
    s_barrier
    v_mfma_f32_16x16x32_bf16 v[56:59], a[88:91], v[48:51], v[56:59]
    s_add_u32 m0, s67, 98304
    s_add_u32 s57, s57, s72
    buffer_load_dwordx4 v95, s[32:35], s57 offen lds
    v_mfma_f32_16x16x32_bf16 v[60:63], a[92:95], v[44:47], v[60:63]
    ds_read_b128 v[36:39], v8 offset:28672
    v_mfma_f32_16x16x32_bf16 v[64:67], a[92:95], v[48:51], v[64:67]
    ds_read_b128 v[40:43], v9 offset:28672
    s_waitcnt lgkmcnt(4)
    v_mfma_f32_16x16x32_bf16 v[52:55], a[96:99], v[20:23], v[52:55]
    s_add_u32 m0, s67, 102400
    s_add_u32 s57, s57, 4096
    v_mfma_f32_16x16x32_bf16 v[56:59], a[96:99], v[24:27], v[56:59]
    buffer_load_dwordx4 v95, s[32:35], s57 offen lds
    v_mfma_f32_16x16x32_bf16 v[60:63], a[100:103], v[20:23], v[60:63]
    ds_read_b128 v[44:47], v10 offset:28672
    v_mfma_f32_16x16x32_bf16 v[64:67], a[100:103], v[24:27], v[64:67]
    ds_read_b128 v[48:51], v11 offset:28672
    s_waitcnt lgkmcnt(4)
    v_mfma_f32_16x16x32_bf16 v[52:55], a[104:107], v[28:31], v[52:55]
    s_add_u32 m0, s67, 106496
    s_add_u32 s57, s57, 0xff000
    v_mfma_f32_16x16x32_bf16 v[56:59], a[104:107], v[32:35], v[56:59]
    buffer_load_dwordx4 v95, s[32:35], s57 offen lds
    v_mfma_f32_16x16x32_bf16 v[60:63], a[108:111], v[28:31], v[60:63]
    ds_read_b128 v[20:23], v8 offset:32768
    v_mfma_f32_16x16x32_bf16 v[64:67], a[108:111], v[32:35], v[64:67]
    ds_read_b128 v[24:27], v9 offset:32768
    s_waitcnt lgkmcnt(4)
    v_mfma_f32_16x16x32_bf16 v[52:55], a[112:115], v[36:39], v[52:55]
    s_add_u32 m0, s67, 110592
    s_add_u32 s57, s57, 4096
    v_mfma_f32_16x16x32_bf16 v[56:59], a[112:115], v[40:43], v[56:59]
    buffer_load_dwordx4 v95, s[32:35], s57 offen lds
    v_mfma_f32_16x16x32_bf16 v[60:63], a[116:119], v[36:39], v[60:63]
    ds_read_b128 v[28:31], v10 offset:32768
    v_mfma_f32_16x16x32_bf16 v[64:67], a[116:119], v[40:43], v[64:67]
    ds_read_b128 v[32:35], v11 offset:32768
    s_waitcnt lgkmcnt(4)
    v_mfma_f32_16x16x32_bf16 v[52:55], a[120:123], v[44:47], v[52:55]
    s_add_u32 m0, s67, 114688
    s_add_u32 s57, s57, s71
    v_mfma_f32_16x16x32_bf16 v[56:59], a[120:123], v[48:51], v[56:59]
    buffer_load_dwordx4 v95, s[32:35], s57 offen lds
    v_mfma_f32_16x16x32_bf16 v[60:63], a[124:127], v[44:47], v[60:63]
    ds_read_b128 v[36:39], v8 offset:36864
    v_mfma_f32_16x16x32_bf16 v[64:67], a[124:127], v[48:51], v[64:67]
    ds_read_b128 v[40:43], v9 offset:36864
    s_waitcnt lgkmcnt(4)
    v_mfma_f32_16x16x32_bf16 v[52:55], a[128:131], v[20:23], v[52:55]
    s_add_u32 m0, s67, 118784
    s_add_u32 s57, s57, 4096
    v_mfma_f32_16x16x32_bf16 v[56:59], a[128:131], v[24:27], v[56:59]
    buffer_load_dwordx4 v95, s[32:35], s57 offen lds
    v_mfma_f32_16x16x32_bf16 v[60:63], a[132:135], v[20:23], v[60:63]
    ds_read_b128 v[44:47], v10 offset:36864
    v_mfma_f32_16x16x32_bf16 v[64:67], a[132:135], v[24:27], v[64:67]
    ds_read_b128 v[48:51], v11 offset:36864
    s_waitcnt lgkmcnt(4)
    v_mfma_f32_16x16x32_bf16 v[52:55], a[136:139], v[28:31], v[52:55]
    s_add_u32 m0, s67, 122880
    s_add_u32 s57, s57, 0xff000
    v_mfma_f32_16x16x32_bf16 v[56:59], a[136:139], v[32:35], v[56:59]
    buffer_load_dwordx4 v95, s[32:35], s57 offen lds
    v_mfma_f32_16x16x32_bf16 v[60:63], a[140:143], v[28:31], v[60:63]
    ds_read_b128 v[20:23], v8 offset:40960
    v_mfma_f32_16x16x32_bf16 v[64:67], a[140:143], v[32:35], v[64:67]
    ds_read_b128 v[24:27], v9 offset:40960
    s_waitcnt lgkmcnt(4)
    v_mfma_f32_16x16x32_bf16 v[52:55], a[144:147], v[36:39], v[52:55]
    s_add_u32 m0, s67, 126976
    s_add_u32 s57, s57, 4096
    v_mfma_f32_16x16x32_bf16 v[56:59], a[144:147], v[40:43], v[56:59]
    buffer_load_dwordx4 v95, s[32:35], s57 offen lds
    v_mfma_f32_16x16x32_bf16 v[60:63], a[148:151], v[36:39], v[60:63]
    ds_read_b128 v[28:31], v10 offset:40960
    v_mfma_f32_16x16x32_bf16 v[64:67], a[148:151], v[40:43], v[64:67]
    ds_read_b128 v[32:35], v11 offset:40960
    s_waitcnt lgkmcnt(4)
    v_mfma_f32_16x16x32_bf16 v[52:55], a[152:155], v[44:47], v[52:55]
    s_sub_u32 s79, s60, 4
    s_lshl_b32 s81, s79, 19
    s_cmp_lt_i32 s79, 0
    s_cselect_b32 s79, 0x40000000, s81
    v_mfma_f32_16x16x32_bf16 v[56:59], a[152:155], v[48:51], v[56:59]
    v_mfma_f32_16x16x32_bf16 v[128:131], v[184:187], v[96:99], 0
    v_mfma_f32_16x16x32_bf16 v[60:63], a[156:159], v[44:47], v[60:63]
    ds_read_b128 v[36:39], v8 offset:45056
    v_mfma_f32_16x16x32_bf16 v[64:67], a[156:159], v[48:51], v[64:67]
    ds_read_b128 v[40:43], v9 offset:45056
    s_waitcnt lgkmcnt(4)
    v_mfma_f32_16x16x32_bf16 v[52:55], a[160:163], v[20:23], v[52:55]
    v_mfma_f32_16x16x32_bf16 v[132:135], v[184:187], v[100:103], 0
    v_mfma_f32_16x16x32_bf16 v[56:59], a[160:163], v[24:27], v[56:59]
    v_mfma_f32_16x16x32_bf16 v[60:63], a[164:167], v[20:23], v[60:63]
    ds_read_b128 v[44:47], v10 offset:45056
    v_mfma_f32_16x16x32_bf16 v[64:67], a[164:167], v[24:27], v[64:67]
    ds_read_b128 v[48:51], v11 offset:45056
    s_waitcnt lgkmcnt(4)
    v_mfma_f32_16x16x32_bf16 v[52:55], a[168:171], v[28:31], v[52:55]
    v_mfma_f32_16x16x32_bf16 v[56:59], a[168:171], v[32:35], v[56:59]
    v_mfma_f32_16x16x32_bf16 v[60:63], a[172:175], v[28:31], v[60:63]
    ds_read_b128 v[20:23], v8 offset:49152
    v_mfma_f32_16x16x32_bf16 v[64:67], a[172:175], v[32:35], v[64:67]
    ds_read_b128 v[24:27], v9 offset:49152
    s_waitcnt lgkmcnt(4)
    v_mfma_f32_16x16x32_bf16 v[52:55], a[176:179], v[36:39], v[52:55]
    v_cvt_pk_bf16_f32 v160, v128, v129
    v_cvt_pk_bf16_f32 v161, v130, v131
    v_mfma_f32_16x16x32_bf16 v[56:59], a[176:179], v[40:43], v[56:59]
    v_cvt_pk_bf16_f32 v162, v132, v133
    v_cvt_pk_bf16_f32 v163, v134, v135
    v_mfma_f32_16x16x32_bf16 v[60:63], a[180:183], v[36:39], v[60:63]
    ds_read_b128 v[28:31], v10 offset:49152
    v_mfma_f32_16x16x32_bf16 v[64:67], a[180:183], v[40:43], v[64:67]
    ds_read_b128 v[32:35], v11 offset:49152
    s_waitcnt lgkmcnt(4)
    v_mfma_f32_16x16x32_bf16 v[52:55], a[184:187], v[44:47], v[52:55]
    v_permlane32_swap_b32 v160, v162
    v_permlane32_swap_b32 v161, v163
    v_mfma_f32_16x16x32_bf16 v[56:59], a[184:187], v[48:51], v[56:59]
    v_mfma_f32_16x16x32_bf16 v[60:63], a[188:191], v[44:47], v[60:63]
    ds_read_b128 v[36:39], v8 offset:53248
    v_mfma_f32_16x16x32_bf16 v[64:67], a[188:191], v[48:51], v[64:67]
    ds_read_b128 v[40:43], v9 offset:53248
    s_waitcnt lgkmcnt(4)
    v_mfma_f32_16x16x32_bf16 v[52:55], a[192:195], v[20:23], v[52:55]
    buffer_store_dwordx2 v[160:161], v171, s[40:43], s79 offen
    v_mfma_f32_16x16x32_bf16 v[56:59], a[192:195], v[24:27], v[56:59]
    s_sub_u32 s78, s60, 3
    s_and_b32 s78, s78, 7
    v_mfma_f32_16x16x32_bf16 v[60:63], a[196:199], v[20:23], v[60:63]
    ds_read_b128 v[44:47], v10 offset:53248
    s_lshl_b32 s78, s78, 14
    v_mfma_f32_16x16x32_bf16 v[64:67], a[196:199], v[24:27], v[64:67]
    ds_read_b128 v[48:51], v11 offset:53248
    s_waitcnt lgkmcnt(4)
    v_mfma_f32_16x16x32_bf16 v[52:55], a[200:203], v[28:31], v[52:55]
    v_mfma_f32_16x16x32_bf16 v[56:59], a[200:203], v[32:35], v[56:59]
    v_mfma_f32_16x16x32_bf16 v[60:63], a[204:207], v[28:31], v[60:63]
    ds_read_b128 v[20:23], v8 offset:57344
    v_mfma_f32_16x16x32_bf16 v[64:67], a[204:207], v[32:35], v[64:67]
    ds_read_b128 v[24:27], v9 offset:57344
    s_waitcnt lgkmcnt(4)
    v_mfma_f32_16x16x32_bf16 v[52:55], a[208:211], v[36:39], v[52:55]
    v_mov_b32 v172, s60
    v_mfma_f32_16x16x32_bf16 v[56:59], a[208:211], v[40:43], v[56:59]
    v_mfma_f32_16x16x32_bf16 v[60:63], a[212:215], v[36:39], v[60:63]
    ds_read_b128 v[28:31], v10 offset:57344
    v_mfma_f32_16x16x32_bf16 v[64:67], a[212:215], v[40:43], v[64:67]
    ds_read_b128 v[32:35], v11 offset:57344
    s_waitcnt lgkmcnt(4)
    v_mfma_f32_16x16x32_bf16 v[52:55], a[216:219], v[44:47], v[52:55]
    s_waitcnt vmcnt(9)
    s_barrier
    v_mfma_f32_16x16x32_bf16 v[56:59], a[216:219], v[48:51], v[56:59]
    v_cmp_gt_u32 vcc, s75, v169
    s_cbranch_vccnz L_q_gw1
L_q_gok1:
    s_cmp_lt_u32 s82, s74
    s_cbranch_scc1 L_q_fw1
L_q_fok1:
    s_cmp_eq_u32 s60, 14
    s_cselect_b32 s57, 0x50000000, s57
    buffer_load_dwordx4 v[96:99], v165, s[32:35], s78 offen offset:0 sc1
    v_mfma_f32_16x16x32_bf16 v[60:63], a[220:223], v[44:47], v[60:63]
    ds_read_b128 v[36:39], v8 offset:61440
    v_mfma_f32_16x16x32_bf16 v[64:67], a[220:223], v[48:51], v[64:67]
    ds_read_b128 v[40:43], v9 offset:61440
    s_waitcnt lgkmcnt(4)
    v_mfma_f32_16x16x32_bf16 v[52:55], a[224:227], v[20:23], v[52:55]
    buffer_load_dwordx4 v[100:103], v165, s[32:35], s78 offen offset:512 sc1
    v_mfma_f32_16x16x32_bf16 v[56:59], a[224:227], v[24:27], v[56:59]
    s_add_u32 m0, s67, 0
    s_add_u32 s57, s57, s73
    buffer_load_dwordx4 v95, s[32:35], s57 offen lds
    v_mfma_f32_16x16x32_bf16 v[60:63], a[228:231], v[20:23], v[60:63]
    ds_read_b128 v[44:47], v10 offset:61440
    v_mfma_f32_16x16x32_bf16 v[64:67], a[228:231], v[24:27], v[64:67]
    ds_read_b128 v[48:51], v11 offset:61440
    s_waitcnt lgkmcnt(4)
    v_mfma_f32_16x16x32_bf16 v[52:55], a[232:235], v[28:31], v[52:55]
    buffer_store_dword v172, v170, s[32:35], 0 offen sc1
    v_mfma_f32_16x16x32_bf16 v[56:59], a[232:235], v[32:35], v[56:59]
    s_add_u32 m0, s67, 4096
    s_add_u32 s57, s57, 4096
    buffer_load_dwordx4 v95, s[32:35], s57 offen lds
    v_mfma_f32_16x16x32_bf16 v[60:63], a[236:239], v[28:31], v[60:63]
    ds_read_b128 v[20:23], v12 offset:0
    v_mfma_f32_16x16x32_bf16 v[64:67], a[236:239], v[32:35], v[64:67]
    ds_read_b128 v[24:27], v13 offset:0
    s_waitcnt lgkmcnt(4)
    v_mfma_f32_16x16x32_bf16 v[52:55], a[240:243], v[36:39], v[52:55]
    s_add_u32 s60, s60, 1
    s_add_u32 m0, s67, 8192
    v_mfma_f32_16x16x32_bf16 v[56:59], a[240:243], v[40:43], v[56:59]
    s_add_u32 s57, s57, 0xff000
    buffer_load_dwordx4 v95, s[32:35], s57 offen lds
    v_mfma_f32_16x16x32_bf16 v[60:63], a[244:247], v[36:39], v[60:63]
    ds_read_b128 v[28:31], v14 offset:0
    v_mfma_f32_16x16x32_bf16 v[64:67], a[244:247], v[40:43], v[64:67]
    ds_read_b128 v[32:35], v15 offset:0
    s_waitcnt lgkmcnt(4)
    v_mfma_f32_16x16x32_bf16 v[52:55], a[248:251], v[44:47], v[52:55]
    s_add_u32 m0, s67, 12288
    s_add_u32 s57, s57, 4096
    v_mfma_f32_16x16x32_bf16 v[56:59], a[248:251], v[48:51], v[56:59]
    buffer_load_dwordx4 v95, s[32:35], s57 offen lds
    v_mfma_f32_16x16x32_bf16 v[60:63], a[252:255], v[44:47], v[60:63]
    ds_read_b128 v[36:39], v12 offset:4096
    s_add_u32 m0, s67, 16384
    v_mfma_f32_16x16x32_bf16 v[64:67], a[252:255], v[48:51], v[64:67]
    ds_read_b128 v[40:43], v13 offset:4096
    s_add_u32 s57, s57, s71
    buffer_load_dwordx4 v95, s[32:35], s57 offen lds
    s_waitcnt lgkmcnt(4)
    v_mfma_f32_16x16x32_bf16 v[68:71], a[0:3], v[20:23], 0
    s_lshl_b32 s74, s60, 2
    s_add_u32 s74, s74, s70
    v_mfma_f32_16x16x32_bf16 v[72:75], a[0:3], v[24:27], 0
    s_add_u32 s74, s74, 9
    s_add_u32 m0, s67, 20480
    v_mfma_f32_16x16x32_bf16 v[76:79], a[4:7], v[20:23], 0
    ds_read_b128 v[44:47], v14 offset:4096
    s_add_u32 s57, s57, 4096
    buffer_load_dwordx4 v95, s[32:35], s57 offen lds
    v_mfma_f32_16x16x32_bf16 v[80:83], a[4:7], v[24:27], 0
    ds_read_b128 v[48:51], v15 offset:4096
    s_waitcnt lgkmcnt(4)
    v_mfma_f32_16x16x32_bf16 v[68:71], a[8:11], v[28:31], v[68:71]
    s_cmp_lt_u32 s60, 14
    s_cselect_b32 s74, s74, 0
    v_mfma_f32_16x16x32_bf16 v[72:75], a[8:11], v[32:35], v[72:75]
    s_add_u32 m0, s67, 24576
    s_add_u32 s57, s57, 0xff000
    buffer_load_dwordx4 v95, s[32:35], s57 offen lds
    v_mfma_f32_16x16x32_bf16 v[76:79], a[12:15], v[28:31], v[76:79]
    ds_read_b128 v[20:23], v12 offset:8192
    v_mfma_f32_16x16x32_bf16 v[80:83], a[12:15], v[32:35], v[80:83]
    ds_read_b128 v[24:27], v13 offset:8192
    s_waitcnt lgkmcnt(4)
    v_mfma_f32_16x16x32_bf16 v[68:71], a[16:19], v[36:39], v[68:71]
    s_cmp_lt_u32 s82, s74
    s_cselect_b32 s83, 0, 0x40000000
    v_mfma_f32_16x16x32_bf16 v[72:75], a[16:19], v[40:43], v[72:75]
    s_add_u32 m0, s67, 28672
    s_add_u32 s57, s57, 4096
    buffer_load_dwordx4 v95, s[32:35], s57 offen lds
    v_mfma_f32_16x16x32_bf16 v[76:79], a[20:23], v[36:39], v[76:79]
    ds_read_b128 v[28:31], v14 offset:8192
    v_mfma_f32_16x16x32_bf16 v[80:83], a[20:23], v[40:43], v[80:83]
    ds_read_b128 v[32:35], v15 offset:8192
    s_waitcnt lgkmcnt(4)
    v_mfma_f32_16x16x32_bf16 v[68:71], a[24:27], v[44:47], v[68:71]
    buffer_load_dword v167, v166, s[32:35], s83 offen sc1
    v_mfma_f32_16x16x32_bf16 v[72:75], a[24:27], v[48:51], v[72:75]
    buffer_load_dword v169, v168, s[32:35], 0 offen sc1
    v_mfma_f32_16x16x32_bf16 v[76:79], a[28:31], v[44:47], v[76:79]
    ds_read_b128 v[36:39], v12 offset:12288
    v_mfma_f32_16x16x32_bf16 v[80:83], a[28:31], v[48:51], v[80:83]
    ds_read_b128 v[40:43], v13 offset:12288
    s_waitcnt lgkmcnt(4)
    v_mfma_f32_16x16x32_bf16 v[68:71], a[32:35], v[20:23], v[68:71]
    s_sub_u32 s76, s60, 1
    s_and_b32 s76, s76, 7
    v_mfma_f32_16x16x32_bf16 v[72:75], a[32:35], v[24:27], v[72:75]
    s_lshl_b32 s76, s76, 14
    s_sub_u32 s75, s60, 2
    v_mfma_f32_16x16x32_bf16 v[76:79], a[36:39], v[20:23], v[76:79]
    ds_read_b128 v[44:47], v14 offset:12288
    s_max_i32 s75, s75, 0
    v_mfma_f32_16x16x32_bf16 v[80:83], a[36:39], v[24:27], v[80:83]
    ds_read_b128 v[48:51], v15 offset:12288
    s_waitcnt lgkmcnt(4)
    v_mfma_f32_16x16x32_bf16 v[68:71], a[40:43], v[28:31], v[68:71]
    v_cvt_pk_bf16_f32 v176, v52, v53
    v_cvt_pk_bf16_f32 v177, v54, v55
    v_mfma_f32_16x16x32_bf16 v[72:75], a[40:43], v[32:35], v[72:75]
    v_cvt_pk_bf16_f32 v178, v60, v61
    v_cvt_pk_bf16_f32 v179, v62, v63
    v_mfma_f32_16x16x32_bf16 v[76:79], a[44:47], v[28:31], v[76:79]
    ds_read_b128 v[20:23], v12 offset:16384
    v_mfma_f32_16x16x32_bf16 v[80:83], a[44:47], v[32:35], v[80:83]
    ds_read_b128 v[24:27], v13 offset:16384
    s_waitcnt lgkmcnt(4)
    v_mfma_f32_16x16x32_bf16 v[68:71], a[48:51], v[36:39], v[68:71]
    v_cvt_pk_bf16_f32 v180, v56, v57
    v_cvt_pk_bf16_f32 v181, v58, v59
    v_mfma_f32_16x16x32_bf16 v[72:75], a[48:51], v[40:43], v[72:75]
    v_cvt_pk_bf16_f32 v182, v64, v65
    v_cvt_pk_bf16_f32 v183, v66, v67
    v_mfma_f32_16x16x32_bf16 v[76:79], a[52:55], v[36:39], v[76:79]
    ds_read_b128 v[28:31], v14 offset:16384
    v_mfma_f32_16x16x32_bf16 v[80:83], a[52:55], v[40:43], v[80:83]
    ds_read_b128 v[32:35], v15 offset:16384
    s_waitcnt lgkmcnt(4)
    v_mfma_f32_16x16x32_bf16 v[68:71], a[56:59], v[44:47], v[68:71]
    v_mfma_f32_16x16x32_bf16 v[72:75], a[56:59], v[48:51], v[72:75]
    v_mfma_f32_16x16x32_bf16 v[76:79], a[60:63], v[44:47], v[76:79]
    ds_read_b128 v[36:39], v12 offset:20480
    v_mfma_f32_16x16x32_bf16 v[80:83], a[60:63], v[48:51], v[80:83]
    ds_read_b128 v[40:43], v13 offset:20480
    s_waitcnt lgkmcnt(4)
    v_mfma_f32_16x16x32_bf16 v[68:71], a[64:67], v[20:23], v[68:71]
    buffer_store_dwordx4 v[176:179], v164, s[32:35], s76 offen offset:0 sc1
    v_mfma_f32_16x16x32_bf16 v[72:75], a[64:67], v[24:27], v[72:75]
    v_mfma_f32_16x16x32_bf16 v[76:79], a[68:71], v[20:23], v[76:79]
    ds_read_b128 v[44:47], v14 offset:20480
    v_mfma_f32_16x16x32_bf16 v[80:83], a[68:71], v[24:27], v[80:83]
    ds_read_b128 v[48:51], v15 offset:20480
    s_waitcnt lgkmcnt(4)
    v_mfma_f32_16x16x32_bf16 v[68:71], a[72:75], v[28:31], v[68:71]
    buffer_store_dwordx4 v[180:183], v164, s[32:35], s76 offen offset:1024 sc1
    v_mfma_f32_16x16x32_bf16 v[72:75], a[72:75], v[32:35], v[72:75]
    v_mfma_f32_16x16x32_bf16 v[76:79], a[76:79], v[28:31], v[76:79]
    ds_read_b128 v[20:23], v12 offset:24576
    v_mfma_f32_16x16x32_bf16 v[80:83], a[76:79], v[32:35], v[80:83]
    ds_read_b128 v[24:27], v13 offset:24576
    s_waitcnt lgkmcnt(4)
    v_mfma_f32_16x16x32_bf16 v[68:71], a[80:83], v[36:39], v[68:71]
    s_cmp_lg_u32 s60, 14
    s_cbranch_scc1 L_q_nc2
    s_xor_b32 s80, s76, 32768
    buffer_store_dwordx4 v[188:191], v164, s[32:35], s80 offen offset:0 sc1
    buffer_store_dwordx4 v[188:191], v164, s[32:35], s80 offen offset:1024 sc1
L_q_nc2:
    v_mfma_f32_16x16x32_bf16 v[72:75], a[80:83], v[40:43], v[72:75]
    v_mfma_f32_16x16x32_bf16 v[76:79], a[84:87], v[36:39], v[76:79]
    ds_read_b128 v[28:31], v14 offset:24576
    v_mfma_f32_16x16x32_bf16 v[80:83], a[84:87], v[40:43], v[80:83]
    ds_read_b128 v[32:35], v15 offset:24576
    s_waitcnt lgkmcnt(4)
    v_mfma_f32_16x16x32_bf16 v[68:71], a[88:91], v[44:47], v[68:71]
    s_waitcnt vmcnt(12)
    s_barrier
    v_mfma_f32_16x16x32_bf16 v[72:75], a[88:91], v[48:51], v[72:75]
    s_add_u32 m0, s67, 32768
    s_add_u32 s57, s57, s72
    buffer_load_dwordx4 v95, s[32:35], s57 offen lds
    v_mfma_f32_16x16x32_bf16 v[76:79], a[92:95], v[44:47], v[76:79]
    ds_read_b128 v[36:39], v12 offset:28672
    v_mfma_f32_16x16x32_bf16 v[80:83], a[92:95], v[48:51], v[80:83]
    ds_read_b128 v[40:43], v13 offset:28672
    s_waitcnt lgkmcnt(4)
    v_mfma_f32_16x16x32_bf16 v[68:71], a[96:99], v[20:23], v[68:71]
    s_add_u32 m0, s67, 36864
    s_add_u32 s57, s57, 4096
    v_mfma_f32_16x16x32_bf16 v[72:75], a[96:99], v[24:27], v[72:75]
    buffer_load_dwordx4 v95, s[32:35], s57 offen lds
    v_mfma_f32_16x16x32_bf16 v[76:79], a[100:103], v[20:23], v[76:79]
    ds_read_b128 v[44:47], v14 offset:28672
    v_mfma_f32_16x16x32_bf16 v[80:83], a[100:103], v[24:27], v[80:83]
    ds_read_b128 v[48:51], v15 offset:28672
    s_waitcnt lgkmcnt(4)
    v_mfma_f32_16x16x32_bf16 v[68:71], a[104:107], v[28:31], v[68:71]
    s_add_u32 m0, s67, 40960
    s_add_u32 s57, s57, 0xff000
    v_mfma_f32_16x16x32_bf16 v[72:75], a[104:107], v[32:35], v[72:75]
    buffer_load_dwordx4 v95, s[32:35], s57 offen lds
    v_mfma_f32_16x16x32_bf16 v[76:79], a[108:111], v[28:31], v[76:79]
    ds_read_b128 v[20:23], v12 offset:32768
    v_mfma_f32_16x16x32_bf16 v[80:83], a[108:111], v[32:35], v[80:83]
    ds_read_b128 v[24:27], v13 offset:32768
    s_waitcnt lgkmcnt(4)
    v_mfma_f32_16x16x32_bf16 v[68:71], a[112:115], v[36:39], v[68:71]
    s_add_u32 m0, s67, 45056
    s_add_u32 s57, s57, 4096
    v_mfma_f32_16x16x32_bf16 v[72:75], a[112:115], v[40:43], v[72:75]
    buffer_load_dwordx4 v95, s[32:35], s57 offen lds
    v_mfma_f32_16x16x32_bf16 v[76:79], a[116:119], v[36:39], v[76:79]
    ds_read_b128 v[28:31], v14 offset:32768
    v_mfma_f32_16x16x32_bf16 v[80:83], a[116:119], v[40:43], v[80:83]
    ds_read_b128 v[32:35], v15 offset:32768
    s_waitcnt lgkmcnt(4)
    v_mfma_f32_16x16x32_bf16 v[68:71], a[120:123], v[44:47], v[68:71]
    s_add_u32 m0, s67, 49152
    s_add_u32 s57, s57, s71
    v_mfma_f32_16x16x32_bf16 v[72:75], a[120:123], v[48:51], v[72:75]
    buffer_load_dwordx4 v95, s[32:35], s57 offen lds
    v_mfma_f32_16x16x32_bf16 v[76:79], a[124:127], v[44:47], v[76:79]
    ds_read_b128 v[36:39], v12 offset:36864
    v_mfma_f32_16x16x32_bf16 v[80:83], a[124:127], v[48:51], v[80:83]
    ds_read_b128 v[40:43], v13 offset:36864
    s_waitcnt lgkmcnt(4)
    v_mfma_f32_16x16x32_bf16 v[68:71], a[128:131], v[20:23], v[68:71]
    s_add_u32 m0, s67, 53248
    s_add_u32 s57, s57, 4096
    v_mfma_f32_16x16x32_bf16 v[72:75], a[128:131], v[24:27], v[72:75]
    buffer_load_dwordx4 v95, s[32:35], s57 offen lds
    v_mfma_f32_16x16x32_bf16 v[76:79], a[132:135], v[20:23], v[76:79]
    ds_read_b128 v[44:47], v14 offset:36864
    v_mfma_f32_16x16x32_bf16 v[80:83], a[132:135], v[24:27], v[80:83]
    ds_read_b128 v[48:51], v15 offset:36864
    s_waitcnt lgkmcnt(4)
    v_mfma_f32_16x16x32_bf16 v[68:71], a[136:139], v[28:31], v[68:71]
    s_add_u32 m0, s67, 57344
    s_add_u32 s57, s57, 0xff000
    v_mfma_f32_16x16x32_bf16 v[72:75], a[136:139], v[32:35], v[72:75]
    buffer_load_dwordx4 v95, s[32:35], s57 offen lds
    v_mfma_f32_16x16x32_bf16 v[76:79], a[140:143], v[28:31], v[76:79]
    ds_read_b128 v[20:23], v12 offset:40960
    v_mfma_f32_16x16x32_bf16 v[80:83], a[140:143], v[32:35], v[80:83]
    ds_read_b128 v[24:27], v13 offset:40960
    s_waitcnt lgkmcnt(4)
    v_mfma_f32_16x16x32_bf16 v[68:71], a[144:147], v[36:39], v[68:71]
    s_add_u32 m0, s67, 61440
    s_add_u32 s57, s57, 4096
    v_mfma_f32_16x16x32_bf16 v[72:75], a[144:147], v[40:43], v[72:75]
    buffer_load_dwordx4 v95, s[32:35], s57 offen lds
    v_mfma_f32_16x16x32_bf16 v[76:79], a[148:151], v[36:39], v[76:79]
    ds_read_b128 v[28:31], v14 offset:40960
    v_mfma_f32_16x16x32_bf16 v[80:83], a[148:151], v[40:43], v[80:83]
    ds_read_b128 v[32:35], v15 offset:40960
    s_waitcnt lgkmcnt(4)
    v_mfma_f32_16x16x32_bf16 v[68:71], a[152:155], v[44:47], v[68:71]
    s_sub_u32 s79, s60, 4
    s_lshl_b32 s81, s79, 19
    s_cmp_lt_i32 s79, 0
    s_cselect_b32 s79, 0x40000000, s81
    v_mfma_f32_16x16x32_bf16 v[72:75], a[152:155], v[48:51], v[72:75]
    v_mfma_f32_16x16x32_bf16 v[128:131], v[184:187], v[96:99], 0
    v_mfma_f32_16x16x32_bf16 v[76:79], a[156:159], v[44:47], v[76:79]
    ds_read_b128 v[36:39], v12 offset:45056
    v_mfma_f32_16x16x32_bf16 v[80:83], a[156:159], v[48:51], v[80:83]
    ds_read_b128 v[40:43], v13 offset:45056
    s_waitcnt lgkmcnt(4)
    v_mfma_f32_16x16x32_bf16 v[68:71], a[160:163], v[20:23], v[68:71]
    v_mfma_f32_16x16x32_bf16 v[132:135], v[184:187], v[100:103], 0
    v_mfma_f32_16x16x32_bf16 v[72:75], a[160:163], v[24:27], v[72:75]
    v_mfma_f32_16x16x32_bf16 v[76:79], a[164:167], v[20:23], v[76:79]
    ds_read_b128 v[44:47], v14 offset:45056
    v_mfma_f32_16x16x32_bf16 v[80:83], a[164:167], v[24:27], v[80:83]
    ds_read_b128 v[48:51], v15 offset:45056
    s_waitcnt lgkmcnt(4)
    v_mfma_f32_16x16x32_bf16 v[68:71], a[168:171], v[28:31], v[68:71]
    v_mfma_f32_16x16x32_bf16 v[72:75], a[168:171], v[32:35], v[72:75]
    v_mfma_f32_16x16x32_bf16 v[76:79], a[172:175], v[28:31], v[76:79]
    ds_read_b128 v[20:23], v12 offset:49152
    v_mfma_f32_16x16x32_bf16 v[80:83], a[172:175], v[32:35], v[80:83]
    ds_read_b128 v[24:27], v13 offset:49152
    s_waitcnt lgkmcnt(4)
    v_mfma_f32_16x16x32_bf16 v[68:71], a[176:179], v[36:39], v[68:71]
    v_cvt_pk_bf16_f32 v160, v128, v129
    v_cvt_pk_bf16_f32 v161, v130, v131
    v_mfma_f32_16x16x32_bf16 v[72:75], a[176:179], v[40:43], v[72:75]
    v_cvt_pk_bf16_f32 v162, v132, v133
    v_cvt_pk_bf16_f32 v163, v134, v135
    v_mfma_f32_16x16x32_bf16 v[76:79], a[180:183], v[36:39], v[76:79]
    ds_read_b128 v[28:31], v14 offset:49152
    v_mfma_f32_16x16x32_bf16 v[80:83], a[180:183], v[40:43], v[80:83]
    ds_read_b128 v[32:35], v15 offset:49152
    s_waitcnt lgkmcnt(4)
    v_mfma_f32_16x16x32_bf16 v[68:71], a[184:187], v[44:47], v[68:71]
    v_permlane32_swap_b32 v160, v162
    v_permlane32_swap_b32 v161, v163
    v_mfma_f32_16x16x32_bf16 v[72:75], a[184:187], v[48:51], v[72:75]
    v_mfma_f32_16x16x32_bf16 v[76:79], a[188:191], v[44:47], v[76:79]
    ds_read_b128 v[36:39], v12 offset:53248
    v_mfma_f32_16x16x32_bf16 v[80:83], a[188:191], v[48:51], v[80:83]
    ds_read_b128 v[40:43], v13 offset:53248
    s_waitcnt lgkmcnt(4)
    v_mfma_f32_16x16x32_bf16 v[68:71], a[192:195], v[20:23], v[68:71]
    buffer_store_dwordx2 v[160:161], v171, s[40:43], s79 offen
    v_mfma_f32_16x16x32_bf16 v[72:75], a[192:195], v[24:27], v[72:75]
    s_sub_u32 s78, s60, 3
    s_and_b32 s78, s78, 7
    v_mfma_f32_16x16x32_bf16 v[76:79], a[196:199], v[20:23], v[76:79]
    ds_read_b128 v[44:47], v14 offset:53248
    s_lshl_b32 s78, s78, 14
    v_mfma_f32_16x16x32_bf16 v[80:83], a[196:199], v[24:27], v[80:83]
    ds_read_b128 v[48:51], v15 offset:53248
    s_waitcnt lgkmcnt(4)
    v_mfma_f32_16x16x32_bf16 v[68:71], a[200:203], v[28:31], v[68:71]
    v_mfma_f32_16x16x32_bf16 v[72:75], a[200:203], v[32:35], v[72:75]
    v_mfma_f32_16x16x32_bf16 v[76:79], a[204:207], v[28:31], v[76:79]
    ds_read_b128 v[20:23], v12 offset:57344
    v_mfma_f32_16x16x32_bf16 v[80:83], a[204:207], v[32:35], v[80:83]
    ds_read_b128 v[24:27], v13 offset:57344
    s_waitcnt lgkmcnt(4)
    v_mfma_f32_16x16x32_bf16 v[68:71], a[208:211], v[36:39], v[68:71]
    v_mov_b32 v172, s60
    v_mfma_f32_16x16x32_bf16 v[72:75], a[208:211], v[40:43], v[72:75]
    v_mfma_f32_16x16x32_bf16 v[76:79], a[212:215], v[36:39], v[76:79]
    ds_read_b128 v[28:31], v14 offset:57344
    v_mfma_f32_16x16x32_bf16 v[80:83], a[212:215], v[40:43], v[80:83]
    ds_read_b128 v[32:35], v15 offset:57344
    s_waitcnt lgkmcnt(4)
    v_mfma_f32_16x16x32_bf16 v[68:71], a[216:219], v[44:47], v[68:71]
    s_waitcnt vmcnt(9)
    s_barrier
    v_mfma_f32_16x16x32_bf16 v[72:75], a[216:219], v[48:51], v[72:75]
    v_cmp_gt_u32 vcc, s75, v169
    s_cbranch_vccnz L_q_gw3
L_q_gok3:
    s_cmp_lt_u32 s82, s74
    s_cbranch_scc1 L_q_fw3
L_q_fok3:
    s_cmp_eq_u32 s60, 14
    s_cselect_b32 s57, 0x50000000, s57
    buffer_load_dwordx4 v[96:99], v165, s[32:35], s78 offen offset:0 sc1
    v_mfma_f32_16x16x32_bf16 v[76:79], a[220:223], v[44:47], v[76:79]
    ds_read_b128 v[36:39], v12 offset:61440
    v_mfma_f32_16x16x32_bf16 v[80:83], a[220:223], v[48:51], v[80:83]
    ds_read_b128 v[40:43], v13 offset:61440
    s_waitcnt lgkmcnt(4)
    v_mfma_f32_16x16x32_bf16 v[68:71], a[224:227], v[20:23], v[68:71]
    buffer_load_dwordx4 v[100:103], v165, s[32:35], s78 offen offset:512 sc1
    v_mfma_f32_16x16x32_bf16 v[72:75], a[224:227], v[24:27], v[72:75]
    s_add_u32 m0, s67, 65536
    s_add_u32 s57, s57, s73
    buffer_load_dwordx4 v95, s[32:35], s57 offen lds
    v_mfma_f32_16x16x32_bf16 v[76:79], a[228:231], v[20:23], v[76:79]
    ds_read_b128 v[44:47], v14 offset:61440
    v_mfma_f32_16x16x32_bf16 v[80:83], a[228:231], v[24:27], v[80:83]
    ds_read_b128 v[48:51], v15 offset:61440
    s_waitcnt lgkmcnt(4)
    v_mfma_f32_16x16x32_bf16 v[68:71], a[232:235], v[28:31], v[68:71]
    buffer_store_dword v172, v170, s[32:35], 0 offen sc1
    v_mfma_f32_16x16x32_bf16 v[72:75], a[232:235], v[32:35], v[72:75]
    s_add_u32 m0, s67, 69632
    s_add_u32 s57, s57, 4096
    buffer_load_dwordx4 v95, s[32:35], s57 offen lds
    v_mfma_f32_16x16x32_bf16 v[76:79], a[236:239], v[28:31], v[76:79]
    ds_read_b128 v[20:23], v8 offset:0
    v_mfma_f32_16x16x32_bf16 v[80:83], a[236:239], v[32:35], v[80:83]
    ds_read_b128 v[24:27], v9 offset:0
    s_waitcnt lgkmcnt(4)
    v_mfma_f32_16x16x32_bf16 v[68:71], a[240:243], v[36:39], v[68:71]
    s_add_u32 s60, s60, 1
    s_add_u32 m0, s67, 73728
    v_mfma_f32_16x16x32_bf16 v[72:75], a[240:243], v[40:43], v[72:75]
    s_add_u32 s57, s57, 0xff000
    buffer_load_dwordx4 v95, s[32:35], s57 offen lds
    v_mfma_f32_16x16x32_bf16 v[76:79], a[244:247], v[36:39], v[76:79]
    ds_read_b128 v[28:31], v10 offset:0
    v_mfma_f32_16x16x32_bf16 v[80:83], a[244:247], v[40:43], v[80:83]
    ds_read_b128 v[32:35], v11 offset:0
    s_waitcnt lgkmcnt(4)
    v_mfma_f32_16x16x32_bf16 v[68:71], a[248:251], v[44:47], v[68:71]
    s_add_u32 m0, s67, 77824
    s_add_u32 s57, s57, 4096
    v_mfma_f32_16x16x32_bf16 v[72:75], a[248:251], v[48:51], v[72:75]
    buffer_load_dwordx4 v95, s[32:35], s57 offen lds
    v_mfma_f32_16x16x32_bf16 v[76:79], a[252:255], v[44:47], v[76:79]
    ds_read_b128 v[36:39], v8 offset:4096
    s_add_u32 m0, s67, 81920
    v_mfma_f32_16x16x32_bf16 v[80:83], a[252:255], v[48:51], v[80:83]
    ds_read_b128 v[40:43], v9 offset:4096
    s_add_u32 s57, s57, s71
    buffer_load_dwordx4 v95, s[32:35], s57 offen lds
    s_cmp_lt_u32 s60, s61
    s_cbranch_scc1 L_ws_E5
    buffer_load_dword v169, v168, s[32:35], 0 offen sc1
    s_sub_u32 s76, s60, 1
    s_and_b32 s76, s76, 7
    s_lshl_b32 s76, s76, 14
    v_cvt_pk_bf16_f32 v176, v68, v69
    v_cvt_pk_bf16_f32 v177, v70, v71
    v_cvt_pk_bf16_f32 v178, v76, v77
    v_cvt_pk_bf16_f32 v179, v78, v79
    v_cvt_pk_bf16_f32 v180, v72, v73
    v_cvt_pk_bf16_f32 v181, v74, v75
    v_cvt_pk_bf16_f32 v182, v80, v81
    v_cvt_pk_bf16_f32 v183, v82, v83
    buffer_store_dwordx4 v[176:179], v164, s[32:35], s76 offen offset:0 sc1
    buffer_store_dwordx4 v[180:183], v164, s[32:35], s76 offen offset:1024 sc1
    s_waitcnt vmcnt(2) lgkmcnt(0)
    s_sub_u32 s79, s60, 4
    s_lshl_b32 s81, s79, 19
    s_cmp_lt_i32 s79, 0
    s_cselect_b32 s79, 0x40000000, s81
    v_mfma_f32_16x16x32_bf16 v[128:131], v[184:187], v[96:99], 0
    v_mfma_f32_16x16x32_bf16 v[132:135], v[184:187], v[100:103], 0
    s_nop 6
    v_cvt_pk_bf16_f32 v160, v128, v129
    v_cvt_pk_bf16_f32 v161, v130, v131
    v_cvt_pk_bf16_f32 v162, v132, v133
    v_cvt_pk_bf16_f32 v163, v134, v135
    s_nop 0
    v_permlane32_swap_b32 v160, v162
    v_permlane32_swap_b32 v161, v163
    buffer_store_dwordx2 v[160:161], v171, s[40:43], s79 offen
    v_cmp_gt_u32 vcc, 15, v169
    s_cbranch_vccz L_q_l0
    s_mov_b32 s88, 0
L_wf_31:
    s_add_u32 s88, s88, 1
    s_mov_b32 s89, 17
    s_cmp_ge_u32 s88, 262144
    s_cbranch_scc1 L_abort
    buffer_load_dword v169, v168, s[32:35], 0 offen sc1
    s_waitcnt vmcnt(0)
    v_cmp_gt_u32 vcc, 15, v169
    s_cbranch_vccnz L_wf_31
L_q_l0:
    s_mov_b32 s88, 0
L_q_last:
    s_add_u32 s88, s88, 1
    s_mov_b32 s89, 17
    s_cmp_ge_u32 s88, 262144
    s_cbranch_scc1 L_abort
    s_sub_u32 s78, s60, 3
    s_and_b32 s78, s78, 7
    s_lshl_b32 s78, s78, 14
    buffer_load_dwordx4 v[96:99], v165, s[32:35], s78 offen offset:0 sc1
    buffer_load_dwordx4 v[100:103], v165, s[32:35], s78 offen offset:512 sc1
    s_sub_u32 s78, s60, 2
    s_and_b32 s78, s78, 7
    s_lshl_b32 s78, s78, 14
    buffer_load_dwordx4 v[104:107], v165, s[32:35], s78 offen offset:0 sc1
    buffer_load_dwordx4 v[108:111], v165, s[32:35], s78 offen offset:512 sc1
    s_sub_u32 s78, s60, 1
    s_and_b32 s78, s78, 7
    s_lshl_b32 s78, s78, 14
    buffer_load_dwordx4 v[112:115], v165, s[32:35], s78 offen offset:0 sc1
    buffer_load_dwordx4 v[116:119], v165, s[32:35], s78 offen offset:512 sc1
    s_waitcnt vmcnt(0)
    v_max3_u32 v192, v112, v113, v114
    v_max3_u32 v192, v192, v115, v116
    v_max3_u32 v192, v192, v117, v118
    v_max_u32 v192, v192, v119
    v_cmp_eq_u32 vcc, -1, v192
    s_cbranch_vccnz L_q_last
    s_sub_u32 s79, s60, 3
    s_lshl_b32 s81, s79, 19
    s_cmp_lt_i32 s79, 0
    s_cselect_b32 s79, 0x40000000, s81
    v_mfma_f32_16x16x32_bf16 v[128:131], v[184:187], v[96:99], 0
    v_mfma_f32_16x16x32_bf16 v[132:135], v[184:187], v[100:103], 0
    s_nop 6
    v_cvt_pk_bf16_f32 v160, v128, v129
    v_cvt_pk_bf16_f32 v161, v130, v131
    v_cvt_pk_bf16_f32 v162, v132, v133
    v_cvt_pk_bf16_f32 v163, v134, v135
    s_nop 0
    v_permlane32_swap_b32 v160, v162
    v_permlane32_swap_b32 v161, v163
    buffer_store_dwordx2 v[160:161], v171, s[40:43], s79 offen
    s_sub_u32 s79, s60, 2
    s_lshl_b32 s81, s79, 19
    s_cmp_lt_i32 s79, 0
    s_cselect_b32 s79, 0x40000000, s81
    v_mfma_f32_16x16x32_bf16 v[128:131], v[184:187], v[104:107], 0
    v_mfma_f32_16x16x32_bf16 v[132:135], v[184:187], v[108:111], 0
    s_nop 6
    v_cvt_pk_bf16_f32 v160, v128, v129
    v_cvt_pk_bf16_f32 v161, v130, v131
    s_nop 5
    v_cvt_pk_bf16_f32 v162, v132, v133
    v_cvt_pk_bf16_f32 v163, v134, v135
    s_nop 0
    v_permlane32_swap_b32 v160, v162
    s_nop 0
    v_permlane32_swap_b32 v161, v163
    buffer_store_dwordx2 v[160:161], v171, s[40:43], s79 offen
    s_sub_u32 s79, s60, 1
    s_lshl_b32 s81, s79, 19
    s_cmp_lt_i32 s79, 0
    s_cselect_b32 s79, 0x40000000, s81
    v_mfma_f32_16x16x32_bf16 v[128:131], v[184:187], v[112:115], 0
    v_mfma_f32_16x16x32_bf16 v[132:135], v[184:187], v[116:119], 0
    s_nop 6
    v_cvt_pk_bf16_f32 v160, v128, v129
    v_cvt_pk_bf16_f32 v161, v130, v131
    v_cvt_pk_bf16_f32 v162, v132, v133
    v_cvt_pk_bf16_f32 v163, v134, v135
    s_nop 0
    v_permlane32_swap_b32 v160, v162
    v_permlane32_swap_b32 v161, v163
    buffer_store_dwordx2 v[160:161], v171, s[40:43], s79 offen
    s_waitcnt vmcnt(0)
    s_branch L_q_done
L_q_gw1:
    s_mov_b32 s88, 0
L_wf_32:
    s_add_u32 s88, s88, 1
    s_mov_b32 s89, 17
    s_cmp_ge_u32 s88, 262144
    s_cbranch_scc1 L_abort
    buffer_load_dword v169, v168, s[32:35], 0 offen sc1
    s_waitcnt vmcnt(0)
    v_cmp_gt_u32 vcc, s75, v169
    s_cbranch_vccnz L_wf_32
    s_branch L_q_gok1
L_q_fw1:
    v_min_u32_dpp v167, v167, v167 row_ror:8 row_mask:0xf bank_mask:0xf
    s_nop 1
    v_min_u32_dpp v167, v167, v167 row_ror:4 row_mask:0xf bank_mask:0xf
    s_nop 1
    v_min_u32_dpp v167, v167, v167 row_ror:2 row_mask:0xf bank_mask:0xf
    s_nop 1
    v_min_u32_dpp v167, v167, v167 row_ror:1 row_mask:0xf bank_mask:0xf
    v_mov_b32 v169, v167
    s_nop 1
    v_permlane16_swap_b32 v167, v169
    v_min_u32 v167, v167, v169
    s_nop 0
    v_readfirstlane_b32 s82, v167
    s_cmp_ge_u32 s82, s74
    s_cbranch_scc1 L_q_fok1
    s_mov_b32 s88, 0
L_wf_33:
    s_add_u32 s88, s88, 1
    s_mov_b32 s89, 16
    s_cmp_ge_u32 s88, 262144
    s_cbranch_scc1 L_abort
    buffer_load_dword v167, v166, s[32:35], 0 offen sc1
    s_waitcnt vmcnt(0)
    v_cmp_gt_u32 vcc, s74, v167
    s_cbranch_vccnz L_wf_33
    v_min_u32_dpp v167, v167, v167 row_ror:8 row_mask:0xf bank_mask:0xf
    s_nop 1
    v_min_u32_dpp v167, v167, v167 row_ror:4 row_mask:0xf bank_mask:0xf
    s_nop 1
    v_min_u32_dpp v167, v167, v167 row_ror:2 row_mask:0xf bank_mask:0xf
    s_nop 1
    v_min_u32_dpp v167, v167, v167 row_ror:1 row_mask:0xf bank_mask:0xf
    v_mov_b32 v169, v167
    s_nop 1
    v_permlane16_swap_b32 v167, v169
    v_min_u32 v167, v167, v169
    s_nop 0
    v_readfirstlane_b32 s82, v167
    s_branch L_q_fok1
L_q_gw3:
    s_mov_b32 s88, 0
L_wf_34:
    s_add_u32 s88, s88, 1
    s_mov_b32 s89, 17
    s_cmp_ge_u32 s88, 262144
    s_cbranch_scc1 L_abort
    buffer_load_dword v169, v168, s[32:35], 0 offen sc1
    s_waitcnt vmcnt(0)
    v_cmp_gt_u32 vcc, s75, v169
    s_cbranch_vccnz L_wf_34
    s_branch L_q_gok3
L_q_fw3:
    v_min_u32_dpp v167, v167, v167 row_ror:8 row_mask:0xf bank_mask:0xf
    s_nop 1
    v_min_u32_dpp v167, v167, v167 row_ror:4 row_mask:0xf bank_mask:0xf
    s_nop 1
    v_min_u32_dpp v167, v167, v167 row_ror:2 row_mask:0xf bank_mask:0xf
    s_nop 1
    v_min_u32_dpp v167, v167, v167 row_ror:1 row_mask:0xf bank_mask:0xf
    v_mov_b32 v169, v167
    s_nop 1
    v_permlane16_swap_b32 v167, v169
    v_min_u32 v167, v167, v169
    s_nop 0
    v_readfirstlane_b32 s82, v167
    s_cmp_ge_u32 s82, s74
    s_cbranch_scc1 L_q_fok3
    s_mov_b32 s88, 0
L_wf_35:
    s_add_u32 s88, s88, 1
    s_mov_b32 s89, 16
    s_cmp_ge_u32 s88, 262144
    s_cbranch_scc1 L_abort
    buffer_load_dword v167, v166, s[32:35], 0 offen sc1
    s_waitcnt vmcnt(0)
    v_cmp_gt_u32 vcc, s74, v167
    s_cbranch_vccnz L_wf_35
    v_min_u32_dpp v167, v167, v167 row_ror:8 row_mask:0xf bank_mask:0xf
    s_nop 1
    v_min_u32_dpp v167, v167, v167 row_ror:4 row_mask:0xf bank_mask:0xf
    s_nop 1
    v_min_u32_dpp v167, v167, v167 row_ror:2 row_mask:0xf bank_mask:0xf
    s_nop 1
    v_min_u32_dpp v167, v167, v167 row_ror:1 row_mask:0xf bank_mask:0xf
    v_mov_b32 v169, v167
    s_nop 1
    v_permlane16_swap_b32 v167, v169
    v_min_u32 v167, v167, v169
    s_nop 0
    v_readfirstlane_b32 s82, v167
    s_branch L_q_fok3
L_q_done:
L_fin:
    s_branch L_end
L_abort:
    s_waitcnt vmcnt(0) lgkmcnt(0)
    v_mov_b32 v246, s89
    s_and_b32 s89, s89, 15
    s_lshl_b32 s89, s89, 2
    s_add_u32 s89, s89, 192
    v_mov_b32 v247, s89
    buffer_store_dword v246, v247, s[36:39], 0 offen
    s_waitcnt vmcnt(0)
L_end:
    s_endpgm

.section .rodata,"a"
.p2align 6
.amdhsa_kernel concat_heads__softmax_full_mha__memory_aug_recurrent_mem_tr__prompt_kernel
  .amdhsa_next_free_vgpr 512
  .amdhsa_next_free_sgpr 102
  .amdhsa_accum_offset 256
  .amdhsa_group_segment_fixed_size 0
  .amdhsa_kernarg_size 104
  .amdhsa_user_sgpr_count 2
  .amdhsa_user_sgpr_kernarg_segment_ptr 1
  .amdhsa_system_sgpr_workgroup_id_x 1
.end_amdhsa_kernel
```
